```python
import torch

def _softmax(x, axis=-1):
    return torch.softmax(x, dim=axis)
def _gelu(x):
    return torch.nn.functional.gelu(x, approximate="tanh")
def _silu(x):
    return torch.nn.functional.silu(x)
def _sigmoid(x):
    return torch.sigmoid(x)
def _layernorm(x, axis=-1, eps=1e-5):
    m = x.mean(dim=axis, keepdim=True)
    v = x.var(dim=axis, keepdim=True, unbiased=False)
    return (x - m) / torch.sqrt(v + eps)
def _scatter_add(tgt, idx, src, axis=0):
    return tgt.clone().index_add_(axis, idx, src)
def _segment_sum(src, seg, n):
    out = torch.zeros((n,) + src.shape[1:], dtype=src.dtype)
    return out.index_add_(0, seg, src)
def _pad(x, pw):
    flat = tuple(v for pair in reversed(pw) for v in pair)
    return torch.nn.functional.pad(x, flat)

kernel_name = 'sequential_preLN__linear_attn_block__geglu_ffn__prompt'

def setup_inputs():

    _w = (lambda a: (lambda t: t.to(torch.bfloat16) if t.is_floating_point() else t)(torch.as_tensor(a)))
    def _A_setup():
        B, S, D = 1, 2048, 1024
        return {
            "x": _w((lambda *s: torch.randn(*s, dtype=torch.bfloat16) * 0.05)(B, S, D)),
            "wqkv": _w((lambda *s: torch.randn(*s, dtype=torch.bfloat16) * 0.05)(D, 3 * D)),
            "wo": _w((lambda *s: torch.randn(*s, dtype=torch.bfloat16) * 0.05)(D, D)),
        }
    _A_in = _A_setup()

    def _B_setup():
        B, S, D, F = 1, 2048, 1024, 3584
        return {
            "x": _w((lambda *s: torch.randn(*s, dtype=torch.bfloat16) * 0.05)(B, S, D)),
            "w_gate": _w((lambda *s: torch.randn(*s, dtype=torch.bfloat16) * 0.05)(D, F)),
            "w_up": _w((lambda *s: torch.randn(*s, dtype=torch.bfloat16) * 0.05)(D, F)),
            "w_down": _w((lambda *s: torch.randn(*s, dtype=torch.bfloat16) * 0.05)(F, D)),
        }
    _B_in = _B_setup()

    return {
        "A_x": _A_in["x"],
        "A_wqkv": _A_in["wqkv"],
        "A_wo": _A_in["wo"],
        "B_x": _B_in["x"],
        "B_w_gate": _B_in["w_gate"],
        "B_w_up": _B_in["w_up"],
        "B_w_down": _B_in["w_down"],
    }

def reference(A_x, A_wqkv, A_wo, B_x, B_w_gate, B_w_up, B_w_down):
    def _A_ref(x, wqkv, wo):
        B, S, D = x.shape
        H = 32; Dh = D // H
        qkv = (lambda x, *d: x.permute(*d))((x @ wqkv).reshape(B, S, 3, H, Dh), 2, 0, 3, 1, 4)
        q, k, v = qkv[0], qkv[1], qkv[2]
        phi = lambda t: torch.where(t > 0, t + 1, torch.exp(t)) + 1e-6
        pq, pk = phi(q), phi(k)
        kv = torch.einsum("bhsd,bhse->bhde", pk, v)
        z = torch.einsum("bhsd->bhd", pk)
        num = torch.einsum("bhqd,bhde->bhqe", pq, kv)
        den = torch.einsum("bhqd,bhd->bhq", pq, z)[..., None] + 1e-6
        o = num / den
        return (lambda x, *d: x.permute(*d))(o, 0, 2, 1, 3).reshape(B, S, D) @ wo

    def _B_ref(x, w_gate, w_up, w_down):
        return (_gelu(x @ w_gate) * (x @ w_up)) @ w_down

    x = A_x
    h = x + _A_ref(_layernorm(x, axis=-1), A_wqkv, A_wo)
    h2 = h + _B_ref(_layernorm(h, axis=-1), B_w_gate, B_w_up, B_w_down)
    return h2
```

```asm
; @launch kernel=k0_ln_kernel grid=(256,1,1) block=(256,1,1) lds=256
; @launch kernel=k1_qkv_kernel grid=(256,1,1) block=(320,1,1) lds=122880
; @launch kernel=k34_kernel grid=(256,1,1) block=(512,1,1) lds=153984
; @launch kernel=k5_down_kernel grid=(256,1,1) block=(256,1,1) lds=147456
.amdgcn_target "amdgcn-amd-amdhsa--gfx950"
.text
.globl k0_ln_kernel
.p2align 8
.type k0_ln_kernel,@function
k0_ln_kernel:
    s_cmp_ge_u32 s2, 256
    s_cbranch_scc1 k0_done
    v_and_b32 v2, 63, v0
    v_lshrrev_b32 v1, 6, v0
    s_nop 0
    v_readfirstlane_b32 s3, v1
    s_load_dwordx4 s[4:7], s[0:1], 0
    s_load_dwordx2 s[28:29], s[0:1], 72
    v_and_b32 v3, 7, v2
    v_lshrrev_b32 v4, 3, v2
    s_lshl_b32 s16, s2, 3
    v_add_u32 v5, s16, v3
    v_lshlrev_b32 v5, 11, v5
    s_lshl_b32 s17, s3, 4
    v_add_u32 v6, s17, v4
    v_lshl_add_u32 v5, v6, 5, v5
    s_waitcnt lgkmcnt(0)
    s_mov_b32 s8, s4
    s_mov_b32 s9, s5
    s_mov_b32 s10, 4194304
    s_mov_b32 s11, 0x00020000
    s_mov_b32 s12, s28
    s_mov_b32 s13, s29
    s_mov_b32 s14, 4194304
    s_mov_b32 s15, 0x00020000
    buffer_load_dwordx4 v[8:11], v5, s[8:11], 0 offen
    buffer_load_dwordx4 v[12:15], v5, s[8:11], 0 offen offset:16
    buffer_load_dwordx4 v[16:19], v5, s[8:11], 0 offen offset:256
    buffer_load_dwordx4 v[20:23], v5, s[8:11], 0 offen offset:272
    s_mov_b32 s24, s6
    s_mov_b32 s25, s7
    s_mov_b32 s26, 6291456
    s_mov_b32 s27, 0x00020000
    s_lshl_b32 s22, s2, 14
    v_lshl_add_u32 v28, v0, 6, s22
    s_mov_b32 s23, 4194304
    buffer_load_dword v29, v28, s[24:27], 0 offen
    buffer_load_dword v30, v28, s[24:27], s23 offen
    s_add_u32 s32, s28, 12582912
    s_addc_u32 s33, s29, 0
    s_mov_b32 s34, 2162688
    s_mov_b32 s35, 0x00020000
    v_mov_b32 v60, -1
    v_mov_b32 v61, -1
    v_mov_b32 v62, -1
    v_mov_b32 v63, -1
    s_lshl_b32 s22, s2, 13
    s_lshr_b32 s23, s3, 1
    s_lshl_b32 s23, s23, 12
    s_add_u32 s22, s22, s23
    s_and_b32 s23, s3, 1
    s_lshl_b32 s23, s23, 10
    s_add_u32 s22, s22, s23
    v_lshl_add_u32 v31, v2, 4, s22
    buffer_store_dwordx4 v[60:63], v31, s[32:35], 0 offen sc1
    s_lshl_b32 s22, s2, 8
    s_lshl_b32 s23, s3, 6
    s_add_u32 s22, s22, s23
    s_add_u32 s22, s22, 2097152
    v_lshl_add_u32 v31, v2, 4, s22
    s_mov_b64 exec, 15
    buffer_store_dwordx4 v[60:63], v31, s[32:35], 0 offen sc1
    s_mov_b64 exec, -1
    s_lshr_b32 s18, s2, 2
    s_lshl_b32 s18, s18, 16
    s_and_b32 s19, s2, 3
    s_lshl_b32 s19, s19, 7
    s_add_u32 s18, s18, s19
    v_lshlrev_b32 v7, 10, v6
    v_lshl_add_u32 v7, v3, 4, v7
    v_add_u32 v7, s18, v7
    v_mov_b32 v24, 0
    v_mov_b32 v25, 0
    s_waitcnt vmcnt(4)
    v_lshlrev_b32 v32, 16, v8
    v_and_b32 v33, 0xffff0000, v8
    v_lshlrev_b32 v34, 16, v9
    v_and_b32 v35, 0xffff0000, v9
    v_lshlrev_b32 v36, 16, v10
    v_and_b32 v37, 0xffff0000, v10
    v_lshlrev_b32 v38, 16, v11
    v_and_b32 v39, 0xffff0000, v11
    v_lshlrev_b32 v40, 16, v12
    v_and_b32 v41, 0xffff0000, v12
    v_lshlrev_b32 v42, 16, v13
    v_and_b32 v43, 0xffff0000, v13
    v_lshlrev_b32 v44, 16, v14
    v_and_b32 v45, 0xffff0000, v14
    v_lshlrev_b32 v46, 16, v15
    v_and_b32 v47, 0xffff0000, v15
    v_lshlrev_b32 v48, 16, v16
    v_and_b32 v49, 0xffff0000, v16
    v_lshlrev_b32 v50, 16, v17
    v_and_b32 v51, 0xffff0000, v17
    v_lshlrev_b32 v52, 16, v18
    v_and_b32 v53, 0xffff0000, v18
    v_lshlrev_b32 v54, 16, v19
    v_and_b32 v55, 0xffff0000, v19
    v_lshlrev_b32 v56, 16, v20
    v_and_b32 v57, 0xffff0000, v20
    v_lshlrev_b32 v58, 16, v21
    v_and_b32 v59, 0xffff0000, v21
    v_lshlrev_b32 v60, 16, v22
    v_and_b32 v61, 0xffff0000, v22
    v_lshlrev_b32 v62, 16, v23
    v_and_b32 v63, 0xffff0000, v23
    v_add_f32 v24, v24, v32
    v_fma_f32 v25, v32, v32, v25
    v_add_f32 v24, v24, v33
    v_fma_f32 v25, v33, v33, v25
    v_add_f32 v24, v24, v34
    v_fma_f32 v25, v34, v34, v25
    v_add_f32 v24, v24, v35
    v_fma_f32 v25, v35, v35, v25
    v_add_f32 v24, v24, v36
    v_fma_f32 v25, v36, v36, v25
    v_add_f32 v24, v24, v37
    v_fma_f32 v25, v37, v37, v25
    v_add_f32 v24, v24, v38
    v_fma_f32 v25, v38, v38, v25
    v_add_f32 v24, v24, v39
    v_fma_f32 v25, v39, v39, v25
    v_add_f32 v24, v24, v40
    v_fma_f32 v25, v40, v40, v25
    v_add_f32 v24, v24, v41
    v_fma_f32 v25, v41, v41, v25
    v_add_f32 v24, v24, v42
    v_fma_f32 v25, v42, v42, v25
    v_add_f32 v24, v24, v43
    v_fma_f32 v25, v43, v43, v25
    v_add_f32 v24, v24, v44
    v_fma_f32 v25, v44, v44, v25
    v_add_f32 v24, v24, v45
    v_fma_f32 v25, v45, v45, v25
    v_add_f32 v24, v24, v46
    v_fma_f32 v25, v46, v46, v25
    v_add_f32 v24, v24, v47
    v_fma_f32 v25, v47, v47, v25
    v_add_f32 v24, v24, v48
    v_fma_f32 v25, v48, v48, v25
    v_add_f32 v24, v24, v49
    v_fma_f32 v25, v49, v49, v25
    v_add_f32 v24, v24, v50
    v_fma_f32 v25, v50, v50, v25
    v_add_f32 v24, v24, v51
    v_fma_f32 v25, v51, v51, v25
    v_add_f32 v24, v24, v52
    v_fma_f32 v25, v52, v52, v25
    v_add_f32 v24, v24, v53
    v_fma_f32 v25, v53, v53, v25
    v_add_f32 v24, v24, v54
    v_fma_f32 v25, v54, v54, v25
    v_add_f32 v24, v24, v55
    v_fma_f32 v25, v55, v55, v25
    v_add_f32 v24, v24, v56
    v_fma_f32 v25, v56, v56, v25
    v_add_f32 v24, v24, v57
    v_fma_f32 v25, v57, v57, v25
    v_add_f32 v24, v24, v58
    v_fma_f32 v25, v58, v58, v25
    v_add_f32 v24, v24, v59
    v_fma_f32 v25, v59, v59, v25
    v_add_f32 v24, v24, v60
    v_fma_f32 v25, v60, v60, v25
    v_add_f32 v24, v24, v61
    v_fma_f32 v25, v61, v61, v25
    v_add_f32 v24, v24, v62
    v_fma_f32 v25, v62, v62, v25
    v_add_f32 v24, v24, v63
    v_fma_f32 v25, v63, v63, v25
    s_nop 1
    v_add_f32_dpp v24, v24, v24 row_ror:8 row_mask:0xf bank_mask:0xf
    v_add_f32_dpp v25, v25, v25 row_ror:8 row_mask:0xf bank_mask:0xf
    v_mov_b32 v26, v24
    v_mov_b32 v27, v25
    s_nop 1
    v_permlane16_swap_b32 v24, v26
    v_permlane16_swap_b32 v25, v27
    s_nop 1
    v_add_f32 v24, v24, v26
    v_add_f32 v25, v25, v27
    v_mov_b32 v26, v24
    v_mov_b32 v27, v25
    s_nop 1
    v_permlane32_swap_b32 v24, v26
    v_permlane32_swap_b32 v25, v27
    s_nop 1
    v_add_f32 v24, v24, v26
    v_add_f32 v25, v25, v27
    s_lshl_b32 s20, s3, 6
    v_lshlrev_b32 v26, 3, v3
    v_add_u32 v27, s20, v26
    ds_write_b64 v27, v[24:25]
    s_waitcnt lgkmcnt(0)
    s_barrier
    ds_read_b64 v[8:9], v26
    ds_read_b64 v[10:11], v26 offset:64
    ds_read_b64 v[12:13], v26 offset:128
    ds_read_b64 v[14:15], v26 offset:192
    s_waitcnt lgkmcnt(0)
    v_add_f32 v8, v8, v10
    v_add_f32 v9, v9, v11
    v_add_f32 v12, v12, v14
    v_add_f32 v13, v13, v15
    v_add_f32 v8, v8, v12
    v_add_f32 v9, v9, v13
    v_mul_f32 v8, 0x3a800000, v8
    v_mul_f32 v9, 0x3a800000, v9
    v_fma_f32 v9, -v8, v8, v9
    v_max_f32 v9, 0, v9
    v_add_f32 v9, 0x3727c5ac, v9
    v_rsq_f32 v9, v9
    s_nop 0
    v_mul_f32 v8, v8, v9
    v_fma_f32 v32, v32, v9, -v8
    v_fma_f32 v33, v33, v9, -v8
    v_fma_f32 v34, v34, v9, -v8
    v_fma_f32 v35, v35, v9, -v8
    v_fma_f32 v36, v36, v9, -v8
    v_fma_f32 v37, v37, v9, -v8
    v_fma_f32 v38, v38, v9, -v8
    v_fma_f32 v39, v39, v9, -v8
    v_fma_f32 v40, v40, v9, -v8
    v_fma_f32 v41, v41, v9, -v8
    v_fma_f32 v42, v42, v9, -v8
    v_fma_f32 v43, v43, v9, -v8
    v_fma_f32 v44, v44, v9, -v8
    v_fma_f32 v45, v45, v9, -v8
    v_fma_f32 v46, v46, v9, -v8
    v_fma_f32 v47, v47, v9, -v8
    v_fma_f32 v48, v48, v9, -v8
    v_fma_f32 v49, v49, v9, -v8
    v_fma_f32 v50, v50, v9, -v8
    v_fma_f32 v51, v51, v9, -v8
    v_fma_f32 v52, v52, v9, -v8
    v_fma_f32 v53, v53, v9, -v8
    v_fma_f32 v54, v54, v9, -v8
    v_fma_f32 v55, v55, v9, -v8
    v_fma_f32 v56, v56, v9, -v8
    v_fma_f32 v57, v57, v9, -v8
    v_fma_f32 v58, v58, v9, -v8
    v_fma_f32 v59, v59, v9, -v8
    v_fma_f32 v60, v60, v9, -v8
    v_fma_f32 v61, v61, v9, -v8
    v_fma_f32 v62, v62, v9, -v8
    v_fma_f32 v63, v63, v9, -v8
    v_cvt_pk_bf16_f32 v8, v32, v33
    v_cvt_pk_bf16_f32 v9, v34, v35
    v_cvt_pk_bf16_f32 v10, v40, v41
    v_cvt_pk_bf16_f32 v11, v42, v43
    v_cvt_pk_bf16_f32 v12, v36, v37
    v_cvt_pk_bf16_f32 v13, v38, v39
    v_cvt_pk_bf16_f32 v14, v44, v45
    v_cvt_pk_bf16_f32 v15, v46, v47
    v_cvt_pk_bf16_f32 v16, v48, v49
    v_cvt_pk_bf16_f32 v17, v50, v51
    v_cvt_pk_bf16_f32 v18, v56, v57
    v_cvt_pk_bf16_f32 v19, v58, v59
    v_cvt_pk_bf16_f32 v20, v52, v53
    v_cvt_pk_bf16_f32 v21, v54, v55
    v_cvt_pk_bf16_f32 v22, v60, v61
    v_cvt_pk_bf16_f32 v23, v62, v63
    s_mov_b32 s21, 8192
    buffer_store_dwordx4 v[8:11], v7, s[12:15], 0 offen sc1
    buffer_store_dwordx4 v[12:15], v7, s[12:15], 0 offen offset:512 sc1
    buffer_store_dwordx4 v[16:19], v7, s[12:15], s21 offen sc1
    buffer_store_dwordx4 v[20:23], v7, s[12:15], s21 offen offset:512 sc1
    s_waitcnt vmcnt(0)
k0_done:
    s_endpgm
.globl k1_qkv_kernel
.p2align 8
.type k1_qkv_kernel,@function
k1_qkv_kernel:
    s_cmp_ge_u32 s2, 256
    s_cbranch_scc1 k1_done
    v_and_b32 v2, 63, v0
    v_lshrrev_b32 v1, 6, v0
    s_nop 0
    v_readfirstlane_b32 s3, v1
    s_load_dwordx2 s[4:5], s[0:1], 8
    s_load_dwordx2 s[6:7], s[0:1], 72
    s_cmp_eq_u32 s3, 4
    s_cbranch_scc1 k1_pf
    s_and_b32 s16, s2, 7
    s_lshr_b32 s17, s2, 3
    s_and_b32 s18, s16, 1
    s_lshl_b32 s18, s18, 3
    s_and_b32 s19, s17, 7
    s_add_u32 s20, s18, s19
    s_lshr_b32 s18, s16, 1
    s_lshl_b32 s18, s18, 2
    s_lshr_b32 s19, s17, 3
    s_add_u32 s21, s18, s19
    s_lshl_b32 s22, s20, 2
    s_add_u32 s22, s22, s3
    s_lshl_b32 s16, s22, 16
    v_lshlrev_b32 v188, 4, v2
    v_add_u32 v188, s16, v188
    v_lshrrev_b32 v189, 5, v2
    v_lshlrev_b32 v189, 8, v189
    v_bfe_u32 v3, v2, 2, 2
    v_lshl_add_u32 v189, v3, 6, v189
    v_bfe_u32 v3, v2, 4, 1
    v_lshl_add_u32 v189, v3, 5, v189
    v_and_b32 v3, 3, v2
    v_lshl_add_u32 v189, v3, 3, v189
    v_bfe_u32 v3, v2, 2, 3
    s_mov_b32 s16, 6144
    v_mul_lo_u32 v191, v3, s16
    v_lshrrev_b32 v3, 5, v2
    v_lshl_add_u32 v191, v3, 6, v191
    v_and_b32 v3, 3, v2
    v_lshl_add_u32 v191, v3, 4, v191
    s_mul_i32 s16, s3, 98304
    s_lshl_b32 s17, s21, 7
    s_add_u32 s16, s16, s17
    v_add_u32 v191, s16, v191
    v_add_u32 v192, 2048, v191
    v_add_u32 v193, 4096, v191
    v_add_u32 v194, 49152, v191
    v_add_u32 v195, 51200, v191
    v_add_u32 v196, 53248, v191
    s_mul_i32 s23, s3, 6144
    s_waitcnt lgkmcnt(0)
    s_mov_b32 s8, s6
    s_mov_b32 s9, s7
    s_mov_b32 s10, 4194304
    s_mov_b32 s11, 0x00020000
    s_mov_b32 s12, s4
    s_mov_b32 s13, s5
    s_mov_b32 s14, 6291456
    s_mov_b32 s15, 0x00020000
    s_mov_b32 s25, 0
    s_add_u32 m0, s23, 0
    s_nop 0
    buffer_load_dwordx4 v191, s[12:15], s25 offen lds
    s_add_u32 m0, s23, 1024
    s_nop 0
    buffer_load_dwordx4 v192, s[12:15], s25 offen lds
    s_add_u32 m0, s23, 2048
    s_nop 0
    buffer_load_dwordx4 v193, s[12:15], s25 offen lds
    s_add_u32 m0, s23, 3072
    s_nop 0
    buffer_load_dwordx4 v194, s[12:15], s25 offen lds
    s_add_u32 m0, s23, 4096
    s_nop 0
    buffer_load_dwordx4 v195, s[12:15], s25 offen lds
    s_add_u32 m0, s23, 5120
    s_nop 0
    buffer_load_dwordx4 v196, s[12:15], s25 offen lds
    s_mov_b32 s24, 0
    buffer_load_dwordx4 v[100:103], v188, s[8:11], s24 offen offset:0
    buffer_load_dwordx4 v[104:107], v188, s[8:11], s24 offen offset:1024
    buffer_load_dwordx4 v[108:111], v188, s[8:11], s24 offen offset:2048
    buffer_load_dwordx4 v[112:115], v188, s[8:11], s24 offen offset:3072
    s_mov_b32 s25, 393216
    s_add_u32 m0, s23, 24576
    s_nop 0
    buffer_load_dwordx4 v191, s[12:15], s25 offen lds
    s_add_u32 m0, s23, 25600
    s_nop 0
    buffer_load_dwordx4 v192, s[12:15], s25 offen lds
    s_add_u32 m0, s23, 26624
    s_nop 0
    buffer_load_dwordx4 v193, s[12:15], s25 offen lds
    s_add_u32 m0, s23, 27648
    s_nop 0
    buffer_load_dwordx4 v194, s[12:15], s25 offen lds
    s_add_u32 m0, s23, 28672
    s_nop 0
    buffer_load_dwordx4 v195, s[12:15], s25 offen lds
    s_add_u32 m0, s23, 29696
    s_nop 0
    buffer_load_dwordx4 v196, s[12:15], s25 offen lds
    s_mov_b32 s24, 4096
    buffer_load_dwordx4 v[116:119], v188, s[8:11], s24 offen offset:0
    buffer_load_dwordx4 v[120:123], v188, s[8:11], s24 offen offset:1024
    buffer_load_dwordx4 v[124:127], v188, s[8:11], s24 offen offset:2048
    buffer_load_dwordx4 v[128:131], v188, s[8:11], s24 offen offset:3072
    s_waitcnt vmcnt(14)
    s_barrier
    v_mov_b32 v190, v189
    ds_read_b64_tr_b16 v[164:165], v190 offset:0
    ds_read_b64_tr_b16 v[166:167], v190 offset:3072
    ds_read_b64_tr_b16 v[168:169], v190 offset:512
    ds_read_b64_tr_b16 v[170:171], v190 offset:3584
    ds_read_b64_tr_b16 v[172:173], v190 offset:1024
    ds_read_b64_tr_b16 v[174:175], v190 offset:4096
    ds_read_b64_tr_b16 v[176:177], v190 offset:1536
    ds_read_b64_tr_b16 v[178:179], v190 offset:4608
    ds_read_b64_tr_b16 v[180:181], v190 offset:2048
    ds_read_b64_tr_b16 v[182:183], v190 offset:5120
    ds_read_b64_tr_b16 v[184:185], v190 offset:2560
    ds_read_b64_tr_b16 v[186:187], v190 offset:5632
    s_waitcnt lgkmcnt(10)
    s_waitcnt vmcnt(13)
    v_mfma_f32_32x32x16_bf16 v[4:19], v[164:167], v[100:103], 0
    ds_read_b64_tr_b16 v[164:165], v190 offset:6144
    ds_read_b64_tr_b16 v[166:167], v190 offset:9216
    s_mov_b32 s25, 786432
    s_add_u32 m0, s23, 49152
    s_nop 0
    buffer_load_dwordx4 v191, s[12:15], s25 offen lds
    s_add_u32 m0, s23, 50176
    s_nop 0
    buffer_load_dwordx4 v192, s[12:15], s25 offen lds
    s_waitcnt lgkmcnt(10)
    v_mfma_f32_32x32x16_bf16 v[20:35], v[168:171], v[100:103], 0
    ds_read_b64_tr_b16 v[168:169], v190 offset:6656
    ds_read_b64_tr_b16 v[170:171], v190 offset:9728
    s_add_u32 m0, s23, 51200
    s_nop 0
    buffer_load_dwordx4 v193, s[12:15], s25 offen lds
    s_add_u32 m0, s23, 52224
    s_nop 0
    buffer_load_dwordx4 v194, s[12:15], s25 offen lds
    s_waitcnt lgkmcnt(10)
    v_mfma_f32_32x32x16_bf16 v[36:51], v[100:103], v[172:175], 0
    ds_read_b64_tr_b16 v[172:173], v190 offset:7168
    ds_read_b64_tr_b16 v[174:175], v190 offset:10240
    s_add_u32 m0, s23, 53248
    s_nop 0
    buffer_load_dwordx4 v195, s[12:15], s25 offen lds
    s_add_u32 m0, s23, 54272
    s_nop 0
    buffer_load_dwordx4 v196, s[12:15], s25 offen lds
    s_waitcnt lgkmcnt(10)
    v_mfma_f32_32x32x16_bf16 v[52:67], v[100:103], v[176:179], 0
    ds_read_b64_tr_b16 v[176:177], v190 offset:7680
    ds_read_b64_tr_b16 v[178:179], v190 offset:10752
    s_mov_b32 s24, 8192
    buffer_load_dwordx4 v[132:135], v188, s[8:11], s24 offen offset:0
    buffer_load_dwordx4 v[136:139], v188, s[8:11], s24 offen offset:1024
    s_waitcnt lgkmcnt(10)
    v_mfma_f32_32x32x16_bf16 v[68:83], v[100:103], v[180:183], 0
    ds_read_b64_tr_b16 v[180:181], v190 offset:8192
    ds_read_b64_tr_b16 v[182:183], v190 offset:11264
    buffer_load_dwordx4 v[140:143], v188, s[8:11], s24 offen offset:2048
    buffer_load_dwordx4 v[144:147], v188, s[8:11], s24 offen offset:3072
    s_waitcnt lgkmcnt(10)
    v_mfma_f32_32x32x16_bf16 v[84:99], v[100:103], v[184:187], 0
    ds_read_b64_tr_b16 v[184:185], v190 offset:8704
    ds_read_b64_tr_b16 v[186:187], v190 offset:11776
    s_mov_b32 s25, 1179648
    s_add_u32 m0, s23, 73728
    s_nop 0
    buffer_load_dwordx4 v191, s[12:15], s25 offen lds
    s_add_u32 m0, s23, 74752
    s_nop 0
    buffer_load_dwordx4 v192, s[12:15], s25 offen lds
    s_waitcnt lgkmcnt(10)
    s_waitcnt vmcnt(24)
    v_mfma_f32_32x32x16_bf16 v[4:19], v[164:167], v[104:107], v[4:19]
    ds_read_b64_tr_b16 v[164:165], v190 offset:12288
    ds_read_b64_tr_b16 v[166:167], v190 offset:15360
    s_add_u32 m0, s23, 75776
    s_nop 0
    buffer_load_dwordx4 v193, s[12:15], s25 offen lds
    s_add_u32 m0, s23, 76800
    s_nop 0
    buffer_load_dwordx4 v194, s[12:15], s25 offen lds
    s_waitcnt lgkmcnt(10)
    v_mfma_f32_32x32x16_bf16 v[20:35], v[168:171], v[104:107], v[20:35]
    ds_read_b64_tr_b16 v[168:169], v190 offset:12800
    ds_read_b64_tr_b16 v[170:171], v190 offset:15872
    s_add_u32 m0, s23, 77824
    s_nop 0
    buffer_load_dwordx4 v195, s[12:15], s25 offen lds
    s_add_u32 m0, s23, 78848
    s_nop 0
    buffer_load_dwordx4 v196, s[12:15], s25 offen lds
    s_waitcnt lgkmcnt(10)
    v_mfma_f32_32x32x16_bf16 v[36:51], v[104:107], v[172:175], v[36:51]
    ds_read_b64_tr_b16 v[172:173], v190 offset:13312
    ds_read_b64_tr_b16 v[174:175], v190 offset:16384
    s_mov_b32 s24, 12288
    buffer_load_dwordx4 v[148:151], v188, s[8:11], s24 offen offset:0
    buffer_load_dwordx4 v[152:155], v188, s[8:11], s24 offen offset:1024
    s_waitcnt lgkmcnt(10)
    v_mfma_f32_32x32x16_bf16 v[52:67], v[104:107], v[176:179], v[52:67]
    ds_read_b64_tr_b16 v[176:177], v190 offset:13824
    ds_read_b64_tr_b16 v[178:179], v190 offset:16896
    buffer_load_dwordx4 v[156:159], v188, s[8:11], s24 offen offset:2048
    buffer_load_dwordx4 v[160:163], v188, s[8:11], s24 offen offset:3072
    s_waitcnt lgkmcnt(10)
    v_mfma_f32_32x32x16_bf16 v[68:83], v[104:107], v[180:183], v[68:83]
    ds_read_b64_tr_b16 v[180:181], v190 offset:14336
    ds_read_b64_tr_b16 v[182:183], v190 offset:17408
    s_mov_b32 s24, 16384
    buffer_load_dwordx4 v[100:103], v188, s[8:11], s24 offen offset:0
    s_waitcnt lgkmcnt(10)
    v_mfma_f32_32x32x16_bf16 v[84:99], v[104:107], v[184:187], v[84:99]
    ds_read_b64_tr_b16 v[184:185], v190 offset:14848
    ds_read_b64_tr_b16 v[186:187], v190 offset:17920
    s_waitcnt lgkmcnt(10)
    s_waitcnt vmcnt(32)
    v_mfma_f32_32x32x16_bf16 v[4:19], v[164:167], v[108:111], v[4:19]
    ds_read_b64_tr_b16 v[164:165], v190 offset:18432
    ds_read_b64_tr_b16 v[166:167], v190 offset:21504
    buffer_load_dwordx4 v[104:107], v188, s[8:11], s24 offen offset:1024
    s_waitcnt lgkmcnt(10)
    v_mfma_f32_32x32x16_bf16 v[20:35], v[168:171], v[108:111], v[20:35]
    ds_read_b64_tr_b16 v[168:169], v190 offset:18944
    ds_read_b64_tr_b16 v[170:171], v190 offset:22016
    s_waitcnt lgkmcnt(10)
    v_mfma_f32_32x32x16_bf16 v[36:51], v[108:111], v[172:175], v[36:51]
    ds_read_b64_tr_b16 v[172:173], v190 offset:19456
    ds_read_b64_tr_b16 v[174:175], v190 offset:22528
    s_waitcnt lgkmcnt(10)
    v_mfma_f32_32x32x16_bf16 v[52:67], v[108:111], v[176:179], v[52:67]
    ds_read_b64_tr_b16 v[176:177], v190 offset:19968
    ds_read_b64_tr_b16 v[178:179], v190 offset:23040
    s_waitcnt lgkmcnt(10)
    v_mfma_f32_32x32x16_bf16 v[68:83], v[108:111], v[180:183], v[68:83]
    ds_read_b64_tr_b16 v[180:181], v190 offset:20480
    ds_read_b64_tr_b16 v[182:183], v190 offset:23552
    s_waitcnt lgkmcnt(10)
    v_mfma_f32_32x32x16_bf16 v[84:99], v[108:111], v[184:187], v[84:99]
    ds_read_b64_tr_b16 v[184:185], v190 offset:20992
    ds_read_b64_tr_b16 v[186:187], v190 offset:24064
    s_waitcnt lgkmcnt(10)
    s_waitcnt vmcnt(32)
    v_mfma_f32_32x32x16_bf16 v[4:19], v[164:167], v[112:115], v[4:19]
    buffer_load_dwordx4 v[108:111], v188, s[8:11], s24 offen offset:2048
    s_waitcnt lgkmcnt(8)
    v_mfma_f32_32x32x16_bf16 v[20:35], v[168:171], v[112:115], v[20:35]
    s_waitcnt vmcnt(27)
    s_barrier
    v_add_u32 v190, 24576, v189
    ds_read_b64_tr_b16 v[164:165], v190 offset:0
    ds_read_b64_tr_b16 v[166:167], v190 offset:3072
    ds_read_b64_tr_b16 v[168:169], v190 offset:512
    ds_read_b64_tr_b16 v[170:171], v190 offset:3584
    s_mov_b32 s25, 1572864
    s_add_u32 m0, s23, 98304
    s_nop 0
    buffer_load_dwordx4 v191, s[12:15], s25 offen lds
    s_add_u32 m0, s23, 99328
    s_nop 0
    buffer_load_dwordx4 v192, s[12:15], s25 offen lds
    s_waitcnt lgkmcnt(10)
    v_mfma_f32_32x32x16_bf16 v[36:51], v[112:115], v[172:175], v[36:51]
    ds_read_b64_tr_b16 v[172:173], v190 offset:1024
    ds_read_b64_tr_b16 v[174:175], v190 offset:4096
    s_add_u32 m0, s23, 100352
    s_nop 0
    buffer_load_dwordx4 v193, s[12:15], s25 offen lds
    s_add_u32 m0, s23, 101376
    s_nop 0
    buffer_load_dwordx4 v194, s[12:15], s25 offen lds
    s_waitcnt lgkmcnt(10)
    v_mfma_f32_32x32x16_bf16 v[52:67], v[112:115], v[176:179], v[52:67]
    ds_read_b64_tr_b16 v[176:177], v190 offset:1536
    ds_read_b64_tr_b16 v[178:179], v190 offset:4608
    s_add_u32 m0, s23, 102400
    s_nop 0
    buffer_load_dwordx4 v195, s[12:15], s25 offen lds
    s_add_u32 m0, s23, 103424
    s_nop 0
    buffer_load_dwordx4 v196, s[12:15], s25 offen lds
    s_waitcnt lgkmcnt(10)
    v_mfma_f32_32x32x16_bf16 v[68:83], v[112:115], v[180:183], v[68:83]
    ds_read_b64_tr_b16 v[180:181], v190 offset:2048
    ds_read_b64_tr_b16 v[182:183], v190 offset:5120
    s_waitcnt lgkmcnt(10)
    v_mfma_f32_32x32x16_bf16 v[84:99], v[112:115], v[184:187], v[84:99]
    ds_read_b64_tr_b16 v[184:185], v190 offset:2560
    ds_read_b64_tr_b16 v[186:187], v190 offset:5632
    s_waitcnt lgkmcnt(10)
    s_waitcnt vmcnt(32)
    v_mfma_f32_32x32x16_bf16 v[4:19], v[164:167], v[116:119], v[4:19]
    ds_read_b64_tr_b16 v[164:165], v190 offset:6144
    ds_read_b64_tr_b16 v[166:167], v190 offset:9216
    buffer_load_dwordx4 v[112:115], v188, s[8:11], s24 offen offset:3072
    s_waitcnt lgkmcnt(10)
    v_mfma_f32_32x32x16_bf16 v[20:35], v[168:171], v[116:119], v[20:35]
    ds_read_b64_tr_b16 v[168:169], v190 offset:6656
    ds_read_b64_tr_b16 v[170:171], v190 offset:9728
    s_waitcnt lgkmcnt(10)
    v_mfma_f32_32x32x16_bf16 v[36:51], v[116:119], v[172:175], v[36:51]
    ds_read_b64_tr_b16 v[172:173], v190 offset:7168
    ds_read_b64_tr_b16 v[174:175], v190 offset:10240
    s_waitcnt lgkmcnt(10)
    v_mfma_f32_32x32x16_bf16 v[52:67], v[116:119], v[176:179], v[52:67]
    ds_read_b64_tr_b16 v[176:177], v190 offset:7680
    ds_read_b64_tr_b16 v[178:179], v190 offset:10752
    s_waitcnt lgkmcnt(10)
    v_mfma_f32_32x32x16_bf16 v[68:83], v[116:119], v[180:183], v[68:83]
    ds_read_b64_tr_b16 v[180:181], v190 offset:8192
    ds_read_b64_tr_b16 v[182:183], v190 offset:11264
    s_waitcnt lgkmcnt(10)
    v_mfma_f32_32x32x16_bf16 v[84:99], v[116:119], v[184:187], v[84:99]
    ds_read_b64_tr_b16 v[184:185], v190 offset:8704
    ds_read_b64_tr_b16 v[186:187], v190 offset:11776
    s_waitcnt lgkmcnt(10)
    s_waitcnt vmcnt(32)
    v_mfma_f32_32x32x16_bf16 v[4:19], v[164:167], v[120:123], v[4:19]
    ds_read_b64_tr_b16 v[164:165], v190 offset:12288
    ds_read_b64_tr_b16 v[166:167], v190 offset:15360
    s_mov_b32 s24, 20480
    buffer_load_dwordx4 v[116:119], v188, s[8:11], s24 offen offset:0
    s_waitcnt lgkmcnt(10)
    v_mfma_f32_32x32x16_bf16 v[20:35], v[168:171], v[120:123], v[20:35]
    ds_read_b64_tr_b16 v[168:169], v190 offset:12800
    ds_read_b64_tr_b16 v[170:171], v190 offset:15872
    s_waitcnt lgkmcnt(10)
    v_mfma_f32_32x32x16_bf16 v[36:51], v[120:123], v[172:175], v[36:51]
    ds_read_b64_tr_b16 v[172:173], v190 offset:13312
    ds_read_b64_tr_b16 v[174:175], v190 offset:16384
    s_waitcnt lgkmcnt(10)
    v_mfma_f32_32x32x16_bf16 v[52:67], v[120:123], v[176:179], v[52:67]
    ds_read_b64_tr_b16 v[176:177], v190 offset:13824
    ds_read_b64_tr_b16 v[178:179], v190 offset:16896
    s_waitcnt lgkmcnt(10)
    v_mfma_f32_32x32x16_bf16 v[68:83], v[120:123], v[180:183], v[68:83]
    ds_read_b64_tr_b16 v[180:181], v190 offset:14336
    ds_read_b64_tr_b16 v[182:183], v190 offset:17408
    s_waitcnt lgkmcnt(10)
    v_mfma_f32_32x32x16_bf16 v[84:99], v[120:123], v[184:187], v[84:99]
    ds_read_b64_tr_b16 v[184:185], v190 offset:14848
    ds_read_b64_tr_b16 v[186:187], v190 offset:17920
    s_waitcnt lgkmcnt(10)
    s_waitcnt vmcnt(32)
    v_mfma_f32_32x32x16_bf16 v[4:19], v[164:167], v[124:127], v[4:19]
    ds_read_b64_tr_b16 v[164:165], v190 offset:18432
    ds_read_b64_tr_b16 v[166:167], v190 offset:21504
    buffer_load_dwordx4 v[120:123], v188, s[8:11], s24 offen offset:1024
    s_waitcnt lgkmcnt(10)
    v_mfma_f32_32x32x16_bf16 v[20:35], v[168:171], v[124:127], v[20:35]
    ds_read_b64_tr_b16 v[168:169], v190 offset:18944
    ds_read_b64_tr_b16 v[170:171], v190 offset:22016
    s_waitcnt lgkmcnt(10)
    v_mfma_f32_32x32x16_bf16 v[36:51], v[124:127], v[172:175], v[36:51]
    ds_read_b64_tr_b16 v[172:173], v190 offset:19456
    ds_read_b64_tr_b16 v[174:175], v190 offset:22528
    s_waitcnt lgkmcnt(10)
    v_mfma_f32_32x32x16_bf16 v[52:67], v[124:127], v[176:179], v[52:67]
    ds_read_b64_tr_b16 v[176:177], v190 offset:19968
    ds_read_b64_tr_b16 v[178:179], v190 offset:23040
    s_waitcnt lgkmcnt(10)
    v_mfma_f32_32x32x16_bf16 v[68:83], v[124:127], v[180:183], v[68:83]
    ds_read_b64_tr_b16 v[180:181], v190 offset:20480
    ds_read_b64_tr_b16 v[182:183], v190 offset:23552
    s_waitcnt lgkmcnt(10)
    v_mfma_f32_32x32x16_bf16 v[84:99], v[124:127], v[184:187], v[84:99]
    ds_read_b64_tr_b16 v[184:185], v190 offset:20992
    ds_read_b64_tr_b16 v[186:187], v190 offset:24064
    s_waitcnt lgkmcnt(10)
    s_waitcnt vmcnt(32)
    v_mfma_f32_32x32x16_bf16 v[4:19], v[164:167], v[128:131], v[4:19]
    buffer_load_dwordx4 v[124:127], v188, s[8:11], s24 offen offset:2048
    s_waitcnt lgkmcnt(8)
    v_mfma_f32_32x32x16_bf16 v[20:35], v[168:171], v[128:131], v[20:35]
    s_waitcnt vmcnt(27)
    s_barrier
    v_add_u32 v190, 49152, v189
    ds_read_b64_tr_b16 v[164:165], v190 offset:0
    ds_read_b64_tr_b16 v[166:167], v190 offset:3072
    ds_read_b64_tr_b16 v[168:169], v190 offset:512
    ds_read_b64_tr_b16 v[170:171], v190 offset:3584
    s_mov_b32 s25, 1966080
    s_add_u32 m0, s23, 0
    s_nop 0
    buffer_load_dwordx4 v191, s[12:15], s25 offen lds
    s_add_u32 m0, s23, 1024
    s_nop 0
    buffer_load_dwordx4 v192, s[12:15], s25 offen lds
    s_waitcnt lgkmcnt(10)
    v_mfma_f32_32x32x16_bf16 v[36:51], v[128:131], v[172:175], v[36:51]
    ds_read_b64_tr_b16 v[172:173], v190 offset:1024
    ds_read_b64_tr_b16 v[174:175], v190 offset:4096
    s_add_u32 m0, s23, 2048
    s_nop 0
    buffer_load_dwordx4 v193, s[12:15], s25 offen lds
    s_add_u32 m0, s23, 3072
    s_nop 0
    buffer_load_dwordx4 v194, s[12:15], s25 offen lds
    s_waitcnt lgkmcnt(10)
    v_mfma_f32_32x32x16_bf16 v[52:67], v[128:131], v[176:179], v[52:67]
    ds_read_b64_tr_b16 v[176:177], v190 offset:1536
    ds_read_b64_tr_b16 v[178:179], v190 offset:4608
    s_add_u32 m0, s23, 4096
    s_nop 0
    buffer_load_dwordx4 v195, s[12:15], s25 offen lds
    s_add_u32 m0, s23, 5120
    s_nop 0
    buffer_load_dwordx4 v196, s[12:15], s25 offen lds
    s_waitcnt lgkmcnt(10)
    v_mfma_f32_32x32x16_bf16 v[68:83], v[128:131], v[180:183], v[68:83]
    ds_read_b64_tr_b16 v[180:181], v190 offset:2048
    ds_read_b64_tr_b16 v[182:183], v190 offset:5120
    s_waitcnt lgkmcnt(10)
    v_mfma_f32_32x32x16_bf16 v[84:99], v[128:131], v[184:187], v[84:99]
    ds_read_b64_tr_b16 v[184:185], v190 offset:2560
    ds_read_b64_tr_b16 v[186:187], v190 offset:5632
    s_waitcnt lgkmcnt(10)
    s_waitcnt vmcnt(32)
    v_mfma_f32_32x32x16_bf16 v[4:19], v[164:167], v[132:135], v[4:19]
    ds_read_b64_tr_b16 v[164:165], v190 offset:6144
    ds_read_b64_tr_b16 v[166:167], v190 offset:9216
    buffer_load_dwordx4 v[128:131], v188, s[8:11], s24 offen offset:3072
    s_waitcnt lgkmcnt(10)
    v_mfma_f32_32x32x16_bf16 v[20:35], v[168:171], v[132:135], v[20:35]
    ds_read_b64_tr_b16 v[168:169], v190 offset:6656
    ds_read_b64_tr_b16 v[170:171], v190 offset:9728
    s_waitcnt lgkmcnt(10)
    v_mfma_f32_32x32x16_bf16 v[36:51], v[132:135], v[172:175], v[36:51]
    ds_read_b64_tr_b16 v[172:173], v190 offset:7168
    ds_read_b64_tr_b16 v[174:175], v190 offset:10240
    s_waitcnt lgkmcnt(10)
    v_mfma_f32_32x32x16_bf16 v[52:67], v[132:135], v[176:179], v[52:67]
    ds_read_b64_tr_b16 v[176:177], v190 offset:7680
    ds_read_b64_tr_b16 v[178:179], v190 offset:10752
    s_waitcnt lgkmcnt(10)
    v_mfma_f32_32x32x16_bf16 v[68:83], v[132:135], v[180:183], v[68:83]
    ds_read_b64_tr_b16 v[180:181], v190 offset:8192
    ds_read_b64_tr_b16 v[182:183], v190 offset:11264
    s_waitcnt lgkmcnt(10)
    v_mfma_f32_32x32x16_bf16 v[84:99], v[132:135], v[184:187], v[84:99]
    ds_read_b64_tr_b16 v[184:185], v190 offset:8704
    ds_read_b64_tr_b16 v[186:187], v190 offset:11776
    s_waitcnt lgkmcnt(10)
    s_waitcnt vmcnt(32)
    v_mfma_f32_32x32x16_bf16 v[4:19], v[164:167], v[136:139], v[4:19]
    ds_read_b64_tr_b16 v[164:165], v190 offset:12288
    ds_read_b64_tr_b16 v[166:167], v190 offset:15360
    s_mov_b32 s24, 24576
    buffer_load_dwordx4 v[132:135], v188, s[8:11], s24 offen offset:0
    s_waitcnt lgkmcnt(10)
    v_mfma_f32_32x32x16_bf16 v[20:35], v[168:171], v[136:139], v[20:35]
    ds_read_b64_tr_b16 v[168:169], v190 offset:12800
    ds_read_b64_tr_b16 v[170:171], v190 offset:15872
    s_waitcnt lgkmcnt(10)
    v_mfma_f32_32x32x16_bf16 v[36:51], v[136:139], v[172:175], v[36:51]
    ds_read_b64_tr_b16 v[172:173], v190 offset:13312
    ds_read_b64_tr_b16 v[174:175], v190 offset:16384
    s_waitcnt lgkmcnt(10)
    v_mfma_f32_32x32x16_bf16 v[52:67], v[136:139], v[176:179], v[52:67]
    ds_read_b64_tr_b16 v[176:177], v190 offset:13824
    ds_read_b64_tr_b16 v[178:179], v190 offset:16896
    s_waitcnt lgkmcnt(10)
    v_mfma_f32_32x32x16_bf16 v[68:83], v[136:139], v[180:183], v[68:83]
    ds_read_b64_tr_b16 v[180:181], v190 offset:14336
    ds_read_b64_tr_b16 v[182:183], v190 offset:17408
    s_waitcnt lgkmcnt(10)
    v_mfma_f32_32x32x16_bf16 v[84:99], v[136:139], v[184:187], v[84:99]
    ds_read_b64_tr_b16 v[184:185], v190 offset:14848
    ds_read_b64_tr_b16 v[186:187], v190 offset:17920
    s_waitcnt lgkmcnt(10)
    s_waitcnt vmcnt(32)
    v_mfma_f32_32x32x16_bf16 v[4:19], v[164:167], v[140:143], v[4:19]
    ds_read_b64_tr_b16 v[164:165], v190 offset:18432
    ds_read_b64_tr_b16 v[166:167], v190 offset:21504
    buffer_load_dwordx4 v[136:139], v188, s[8:11], s24 offen offset:1024
    s_waitcnt lgkmcnt(10)
    v_mfma_f32_32x32x16_bf16 v[20:35], v[168:171], v[140:143], v[20:35]
    ds_read_b64_tr_b16 v[168:169], v190 offset:18944
    ds_read_b64_tr_b16 v[170:171], v190 offset:22016
    s_waitcnt lgkmcnt(10)
    v_mfma_f32_32x32x16_bf16 v[36:51], v[140:143], v[172:175], v[36:51]
    ds_read_b64_tr_b16 v[172:173], v190 offset:19456
    ds_read_b64_tr_b16 v[174:175], v190 offset:22528
    s_waitcnt lgkmcnt(10)
    v_mfma_f32_32x32x16_bf16 v[52:67], v[140:143], v[176:179], v[52:67]
    ds_read_b64_tr_b16 v[176:177], v190 offset:19968
    ds_read_b64_tr_b16 v[178:179], v190 offset:23040
    s_waitcnt lgkmcnt(10)
    v_mfma_f32_32x32x16_bf16 v[68:83], v[140:143], v[180:183], v[68:83]
    ds_read_b64_tr_b16 v[180:181], v190 offset:20480
    ds_read_b64_tr_b16 v[182:183], v190 offset:23552
    s_waitcnt lgkmcnt(10)
    v_mfma_f32_32x32x16_bf16 v[84:99], v[140:143], v[184:187], v[84:99]
    ds_read_b64_tr_b16 v[184:185], v190 offset:20992
    ds_read_b64_tr_b16 v[186:187], v190 offset:24064
    s_waitcnt lgkmcnt(10)
    s_waitcnt vmcnt(32)
    v_mfma_f32_32x32x16_bf16 v[4:19], v[164:167], v[144:147], v[4:19]
    buffer_load_dwordx4 v[140:143], v188, s[8:11], s24 offen offset:2048
    s_waitcnt lgkmcnt(8)
    v_mfma_f32_32x32x16_bf16 v[20:35], v[168:171], v[144:147], v[20:35]
    s_waitcnt vmcnt(27)
    s_barrier
    v_add_u32 v190, 73728, v189
    ds_read_b64_tr_b16 v[164:165], v190 offset:0
    ds_read_b64_tr_b16 v[166:167], v190 offset:3072
    ds_read_b64_tr_b16 v[168:169], v190 offset:512
    ds_read_b64_tr_b16 v[170:171], v190 offset:3584
    s_mov_b32 s25, 2359296
    s_add_u32 m0, s23, 24576
    s_nop 0
    buffer_load_dwordx4 v191, s[12:15], s25 offen lds
    s_add_u32 m0, s23, 25600
    s_nop 0
    buffer_load_dwordx4 v192, s[12:15], s25 offen lds
    s_waitcnt lgkmcnt(10)
    v_mfma_f32_32x32x16_bf16 v[36:51], v[144:147], v[172:175], v[36:51]
    ds_read_b64_tr_b16 v[172:173], v190 offset:1024
    ds_read_b64_tr_b16 v[174:175], v190 offset:4096
    s_add_u32 m0, s23, 26624
    s_nop 0
    buffer_load_dwordx4 v193, s[12:15], s25 offen lds
    s_add_u32 m0, s23, 27648
    s_nop 0
    buffer_load_dwordx4 v194, s[12:15], s25 offen lds
    s_waitcnt lgkmcnt(10)
    v_mfma_f32_32x32x16_bf16 v[52:67], v[144:147], v[176:179], v[52:67]
    ds_read_b64_tr_b16 v[176:177], v190 offset:1536
    ds_read_b64_tr_b16 v[178:179], v190 offset:4608
    s_add_u32 m0, s23, 28672
    s_nop 0
    buffer_load_dwordx4 v195, s[12:15], s25 offen lds
    s_add_u32 m0, s23, 29696
    s_nop 0
    buffer_load_dwordx4 v196, s[12:15], s25 offen lds
    s_waitcnt lgkmcnt(10)
    v_mfma_f32_32x32x16_bf16 v[68:83], v[144:147], v[180:183], v[68:83]
    ds_read_b64_tr_b16 v[180:181], v190 offset:2048
    ds_read_b64_tr_b16 v[182:183], v190 offset:5120
    s_waitcnt lgkmcnt(10)
    v_mfma_f32_32x32x16_bf16 v[84:99], v[144:147], v[184:187], v[84:99]
    ds_read_b64_tr_b16 v[184:185], v190 offset:2560
    ds_read_b64_tr_b16 v[186:187], v190 offset:5632
    s_waitcnt lgkmcnt(10)
    s_waitcnt vmcnt(32)
    v_mfma_f32_32x32x16_bf16 v[4:19], v[164:167], v[148:151], v[4:19]
    ds_read_b64_tr_b16 v[164:165], v190 offset:6144
    ds_read_b64_tr_b16 v[166:167], v190 offset:9216
    buffer_load_dwordx4 v[144:147], v188, s[8:11], s24 offen offset:3072
    s_waitcnt lgkmcnt(10)
    v_mfma_f32_32x32x16_bf16 v[20:35], v[168:171], v[148:151], v[20:35]
    ds_read_b64_tr_b16 v[168:169], v190 offset:6656
    ds_read_b64_tr_b16 v[170:171], v190 offset:9728
    s_waitcnt lgkmcnt(10)
    v_mfma_f32_32x32x16_bf16 v[36:51], v[148:151], v[172:175], v[36:51]
    ds_read_b64_tr_b16 v[172:173], v190 offset:7168
    ds_read_b64_tr_b16 v[174:175], v190 offset:10240
    s_waitcnt lgkmcnt(10)
    v_mfma_f32_32x32x16_bf16 v[52:67], v[148:151], v[176:179], v[52:67]
    ds_read_b64_tr_b16 v[176:177], v190 offset:7680
    ds_read_b64_tr_b16 v[178:179], v190 offset:10752
    s_waitcnt lgkmcnt(10)
    v_mfma_f32_32x32x16_bf16 v[68:83], v[148:151], v[180:183], v[68:83]
    ds_read_b64_tr_b16 v[180:181], v190 offset:8192
    ds_read_b64_tr_b16 v[182:183], v190 offset:11264
    s_waitcnt lgkmcnt(10)
    v_mfma_f32_32x32x16_bf16 v[84:99], v[148:151], v[184:187], v[84:99]
    ds_read_b64_tr_b16 v[184:185], v190 offset:8704
    ds_read_b64_tr_b16 v[186:187], v190 offset:11776
    s_waitcnt lgkmcnt(10)
    s_waitcnt vmcnt(32)
    v_mfma_f32_32x32x16_bf16 v[4:19], v[164:167], v[152:155], v[4:19]
    ds_read_b64_tr_b16 v[164:165], v190 offset:12288
    ds_read_b64_tr_b16 v[166:167], v190 offset:15360
    s_mov_b32 s24, 28672
    buffer_load_dwordx4 v[148:151], v188, s[8:11], s24 offen offset:0
    s_waitcnt lgkmcnt(10)
    v_mfma_f32_32x32x16_bf16 v[20:35], v[168:171], v[152:155], v[20:35]
    ds_read_b64_tr_b16 v[168:169], v190 offset:12800
    ds_read_b64_tr_b16 v[170:171], v190 offset:15872
    s_waitcnt lgkmcnt(10)
    v_mfma_f32_32x32x16_bf16 v[36:51], v[152:155], v[172:175], v[36:51]
    ds_read_b64_tr_b16 v[172:173], v190 offset:13312
    ds_read_b64_tr_b16 v[174:175], v190 offset:16384
    s_waitcnt lgkmcnt(10)
    v_mfma_f32_32x32x16_bf16 v[52:67], v[152:155], v[176:179], v[52:67]
    ds_read_b64_tr_b16 v[176:177], v190 offset:13824
    ds_read_b64_tr_b16 v[178:179], v190 offset:16896
    s_waitcnt lgkmcnt(10)
    v_mfma_f32_32x32x16_bf16 v[68:83], v[152:155], v[180:183], v[68:83]
    ds_read_b64_tr_b16 v[180:181], v190 offset:14336
    ds_read_b64_tr_b16 v[182:183], v190 offset:17408
    s_waitcnt lgkmcnt(10)
    v_mfma_f32_32x32x16_bf16 v[84:99], v[152:155], v[184:187], v[84:99]
    ds_read_b64_tr_b16 v[184:185], v190 offset:14848
    ds_read_b64_tr_b16 v[186:187], v190 offset:17920
    s_waitcnt lgkmcnt(10)
    s_waitcnt vmcnt(32)
    v_mfma_f32_32x32x16_bf16 v[4:19], v[164:167], v[156:159], v[4:19]
    ds_read_b64_tr_b16 v[164:165], v190 offset:18432
    ds_read_b64_tr_b16 v[166:167], v190 offset:21504
    buffer_load_dwordx4 v[152:155], v188, s[8:11], s24 offen offset:1024
    s_waitcnt lgkmcnt(10)
    v_mfma_f32_32x32x16_bf16 v[20:35], v[168:171], v[156:159], v[20:35]
    ds_read_b64_tr_b16 v[168:169], v190 offset:18944
    ds_read_b64_tr_b16 v[170:171], v190 offset:22016
    s_waitcnt lgkmcnt(10)
    v_mfma_f32_32x32x16_bf16 v[36:51], v[156:159], v[172:175], v[36:51]
    ds_read_b64_tr_b16 v[172:173], v190 offset:19456
    ds_read_b64_tr_b16 v[174:175], v190 offset:22528
    s_waitcnt lgkmcnt(10)
    v_mfma_f32_32x32x16_bf16 v[52:67], v[156:159], v[176:179], v[52:67]
    ds_read_b64_tr_b16 v[176:177], v190 offset:19968
    ds_read_b64_tr_b16 v[178:179], v190 offset:23040
    s_waitcnt lgkmcnt(10)
    v_mfma_f32_32x32x16_bf16 v[68:83], v[156:159], v[180:183], v[68:83]
    ds_read_b64_tr_b16 v[180:181], v190 offset:20480
    ds_read_b64_tr_b16 v[182:183], v190 offset:23552
    s_waitcnt lgkmcnt(10)
    v_mfma_f32_32x32x16_bf16 v[84:99], v[156:159], v[184:187], v[84:99]
    ds_read_b64_tr_b16 v[184:185], v190 offset:20992
    ds_read_b64_tr_b16 v[186:187], v190 offset:24064
    s_waitcnt lgkmcnt(10)
    s_waitcnt vmcnt(32)
    v_mfma_f32_32x32x16_bf16 v[4:19], v[164:167], v[160:163], v[4:19]
    buffer_load_dwordx4 v[156:159], v188, s[8:11], s24 offen offset:2048
    s_waitcnt lgkmcnt(8)
    v_mfma_f32_32x32x16_bf16 v[20:35], v[168:171], v[160:163], v[20:35]
    s_waitcnt vmcnt(24)
    s_barrier
    v_add_u32 v190, 98304, v189
    ds_read_b64_tr_b16 v[164:165], v190 offset:0
    ds_read_b64_tr_b16 v[166:167], v190 offset:3072
    ds_read_b64_tr_b16 v[168:169], v190 offset:512
    ds_read_b64_tr_b16 v[170:171], v190 offset:3584
    s_mov_b32 s25, 2752512
    s_add_u32 m0, s23, 49152
    s_nop 0
    buffer_load_dwordx4 v191, s[12:15], s25 offen lds
    s_add_u32 m0, s23, 50176
    s_nop 0
    buffer_load_dwordx4 v192, s[12:15], s25 offen lds
    s_waitcnt lgkmcnt(10)
    v_mfma_f32_32x32x16_bf16 v[36:51], v[160:163], v[172:175], v[36:51]
    ds_read_b64_tr_b16 v[172:173], v190 offset:1024
    ds_read_b64_tr_b16 v[174:175], v190 offset:4096
    s_add_u32 m0, s23, 51200
    s_nop 0
    buffer_load_dwordx4 v193, s[12:15], s25 offen lds
    s_add_u32 m0, s23, 52224
    s_nop 0
    buffer_load_dwordx4 v194, s[12:15], s25 offen lds
    s_waitcnt lgkmcnt(10)
    v_mfma_f32_32x32x16_bf16 v[52:67], v[160:163], v[176:179], v[52:67]
    ds_read_b64_tr_b16 v[176:177], v190 offset:1536
    ds_read_b64_tr_b16 v[178:179], v190 offset:4608
    s_add_u32 m0, s23, 53248
    s_nop 0
    buffer_load_dwordx4 v195, s[12:15], s25 offen lds
    s_add_u32 m0, s23, 54272
    s_nop 0
    buffer_load_dwordx4 v196, s[12:15], s25 offen lds
    s_waitcnt lgkmcnt(10)
    v_mfma_f32_32x32x16_bf16 v[68:83], v[160:163], v[180:183], v[68:83]
    ds_read_b64_tr_b16 v[180:181], v190 offset:2048
    ds_read_b64_tr_b16 v[182:183], v190 offset:5120
    s_waitcnt lgkmcnt(10)
    v_mfma_f32_32x32x16_bf16 v[84:99], v[160:163], v[184:187], v[84:99]
    ds_read_b64_tr_b16 v[184:185], v190 offset:2560
    ds_read_b64_tr_b16 v[186:187], v190 offset:5632
    s_waitcnt lgkmcnt(10)
    v_mfma_f32_32x32x16_bf16 v[4:19], v[164:167], v[100:103], v[4:19]
    ds_read_b64_tr_b16 v[164:165], v190 offset:6144
    ds_read_b64_tr_b16 v[166:167], v190 offset:9216
    buffer_load_dwordx4 v[160:163], v188, s[8:11], s24 offen offset:3072
    s_waitcnt lgkmcnt(10)
    v_mfma_f32_32x32x16_bf16 v[20:35], v[168:171], v[100:103], v[20:35]
    ds_read_b64_tr_b16 v[168:169], v190 offset:6656
    ds_read_b64_tr_b16 v[170:171], v190 offset:9728
    s_waitcnt lgkmcnt(10)
    v_mfma_f32_32x32x16_bf16 v[36:51], v[100:103], v[172:175], v[36:51]
    ds_read_b64_tr_b16 v[172:173], v190 offset:7168
    ds_read_b64_tr_b16 v[174:175], v190 offset:10240
    s_waitcnt lgkmcnt(10)
    v_mfma_f32_32x32x16_bf16 v[52:67], v[100:103], v[176:179], v[52:67]
    ds_read_b64_tr_b16 v[176:177], v190 offset:7680
    ds_read_b64_tr_b16 v[178:179], v190 offset:10752
    s_waitcnt lgkmcnt(10)
    v_mfma_f32_32x32x16_bf16 v[68:83], v[100:103], v[180:183], v[68:83]
    ds_read_b64_tr_b16 v[180:181], v190 offset:8192
    ds_read_b64_tr_b16 v[182:183], v190 offset:11264
    s_waitcnt lgkmcnt(10)
    v_mfma_f32_32x32x16_bf16 v[84:99], v[100:103], v[184:187], v[84:99]
    ds_read_b64_tr_b16 v[184:185], v190 offset:8704
    ds_read_b64_tr_b16 v[186:187], v190 offset:11776
    s_waitcnt lgkmcnt(10)
    v_mfma_f32_32x32x16_bf16 v[4:19], v[164:167], v[104:107], v[4:19]
    ds_read_b64_tr_b16 v[164:165], v190 offset:12288
    ds_read_b64_tr_b16 v[166:167], v190 offset:15360
    s_mov_b32 s24, 32768
    buffer_load_dwordx4 v[100:103], v188, s[8:11], s24 offen offset:0
    s_waitcnt lgkmcnt(10)
    v_mfma_f32_32x32x16_bf16 v[20:35], v[168:171], v[104:107], v[20:35]
    ds_read_b64_tr_b16 v[168:169], v190 offset:12800
    ds_read_b64_tr_b16 v[170:171], v190 offset:15872
    s_waitcnt lgkmcnt(10)
    v_mfma_f32_32x32x16_bf16 v[36:51], v[104:107], v[172:175], v[36:51]
    ds_read_b64_tr_b16 v[172:173], v190 offset:13312
    ds_read_b64_tr_b16 v[174:175], v190 offset:16384
    s_waitcnt lgkmcnt(10)
    v_mfma_f32_32x32x16_bf16 v[52:67], v[104:107], v[176:179], v[52:67]
    ds_read_b64_tr_b16 v[176:177], v190 offset:13824
    ds_read_b64_tr_b16 v[178:179], v190 offset:16896
    s_waitcnt lgkmcnt(10)
    v_mfma_f32_32x32x16_bf16 v[68:83], v[104:107], v[180:183], v[68:83]
    ds_read_b64_tr_b16 v[180:181], v190 offset:14336
    ds_read_b64_tr_b16 v[182:183], v190 offset:17408
    s_waitcnt lgkmcnt(10)
    v_mfma_f32_32x32x16_bf16 v[84:99], v[104:107], v[184:187], v[84:99]
    ds_read_b64_tr_b16 v[184:185], v190 offset:14848
    ds_read_b64_tr_b16 v[186:187], v190 offset:17920
    s_waitcnt lgkmcnt(10)
    v_mfma_f32_32x32x16_bf16 v[4:19], v[164:167], v[108:111], v[4:19]
    ds_read_b64_tr_b16 v[164:165], v190 offset:18432
    ds_read_b64_tr_b16 v[166:167], v190 offset:21504
    buffer_load_dwordx4 v[104:107], v188, s[8:11], s24 offen offset:1024
    s_waitcnt lgkmcnt(10)
    v_mfma_f32_32x32x16_bf16 v[20:35], v[168:171], v[108:111], v[20:35]
    ds_read_b64_tr_b16 v[168:169], v190 offset:18944
    ds_read_b64_tr_b16 v[170:171], v190 offset:22016
    s_waitcnt lgkmcnt(10)
    v_mfma_f32_32x32x16_bf16 v[36:51], v[108:111], v[172:175], v[36:51]
    ds_read_b64_tr_b16 v[172:173], v190 offset:19456
    ds_read_b64_tr_b16 v[174:175], v190 offset:22528
    s_waitcnt lgkmcnt(10)
    v_mfma_f32_32x32x16_bf16 v[52:67], v[108:111], v[176:179], v[52:67]
    ds_read_b64_tr_b16 v[176:177], v190 offset:19968
    ds_read_b64_tr_b16 v[178:179], v190 offset:23040
    s_waitcnt lgkmcnt(10)
    v_mfma_f32_32x32x16_bf16 v[68:83], v[108:111], v[180:183], v[68:83]
    ds_read_b64_tr_b16 v[180:181], v190 offset:20480
    ds_read_b64_tr_b16 v[182:183], v190 offset:23552
    s_waitcnt lgkmcnt(10)
    v_mfma_f32_32x32x16_bf16 v[84:99], v[108:111], v[184:187], v[84:99]
    ds_read_b64_tr_b16 v[184:185], v190 offset:20992
    ds_read_b64_tr_b16 v[186:187], v190 offset:24064
    s_waitcnt lgkmcnt(10)
    s_waitcnt vmcnt(32)
    v_mfma_f32_32x32x16_bf16 v[4:19], v[164:167], v[112:115], v[4:19]
    buffer_load_dwordx4 v[108:111], v188, s[8:11], s24 offen offset:2048
    s_waitcnt lgkmcnt(8)
    v_mfma_f32_32x32x16_bf16 v[20:35], v[168:171], v[112:115], v[20:35]
    s_waitcnt vmcnt(24)
    s_barrier
    v_add_u32 v190, 0, v189
    ds_read_b64_tr_b16 v[164:165], v190 offset:0
    ds_read_b64_tr_b16 v[166:167], v190 offset:3072
    ds_read_b64_tr_b16 v[168:169], v190 offset:512
    ds_read_b64_tr_b16 v[170:171], v190 offset:3584
    s_mov_b32 s25, 3145728
    s_add_u32 m0, s23, 73728
    s_nop 0
    buffer_load_dwordx4 v191, s[12:15], s25 offen lds
    s_add_u32 m0, s23, 74752
    s_nop 0
    buffer_load_dwordx4 v192, s[12:15], s25 offen lds
    s_waitcnt lgkmcnt(10)
    v_mfma_f32_32x32x16_bf16 v[36:51], v[112:115], v[172:175], v[36:51]
    ds_read_b64_tr_b16 v[172:173], v190 offset:1024
    ds_read_b64_tr_b16 v[174:175], v190 offset:4096
    s_add_u32 m0, s23, 75776
    s_nop 0
    buffer_load_dwordx4 v193, s[12:15], s25 offen lds
    s_add_u32 m0, s23, 76800
    s_nop 0
    buffer_load_dwordx4 v194, s[12:15], s25 offen lds
    s_waitcnt lgkmcnt(10)
    v_mfma_f32_32x32x16_bf16 v[52:67], v[112:115], v[176:179], v[52:67]
    ds_read_b64_tr_b16 v[176:177], v190 offset:1536
    ds_read_b64_tr_b16 v[178:179], v190 offset:4608
    s_add_u32 m0, s23, 77824
    s_nop 0
    buffer_load_dwordx4 v195, s[12:15], s25 offen lds
    s_add_u32 m0, s23, 78848
    s_nop 0
    buffer_load_dwordx4 v196, s[12:15], s25 offen lds
    s_waitcnt lgkmcnt(10)
    v_mfma_f32_32x32x16_bf16 v[68:83], v[112:115], v[180:183], v[68:83]
    ds_read_b64_tr_b16 v[180:181], v190 offset:2048
    ds_read_b64_tr_b16 v[182:183], v190 offset:5120
    s_waitcnt lgkmcnt(10)
    v_mfma_f32_32x32x16_bf16 v[84:99], v[112:115], v[184:187], v[84:99]
    ds_read_b64_tr_b16 v[184:185], v190 offset:2560
    ds_read_b64_tr_b16 v[186:187], v190 offset:5632
    s_waitcnt lgkmcnt(10)
    v_mfma_f32_32x32x16_bf16 v[4:19], v[164:167], v[116:119], v[4:19]
    ds_read_b64_tr_b16 v[164:165], v190 offset:6144
    ds_read_b64_tr_b16 v[166:167], v190 offset:9216
    buffer_load_dwordx4 v[112:115], v188, s[8:11], s24 offen offset:3072
    s_waitcnt lgkmcnt(10)
    v_mfma_f32_32x32x16_bf16 v[20:35], v[168:171], v[116:119], v[20:35]
    ds_read_b64_tr_b16 v[168:169], v190 offset:6656
    ds_read_b64_tr_b16 v[170:171], v190 offset:9728
    s_waitcnt lgkmcnt(10)
    v_mfma_f32_32x32x16_bf16 v[36:51], v[116:119], v[172:175], v[36:51]
    ds_read_b64_tr_b16 v[172:173], v190 offset:7168
    ds_read_b64_tr_b16 v[174:175], v190 offset:10240
    s_waitcnt lgkmcnt(10)
    v_mfma_f32_32x32x16_bf16 v[52:67], v[116:119], v[176:179], v[52:67]
    ds_read_b64_tr_b16 v[176:177], v190 offset:7680
    ds_read_b64_tr_b16 v[178:179], v190 offset:10752
    s_waitcnt lgkmcnt(10)
    v_mfma_f32_32x32x16_bf16 v[68:83], v[116:119], v[180:183], v[68:83]
    ds_read_b64_tr_b16 v[180:181], v190 offset:8192
    ds_read_b64_tr_b16 v[182:183], v190 offset:11264
    s_waitcnt lgkmcnt(10)
    v_mfma_f32_32x32x16_bf16 v[84:99], v[116:119], v[184:187], v[84:99]
    ds_read_b64_tr_b16 v[184:185], v190 offset:8704
    ds_read_b64_tr_b16 v[186:187], v190 offset:11776
    s_waitcnt lgkmcnt(10)
    v_mfma_f32_32x32x16_bf16 v[4:19], v[164:167], v[120:123], v[4:19]
    ds_read_b64_tr_b16 v[164:165], v190 offset:12288
    ds_read_b64_tr_b16 v[166:167], v190 offset:15360
    s_mov_b32 s24, 36864
    buffer_load_dwordx4 v[116:119], v188, s[8:11], s24 offen offset:0
    s_waitcnt lgkmcnt(10)
    v_mfma_f32_32x32x16_bf16 v[20:35], v[168:171], v[120:123], v[20:35]
    ds_read_b64_tr_b16 v[168:169], v190 offset:12800
    ds_read_b64_tr_b16 v[170:171], v190 offset:15872
    s_waitcnt lgkmcnt(10)
    v_mfma_f32_32x32x16_bf16 v[36:51], v[120:123], v[172:175], v[36:51]
    ds_read_b64_tr_b16 v[172:173], v190 offset:13312
    ds_read_b64_tr_b16 v[174:175], v190 offset:16384
    s_waitcnt lgkmcnt(10)
    v_mfma_f32_32x32x16_bf16 v[52:67], v[120:123], v[176:179], v[52:67]
    ds_read_b64_tr_b16 v[176:177], v190 offset:13824
    ds_read_b64_tr_b16 v[178:179], v190 offset:16896
    s_waitcnt lgkmcnt(10)
    v_mfma_f32_32x32x16_bf16 v[68:83], v[120:123], v[180:183], v[68:83]
    ds_read_b64_tr_b16 v[180:181], v190 offset:14336
    ds_read_b64_tr_b16 v[182:183], v190 offset:17408
    s_waitcnt lgkmcnt(10)
    v_mfma_f32_32x32x16_bf16 v[84:99], v[120:123], v[184:187], v[84:99]
    ds_read_b64_tr_b16 v[184:185], v190 offset:14848
    ds_read_b64_tr_b16 v[186:187], v190 offset:17920
    s_waitcnt lgkmcnt(10)
    v_mfma_f32_32x32x16_bf16 v[4:19], v[164:167], v[124:127], v[4:19]
    ds_read_b64_tr_b16 v[164:165], v190 offset:18432
    ds_read_b64_tr_b16 v[166:167], v190 offset:21504
    buffer_load_dwordx4 v[120:123], v188, s[8:11], s24 offen offset:1024
    s_waitcnt lgkmcnt(10)
    v_mfma_f32_32x32x16_bf16 v[20:35], v[168:171], v[124:127], v[20:35]
    ds_read_b64_tr_b16 v[168:169], v190 offset:18944
    ds_read_b64_tr_b16 v[170:171], v190 offset:22016
    s_waitcnt lgkmcnt(10)
    v_mfma_f32_32x32x16_bf16 v[36:51], v[124:127], v[172:175], v[36:51]
    ds_read_b64_tr_b16 v[172:173], v190 offset:19456
    ds_read_b64_tr_b16 v[174:175], v190 offset:22528
    s_waitcnt lgkmcnt(10)
    v_mfma_f32_32x32x16_bf16 v[52:67], v[124:127], v[176:179], v[52:67]
    ds_read_b64_tr_b16 v[176:177], v190 offset:19968
    ds_read_b64_tr_b16 v[178:179], v190 offset:23040
    s_waitcnt lgkmcnt(10)
    v_mfma_f32_32x32x16_bf16 v[68:83], v[124:127], v[180:183], v[68:83]
    ds_read_b64_tr_b16 v[180:181], v190 offset:20480
    ds_read_b64_tr_b16 v[182:183], v190 offset:23552
    s_waitcnt lgkmcnt(10)
    v_mfma_f32_32x32x16_bf16 v[84:99], v[124:127], v[184:187], v[84:99]
    ds_read_b64_tr_b16 v[184:185], v190 offset:20992
    ds_read_b64_tr_b16 v[186:187], v190 offset:24064
    s_waitcnt lgkmcnt(10)
    s_waitcnt vmcnt(32)
    v_mfma_f32_32x32x16_bf16 v[4:19], v[164:167], v[128:131], v[4:19]
    buffer_load_dwordx4 v[124:127], v188, s[8:11], s24 offen offset:2048
    s_waitcnt lgkmcnt(8)
    v_mfma_f32_32x32x16_bf16 v[20:35], v[168:171], v[128:131], v[20:35]
    s_waitcnt vmcnt(24)
    s_barrier
    v_add_u32 v190, 24576, v189
    ds_read_b64_tr_b16 v[164:165], v190 offset:0
    ds_read_b64_tr_b16 v[166:167], v190 offset:3072
    ds_read_b64_tr_b16 v[168:169], v190 offset:512
    ds_read_b64_tr_b16 v[170:171], v190 offset:3584
    s_mov_b32 s25, 3538944
    s_add_u32 m0, s23, 98304
    s_nop 0
    buffer_load_dwordx4 v191, s[12:15], s25 offen lds
    s_add_u32 m0, s23, 99328
    s_nop 0
    buffer_load_dwordx4 v192, s[12:15], s25 offen lds
    s_waitcnt lgkmcnt(10)
    v_mfma_f32_32x32x16_bf16 v[36:51], v[128:131], v[172:175], v[36:51]
    ds_read_b64_tr_b16 v[172:173], v190 offset:1024
    ds_read_b64_tr_b16 v[174:175], v190 offset:4096
    s_add_u32 m0, s23, 100352
    s_nop 0
    buffer_load_dwordx4 v193, s[12:15], s25 offen lds
    s_add_u32 m0, s23, 101376
    s_nop 0
    buffer_load_dwordx4 v194, s[12:15], s25 offen lds
    s_waitcnt lgkmcnt(10)
    v_mfma_f32_32x32x16_bf16 v[52:67], v[128:131], v[176:179], v[52:67]
    ds_read_b64_tr_b16 v[176:177], v190 offset:1536
    ds_read_b64_tr_b16 v[178:179], v190 offset:4608
    s_add_u32 m0, s23, 102400
    s_nop 0
    buffer_load_dwordx4 v195, s[12:15], s25 offen lds
    s_add_u32 m0, s23, 103424
    s_nop 0
    buffer_load_dwordx4 v196, s[12:15], s25 offen lds
    s_waitcnt lgkmcnt(10)
    v_mfma_f32_32x32x16_bf16 v[68:83], v[128:131], v[180:183], v[68:83]
    ds_read_b64_tr_b16 v[180:181], v190 offset:2048
    ds_read_b64_tr_b16 v[182:183], v190 offset:5120
    s_waitcnt lgkmcnt(10)
    v_mfma_f32_32x32x16_bf16 v[84:99], v[128:131], v[184:187], v[84:99]
    ds_read_b64_tr_b16 v[184:185], v190 offset:2560
    ds_read_b64_tr_b16 v[186:187], v190 offset:5632
    s_waitcnt lgkmcnt(10)
    v_mfma_f32_32x32x16_bf16 v[4:19], v[164:167], v[132:135], v[4:19]
    ds_read_b64_tr_b16 v[164:165], v190 offset:6144
    ds_read_b64_tr_b16 v[166:167], v190 offset:9216
    buffer_load_dwordx4 v[128:131], v188, s[8:11], s24 offen offset:3072
    s_waitcnt lgkmcnt(10)
    v_mfma_f32_32x32x16_bf16 v[20:35], v[168:171], v[132:135], v[20:35]
    ds_read_b64_tr_b16 v[168:169], v190 offset:6656
    ds_read_b64_tr_b16 v[170:171], v190 offset:9728
    s_waitcnt lgkmcnt(10)
    v_mfma_f32_32x32x16_bf16 v[36:51], v[132:135], v[172:175], v[36:51]
    ds_read_b64_tr_b16 v[172:173], v190 offset:7168
    ds_read_b64_tr_b16 v[174:175], v190 offset:10240
    s_waitcnt lgkmcnt(10)
    v_mfma_f32_32x32x16_bf16 v[52:67], v[132:135], v[176:179], v[52:67]
    ds_read_b64_tr_b16 v[176:177], v190 offset:7680
    ds_read_b64_tr_b16 v[178:179], v190 offset:10752
    s_waitcnt lgkmcnt(10)
    v_mfma_f32_32x32x16_bf16 v[68:83], v[132:135], v[180:183], v[68:83]
    ds_read_b64_tr_b16 v[180:181], v190 offset:8192
    ds_read_b64_tr_b16 v[182:183], v190 offset:11264
    s_waitcnt lgkmcnt(10)
    v_mfma_f32_32x32x16_bf16 v[84:99], v[132:135], v[184:187], v[84:99]
    ds_read_b64_tr_b16 v[184:185], v190 offset:8704
    ds_read_b64_tr_b16 v[186:187], v190 offset:11776
    s_waitcnt lgkmcnt(10)
    v_mfma_f32_32x32x16_bf16 v[4:19], v[164:167], v[136:139], v[4:19]
    ds_read_b64_tr_b16 v[164:165], v190 offset:12288
    ds_read_b64_tr_b16 v[166:167], v190 offset:15360
    s_mov_b32 s24, 40960
    buffer_load_dwordx4 v[132:135], v188, s[8:11], s24 offen offset:0
    s_waitcnt lgkmcnt(10)
    v_mfma_f32_32x32x16_bf16 v[20:35], v[168:171], v[136:139], v[20:35]
    ds_read_b64_tr_b16 v[168:169], v190 offset:12800
    ds_read_b64_tr_b16 v[170:171], v190 offset:15872
    s_waitcnt lgkmcnt(10)
    v_mfma_f32_32x32x16_bf16 v[36:51], v[136:139], v[172:175], v[36:51]
    ds_read_b64_tr_b16 v[172:173], v190 offset:13312
    ds_read_b64_tr_b16 v[174:175], v190 offset:16384
    s_waitcnt lgkmcnt(10)
    v_mfma_f32_32x32x16_bf16 v[52:67], v[136:139], v[176:179], v[52:67]
    ds_read_b64_tr_b16 v[176:177], v190 offset:13824
    ds_read_b64_tr_b16 v[178:179], v190 offset:16896
    s_waitcnt lgkmcnt(10)
    v_mfma_f32_32x32x16_bf16 v[68:83], v[136:139], v[180:183], v[68:83]
    ds_read_b64_tr_b16 v[180:181], v190 offset:14336
    ds_read_b64_tr_b16 v[182:183], v190 offset:17408
    s_waitcnt lgkmcnt(10)
    v_mfma_f32_32x32x16_bf16 v[84:99], v[136:139], v[184:187], v[84:99]
    ds_read_b64_tr_b16 v[184:185], v190 offset:14848
    ds_read_b64_tr_b16 v[186:187], v190 offset:17920
    s_waitcnt lgkmcnt(10)
    v_mfma_f32_32x32x16_bf16 v[4:19], v[164:167], v[140:143], v[4:19]
    ds_read_b64_tr_b16 v[164:165], v190 offset:18432
    ds_read_b64_tr_b16 v[166:167], v190 offset:21504
    buffer_load_dwordx4 v[136:139], v188, s[8:11], s24 offen offset:1024
    s_waitcnt lgkmcnt(10)
    v_mfma_f32_32x32x16_bf16 v[20:35], v[168:171], v[140:143], v[20:35]
    ds_read_b64_tr_b16 v[168:169], v190 offset:18944
    ds_read_b64_tr_b16 v[170:171], v190 offset:22016
    s_waitcnt lgkmcnt(10)
    v_mfma_f32_32x32x16_bf16 v[36:51], v[140:143], v[172:175], v[36:51]
    ds_read_b64_tr_b16 v[172:173], v190 offset:19456
    ds_read_b64_tr_b16 v[174:175], v190 offset:22528
    s_waitcnt lgkmcnt(10)
    v_mfma_f32_32x32x16_bf16 v[52:67], v[140:143], v[176:179], v[52:67]
    ds_read_b64_tr_b16 v[176:177], v190 offset:19968
    ds_read_b64_tr_b16 v[178:179], v190 offset:23040
    s_waitcnt lgkmcnt(10)
    v_mfma_f32_32x32x16_bf16 v[68:83], v[140:143], v[180:183], v[68:83]
    ds_read_b64_tr_b16 v[180:181], v190 offset:20480
    ds_read_b64_tr_b16 v[182:183], v190 offset:23552
    s_waitcnt lgkmcnt(10)
    v_mfma_f32_32x32x16_bf16 v[84:99], v[140:143], v[184:187], v[84:99]
    ds_read_b64_tr_b16 v[184:185], v190 offset:20992
    ds_read_b64_tr_b16 v[186:187], v190 offset:24064
    s_waitcnt lgkmcnt(10)
    s_waitcnt vmcnt(32)
    v_mfma_f32_32x32x16_bf16 v[4:19], v[164:167], v[144:147], v[4:19]
    buffer_load_dwordx4 v[140:143], v188, s[8:11], s24 offen offset:2048
    s_waitcnt lgkmcnt(8)
    v_mfma_f32_32x32x16_bf16 v[20:35], v[168:171], v[144:147], v[20:35]
    s_waitcnt vmcnt(24)
    s_barrier
    v_add_u32 v190, 49152, v189
    ds_read_b64_tr_b16 v[164:165], v190 offset:0
    ds_read_b64_tr_b16 v[166:167], v190 offset:3072
    ds_read_b64_tr_b16 v[168:169], v190 offset:512
    ds_read_b64_tr_b16 v[170:171], v190 offset:3584
    s_mov_b32 s25, 3932160
    s_add_u32 m0, s23, 0
    s_nop 0
    buffer_load_dwordx4 v191, s[12:15], s25 offen lds
    s_add_u32 m0, s23, 1024
    s_nop 0
    buffer_load_dwordx4 v192, s[12:15], s25 offen lds
    s_waitcnt lgkmcnt(10)
    v_mfma_f32_32x32x16_bf16 v[36:51], v[144:147], v[172:175], v[36:51]
    ds_read_b64_tr_b16 v[172:173], v190 offset:1024
    ds_read_b64_tr_b16 v[174:175], v190 offset:4096
    s_add_u32 m0, s23, 2048
    s_nop 0
    buffer_load_dwordx4 v193, s[12:15], s25 offen lds
    s_add_u32 m0, s23, 3072
    s_nop 0
    buffer_load_dwordx4 v194, s[12:15], s25 offen lds
    s_waitcnt lgkmcnt(10)
    v_mfma_f32_32x32x16_bf16 v[52:67], v[144:147], v[176:179], v[52:67]
    ds_read_b64_tr_b16 v[176:177], v190 offset:1536
    ds_read_b64_tr_b16 v[178:179], v190 offset:4608
    s_add_u32 m0, s23, 4096
    s_nop 0
    buffer_load_dwordx4 v195, s[12:15], s25 offen lds
    s_add_u32 m0, s23, 5120
    s_nop 0
    buffer_load_dwordx4 v196, s[12:15], s25 offen lds
    s_waitcnt lgkmcnt(10)
    v_mfma_f32_32x32x16_bf16 v[68:83], v[144:147], v[180:183], v[68:83]
    ds_read_b64_tr_b16 v[180:181], v190 offset:2048
    ds_read_b64_tr_b16 v[182:183], v190 offset:5120
    s_waitcnt lgkmcnt(10)
    v_mfma_f32_32x32x16_bf16 v[84:99], v[144:147], v[184:187], v[84:99]
    ds_read_b64_tr_b16 v[184:185], v190 offset:2560
    ds_read_b64_tr_b16 v[186:187], v190 offset:5632
    s_waitcnt lgkmcnt(10)
    v_mfma_f32_32x32x16_bf16 v[4:19], v[164:167], v[148:151], v[4:19]
    ds_read_b64_tr_b16 v[164:165], v190 offset:6144
    ds_read_b64_tr_b16 v[166:167], v190 offset:9216
    buffer_load_dwordx4 v[144:147], v188, s[8:11], s24 offen offset:3072
    s_waitcnt lgkmcnt(10)
    v_mfma_f32_32x32x16_bf16 v[20:35], v[168:171], v[148:151], v[20:35]
    ds_read_b64_tr_b16 v[168:169], v190 offset:6656
    ds_read_b64_tr_b16 v[170:171], v190 offset:9728
    s_waitcnt lgkmcnt(10)
    v_mfma_f32_32x32x16_bf16 v[36:51], v[148:151], v[172:175], v[36:51]
    ds_read_b64_tr_b16 v[172:173], v190 offset:7168
    ds_read_b64_tr_b16 v[174:175], v190 offset:10240
    s_waitcnt lgkmcnt(10)
    v_mfma_f32_32x32x16_bf16 v[52:67], v[148:151], v[176:179], v[52:67]
    ds_read_b64_tr_b16 v[176:177], v190 offset:7680
    ds_read_b64_tr_b16 v[178:179], v190 offset:10752
    s_waitcnt lgkmcnt(10)
    v_mfma_f32_32x32x16_bf16 v[68:83], v[148:151], v[180:183], v[68:83]
    ds_read_b64_tr_b16 v[180:181], v190 offset:8192
    ds_read_b64_tr_b16 v[182:183], v190 offset:11264
    s_waitcnt lgkmcnt(10)
    v_mfma_f32_32x32x16_bf16 v[84:99], v[148:151], v[184:187], v[84:99]
    ds_read_b64_tr_b16 v[184:185], v190 offset:8704
    ds_read_b64_tr_b16 v[186:187], v190 offset:11776
    s_waitcnt lgkmcnt(10)
    v_mfma_f32_32x32x16_bf16 v[4:19], v[164:167], v[152:155], v[4:19]
    ds_read_b64_tr_b16 v[164:165], v190 offset:12288
    ds_read_b64_tr_b16 v[166:167], v190 offset:15360
    s_mov_b32 s24, 45056
    buffer_load_dwordx4 v[148:151], v188, s[8:11], s24 offen offset:0
    s_waitcnt lgkmcnt(10)
    v_mfma_f32_32x32x16_bf16 v[20:35], v[168:171], v[152:155], v[20:35]
    ds_read_b64_tr_b16 v[168:169], v190 offset:12800
    ds_read_b64_tr_b16 v[170:171], v190 offset:15872
    s_waitcnt lgkmcnt(10)
    v_mfma_f32_32x32x16_bf16 v[36:51], v[152:155], v[172:175], v[36:51]
    ds_read_b64_tr_b16 v[172:173], v190 offset:13312
    ds_read_b64_tr_b16 v[174:175], v190 offset:16384
    s_waitcnt lgkmcnt(10)
    v_mfma_f32_32x32x16_bf16 v[52:67], v[152:155], v[176:179], v[52:67]
    ds_read_b64_tr_b16 v[176:177], v190 offset:13824
    ds_read_b64_tr_b16 v[178:179], v190 offset:16896
    s_waitcnt lgkmcnt(10)
    v_mfma_f32_32x32x16_bf16 v[68:83], v[152:155], v[180:183], v[68:83]
    ds_read_b64_tr_b16 v[180:181], v190 offset:14336
    ds_read_b64_tr_b16 v[182:183], v190 offset:17408
    s_waitcnt lgkmcnt(10)
    v_mfma_f32_32x32x16_bf16 v[84:99], v[152:155], v[184:187], v[84:99]
    ds_read_b64_tr_b16 v[184:185], v190 offset:14848
    ds_read_b64_tr_b16 v[186:187], v190 offset:17920
    s_waitcnt lgkmcnt(10)
    v_mfma_f32_32x32x16_bf16 v[4:19], v[164:167], v[156:159], v[4:19]
    ds_read_b64_tr_b16 v[164:165], v190 offset:18432
    ds_read_b64_tr_b16 v[166:167], v190 offset:21504
    buffer_load_dwordx4 v[152:155], v188, s[8:11], s24 offen offset:1024
    s_waitcnt lgkmcnt(10)
    v_mfma_f32_32x32x16_bf16 v[20:35], v[168:171], v[156:159], v[20:35]
    ds_read_b64_tr_b16 v[168:169], v190 offset:18944
    ds_read_b64_tr_b16 v[170:171], v190 offset:22016
    s_waitcnt lgkmcnt(10)
    v_mfma_f32_32x32x16_bf16 v[36:51], v[156:159], v[172:175], v[36:51]
    ds_read_b64_tr_b16 v[172:173], v190 offset:19456
    ds_read_b64_tr_b16 v[174:175], v190 offset:22528
    s_waitcnt lgkmcnt(10)
    v_mfma_f32_32x32x16_bf16 v[52:67], v[156:159], v[176:179], v[52:67]
    ds_read_b64_tr_b16 v[176:177], v190 offset:19968
    ds_read_b64_tr_b16 v[178:179], v190 offset:23040
    s_waitcnt lgkmcnt(10)
    v_mfma_f32_32x32x16_bf16 v[68:83], v[156:159], v[180:183], v[68:83]
    ds_read_b64_tr_b16 v[180:181], v190 offset:20480
    ds_read_b64_tr_b16 v[182:183], v190 offset:23552
    s_waitcnt lgkmcnt(10)
    v_mfma_f32_32x32x16_bf16 v[84:99], v[156:159], v[184:187], v[84:99]
    ds_read_b64_tr_b16 v[184:185], v190 offset:20992
    ds_read_b64_tr_b16 v[186:187], v190 offset:24064
    s_waitcnt lgkmcnt(10)
    s_waitcnt vmcnt(32)
    v_mfma_f32_32x32x16_bf16 v[4:19], v[164:167], v[160:163], v[4:19]
    buffer_load_dwordx4 v[156:159], v188, s[8:11], s24 offen offset:2048
    s_waitcnt lgkmcnt(8)
    v_mfma_f32_32x32x16_bf16 v[20:35], v[168:171], v[160:163], v[20:35]
    s_waitcnt vmcnt(24)
    s_barrier
    v_add_u32 v190, 73728, v189
    ds_read_b64_tr_b16 v[164:165], v190 offset:0
    ds_read_b64_tr_b16 v[166:167], v190 offset:3072
    ds_read_b64_tr_b16 v[168:169], v190 offset:512
    ds_read_b64_tr_b16 v[170:171], v190 offset:3584
    s_mov_b32 s25, 4325376
    s_add_u32 m0, s23, 24576
    s_nop 0
    buffer_load_dwordx4 v191, s[12:15], s25 offen lds
    s_add_u32 m0, s23, 25600
    s_nop 0
    buffer_load_dwordx4 v192, s[12:15], s25 offen lds
    s_waitcnt lgkmcnt(10)
    v_mfma_f32_32x32x16_bf16 v[36:51], v[160:163], v[172:175], v[36:51]
    ds_read_b64_tr_b16 v[172:173], v190 offset:1024
    ds_read_b64_tr_b16 v[174:175], v190 offset:4096
    s_add_u32 m0, s23, 26624
    s_nop 0
    buffer_load_dwordx4 v193, s[12:15], s25 offen lds
    s_add_u32 m0, s23, 27648
    s_nop 0
    buffer_load_dwordx4 v194, s[12:15], s25 offen lds
    s_waitcnt lgkmcnt(10)
    v_mfma_f32_32x32x16_bf16 v[52:67], v[160:163], v[176:179], v[52:67]
    ds_read_b64_tr_b16 v[176:177], v190 offset:1536
    ds_read_b64_tr_b16 v[178:179], v190 offset:4608
    s_add_u32 m0, s23, 28672
    s_nop 0
    buffer_load_dwordx4 v195, s[12:15], s25 offen lds
    s_add_u32 m0, s23, 29696
    s_nop 0
    buffer_load_dwordx4 v196, s[12:15], s25 offen lds
    s_waitcnt lgkmcnt(10)
    v_mfma_f32_32x32x16_bf16 v[68:83], v[160:163], v[180:183], v[68:83]
    ds_read_b64_tr_b16 v[180:181], v190 offset:2048
    ds_read_b64_tr_b16 v[182:183], v190 offset:5120
    s_waitcnt lgkmcnt(10)
    v_mfma_f32_32x32x16_bf16 v[84:99], v[160:163], v[184:187], v[84:99]
    ds_read_b64_tr_b16 v[184:185], v190 offset:2560
    ds_read_b64_tr_b16 v[186:187], v190 offset:5632
    s_waitcnt lgkmcnt(10)
    v_mfma_f32_32x32x16_bf16 v[4:19], v[164:167], v[100:103], v[4:19]
    ds_read_b64_tr_b16 v[164:165], v190 offset:6144
    ds_read_b64_tr_b16 v[166:167], v190 offset:9216
    buffer_load_dwordx4 v[160:163], v188, s[8:11], s24 offen offset:3072
    s_waitcnt lgkmcnt(10)
    v_mfma_f32_32x32x16_bf16 v[20:35], v[168:171], v[100:103], v[20:35]
    ds_read_b64_tr_b16 v[168:169], v190 offset:6656
    ds_read_b64_tr_b16 v[170:171], v190 offset:9728
    s_waitcnt lgkmcnt(10)
    v_mfma_f32_32x32x16_bf16 v[36:51], v[100:103], v[172:175], v[36:51]
    ds_read_b64_tr_b16 v[172:173], v190 offset:7168
    ds_read_b64_tr_b16 v[174:175], v190 offset:10240
    s_waitcnt lgkmcnt(10)
    v_mfma_f32_32x32x16_bf16 v[52:67], v[100:103], v[176:179], v[52:67]
    ds_read_b64_tr_b16 v[176:177], v190 offset:7680
    ds_read_b64_tr_b16 v[178:179], v190 offset:10752
    s_waitcnt lgkmcnt(10)
    v_mfma_f32_32x32x16_bf16 v[68:83], v[100:103], v[180:183], v[68:83]
    ds_read_b64_tr_b16 v[180:181], v190 offset:8192
    ds_read_b64_tr_b16 v[182:183], v190 offset:11264
    s_waitcnt lgkmcnt(10)
    v_mfma_f32_32x32x16_bf16 v[84:99], v[100:103], v[184:187], v[84:99]
    ds_read_b64_tr_b16 v[184:185], v190 offset:8704
    ds_read_b64_tr_b16 v[186:187], v190 offset:11776
    s_waitcnt lgkmcnt(10)
    v_mfma_f32_32x32x16_bf16 v[4:19], v[164:167], v[104:107], v[4:19]
    ds_read_b64_tr_b16 v[164:165], v190 offset:12288
    ds_read_b64_tr_b16 v[166:167], v190 offset:15360
    s_mov_b32 s24, 49152
    buffer_load_dwordx4 v[100:103], v188, s[8:11], s24 offen offset:0
    s_waitcnt lgkmcnt(10)
    v_mfma_f32_32x32x16_bf16 v[20:35], v[168:171], v[104:107], v[20:35]
    ds_read_b64_tr_b16 v[168:169], v190 offset:12800
    ds_read_b64_tr_b16 v[170:171], v190 offset:15872
    s_waitcnt lgkmcnt(10)
    v_mfma_f32_32x32x16_bf16 v[36:51], v[104:107], v[172:175], v[36:51]
    ds_read_b64_tr_b16 v[172:173], v190 offset:13312
    ds_read_b64_tr_b16 v[174:175], v190 offset:16384
    s_waitcnt lgkmcnt(10)
    v_mfma_f32_32x32x16_bf16 v[52:67], v[104:107], v[176:179], v[52:67]
    ds_read_b64_tr_b16 v[176:177], v190 offset:13824
    ds_read_b64_tr_b16 v[178:179], v190 offset:16896
    s_waitcnt lgkmcnt(10)
    v_mfma_f32_32x32x16_bf16 v[68:83], v[104:107], v[180:183], v[68:83]
    ds_read_b64_tr_b16 v[180:181], v190 offset:14336
    ds_read_b64_tr_b16 v[182:183], v190 offset:17408
    s_waitcnt lgkmcnt(10)
    v_mfma_f32_32x32x16_bf16 v[84:99], v[104:107], v[184:187], v[84:99]
    ds_read_b64_tr_b16 v[184:185], v190 offset:14848
    ds_read_b64_tr_b16 v[186:187], v190 offset:17920
    s_waitcnt lgkmcnt(10)
    v_mfma_f32_32x32x16_bf16 v[4:19], v[164:167], v[108:111], v[4:19]
    ds_read_b64_tr_b16 v[164:165], v190 offset:18432
    ds_read_b64_tr_b16 v[166:167], v190 offset:21504
    buffer_load_dwordx4 v[104:107], v188, s[8:11], s24 offen offset:1024
    s_waitcnt lgkmcnt(10)
    v_mfma_f32_32x32x16_bf16 v[20:35], v[168:171], v[108:111], v[20:35]
    ds_read_b64_tr_b16 v[168:169], v190 offset:18944
    ds_read_b64_tr_b16 v[170:171], v190 offset:22016
    s_waitcnt lgkmcnt(10)
    v_mfma_f32_32x32x16_bf16 v[36:51], v[108:111], v[172:175], v[36:51]
    ds_read_b64_tr_b16 v[172:173], v190 offset:19456
    ds_read_b64_tr_b16 v[174:175], v190 offset:22528
    s_waitcnt lgkmcnt(10)
    v_mfma_f32_32x32x16_bf16 v[52:67], v[108:111], v[176:179], v[52:67]
    ds_read_b64_tr_b16 v[176:177], v190 offset:19968
    ds_read_b64_tr_b16 v[178:179], v190 offset:23040
    s_waitcnt lgkmcnt(10)
    v_mfma_f32_32x32x16_bf16 v[68:83], v[108:111], v[180:183], v[68:83]
    ds_read_b64_tr_b16 v[180:181], v190 offset:20480
    ds_read_b64_tr_b16 v[182:183], v190 offset:23552
    s_waitcnt lgkmcnt(10)
    v_mfma_f32_32x32x16_bf16 v[84:99], v[108:111], v[184:187], v[84:99]
    ds_read_b64_tr_b16 v[184:185], v190 offset:20992
    ds_read_b64_tr_b16 v[186:187], v190 offset:24064
    s_waitcnt lgkmcnt(10)
    s_waitcnt vmcnt(32)
    v_mfma_f32_32x32x16_bf16 v[4:19], v[164:167], v[112:115], v[4:19]
    buffer_load_dwordx4 v[108:111], v188, s[8:11], s24 offen offset:2048
    s_waitcnt lgkmcnt(8)
    v_mfma_f32_32x32x16_bf16 v[20:35], v[168:171], v[112:115], v[20:35]
    s_waitcnt vmcnt(24)
    s_barrier
    v_add_u32 v190, 98304, v189
    ds_read_b64_tr_b16 v[164:165], v190 offset:0
    ds_read_b64_tr_b16 v[166:167], v190 offset:3072
    ds_read_b64_tr_b16 v[168:169], v190 offset:512
    ds_read_b64_tr_b16 v[170:171], v190 offset:3584
    s_mov_b32 s25, 4718592
    s_add_u32 m0, s23, 49152
    s_nop 0
    buffer_load_dwordx4 v191, s[12:15], s25 offen lds
    s_add_u32 m0, s23, 50176
    s_nop 0
    buffer_load_dwordx4 v192, s[12:15], s25 offen lds
    s_waitcnt lgkmcnt(10)
    v_mfma_f32_32x32x16_bf16 v[36:51], v[112:115], v[172:175], v[36:51]
    ds_read_b64_tr_b16 v[172:173], v190 offset:1024
    ds_read_b64_tr_b16 v[174:175], v190 offset:4096
    s_add_u32 m0, s23, 51200
    s_nop 0
    buffer_load_dwordx4 v193, s[12:15], s25 offen lds
    s_add_u32 m0, s23, 52224
    s_nop 0
    buffer_load_dwordx4 v194, s[12:15], s25 offen lds
    s_waitcnt lgkmcnt(10)
    v_mfma_f32_32x32x16_bf16 v[52:67], v[112:115], v[176:179], v[52:67]
    ds_read_b64_tr_b16 v[176:177], v190 offset:1536
    ds_read_b64_tr_b16 v[178:179], v190 offset:4608
    s_add_u32 m0, s23, 53248
    s_nop 0
    buffer_load_dwordx4 v195, s[12:15], s25 offen lds
    s_add_u32 m0, s23, 54272
    s_nop 0
    buffer_load_dwordx4 v196, s[12:15], s25 offen lds
    s_waitcnt lgkmcnt(10)
    v_mfma_f32_32x32x16_bf16 v[68:83], v[112:115], v[180:183], v[68:83]
    ds_read_b64_tr_b16 v[180:181], v190 offset:2048
    ds_read_b64_tr_b16 v[182:183], v190 offset:5120
    s_waitcnt lgkmcnt(10)
    v_mfma_f32_32x32x16_bf16 v[84:99], v[112:115], v[184:187], v[84:99]
    ds_read_b64_tr_b16 v[184:185], v190 offset:2560
    ds_read_b64_tr_b16 v[186:187], v190 offset:5632
    s_waitcnt lgkmcnt(10)
    v_mfma_f32_32x32x16_bf16 v[4:19], v[164:167], v[116:119], v[4:19]
    ds_read_b64_tr_b16 v[164:165], v190 offset:6144
    ds_read_b64_tr_b16 v[166:167], v190 offset:9216
    buffer_load_dwordx4 v[112:115], v188, s[8:11], s24 offen offset:3072
    s_waitcnt lgkmcnt(10)
    v_mfma_f32_32x32x16_bf16 v[20:35], v[168:171], v[116:119], v[20:35]
    ds_read_b64_tr_b16 v[168:169], v190 offset:6656
    ds_read_b64_tr_b16 v[170:171], v190 offset:9728
    s_waitcnt lgkmcnt(10)
    v_mfma_f32_32x32x16_bf16 v[36:51], v[116:119], v[172:175], v[36:51]
    ds_read_b64_tr_b16 v[172:173], v190 offset:7168
    ds_read_b64_tr_b16 v[174:175], v190 offset:10240
    s_waitcnt lgkmcnt(10)
    v_mfma_f32_32x32x16_bf16 v[52:67], v[116:119], v[176:179], v[52:67]
    ds_read_b64_tr_b16 v[176:177], v190 offset:7680
    ds_read_b64_tr_b16 v[178:179], v190 offset:10752
    s_waitcnt lgkmcnt(10)
    v_mfma_f32_32x32x16_bf16 v[68:83], v[116:119], v[180:183], v[68:83]
    ds_read_b64_tr_b16 v[180:181], v190 offset:8192
    ds_read_b64_tr_b16 v[182:183], v190 offset:11264
    s_waitcnt lgkmcnt(10)
    v_mfma_f32_32x32x16_bf16 v[84:99], v[116:119], v[184:187], v[84:99]
    ds_read_b64_tr_b16 v[184:185], v190 offset:8704
    ds_read_b64_tr_b16 v[186:187], v190 offset:11776
    s_waitcnt lgkmcnt(10)
    v_mfma_f32_32x32x16_bf16 v[4:19], v[164:167], v[120:123], v[4:19]
    ds_read_b64_tr_b16 v[164:165], v190 offset:12288
    ds_read_b64_tr_b16 v[166:167], v190 offset:15360
    s_mov_b32 s24, 53248
    buffer_load_dwordx4 v[116:119], v188, s[8:11], s24 offen offset:0
    s_waitcnt lgkmcnt(10)
    v_mfma_f32_32x32x16_bf16 v[20:35], v[168:171], v[120:123], v[20:35]
    ds_read_b64_tr_b16 v[168:169], v190 offset:12800
    ds_read_b64_tr_b16 v[170:171], v190 offset:15872
    s_waitcnt lgkmcnt(10)
    v_mfma_f32_32x32x16_bf16 v[36:51], v[120:123], v[172:175], v[36:51]
    ds_read_b64_tr_b16 v[172:173], v190 offset:13312
    ds_read_b64_tr_b16 v[174:175], v190 offset:16384
    s_waitcnt lgkmcnt(10)
    v_mfma_f32_32x32x16_bf16 v[52:67], v[120:123], v[176:179], v[52:67]
    ds_read_b64_tr_b16 v[176:177], v190 offset:13824
    ds_read_b64_tr_b16 v[178:179], v190 offset:16896
    s_waitcnt lgkmcnt(10)
    v_mfma_f32_32x32x16_bf16 v[68:83], v[120:123], v[180:183], v[68:83]
    ds_read_b64_tr_b16 v[180:181], v190 offset:14336
    ds_read_b64_tr_b16 v[182:183], v190 offset:17408
    s_waitcnt lgkmcnt(10)
    v_mfma_f32_32x32x16_bf16 v[84:99], v[120:123], v[184:187], v[84:99]
    ds_read_b64_tr_b16 v[184:185], v190 offset:14848
    ds_read_b64_tr_b16 v[186:187], v190 offset:17920
    s_waitcnt lgkmcnt(10)
    v_mfma_f32_32x32x16_bf16 v[4:19], v[164:167], v[124:127], v[4:19]
    ds_read_b64_tr_b16 v[164:165], v190 offset:18432
    ds_read_b64_tr_b16 v[166:167], v190 offset:21504
    buffer_load_dwordx4 v[120:123], v188, s[8:11], s24 offen offset:1024
    s_waitcnt lgkmcnt(10)
    v_mfma_f32_32x32x16_bf16 v[20:35], v[168:171], v[124:127], v[20:35]
    ds_read_b64_tr_b16 v[168:169], v190 offset:18944
    ds_read_b64_tr_b16 v[170:171], v190 offset:22016
    s_waitcnt lgkmcnt(10)
    v_mfma_f32_32x32x16_bf16 v[36:51], v[124:127], v[172:175], v[36:51]
    ds_read_b64_tr_b16 v[172:173], v190 offset:19456
    ds_read_b64_tr_b16 v[174:175], v190 offset:22528
    s_waitcnt lgkmcnt(10)
    v_mfma_f32_32x32x16_bf16 v[52:67], v[124:127], v[176:179], v[52:67]
    ds_read_b64_tr_b16 v[176:177], v190 offset:19968
    ds_read_b64_tr_b16 v[178:179], v190 offset:23040
    s_waitcnt lgkmcnt(10)
    v_mfma_f32_32x32x16_bf16 v[68:83], v[124:127], v[180:183], v[68:83]
    ds_read_b64_tr_b16 v[180:181], v190 offset:20480
    ds_read_b64_tr_b16 v[182:183], v190 offset:23552
    s_waitcnt lgkmcnt(10)
    v_mfma_f32_32x32x16_bf16 v[84:99], v[124:127], v[184:187], v[84:99]
    ds_read_b64_tr_b16 v[184:185], v190 offset:20992
    ds_read_b64_tr_b16 v[186:187], v190 offset:24064
    s_waitcnt lgkmcnt(10)
    s_waitcnt vmcnt(32)
    v_mfma_f32_32x32x16_bf16 v[4:19], v[164:167], v[128:131], v[4:19]
    buffer_load_dwordx4 v[124:127], v188, s[8:11], s24 offen offset:2048
    s_waitcnt lgkmcnt(8)
    v_mfma_f32_32x32x16_bf16 v[20:35], v[168:171], v[128:131], v[20:35]
    s_waitcnt vmcnt(24)
    s_barrier
    v_add_u32 v190, 0, v189
    ds_read_b64_tr_b16 v[164:165], v190 offset:0
    ds_read_b64_tr_b16 v[166:167], v190 offset:3072
    ds_read_b64_tr_b16 v[168:169], v190 offset:512
    ds_read_b64_tr_b16 v[170:171], v190 offset:3584
    s_mov_b32 s25, 5111808
    s_add_u32 m0, s23, 73728
    s_nop 0
    buffer_load_dwordx4 v191, s[12:15], s25 offen lds
    s_add_u32 m0, s23, 74752
    s_nop 0
    buffer_load_dwordx4 v192, s[12:15], s25 offen lds
    s_waitcnt lgkmcnt(10)
    v_mfma_f32_32x32x16_bf16 v[36:51], v[128:131], v[172:175], v[36:51]
    ds_read_b64_tr_b16 v[172:173], v190 offset:1024
    ds_read_b64_tr_b16 v[174:175], v190 offset:4096
    s_add_u32 m0, s23, 75776
    s_nop 0
    buffer_load_dwordx4 v193, s[12:15], s25 offen lds
    s_add_u32 m0, s23, 76800
    s_nop 0
    buffer_load_dwordx4 v194, s[12:15], s25 offen lds
    s_waitcnt lgkmcnt(10)
    v_mfma_f32_32x32x16_bf16 v[52:67], v[128:131], v[176:179], v[52:67]
    ds_read_b64_tr_b16 v[176:177], v190 offset:1536
    ds_read_b64_tr_b16 v[178:179], v190 offset:4608
    s_add_u32 m0, s23, 77824
    s_nop 0
    buffer_load_dwordx4 v195, s[12:15], s25 offen lds
    s_add_u32 m0, s23, 78848
    s_nop 0
    buffer_load_dwordx4 v196, s[12:15], s25 offen lds
    s_waitcnt lgkmcnt(10)
    v_mfma_f32_32x32x16_bf16 v[68:83], v[128:131], v[180:183], v[68:83]
    ds_read_b64_tr_b16 v[180:181], v190 offset:2048
    ds_read_b64_tr_b16 v[182:183], v190 offset:5120
    s_waitcnt lgkmcnt(10)
    v_mfma_f32_32x32x16_bf16 v[84:99], v[128:131], v[184:187], v[84:99]
    ds_read_b64_tr_b16 v[184:185], v190 offset:2560
    ds_read_b64_tr_b16 v[186:187], v190 offset:5632
    s_waitcnt lgkmcnt(10)
    v_mfma_f32_32x32x16_bf16 v[4:19], v[164:167], v[132:135], v[4:19]
    ds_read_b64_tr_b16 v[164:165], v190 offset:6144
    ds_read_b64_tr_b16 v[166:167], v190 offset:9216
    buffer_load_dwordx4 v[128:131], v188, s[8:11], s24 offen offset:3072
    s_waitcnt lgkmcnt(10)
    v_mfma_f32_32x32x16_bf16 v[20:35], v[168:171], v[132:135], v[20:35]
    ds_read_b64_tr_b16 v[168:169], v190 offset:6656
    ds_read_b64_tr_b16 v[170:171], v190 offset:9728
    s_waitcnt lgkmcnt(10)
    v_mfma_f32_32x32x16_bf16 v[36:51], v[132:135], v[172:175], v[36:51]
    ds_read_b64_tr_b16 v[172:173], v190 offset:7168
    ds_read_b64_tr_b16 v[174:175], v190 offset:10240
    s_waitcnt lgkmcnt(10)
    v_mfma_f32_32x32x16_bf16 v[52:67], v[132:135], v[176:179], v[52:67]
    ds_read_b64_tr_b16 v[176:177], v190 offset:7680
    ds_read_b64_tr_b16 v[178:179], v190 offset:10752
    s_waitcnt lgkmcnt(10)
    v_mfma_f32_32x32x16_bf16 v[68:83], v[132:135], v[180:183], v[68:83]
    ds_read_b64_tr_b16 v[180:181], v190 offset:8192
    ds_read_b64_tr_b16 v[182:183], v190 offset:11264
    s_waitcnt lgkmcnt(10)
    v_mfma_f32_32x32x16_bf16 v[84:99], v[132:135], v[184:187], v[84:99]
    ds_read_b64_tr_b16 v[184:185], v190 offset:8704
    ds_read_b64_tr_b16 v[186:187], v190 offset:11776
    s_waitcnt lgkmcnt(10)
    v_mfma_f32_32x32x16_bf16 v[4:19], v[164:167], v[136:139], v[4:19]
    ds_read_b64_tr_b16 v[164:165], v190 offset:12288
    ds_read_b64_tr_b16 v[166:167], v190 offset:15360
    s_mov_b32 s24, 57344
    buffer_load_dwordx4 v[132:135], v188, s[8:11], s24 offen offset:0
    s_waitcnt lgkmcnt(10)
    v_mfma_f32_32x32x16_bf16 v[20:35], v[168:171], v[136:139], v[20:35]
    ds_read_b64_tr_b16 v[168:169], v190 offset:12800
    ds_read_b64_tr_b16 v[170:171], v190 offset:15872
    s_waitcnt lgkmcnt(10)
    v_mfma_f32_32x32x16_bf16 v[36:51], v[136:139], v[172:175], v[36:51]
    ds_read_b64_tr_b16 v[172:173], v190 offset:13312
    ds_read_b64_tr_b16 v[174:175], v190 offset:16384
    s_waitcnt lgkmcnt(10)
    v_mfma_f32_32x32x16_bf16 v[52:67], v[136:139], v[176:179], v[52:67]
    ds_read_b64_tr_b16 v[176:177], v190 offset:13824
    ds_read_b64_tr_b16 v[178:179], v190 offset:16896
    s_waitcnt lgkmcnt(10)
    v_mfma_f32_32x32x16_bf16 v[68:83], v[136:139], v[180:183], v[68:83]
    ds_read_b64_tr_b16 v[180:181], v190 offset:14336
    ds_read_b64_tr_b16 v[182:183], v190 offset:17408
    s_waitcnt lgkmcnt(10)
    v_mfma_f32_32x32x16_bf16 v[84:99], v[136:139], v[184:187], v[84:99]
    ds_read_b64_tr_b16 v[184:185], v190 offset:14848
    ds_read_b64_tr_b16 v[186:187], v190 offset:17920
    s_waitcnt lgkmcnt(10)
    v_mfma_f32_32x32x16_bf16 v[4:19], v[164:167], v[140:143], v[4:19]
    ds_read_b64_tr_b16 v[164:165], v190 offset:18432
    ds_read_b64_tr_b16 v[166:167], v190 offset:21504
    buffer_load_dwordx4 v[136:139], v188, s[8:11], s24 offen offset:1024
    s_waitcnt lgkmcnt(10)
    v_mfma_f32_32x32x16_bf16 v[20:35], v[168:171], v[140:143], v[20:35]
    ds_read_b64_tr_b16 v[168:169], v190 offset:18944
    ds_read_b64_tr_b16 v[170:171], v190 offset:22016
    s_waitcnt lgkmcnt(10)
    v_mfma_f32_32x32x16_bf16 v[36:51], v[140:143], v[172:175], v[36:51]
    ds_read_b64_tr_b16 v[172:173], v190 offset:19456
    ds_read_b64_tr_b16 v[174:175], v190 offset:22528
    s_waitcnt lgkmcnt(10)
    v_mfma_f32_32x32x16_bf16 v[52:67], v[140:143], v[176:179], v[52:67]
    ds_read_b64_tr_b16 v[176:177], v190 offset:19968
    ds_read_b64_tr_b16 v[178:179], v190 offset:23040
    s_waitcnt lgkmcnt(10)
    v_mfma_f32_32x32x16_bf16 v[68:83], v[140:143], v[180:183], v[68:83]
    ds_read_b64_tr_b16 v[180:181], v190 offset:20480
    ds_read_b64_tr_b16 v[182:183], v190 offset:23552
    s_waitcnt lgkmcnt(10)
    v_mfma_f32_32x32x16_bf16 v[84:99], v[140:143], v[184:187], v[84:99]
    ds_read_b64_tr_b16 v[184:185], v190 offset:20992
    ds_read_b64_tr_b16 v[186:187], v190 offset:24064
    s_waitcnt lgkmcnt(10)
    s_waitcnt vmcnt(32)
    v_mfma_f32_32x32x16_bf16 v[4:19], v[164:167], v[144:147], v[4:19]
    buffer_load_dwordx4 v[140:143], v188, s[8:11], s24 offen offset:2048
    s_waitcnt lgkmcnt(8)
    v_mfma_f32_32x32x16_bf16 v[20:35], v[168:171], v[144:147], v[20:35]
    s_waitcnt vmcnt(24)
    s_barrier
    v_add_u32 v190, 24576, v189
    ds_read_b64_tr_b16 v[164:165], v190 offset:0
    ds_read_b64_tr_b16 v[166:167], v190 offset:3072
    ds_read_b64_tr_b16 v[168:169], v190 offset:512
    ds_read_b64_tr_b16 v[170:171], v190 offset:3584
    s_mov_b32 s25, 5505024
    s_add_u32 m0, s23, 98304
    s_nop 0
    buffer_load_dwordx4 v191, s[12:15], s25 offen lds
    s_add_u32 m0, s23, 99328
    s_nop 0
    buffer_load_dwordx4 v192, s[12:15], s25 offen lds
    s_waitcnt lgkmcnt(10)
    v_mfma_f32_32x32x16_bf16 v[36:51], v[144:147], v[172:175], v[36:51]
    ds_read_b64_tr_b16 v[172:173], v190 offset:1024
    ds_read_b64_tr_b16 v[174:175], v190 offset:4096
    s_add_u32 m0, s23, 100352
    s_nop 0
    buffer_load_dwordx4 v193, s[12:15], s25 offen lds
    s_add_u32 m0, s23, 101376
    s_nop 0
    buffer_load_dwordx4 v194, s[12:15], s25 offen lds
    s_waitcnt lgkmcnt(10)
    v_mfma_f32_32x32x16_bf16 v[52:67], v[144:147], v[176:179], v[52:67]
    ds_read_b64_tr_b16 v[176:177], v190 offset:1536
    ds_read_b64_tr_b16 v[178:179], v190 offset:4608
    s_add_u32 m0, s23, 102400
    s_nop 0
    buffer_load_dwordx4 v195, s[12:15], s25 offen lds
    s_add_u32 m0, s23, 103424
    s_nop 0
    buffer_load_dwordx4 v196, s[12:15], s25 offen lds
    s_waitcnt lgkmcnt(10)
    v_mfma_f32_32x32x16_bf16 v[68:83], v[144:147], v[180:183], v[68:83]
    ds_read_b64_tr_b16 v[180:181], v190 offset:2048
    ds_read_b64_tr_b16 v[182:183], v190 offset:5120
    s_waitcnt lgkmcnt(10)
    v_mfma_f32_32x32x16_bf16 v[84:99], v[144:147], v[184:187], v[84:99]
    ds_read_b64_tr_b16 v[184:185], v190 offset:2560
    ds_read_b64_tr_b16 v[186:187], v190 offset:5632
    s_waitcnt lgkmcnt(10)
    v_mfma_f32_32x32x16_bf16 v[4:19], v[164:167], v[148:151], v[4:19]
    ds_read_b64_tr_b16 v[164:165], v190 offset:6144
    ds_read_b64_tr_b16 v[166:167], v190 offset:9216
    buffer_load_dwordx4 v[144:147], v188, s[8:11], s24 offen offset:3072
    s_waitcnt lgkmcnt(10)
    v_mfma_f32_32x32x16_bf16 v[20:35], v[168:171], v[148:151], v[20:35]
    ds_read_b64_tr_b16 v[168:169], v190 offset:6656
    ds_read_b64_tr_b16 v[170:171], v190 offset:9728
    s_waitcnt lgkmcnt(10)
    v_mfma_f32_32x32x16_bf16 v[36:51], v[148:151], v[172:175], v[36:51]
    ds_read_b64_tr_b16 v[172:173], v190 offset:7168
    ds_read_b64_tr_b16 v[174:175], v190 offset:10240
    s_waitcnt lgkmcnt(10)
    v_mfma_f32_32x32x16_bf16 v[52:67], v[148:151], v[176:179], v[52:67]
    ds_read_b64_tr_b16 v[176:177], v190 offset:7680
    ds_read_b64_tr_b16 v[178:179], v190 offset:10752
    s_waitcnt lgkmcnt(10)
    v_mfma_f32_32x32x16_bf16 v[68:83], v[148:151], v[180:183], v[68:83]
    ds_read_b64_tr_b16 v[180:181], v190 offset:8192
    ds_read_b64_tr_b16 v[182:183], v190 offset:11264
    s_waitcnt lgkmcnt(10)
    v_mfma_f32_32x32x16_bf16 v[84:99], v[148:151], v[184:187], v[84:99]
    ds_read_b64_tr_b16 v[184:185], v190 offset:8704
    ds_read_b64_tr_b16 v[186:187], v190 offset:11776
    s_waitcnt lgkmcnt(10)
    v_mfma_f32_32x32x16_bf16 v[4:19], v[164:167], v[152:155], v[4:19]
    ds_read_b64_tr_b16 v[164:165], v190 offset:12288
    ds_read_b64_tr_b16 v[166:167], v190 offset:15360
    s_mov_b32 s24, 61440
    buffer_load_dwordx4 v[148:151], v188, s[8:11], s24 offen offset:0
    s_waitcnt lgkmcnt(10)
    v_mfma_f32_32x32x16_bf16 v[20:35], v[168:171], v[152:155], v[20:35]
    ds_read_b64_tr_b16 v[168:169], v190 offset:12800
    ds_read_b64_tr_b16 v[170:171], v190 offset:15872
    s_waitcnt lgkmcnt(10)
    v_mfma_f32_32x32x16_bf16 v[36:51], v[152:155], v[172:175], v[36:51]
    ds_read_b64_tr_b16 v[172:173], v190 offset:13312
    ds_read_b64_tr_b16 v[174:175], v190 offset:16384
    s_waitcnt lgkmcnt(10)
    v_mfma_f32_32x32x16_bf16 v[52:67], v[152:155], v[176:179], v[52:67]
    ds_read_b64_tr_b16 v[176:177], v190 offset:13824
    ds_read_b64_tr_b16 v[178:179], v190 offset:16896
    s_waitcnt lgkmcnt(10)
    v_mfma_f32_32x32x16_bf16 v[68:83], v[152:155], v[180:183], v[68:83]
    ds_read_b64_tr_b16 v[180:181], v190 offset:14336
    ds_read_b64_tr_b16 v[182:183], v190 offset:17408
    s_waitcnt lgkmcnt(10)
    v_mfma_f32_32x32x16_bf16 v[84:99], v[152:155], v[184:187], v[84:99]
    ds_read_b64_tr_b16 v[184:185], v190 offset:14848
    ds_read_b64_tr_b16 v[186:187], v190 offset:17920
    s_waitcnt lgkmcnt(10)
    v_mfma_f32_32x32x16_bf16 v[4:19], v[164:167], v[156:159], v[4:19]
    ds_read_b64_tr_b16 v[164:165], v190 offset:18432
    ds_read_b64_tr_b16 v[166:167], v190 offset:21504
    buffer_load_dwordx4 v[152:155], v188, s[8:11], s24 offen offset:1024
    s_waitcnt lgkmcnt(10)
    v_mfma_f32_32x32x16_bf16 v[20:35], v[168:171], v[156:159], v[20:35]
    ds_read_b64_tr_b16 v[168:169], v190 offset:18944
    ds_read_b64_tr_b16 v[170:171], v190 offset:22016
    s_waitcnt lgkmcnt(10)
    v_mfma_f32_32x32x16_bf16 v[36:51], v[156:159], v[172:175], v[36:51]
    ds_read_b64_tr_b16 v[172:173], v190 offset:19456
    ds_read_b64_tr_b16 v[174:175], v190 offset:22528
    s_waitcnt lgkmcnt(10)
    v_mfma_f32_32x32x16_bf16 v[52:67], v[156:159], v[176:179], v[52:67]
    ds_read_b64_tr_b16 v[176:177], v190 offset:19968
    ds_read_b64_tr_b16 v[178:179], v190 offset:23040
    s_waitcnt lgkmcnt(10)
    v_mfma_f32_32x32x16_bf16 v[68:83], v[156:159], v[180:183], v[68:83]
    ds_read_b64_tr_b16 v[180:181], v190 offset:20480
    ds_read_b64_tr_b16 v[182:183], v190 offset:23552
    s_waitcnt lgkmcnt(10)
    v_mfma_f32_32x32x16_bf16 v[84:99], v[156:159], v[184:187], v[84:99]
    ds_read_b64_tr_b16 v[184:185], v190 offset:20992
    ds_read_b64_tr_b16 v[186:187], v190 offset:24064
    s_waitcnt lgkmcnt(10)
    s_waitcnt vmcnt(32)
    v_mfma_f32_32x32x16_bf16 v[4:19], v[164:167], v[160:163], v[4:19]
    buffer_load_dwordx4 v[156:159], v188, s[8:11], s24 offen offset:2048
    s_waitcnt lgkmcnt(8)
    v_mfma_f32_32x32x16_bf16 v[20:35], v[168:171], v[160:163], v[20:35]
    s_waitcnt vmcnt(24)
    s_barrier
    v_add_u32 v190, 49152, v189
    ds_read_b64_tr_b16 v[164:165], v190 offset:0
    ds_read_b64_tr_b16 v[166:167], v190 offset:3072
    ds_read_b64_tr_b16 v[168:169], v190 offset:512
    ds_read_b64_tr_b16 v[170:171], v190 offset:3584
    s_mov_b32 s25, 5898240
    s_add_u32 m0, s23, 0
    s_nop 0
    buffer_load_dwordx4 v191, s[12:15], s25 offen lds
    s_add_u32 m0, s23, 1024
    s_nop 0
    buffer_load_dwordx4 v192, s[12:15], s25 offen lds
    s_waitcnt lgkmcnt(10)
    v_mfma_f32_32x32x16_bf16 v[36:51], v[160:163], v[172:175], v[36:51]
    ds_read_b64_tr_b16 v[172:173], v190 offset:1024
    ds_read_b64_tr_b16 v[174:175], v190 offset:4096
    s_add_u32 m0, s23, 2048
    s_nop 0
    buffer_load_dwordx4 v193, s[12:15], s25 offen lds
    s_add_u32 m0, s23, 3072
    s_nop 0
    buffer_load_dwordx4 v194, s[12:15], s25 offen lds
    s_waitcnt lgkmcnt(10)
    v_mfma_f32_32x32x16_bf16 v[52:67], v[160:163], v[176:179], v[52:67]
    ds_read_b64_tr_b16 v[176:177], v190 offset:1536
    ds_read_b64_tr_b16 v[178:179], v190 offset:4608
    s_add_u32 m0, s23, 4096
    s_nop 0
    buffer_load_dwordx4 v195, s[12:15], s25 offen lds
    s_add_u32 m0, s23, 5120
    s_nop 0
    buffer_load_dwordx4 v196, s[12:15], s25 offen lds
    s_waitcnt lgkmcnt(10)
    v_mfma_f32_32x32x16_bf16 v[68:83], v[160:163], v[180:183], v[68:83]
    ds_read_b64_tr_b16 v[180:181], v190 offset:2048
    ds_read_b64_tr_b16 v[182:183], v190 offset:5120
    s_waitcnt lgkmcnt(10)
    v_mfma_f32_32x32x16_bf16 v[84:99], v[160:163], v[184:187], v[84:99]
    ds_read_b64_tr_b16 v[184:185], v190 offset:2560
    ds_read_b64_tr_b16 v[186:187], v190 offset:5632
    s_waitcnt lgkmcnt(10)
    v_mfma_f32_32x32x16_bf16 v[4:19], v[164:167], v[100:103], v[4:19]
    ds_read_b64_tr_b16 v[164:165], v190 offset:6144
    ds_read_b64_tr_b16 v[166:167], v190 offset:9216
    buffer_load_dwordx4 v[160:163], v188, s[8:11], s24 offen offset:3072
    s_waitcnt lgkmcnt(10)
    v_mfma_f32_32x32x16_bf16 v[20:35], v[168:171], v[100:103], v[20:35]
    ds_read_b64_tr_b16 v[168:169], v190 offset:6656
    ds_read_b64_tr_b16 v[170:171], v190 offset:9728
    s_waitcnt lgkmcnt(10)
    v_mfma_f32_32x32x16_bf16 v[36:51], v[100:103], v[172:175], v[36:51]
    ds_read_b64_tr_b16 v[172:173], v190 offset:7168
    ds_read_b64_tr_b16 v[174:175], v190 offset:10240
    s_waitcnt lgkmcnt(10)
    v_mfma_f32_32x32x16_bf16 v[52:67], v[100:103], v[176:179], v[52:67]
    ds_read_b64_tr_b16 v[176:177], v190 offset:7680
    ds_read_b64_tr_b16 v[178:179], v190 offset:10752
    s_waitcnt lgkmcnt(10)
    v_mfma_f32_32x32x16_bf16 v[68:83], v[100:103], v[180:183], v[68:83]
    ds_read_b64_tr_b16 v[180:181], v190 offset:8192
    ds_read_b64_tr_b16 v[182:183], v190 offset:11264
    s_waitcnt lgkmcnt(10)
    v_mfma_f32_32x32x16_bf16 v[84:99], v[100:103], v[184:187], v[84:99]
    ds_read_b64_tr_b16 v[184:185], v190 offset:8704
    ds_read_b64_tr_b16 v[186:187], v190 offset:11776
    s_waitcnt lgkmcnt(10)
    v_mfma_f32_32x32x16_bf16 v[4:19], v[164:167], v[104:107], v[4:19]
    ds_read_b64_tr_b16 v[164:165], v190 offset:12288
    ds_read_b64_tr_b16 v[166:167], v190 offset:15360
    s_waitcnt lgkmcnt(10)
    v_mfma_f32_32x32x16_bf16 v[20:35], v[168:171], v[104:107], v[20:35]
    ds_read_b64_tr_b16 v[168:169], v190 offset:12800
    ds_read_b64_tr_b16 v[170:171], v190 offset:15872
    s_waitcnt lgkmcnt(10)
    v_mfma_f32_32x32x16_bf16 v[36:51], v[104:107], v[172:175], v[36:51]
    ds_read_b64_tr_b16 v[172:173], v190 offset:13312
    ds_read_b64_tr_b16 v[174:175], v190 offset:16384
    s_waitcnt lgkmcnt(10)
    v_mfma_f32_32x32x16_bf16 v[52:67], v[104:107], v[176:179], v[52:67]
    ds_read_b64_tr_b16 v[176:177], v190 offset:13824
    ds_read_b64_tr_b16 v[178:179], v190 offset:16896
    s_waitcnt lgkmcnt(10)
    v_mfma_f32_32x32x16_bf16 v[68:83], v[104:107], v[180:183], v[68:83]
    ds_read_b64_tr_b16 v[180:181], v190 offset:14336
    ds_read_b64_tr_b16 v[182:183], v190 offset:17408
    s_waitcnt lgkmcnt(10)
    v_mfma_f32_32x32x16_bf16 v[84:99], v[104:107], v[184:187], v[84:99]
    ds_read_b64_tr_b16 v[184:185], v190 offset:14848
    ds_read_b64_tr_b16 v[186:187], v190 offset:17920
    s_waitcnt lgkmcnt(10)
    v_mfma_f32_32x32x16_bf16 v[4:19], v[164:167], v[108:111], v[4:19]
    ds_read_b64_tr_b16 v[164:165], v190 offset:18432
    ds_read_b64_tr_b16 v[166:167], v190 offset:21504
    s_waitcnt lgkmcnt(10)
    v_mfma_f32_32x32x16_bf16 v[20:35], v[168:171], v[108:111], v[20:35]
    ds_read_b64_tr_b16 v[168:169], v190 offset:18944
    ds_read_b64_tr_b16 v[170:171], v190 offset:22016
    s_waitcnt lgkmcnt(10)
    v_mfma_f32_32x32x16_bf16 v[36:51], v[108:111], v[172:175], v[36:51]
    ds_read_b64_tr_b16 v[172:173], v190 offset:19456
    ds_read_b64_tr_b16 v[174:175], v190 offset:22528
    s_waitcnt lgkmcnt(10)
    v_mfma_f32_32x32x16_bf16 v[52:67], v[108:111], v[176:179], v[52:67]
    ds_read_b64_tr_b16 v[176:177], v190 offset:19968
    ds_read_b64_tr_b16 v[178:179], v190 offset:23040
    s_waitcnt lgkmcnt(10)
    v_mfma_f32_32x32x16_bf16 v[68:83], v[108:111], v[180:183], v[68:83]
    ds_read_b64_tr_b16 v[180:181], v190 offset:20480
    ds_read_b64_tr_b16 v[182:183], v190 offset:23552
    s_waitcnt lgkmcnt(10)
    v_mfma_f32_32x32x16_bf16 v[84:99], v[108:111], v[184:187], v[84:99]
    ds_read_b64_tr_b16 v[184:185], v190 offset:20992
    ds_read_b64_tr_b16 v[186:187], v190 offset:24064
    s_waitcnt lgkmcnt(10)
    s_waitcnt vmcnt(30)
    v_mfma_f32_32x32x16_bf16 v[4:19], v[164:167], v[112:115], v[4:19]
    s_waitcnt lgkmcnt(8)
    v_mfma_f32_32x32x16_bf16 v[20:35], v[168:171], v[112:115], v[20:35]
    s_waitcnt vmcnt(21)
    s_barrier
    v_add_u32 v190, 73728, v189
    ds_read_b64_tr_b16 v[164:165], v190 offset:0
    ds_read_b64_tr_b16 v[166:167], v190 offset:3072
    ds_read_b64_tr_b16 v[168:169], v190 offset:512
    ds_read_b64_tr_b16 v[170:171], v190 offset:3584
    s_waitcnt lgkmcnt(10)
    v_mfma_f32_32x32x16_bf16 v[36:51], v[112:115], v[172:175], v[36:51]
    ds_read_b64_tr_b16 v[172:173], v190 offset:1024
    ds_read_b64_tr_b16 v[174:175], v190 offset:4096
    s_waitcnt lgkmcnt(10)
    v_mfma_f32_32x32x16_bf16 v[52:67], v[112:115], v[176:179], v[52:67]
    ds_read_b64_tr_b16 v[176:177], v190 offset:1536
    ds_read_b64_tr_b16 v[178:179], v190 offset:4608
    s_waitcnt lgkmcnt(10)
    v_mfma_f32_32x32x16_bf16 v[68:83], v[112:115], v[180:183], v[68:83]
    ds_read_b64_tr_b16 v[180:181], v190 offset:2048
    ds_read_b64_tr_b16 v[182:183], v190 offset:5120
    s_waitcnt lgkmcnt(10)
    v_mfma_f32_32x32x16_bf16 v[84:99], v[112:115], v[184:187], v[84:99]
    ds_read_b64_tr_b16 v[184:185], v190 offset:2560
    ds_read_b64_tr_b16 v[186:187], v190 offset:5632
    s_waitcnt lgkmcnt(10)
    v_mfma_f32_32x32x16_bf16 v[4:19], v[164:167], v[116:119], v[4:19]
    ds_read_b64_tr_b16 v[164:165], v190 offset:6144
    ds_read_b64_tr_b16 v[166:167], v190 offset:9216
    s_waitcnt lgkmcnt(10)
    v_mfma_f32_32x32x16_bf16 v[20:35], v[168:171], v[116:119], v[20:35]
    ds_read_b64_tr_b16 v[168:169], v190 offset:6656
    ds_read_b64_tr_b16 v[170:171], v190 offset:9728
    s_waitcnt lgkmcnt(10)
    v_mfma_f32_32x32x16_bf16 v[36:51], v[116:119], v[172:175], v[36:51]
    ds_read_b64_tr_b16 v[172:173], v190 offset:7168
    ds_read_b64_tr_b16 v[174:175], v190 offset:10240
    s_waitcnt lgkmcnt(10)
    v_mfma_f32_32x32x16_bf16 v[52:67], v[116:119], v[176:179], v[52:67]
    ds_read_b64_tr_b16 v[176:177], v190 offset:7680
    ds_read_b64_tr_b16 v[178:179], v190 offset:10752
    s_waitcnt lgkmcnt(10)
    v_mfma_f32_32x32x16_bf16 v[68:83], v[116:119], v[180:183], v[68:83]
    ds_read_b64_tr_b16 v[180:181], v190 offset:8192
    ds_read_b64_tr_b16 v[182:183], v190 offset:11264
    s_waitcnt lgkmcnt(10)
    v_mfma_f32_32x32x16_bf16 v[84:99], v[116:119], v[184:187], v[84:99]
    ds_read_b64_tr_b16 v[184:185], v190 offset:8704
    ds_read_b64_tr_b16 v[186:187], v190 offset:11776
    s_waitcnt lgkmcnt(10)
    v_mfma_f32_32x32x16_bf16 v[4:19], v[164:167], v[120:123], v[4:19]
    ds_read_b64_tr_b16 v[164:165], v190 offset:12288
    ds_read_b64_tr_b16 v[166:167], v190 offset:15360
    s_waitcnt lgkmcnt(10)
    v_mfma_f32_32x32x16_bf16 v[20:35], v[168:171], v[120:123], v[20:35]
    ds_read_b64_tr_b16 v[168:169], v190 offset:12800
    ds_read_b64_tr_b16 v[170:171], v190 offset:15872
    s_waitcnt lgkmcnt(10)
    v_mfma_f32_32x32x16_bf16 v[36:51], v[120:123], v[172:175], v[36:51]
    ds_read_b64_tr_b16 v[172:173], v190 offset:13312
    ds_read_b64_tr_b16 v[174:175], v190 offset:16384
    s_waitcnt lgkmcnt(10)
    v_mfma_f32_32x32x16_bf16 v[52:67], v[120:123], v[176:179], v[52:67]
    ds_read_b64_tr_b16 v[176:177], v190 offset:13824
    ds_read_b64_tr_b16 v[178:179], v190 offset:16896
    s_waitcnt lgkmcnt(10)
    v_mfma_f32_32x32x16_bf16 v[68:83], v[120:123], v[180:183], v[68:83]
    ds_read_b64_tr_b16 v[180:181], v190 offset:14336
    ds_read_b64_tr_b16 v[182:183], v190 offset:17408
    s_waitcnt lgkmcnt(10)
    v_mfma_f32_32x32x16_bf16 v[84:99], v[120:123], v[184:187], v[84:99]
    ds_read_b64_tr_b16 v[184:185], v190 offset:14848
    ds_read_b64_tr_b16 v[186:187], v190 offset:17920
    s_waitcnt lgkmcnt(10)
    v_mfma_f32_32x32x16_bf16 v[4:19], v[164:167], v[124:127], v[4:19]
    ds_read_b64_tr_b16 v[164:165], v190 offset:18432
    ds_read_b64_tr_b16 v[166:167], v190 offset:21504
    s_waitcnt lgkmcnt(10)
    v_mfma_f32_32x32x16_bf16 v[20:35], v[168:171], v[124:127], v[20:35]
    ds_read_b64_tr_b16 v[168:169], v190 offset:18944
    ds_read_b64_tr_b16 v[170:171], v190 offset:22016
    s_waitcnt lgkmcnt(10)
    v_mfma_f32_32x32x16_bf16 v[36:51], v[124:127], v[172:175], v[36:51]
    ds_read_b64_tr_b16 v[172:173], v190 offset:19456
    ds_read_b64_tr_b16 v[174:175], v190 offset:22528
    s_waitcnt lgkmcnt(10)
    v_mfma_f32_32x32x16_bf16 v[52:67], v[124:127], v[176:179], v[52:67]
    ds_read_b64_tr_b16 v[176:177], v190 offset:19968
    ds_read_b64_tr_b16 v[178:179], v190 offset:23040
    s_waitcnt lgkmcnt(10)
    v_mfma_f32_32x32x16_bf16 v[68:83], v[124:127], v[180:183], v[68:83]
    ds_read_b64_tr_b16 v[180:181], v190 offset:20480
    ds_read_b64_tr_b16 v[182:183], v190 offset:23552
    s_waitcnt lgkmcnt(10)
    v_mfma_f32_32x32x16_bf16 v[84:99], v[124:127], v[184:187], v[84:99]
    ds_read_b64_tr_b16 v[184:185], v190 offset:20992
    ds_read_b64_tr_b16 v[186:187], v190 offset:24064
    s_waitcnt lgkmcnt(10)
    s_waitcnt vmcnt(20)
    v_mfma_f32_32x32x16_bf16 v[4:19], v[164:167], v[128:131], v[4:19]
    s_waitcnt lgkmcnt(8)
    v_mfma_f32_32x32x16_bf16 v[20:35], v[168:171], v[128:131], v[20:35]
    s_waitcnt vmcnt(11)
    s_barrier
    v_add_u32 v190, 98304, v189
    ds_read_b64_tr_b16 v[164:165], v190 offset:0
    ds_read_b64_tr_b16 v[166:167], v190 offset:3072
    ds_read_b64_tr_b16 v[168:169], v190 offset:512
    ds_read_b64_tr_b16 v[170:171], v190 offset:3584
    s_waitcnt lgkmcnt(10)
    v_mfma_f32_32x32x16_bf16 v[36:51], v[128:131], v[172:175], v[36:51]
    ds_read_b64_tr_b16 v[172:173], v190 offset:1024
    ds_read_b64_tr_b16 v[174:175], v190 offset:4096
    s_waitcnt lgkmcnt(10)
    v_mfma_f32_32x32x16_bf16 v[52:67], v[128:131], v[176:179], v[52:67]
    ds_read_b64_tr_b16 v[176:177], v190 offset:1536
    ds_read_b64_tr_b16 v[178:179], v190 offset:4608
    s_waitcnt lgkmcnt(10)
    v_mfma_f32_32x32x16_bf16 v[68:83], v[128:131], v[180:183], v[68:83]
    ds_read_b64_tr_b16 v[180:181], v190 offset:2048
    ds_read_b64_tr_b16 v[182:183], v190 offset:5120
    s_waitcnt lgkmcnt(10)
    v_mfma_f32_32x32x16_bf16 v[84:99], v[128:131], v[184:187], v[84:99]
    ds_read_b64_tr_b16 v[184:185], v190 offset:2560
    ds_read_b64_tr_b16 v[186:187], v190 offset:5632
    s_waitcnt lgkmcnt(10)
    v_mfma_f32_32x32x16_bf16 v[4:19], v[164:167], v[132:135], v[4:19]
    ds_read_b64_tr_b16 v[164:165], v190 offset:6144
    ds_read_b64_tr_b16 v[166:167], v190 offset:9216
    s_waitcnt lgkmcnt(10)
    v_mfma_f32_32x32x16_bf16 v[20:35], v[168:171], v[132:135], v[20:35]
    ds_read_b64_tr_b16 v[168:169], v190 offset:6656
    ds_read_b64_tr_b16 v[170:171], v190 offset:9728
    s_waitcnt lgkmcnt(10)
    v_mfma_f32_32x32x16_bf16 v[36:51], v[132:135], v[172:175], v[36:51]
    ds_read_b64_tr_b16 v[172:173], v190 offset:7168
    ds_read_b64_tr_b16 v[174:175], v190 offset:10240
    s_waitcnt lgkmcnt(10)
    v_mfma_f32_32x32x16_bf16 v[52:67], v[132:135], v[176:179], v[52:67]
    ds_read_b64_tr_b16 v[176:177], v190 offset:7680
    ds_read_b64_tr_b16 v[178:179], v190 offset:10752
    s_waitcnt lgkmcnt(10)
    v_mfma_f32_32x32x16_bf16 v[68:83], v[132:135], v[180:183], v[68:83]
    ds_read_b64_tr_b16 v[180:181], v190 offset:8192
    ds_read_b64_tr_b16 v[182:183], v190 offset:11264
    s_waitcnt lgkmcnt(10)
    v_mfma_f32_32x32x16_bf16 v[84:99], v[132:135], v[184:187], v[84:99]
    ds_read_b64_tr_b16 v[184:185], v190 offset:8704
    ds_read_b64_tr_b16 v[186:187], v190 offset:11776
    s_waitcnt lgkmcnt(10)
    v_mfma_f32_32x32x16_bf16 v[4:19], v[164:167], v[136:139], v[4:19]
    ds_read_b64_tr_b16 v[164:165], v190 offset:12288
    ds_read_b64_tr_b16 v[166:167], v190 offset:15360
    s_waitcnt lgkmcnt(10)
    v_mfma_f32_32x32x16_bf16 v[20:35], v[168:171], v[136:139], v[20:35]
    ds_read_b64_tr_b16 v[168:169], v190 offset:12800
    ds_read_b64_tr_b16 v[170:171], v190 offset:15872
    s_waitcnt lgkmcnt(10)
    v_mfma_f32_32x32x16_bf16 v[36:51], v[136:139], v[172:175], v[36:51]
    ds_read_b64_tr_b16 v[172:173], v190 offset:13312
    ds_read_b64_tr_b16 v[174:175], v190 offset:16384
    s_waitcnt lgkmcnt(10)
    v_mfma_f32_32x32x16_bf16 v[52:67], v[136:139], v[176:179], v[52:67]
    ds_read_b64_tr_b16 v[176:177], v190 offset:13824
    ds_read_b64_tr_b16 v[178:179], v190 offset:16896
    s_waitcnt lgkmcnt(10)
    v_mfma_f32_32x32x16_bf16 v[68:83], v[136:139], v[180:183], v[68:83]
    ds_read_b64_tr_b16 v[180:181], v190 offset:14336
    ds_read_b64_tr_b16 v[182:183], v190 offset:17408
    s_waitcnt lgkmcnt(10)
    v_mfma_f32_32x32x16_bf16 v[84:99], v[136:139], v[184:187], v[84:99]
    ds_read_b64_tr_b16 v[184:185], v190 offset:14848
    ds_read_b64_tr_b16 v[186:187], v190 offset:17920
    s_waitcnt lgkmcnt(10)
    v_mfma_f32_32x32x16_bf16 v[4:19], v[164:167], v[140:143], v[4:19]
    ds_read_b64_tr_b16 v[164:165], v190 offset:18432
    ds_read_b64_tr_b16 v[166:167], v190 offset:21504
    s_waitcnt lgkmcnt(10)
    v_mfma_f32_32x32x16_bf16 v[20:35], v[168:171], v[140:143], v[20:35]
    ds_read_b64_tr_b16 v[168:169], v190 offset:18944
    ds_read_b64_tr_b16 v[170:171], v190 offset:22016
    s_waitcnt lgkmcnt(10)
    v_mfma_f32_32x32x16_bf16 v[36:51], v[140:143], v[172:175], v[36:51]
    ds_read_b64_tr_b16 v[172:173], v190 offset:19456
    ds_read_b64_tr_b16 v[174:175], v190 offset:22528
    s_waitcnt lgkmcnt(10)
    v_mfma_f32_32x32x16_bf16 v[52:67], v[140:143], v[176:179], v[52:67]
    ds_read_b64_tr_b16 v[176:177], v190 offset:19968
    ds_read_b64_tr_b16 v[178:179], v190 offset:23040
    s_waitcnt lgkmcnt(10)
    v_mfma_f32_32x32x16_bf16 v[68:83], v[140:143], v[180:183], v[68:83]
    ds_read_b64_tr_b16 v[180:181], v190 offset:20480
    ds_read_b64_tr_b16 v[182:183], v190 offset:23552
    s_waitcnt lgkmcnt(10)
    v_mfma_f32_32x32x16_bf16 v[84:99], v[140:143], v[184:187], v[84:99]
    ds_read_b64_tr_b16 v[184:185], v190 offset:20992
    ds_read_b64_tr_b16 v[186:187], v190 offset:24064
    s_waitcnt lgkmcnt(10)
    s_waitcnt vmcnt(10)
    v_mfma_f32_32x32x16_bf16 v[4:19], v[164:167], v[144:147], v[4:19]
    s_waitcnt lgkmcnt(8)
    v_mfma_f32_32x32x16_bf16 v[20:35], v[168:171], v[144:147], v[20:35]
    s_waitcnt vmcnt(1)
    s_barrier
    v_add_u32 v190, 0, v189
    ds_read_b64_tr_b16 v[164:165], v190 offset:0
    ds_read_b64_tr_b16 v[166:167], v190 offset:3072
    ds_read_b64_tr_b16 v[168:169], v190 offset:512
    ds_read_b64_tr_b16 v[170:171], v190 offset:3584
    s_waitcnt lgkmcnt(10)
    v_mfma_f32_32x32x16_bf16 v[36:51], v[144:147], v[172:175], v[36:51]
    ds_read_b64_tr_b16 v[172:173], v190 offset:1024
    ds_read_b64_tr_b16 v[174:175], v190 offset:4096
    s_waitcnt lgkmcnt(10)
    v_mfma_f32_32x32x16_bf16 v[52:67], v[144:147], v[176:179], v[52:67]
    ds_read_b64_tr_b16 v[176:177], v190 offset:1536
    ds_read_b64_tr_b16 v[178:179], v190 offset:4608
    s_waitcnt lgkmcnt(10)
    v_mfma_f32_32x32x16_bf16 v[68:83], v[144:147], v[180:183], v[68:83]
    ds_read_b64_tr_b16 v[180:181], v190 offset:2048
    ds_read_b64_tr_b16 v[182:183], v190 offset:5120
    s_waitcnt lgkmcnt(10)
    v_mfma_f32_32x32x16_bf16 v[84:99], v[144:147], v[184:187], v[84:99]
    ds_read_b64_tr_b16 v[184:185], v190 offset:2560
    ds_read_b64_tr_b16 v[186:187], v190 offset:5632
    s_waitcnt lgkmcnt(10)
    v_mfma_f32_32x32x16_bf16 v[4:19], v[164:167], v[148:151], v[4:19]
    ds_read_b64_tr_b16 v[164:165], v190 offset:6144
    ds_read_b64_tr_b16 v[166:167], v190 offset:9216
    s_waitcnt lgkmcnt(10)
    v_mfma_f32_32x32x16_bf16 v[20:35], v[168:171], v[148:151], v[20:35]
    ds_read_b64_tr_b16 v[168:169], v190 offset:6656
    ds_read_b64_tr_b16 v[170:171], v190 offset:9728
    s_waitcnt lgkmcnt(10)
    v_mfma_f32_32x32x16_bf16 v[36:51], v[148:151], v[172:175], v[36:51]
    ds_read_b64_tr_b16 v[172:173], v190 offset:7168
    ds_read_b64_tr_b16 v[174:175], v190 offset:10240
    s_waitcnt lgkmcnt(10)
    v_mfma_f32_32x32x16_bf16 v[52:67], v[148:151], v[176:179], v[52:67]
    ds_read_b64_tr_b16 v[176:177], v190 offset:7680
    ds_read_b64_tr_b16 v[178:179], v190 offset:10752
    s_waitcnt lgkmcnt(10)
    v_mfma_f32_32x32x16_bf16 v[68:83], v[148:151], v[180:183], v[68:83]
    ds_read_b64_tr_b16 v[180:181], v190 offset:8192
    ds_read_b64_tr_b16 v[182:183], v190 offset:11264
    s_waitcnt lgkmcnt(10)
    v_mfma_f32_32x32x16_bf16 v[84:99], v[148:151], v[184:187], v[84:99]
    ds_read_b64_tr_b16 v[184:185], v190 offset:8704
    ds_read_b64_tr_b16 v[186:187], v190 offset:11776
    s_waitcnt lgkmcnt(10)
    v_mfma_f32_32x32x16_bf16 v[4:19], v[164:167], v[152:155], v[4:19]
    ds_read_b64_tr_b16 v[164:165], v190 offset:12288
    ds_read_b64_tr_b16 v[166:167], v190 offset:15360
    s_waitcnt lgkmcnt(10)
    v_mfma_f32_32x32x16_bf16 v[20:35], v[168:171], v[152:155], v[20:35]
    ds_read_b64_tr_b16 v[168:169], v190 offset:12800
    ds_read_b64_tr_b16 v[170:171], v190 offset:15872
    s_waitcnt lgkmcnt(10)
    v_mfma_f32_32x32x16_bf16 v[36:51], v[152:155], v[172:175], v[36:51]
    ds_read_b64_tr_b16 v[172:173], v190 offset:13312
    ds_read_b64_tr_b16 v[174:175], v190 offset:16384
    s_waitcnt lgkmcnt(10)
    v_mfma_f32_32x32x16_bf16 v[52:67], v[152:155], v[176:179], v[52:67]
    ds_read_b64_tr_b16 v[176:177], v190 offset:13824
    ds_read_b64_tr_b16 v[178:179], v190 offset:16896
    s_waitcnt lgkmcnt(10)
    v_mfma_f32_32x32x16_bf16 v[68:83], v[152:155], v[180:183], v[68:83]
    ds_read_b64_tr_b16 v[180:181], v190 offset:14336
    ds_read_b64_tr_b16 v[182:183], v190 offset:17408
    s_waitcnt lgkmcnt(10)
    v_mfma_f32_32x32x16_bf16 v[84:99], v[152:155], v[184:187], v[84:99]
    ds_read_b64_tr_b16 v[184:185], v190 offset:14848
    ds_read_b64_tr_b16 v[186:187], v190 offset:17920
    s_waitcnt lgkmcnt(10)
    v_mfma_f32_32x32x16_bf16 v[4:19], v[164:167], v[156:159], v[4:19]
    ds_read_b64_tr_b16 v[164:165], v190 offset:18432
    ds_read_b64_tr_b16 v[166:167], v190 offset:21504
    s_waitcnt lgkmcnt(10)
    v_mfma_f32_32x32x16_bf16 v[20:35], v[168:171], v[156:159], v[20:35]
    ds_read_b64_tr_b16 v[168:169], v190 offset:18944
    ds_read_b64_tr_b16 v[170:171], v190 offset:22016
    s_waitcnt lgkmcnt(10)
    v_mfma_f32_32x32x16_bf16 v[36:51], v[156:159], v[172:175], v[36:51]
    ds_read_b64_tr_b16 v[172:173], v190 offset:19456
    ds_read_b64_tr_b16 v[174:175], v190 offset:22528
    s_waitcnt lgkmcnt(10)
    v_mfma_f32_32x32x16_bf16 v[52:67], v[156:159], v[176:179], v[52:67]
    ds_read_b64_tr_b16 v[176:177], v190 offset:19968
    ds_read_b64_tr_b16 v[178:179], v190 offset:23040
    s_waitcnt lgkmcnt(10)
    v_mfma_f32_32x32x16_bf16 v[68:83], v[156:159], v[180:183], v[68:83]
    ds_read_b64_tr_b16 v[180:181], v190 offset:20480
    ds_read_b64_tr_b16 v[182:183], v190 offset:23552
    s_waitcnt lgkmcnt(10)
    v_mfma_f32_32x32x16_bf16 v[84:99], v[156:159], v[184:187], v[84:99]
    ds_read_b64_tr_b16 v[184:185], v190 offset:20992
    ds_read_b64_tr_b16 v[186:187], v190 offset:24064
    s_waitcnt lgkmcnt(10)
    s_waitcnt vmcnt(0)
    v_mfma_f32_32x32x16_bf16 v[4:19], v[164:167], v[160:163], v[4:19]
    s_waitcnt lgkmcnt(8)
    v_mfma_f32_32x32x16_bf16 v[20:35], v[168:171], v[160:163], v[20:35]
    s_waitcnt lgkmcnt(6)
    v_mfma_f32_32x32x16_bf16 v[36:51], v[160:163], v[172:175], v[36:51]
    s_waitcnt lgkmcnt(4)
    v_mfma_f32_32x32x16_bf16 v[52:67], v[160:163], v[176:179], v[52:67]
    s_waitcnt lgkmcnt(2)
    v_mfma_f32_32x32x16_bf16 v[68:83], v[160:163], v[180:183], v[68:83]
    s_waitcnt lgkmcnt(0)
    v_mfma_f32_32x32x16_bf16 v[84:99], v[160:163], v[184:187], v[84:99]
    s_waitcnt vmcnt(0) lgkmcnt(0)
    s_nop 15
    s_add_u32 s36, s6, 16777216
    s_addc_u32 s37, s7, 0
    s_mov_b32 s38, 4194304
    s_mov_b32 s39, 0x00020000
    s_add_u32 s40, s6, 12582912
    s_addc_u32 s41, s7, 0
    s_mov_b32 s42, 2097152
    s_mov_b32 s43, 0x00020000
    s_add_u32 s44, s6, 14680064
    s_addc_u32 s45, s7, 0
    s_mov_b32 s46, 65536
    s_mov_b32 s47, 0x00020000
    s_mov_b32 s48, 0x3fb8aa3b
    s_mov_b32 s50, 0x358637bd
    s_mov_b32 s49, 0x3fb8aa3b
    s_mov_b32 s51, 0x358637bd
    v_pk_mul_f32 v[198:199], v[36:37], s[48:49]
    v_pk_add_f32 v[36:37], v[36:37], s[50:51]
    v_min_f32 v198, 0, v198
    v_min_f32 v199, 0, v199
    v_exp_f32 v198, v198
    v_exp_f32 v199, v199
    v_max_f32 v36, s50, v36
    v_max_f32 v37, s50, v37
    v_pk_add_f32 v[36:37], v[36:37], v[198:199]
    v_pk_mul_f32 v[200:201], v[38:39], s[48:49]
    v_pk_add_f32 v[38:39], v[38:39], s[50:51]
    v_min_f32 v200, 0, v200
    v_min_f32 v201, 0, v201
    v_exp_f32 v200, v200
    v_exp_f32 v201, v201
    v_max_f32 v38, s50, v38
    v_max_f32 v39, s50, v39
    v_pk_add_f32 v[38:39], v[38:39], v[200:201]
    v_pk_mul_f32 v[198:199], v[40:41], s[48:49]
    v_pk_add_f32 v[40:41], v[40:41], s[50:51]
    v_min_f32 v198, 0, v198
    v_min_f32 v199, 0, v199
    v_exp_f32 v198, v198
    v_exp_f32 v199, v199
    v_max_f32 v40, s50, v40
    v_max_f32 v41, s50, v41
    v_pk_add_f32 v[40:41], v[40:41], v[198:199]
    v_pk_mul_f32 v[200:201], v[42:43], s[48:49]
    v_pk_add_f32 v[42:43], v[42:43], s[50:51]
    v_min_f32 v200, 0, v200
    v_min_f32 v201, 0, v201
    v_exp_f32 v200, v200
    v_exp_f32 v201, v201
    v_max_f32 v42, s50, v42
    v_max_f32 v43, s50, v43
    v_pk_add_f32 v[42:43], v[42:43], v[200:201]
    v_pk_mul_f32 v[198:199], v[44:45], s[48:49]
    v_pk_add_f32 v[44:45], v[44:45], s[50:51]
    v_min_f32 v198, 0, v198
    v_min_f32 v199, 0, v199
    v_exp_f32 v198, v198
    v_exp_f32 v199, v199
    v_max_f32 v44, s50, v44
    v_max_f32 v45, s50, v45
    v_pk_add_f32 v[44:45], v[44:45], v[198:199]
    v_pk_mul_f32 v[200:201], v[46:47], s[48:49]
    v_pk_add_f32 v[46:47], v[46:47], s[50:51]
    v_min_f32 v200, 0, v200
    v_min_f32 v201, 0, v201
    v_exp_f32 v200, v200
    v_exp_f32 v201, v201
    v_max_f32 v46, s50, v46
    v_max_f32 v47, s50, v47
    v_pk_add_f32 v[46:47], v[46:47], v[200:201]
    v_pk_mul_f32 v[198:199], v[48:49], s[48:49]
    v_pk_add_f32 v[48:49], v[48:49], s[50:51]
    v_min_f32 v198, 0, v198
    v_min_f32 v199, 0, v199
    v_exp_f32 v198, v198
    v_exp_f32 v199, v199
    v_max_f32 v48, s50, v48
    v_max_f32 v49, s50, v49
    v_pk_add_f32 v[48:49], v[48:49], v[198:199]
    v_pk_mul_f32 v[200:201], v[50:51], s[48:49]
    v_pk_add_f32 v[50:51], v[50:51], s[50:51]
    v_min_f32 v200, 0, v200
    v_min_f32 v201, 0, v201
    v_exp_f32 v200, v200
    v_exp_f32 v201, v201
    v_max_f32 v50, s50, v50
    v_max_f32 v51, s50, v51
    v_pk_add_f32 v[50:51], v[50:51], v[200:201]
    v_pk_mul_f32 v[198:199], v[52:53], s[48:49]
    v_pk_add_f32 v[52:53], v[52:53], s[50:51]
    v_min_f32 v198, 0, v198
    v_min_f32 v199, 0, v199
    v_exp_f32 v198, v198
    v_exp_f32 v199, v199
    v_max_f32 v52, s50, v52
    v_max_f32 v53, s50, v53
    v_pk_add_f32 v[52:53], v[52:53], v[198:199]
    v_pk_mul_f32 v[200:201], v[54:55], s[48:49]
    v_pk_add_f32 v[54:55], v[54:55], s[50:51]
    v_min_f32 v200, 0, v200
    v_min_f32 v201, 0, v201
    v_exp_f32 v200, v200
    v_exp_f32 v201, v201
    v_max_f32 v54, s50, v54
    v_max_f32 v55, s50, v55
    v_pk_add_f32 v[54:55], v[54:55], v[200:201]
    v_pk_mul_f32 v[198:199], v[56:57], s[48:49]
    v_pk_add_f32 v[56:57], v[56:57], s[50:51]
    v_min_f32 v198, 0, v198
    v_min_f32 v199, 0, v199
    v_exp_f32 v198, v198
    v_exp_f32 v199, v199
    v_max_f32 v56, s50, v56
    v_max_f32 v57, s50, v57
    v_pk_add_f32 v[56:57], v[56:57], v[198:199]
    v_pk_mul_f32 v[200:201], v[58:59], s[48:49]
    v_pk_add_f32 v[58:59], v[58:59], s[50:51]
    v_min_f32 v200, 0, v200
    v_min_f32 v201, 0, v201
    v_exp_f32 v200, v200
    v_exp_f32 v201, v201
    v_max_f32 v58, s50, v58
    v_max_f32 v59, s50, v59
    v_pk_add_f32 v[58:59], v[58:59], v[200:201]
    v_pk_mul_f32 v[198:199], v[60:61], s[48:49]
    v_pk_add_f32 v[60:61], v[60:61], s[50:51]
    v_min_f32 v198, 0, v198
    v_min_f32 v199, 0, v199
    v_exp_f32 v198, v198
    v_exp_f32 v199, v199
    v_max_f32 v60, s50, v60
    v_max_f32 v61, s50, v61
    v_pk_add_f32 v[60:61], v[60:61], v[198:199]
    v_pk_mul_f32 v[200:201], v[62:63], s[48:49]
    v_pk_add_f32 v[62:63], v[62:63], s[50:51]
    v_min_f32 v200, 0, v200
    v_min_f32 v201, 0, v201
    v_exp_f32 v200, v200
    v_exp_f32 v201, v201
    v_max_f32 v62, s50, v62
    v_max_f32 v63, s50, v63
    v_pk_add_f32 v[62:63], v[62:63], v[200:201]
    v_pk_mul_f32 v[198:199], v[64:65], s[48:49]
    v_pk_add_f32 v[64:65], v[64:65], s[50:51]
    v_min_f32 v198, 0, v198
    v_min_f32 v199, 0, v199
    v_exp_f32 v198, v198
    v_exp_f32 v199, v199
    v_max_f32 v64, s50, v64
    v_max_f32 v65, s50, v65
    v_pk_add_f32 v[64:65], v[64:65], v[198:199]
    v_pk_mul_f32 v[200:201], v[66:67], s[48:49]
    v_pk_add_f32 v[66:67], v[66:67], s[50:51]
    v_min_f32 v200, 0, v200
    v_min_f32 v201, 0, v201
    v_exp_f32 v200, v200
    v_exp_f32 v201, v201
    v_max_f32 v66, s50, v66
    v_max_f32 v67, s50, v67
    v_pk_add_f32 v[66:67], v[66:67], v[200:201]
    v_cvt_pk_bf16_f32 v100, v36, v37
    v_cvt_pk_bf16_f32 v101, v38, v39
    v_cvt_pk_bf16_f32 v102, v40, v41
    v_cvt_pk_bf16_f32 v103, v42, v43
    v_cvt_pk_bf16_f32 v104, v44, v45
    v_cvt_pk_bf16_f32 v105, v46, v47
    v_cvt_pk_bf16_f32 v106, v48, v49
    v_cvt_pk_bf16_f32 v107, v50, v51
    v_cvt_pk_bf16_f32 v108, v52, v53
    v_cvt_pk_bf16_f32 v109, v54, v55
    v_cvt_pk_bf16_f32 v110, v56, v57
    v_cvt_pk_bf16_f32 v111, v58, v59
    v_cvt_pk_bf16_f32 v112, v60, v61
    v_cvt_pk_bf16_f32 v113, v62, v63
    v_cvt_pk_bf16_f32 v114, v64, v65
    v_cvt_pk_bf16_f32 v115, v66, v67
    v_cvt_pk_bf16_f32 v116, v68, v69
    v_cvt_pk_bf16_f32 v117, v70, v71
    v_cvt_pk_bf16_f32 v118, v72, v73
    v_cvt_pk_bf16_f32 v119, v74, v75
    v_cvt_pk_bf16_f32 v120, v76, v77
    v_cvt_pk_bf16_f32 v121, v78, v79
    v_cvt_pk_bf16_f32 v122, v80, v81
    v_cvt_pk_bf16_f32 v123, v82, v83
    v_cvt_pk_bf16_f32 v124, v84, v85
    v_cvt_pk_bf16_f32 v125, v86, v87
    v_cvt_pk_bf16_f32 v126, v88, v89
    v_cvt_pk_bf16_f32 v127, v90, v91
    v_cvt_pk_bf16_f32 v128, v92, v93
    v_cvt_pk_bf16_f32 v129, v94, v95
    v_cvt_pk_bf16_f32 v130, v96, v97
    v_cvt_pk_bf16_f32 v131, v98, v99
    v_mov_b32 v132, 0x3f803f80
    v_mov_b32 v133, 0x3f803f80
    v_mov_b32 v134, 0x3f803f80
    v_mov_b32 v135, 0x3f803f80
    s_nop 1
    v_mfma_f32_32x32x16_bf16 v[36:51], v[100:103], v[116:119], 0
    v_mfma_f32_32x32x16_bf16 v[68:83], v[100:103], v[132:135], 0
    v_mfma_f32_32x32x16_bf16 v[52:67], v[108:111], v[124:127], 0
    v_mfma_f32_32x32x16_bf16 v[84:99], v[108:111], v[132:135], 0
    v_mfma_f32_32x32x16_bf16 v[36:51], v[104:107], v[120:123], v[36:51]
    v_mfma_f32_32x32x16_bf16 v[68:83], v[104:107], v[132:135], v[68:83]
    v_mfma_f32_32x32x16_bf16 v[52:67], v[112:115], v[128:131], v[52:67]
    v_mfma_f32_32x32x16_bf16 v[84:99], v[112:115], v[132:135], v[84:99]
    s_barrier
    v_lshlrev_b32 v220, 4, v2
    s_lshl_b32 s16, s3, 14
    v_add_u32 v221, s16, v220
    s_lshl_b32 s16, s21, 13
    s_and_b32 s17, s3, 1
    s_lshl_b32 s17, s17, 12
    s_add_u32 s16, s16, s17
    s_lshr_b32 s17, s3, 1
    s_lshl_b32 s17, s17, 10
    s_add_u32 s16, s16, s17
    v_add_u32 v222, s16, v220
    v_add_u32 v223, 4096, v222
    v_lshrrev_b32 v224, 2, v2
    v_lshlrev_b32 v224, 12, v224
    v_and_b32 v3, 3, v2
    v_lshl_add_u32 v224, v3, 4, v224
    s_and_b32 s18, s3, 1
    s_lshr_b32 s19, s3, 1
    s_lshl_b32 s16, s21, 8
    s_lshl_b32 s17, s18, 7
    s_add_u32 s16, s16, s17
    s_lshl_b32 s17, s19, 6
    s_add_u32 s16, s16, s17
    v_add_u32 v224, s16, v224
    s_lshl_b32 s16, s19, 10
    s_lshl_b32 s17, s18, 11
    s_add_u32 s16, s16, s17
    s_add_u32 s16, s16, 65536
    v_add_u32 v225, s16, v220
    s_lshl_b32 s16, s18, 6
    s_lshl_b32 s17, s19, 5
    s_add_u32 s16, s16, s17
    s_add_u32 s16, s16, 69632
    v_lshl_add_u32 v226, v3, 3, s16
    v_lshrrev_b32 v227, 5, v2
    v_lshlrev_b32 v227, 5, v227
    v_add_u32 v227, 69632, v227
    ds_write_b128 v221, v[36:39] offset:0
    ds_write_b128 v221, v[40:43] offset:1024
    ds_write_b128 v221, v[44:47] offset:2048
    ds_write_b128 v221, v[48:51] offset:3072
    ds_write_b128 v221, v[52:55] offset:4096
    ds_write_b128 v221, v[56:59] offset:5120
    ds_write_b128 v221, v[60:63] offset:6144
    ds_write_b128 v221, v[64:67] offset:7168
    s_lshl_b32 s16, s3, 8
    s_add_u32 s16, s16, 8192
    v_lshl_add_u32 v221, v2, 1, s16
    s_mov_b32 exec_lo, 1
    s_mov_b32 exec_hi, 1
    ds_write_b128 v221, v[68:71] offset:0
    ds_write_b128 v221, v[72:75] offset:16
    ds_write_b128 v221, v[76:79] offset:32
    ds_write_b128 v221, v[80:83] offset:48
    ds_write_b128 v221, v[84:87] offset:128
    ds_write_b128 v221, v[88:91] offset:144
    ds_write_b128 v221, v[92:95] offset:160
    ds_write_b128 v221, v[96:99] offset:176
    s_mov_b64 exec, -1
    s_lshl_b32 s16, s18, 12
    s_lshl_b32 s17, s19, 11
    s_add_u32 s16, s16, s17
    v_add_u32 v221, s16, v220
    v_lshlrev_b32 v198, 2, v2
    s_waitcnt lgkmcnt(0)
    s_barrier
    ds_read_b128 v[36:39], v221 offset:0
    ds_read_b128 v[40:43], v221 offset:1024
    ds_read_b128 v[52:55], v221 offset:16384
    ds_read_b128 v[56:59], v221 offset:17408
    ds_read_b128 v[68:71], v221 offset:32768
    ds_read_b128 v[72:75], v221 offset:33792
    ds_read_b128 v[84:87], v221 offset:49152
    ds_read_b128 v[88:91], v221 offset:50176
    ds_read_b32 v44, v198 offset:8192
    ds_read_b32 v60, v198 offset:8448
    ds_read_b32 v76, v198 offset:8704
    ds_read_b32 v92, v198 offset:8960
    s_lshl_b32 s17, s21, 1
    s_lshl_b32 s16, s20, 5
    s_add_u32 s17, s16, s17
    s_add_u32 s16, s17, s18
    s_lshl_b32 s16, s16, 12
    s_lshl_b32 s31, s19, 10
    s_add_u32 s16, s16, s31
    s_lshl_b32 s17, s17, 7
    s_waitcnt lgkmcnt(8)
    v_add_f32 v36, v36, v52
    v_add_f32 v37, v37, v53
    v_add_f32 v38, v38, v54
    v_add_f32 v39, v39, v55
    v_add_f32 v40, v40, v56
    v_add_f32 v41, v41, v57
    v_add_f32 v42, v42, v58
    v_add_f32 v43, v43, v59
    s_waitcnt lgkmcnt(4)
    v_add_f32 v68, v68, v84
    v_add_f32 v69, v69, v85
    v_add_f32 v70, v70, v86
    v_add_f32 v71, v71, v87
    v_add_f32 v72, v72, v88
    v_add_f32 v73, v73, v89
    v_add_f32 v74, v74, v90
    v_add_f32 v75, v75, v91
    v_add_f32 v36, v36, v68
    v_add_f32 v37, v37, v69
    v_add_f32 v38, v38, v70
    v_add_f32 v39, v39, v71
    v_add_f32 v40, v40, v72
    v_add_f32 v41, v41, v73
    v_add_f32 v42, v42, v74
    v_add_f32 v43, v43, v75
    v_cvt_pk_bf16_f32 v52, v36, v37
    v_cvt_pk_bf16_f32 v53, v38, v39
    v_cvt_pk_bf16_f32 v54, v40, v41
    v_cvt_pk_bf16_f32 v55, v42, v43
    buffer_store_dwordx4 v[52:55], v220, s[40:43], s16 offen sc1
    s_waitcnt lgkmcnt(0)
    v_add_f32 v44, v44, v60
    v_add_f32 v76, v76, v92
    v_mov_b32 v45, v198
    v_add_f32 v44, v44, v76
    s_cmp_lg_u32 s3, 3
    s_cbranch_scc1 k1_pub
    buffer_store_dword v44, v45, s[44:47], s17 offen sc1
k1_pub:
    v_pk_mul_f32 v[198:199], v[4:5], s[48:49]
    v_pk_add_f32 v[4:5], v[4:5], s[50:51]
    v_min_f32 v198, 0, v198
    v_min_f32 v199, 0, v199
    v_exp_f32 v198, v198
    v_exp_f32 v199, v199
    v_max_f32 v4, s50, v4
    v_max_f32 v5, s50, v5
    v_pk_add_f32 v[4:5], v[4:5], v[198:199]
    v_pk_mul_f32 v[200:201], v[6:7], s[48:49]
    v_pk_add_f32 v[6:7], v[6:7], s[50:51]
    v_min_f32 v200, 0, v200
    v_min_f32 v201, 0, v201
    v_exp_f32 v200, v200
    v_exp_f32 v201, v201
    v_max_f32 v6, s50, v6
    v_max_f32 v7, s50, v7
    v_pk_add_f32 v[6:7], v[6:7], v[200:201]
    v_pk_mul_f32 v[198:199], v[8:9], s[48:49]
    v_pk_add_f32 v[8:9], v[8:9], s[50:51]
    v_min_f32 v198, 0, v198
    v_min_f32 v199, 0, v199
    v_exp_f32 v198, v198
    v_exp_f32 v199, v199
    v_max_f32 v8, s50, v8
    v_max_f32 v9, s50, v9
    v_pk_add_f32 v[8:9], v[8:9], v[198:199]
    v_pk_mul_f32 v[200:201], v[10:11], s[48:49]
    v_pk_add_f32 v[10:11], v[10:11], s[50:51]
    v_min_f32 v200, 0, v200
    v_min_f32 v201, 0, v201
    v_exp_f32 v200, v200
    v_exp_f32 v201, v201
    v_max_f32 v10, s50, v10
    v_max_f32 v11, s50, v11
    v_pk_add_f32 v[10:11], v[10:11], v[200:201]
    v_pk_mul_f32 v[198:199], v[12:13], s[48:49]
    v_pk_add_f32 v[12:13], v[12:13], s[50:51]
    v_min_f32 v198, 0, v198
    v_min_f32 v199, 0, v199
    v_exp_f32 v198, v198
    v_exp_f32 v199, v199
    v_max_f32 v12, s50, v12
    v_max_f32 v13, s50, v13
    v_pk_add_f32 v[12:13], v[12:13], v[198:199]
    v_pk_mul_f32 v[200:201], v[14:15], s[48:49]
    v_pk_add_f32 v[14:15], v[14:15], s[50:51]
    v_min_f32 v200, 0, v200
    v_min_f32 v201, 0, v201
    v_exp_f32 v200, v200
    v_exp_f32 v201, v201
    v_max_f32 v14, s50, v14
    v_max_f32 v15, s50, v15
    v_pk_add_f32 v[14:15], v[14:15], v[200:201]
    v_pk_mul_f32 v[198:199], v[16:17], s[48:49]
    v_pk_add_f32 v[16:17], v[16:17], s[50:51]
    v_min_f32 v198, 0, v198
    v_min_f32 v199, 0, v199
    v_exp_f32 v198, v198
    v_exp_f32 v199, v199
    v_max_f32 v16, s50, v16
    v_max_f32 v17, s50, v17
    v_pk_add_f32 v[16:17], v[16:17], v[198:199]
    v_pk_mul_f32 v[200:201], v[18:19], s[48:49]
    v_pk_add_f32 v[18:19], v[18:19], s[50:51]
    v_min_f32 v200, 0, v200
    v_min_f32 v201, 0, v201
    v_exp_f32 v200, v200
    v_exp_f32 v201, v201
    v_max_f32 v18, s50, v18
    v_max_f32 v19, s50, v19
    v_pk_add_f32 v[18:19], v[18:19], v[200:201]
    v_cvt_pk_bf16_f32 v204, v4, v5
    v_cvt_pk_bf16_f32 v205, v6, v7
    v_cvt_pk_bf16_f32 v206, v8, v9
    v_cvt_pk_bf16_f32 v207, v10, v11
    v_cvt_pk_bf16_f32 v208, v12, v13
    v_cvt_pk_bf16_f32 v209, v14, v15
    v_cvt_pk_bf16_f32 v210, v16, v17
    v_cvt_pk_bf16_f32 v211, v18, v19
    v_pk_mul_f32 v[198:199], v[20:21], s[48:49]
    v_pk_add_f32 v[20:21], v[20:21], s[50:51]
    v_min_f32 v198, 0, v198
    v_min_f32 v199, 0, v199
    v_exp_f32 v198, v198
    v_exp_f32 v199, v199
    v_max_f32 v20, s50, v20
    v_max_f32 v21, s50, v21
    v_pk_add_f32 v[20:21], v[20:21], v[198:199]
    v_pk_mul_f32 v[200:201], v[22:23], s[48:49]
    v_pk_add_f32 v[22:23], v[22:23], s[50:51]
    v_min_f32 v200, 0, v200
    v_min_f32 v201, 0, v201
    v_exp_f32 v200, v200
    v_exp_f32 v201, v201
    v_max_f32 v22, s50, v22
    v_max_f32 v23, s50, v23
    v_pk_add_f32 v[22:23], v[22:23], v[200:201]
    v_pk_mul_f32 v[198:199], v[24:25], s[48:49]
    v_pk_add_f32 v[24:25], v[24:25], s[50:51]
    v_min_f32 v198, 0, v198
    v_min_f32 v199, 0, v199
    v_exp_f32 v198, v198
    v_exp_f32 v199, v199
    v_max_f32 v24, s50, v24
    v_max_f32 v25, s50, v25
    v_pk_add_f32 v[24:25], v[24:25], v[198:199]
    v_pk_mul_f32 v[200:201], v[26:27], s[48:49]
    v_pk_add_f32 v[26:27], v[26:27], s[50:51]
    v_min_f32 v200, 0, v200
    v_min_f32 v201, 0, v201
    v_exp_f32 v200, v200
    v_exp_f32 v201, v201
    v_max_f32 v26, s50, v26
    v_max_f32 v27, s50, v27
    v_pk_add_f32 v[26:27], v[26:27], v[200:201]
    v_pk_mul_f32 v[198:199], v[28:29], s[48:49]
    v_pk_add_f32 v[28:29], v[28:29], s[50:51]
    v_min_f32 v198, 0, v198
    v_min_f32 v199, 0, v199
    v_exp_f32 v198, v198
    v_exp_f32 v199, v199
    v_max_f32 v28, s50, v28
    v_max_f32 v29, s50, v29
    v_pk_add_f32 v[28:29], v[28:29], v[198:199]
    v_pk_mul_f32 v[200:201], v[30:31], s[48:49]
    v_pk_add_f32 v[30:31], v[30:31], s[50:51]
    v_min_f32 v200, 0, v200
    v_min_f32 v201, 0, v201
    v_exp_f32 v200, v200
    v_exp_f32 v201, v201
    v_max_f32 v30, s50, v30
    v_max_f32 v31, s50, v31
    v_pk_add_f32 v[30:31], v[30:31], v[200:201]
    v_pk_mul_f32 v[198:199], v[32:33], s[48:49]
    v_pk_add_f32 v[32:33], v[32:33], s[50:51]
    v_min_f32 v198, 0, v198
    v_min_f32 v199, 0, v199
    v_exp_f32 v198, v198
    v_exp_f32 v199, v199
    v_max_f32 v32, s50, v32
    v_max_f32 v33, s50, v33
    v_pk_add_f32 v[32:33], v[32:33], v[198:199]
    v_pk_mul_f32 v[200:201], v[34:35], s[48:49]
    v_pk_add_f32 v[34:35], v[34:35], s[50:51]
    v_min_f32 v200, 0, v200
    v_min_f32 v201, 0, v201
    v_exp_f32 v200, v200
    v_exp_f32 v201, v201
    v_max_f32 v34, s50, v34
    v_max_f32 v35, s50, v35
    v_pk_add_f32 v[34:35], v[34:35], v[200:201]
    v_cvt_pk_bf16_f32 v212, v20, v21
    v_cvt_pk_bf16_f32 v213, v22, v23
    v_cvt_pk_bf16_f32 v214, v24, v25
    v_cvt_pk_bf16_f32 v215, v26, v27
    v_cvt_pk_bf16_f32 v216, v28, v29
    v_cvt_pk_bf16_f32 v217, v30, v31
    v_cvt_pk_bf16_f32 v218, v32, v33
    v_cvt_pk_bf16_f32 v219, v34, v35
    s_mov_b32 s17, 0
    buffer_load_dwordx4 v[116:119], v222, s[40:43], s17 offen sc1
    s_mov_b32 s17, 131072
    buffer_load_dwordx4 v[120:123], v222, s[40:43], s17 offen sc1
    s_mov_b32 s17, 262144
    buffer_load_dwordx4 v[124:127], v222, s[40:43], s17 offen sc1
    s_mov_b32 s17, 393216
    buffer_load_dwordx4 v[128:131], v222, s[40:43], s17 offen sc1
    s_mov_b32 s17, 524288
    buffer_load_dwordx4 v[132:135], v222, s[40:43], s17 offen sc1
    s_mov_b32 s17, 655360
    buffer_load_dwordx4 v[136:139], v222, s[40:43], s17 offen sc1
    s_mov_b32 s17, 786432
    buffer_load_dwordx4 v[140:143], v222, s[40:43], s17 offen sc1
    s_mov_b32 s17, 917504
    buffer_load_dwordx4 v[144:147], v222, s[40:43], s17 offen sc1
    s_mov_b32 s17, 1048576
    buffer_load_dwordx4 v[148:151], v222, s[40:43], s17 offen sc1
    s_mov_b32 s17, 1179648
    buffer_load_dwordx4 v[152:155], v222, s[40:43], s17 offen sc1
    s_mov_b32 s17, 1310720
    buffer_load_dwordx4 v[156:159], v222, s[40:43], s17 offen sc1
    s_mov_b32 s17, 1441792
    buffer_load_dwordx4 v[160:163], v222, s[40:43], s17 offen sc1
    s_mov_b32 s17, 1572864
    buffer_load_dwordx4 v[164:167], v222, s[40:43], s17 offen sc1
    s_mov_b32 s17, 1703936
    buffer_load_dwordx4 v[168:171], v222, s[40:43], s17 offen sc1
    s_mov_b32 s17, 1835008
    buffer_load_dwordx4 v[172:175], v222, s[40:43], s17 offen sc1
    s_mov_b32 s17, 1966080
    buffer_load_dwordx4 v[176:179], v222, s[40:43], s17 offen sc1
    buffer_load_dwordx4 v[180:183], v224, s[44:47], 0 offen sc1
    s_mov_b32 s30, 4000
k1_poll:
    s_waitcnt vmcnt(16)
    v_lshlrev_b32 v68, 16, v116
    v_and_b32 v69, 0xffff0000, v116
    v_lshlrev_b32 v70, 16, v117
    v_and_b32 v71, 0xffff0000, v117
    v_lshlrev_b32 v72, 16, v118
    v_and_b32 v73, 0xffff0000, v118
    v_lshlrev_b32 v74, 16, v119
    v_and_b32 v75, 0xffff0000, v119
    s_waitcnt vmcnt(15)
    v_lshlrev_b32 v76, 16, v120
    v_and_b32 v77, 0xffff0000, v120
    v_lshlrev_b32 v78, 16, v121
    v_and_b32 v79, 0xffff0000, v121
    v_lshlrev_b32 v80, 16, v122
    v_and_b32 v81, 0xffff0000, v122
    v_lshlrev_b32 v82, 16, v123
    v_and_b32 v83, 0xffff0000, v123
    v_add_f32 v68, v68, v76
    v_add_f32 v69, v69, v77
    v_add_f32 v70, v70, v78
    v_add_f32 v71, v71, v79
    v_add_f32 v72, v72, v80
    v_add_f32 v73, v73, v81
    v_add_f32 v74, v74, v82
    v_add_f32 v75, v75, v83
    s_waitcnt vmcnt(14)
    v_lshlrev_b32 v76, 16, v124
    v_and_b32 v77, 0xffff0000, v124
    v_lshlrev_b32 v78, 16, v125
    v_and_b32 v79, 0xffff0000, v125
    v_lshlrev_b32 v80, 16, v126
    v_and_b32 v81, 0xffff0000, v126
    v_lshlrev_b32 v82, 16, v127
    v_and_b32 v83, 0xffff0000, v127
    v_add_f32 v68, v68, v76
    v_add_f32 v69, v69, v77
    v_add_f32 v70, v70, v78
    v_add_f32 v71, v71, v79
    v_add_f32 v72, v72, v80
    v_add_f32 v73, v73, v81
    v_add_f32 v74, v74, v82
    v_add_f32 v75, v75, v83
    s_waitcnt vmcnt(13)
    v_lshlrev_b32 v76, 16, v128
    v_and_b32 v77, 0xffff0000, v128
    v_lshlrev_b32 v78, 16, v129
    v_and_b32 v79, 0xffff0000, v129
    v_lshlrev_b32 v80, 16, v130
    v_and_b32 v81, 0xffff0000, v130
    v_lshlrev_b32 v82, 16, v131
    v_and_b32 v83, 0xffff0000, v131
    v_add_f32 v68, v68, v76
    v_add_f32 v69, v69, v77
    v_add_f32 v70, v70, v78
    v_add_f32 v71, v71, v79
    v_add_f32 v72, v72, v80
    v_add_f32 v73, v73, v81
    v_add_f32 v74, v74, v82
    v_add_f32 v75, v75, v83
    s_waitcnt vmcnt(12)
    v_lshlrev_b32 v76, 16, v132
    v_and_b32 v77, 0xffff0000, v132
    v_lshlrev_b32 v78, 16, v133
    v_and_b32 v79, 0xffff0000, v133
    v_lshlrev_b32 v80, 16, v134
    v_and_b32 v81, 0xffff0000, v134
    v_lshlrev_b32 v82, 16, v135
    v_and_b32 v83, 0xffff0000, v135
    v_add_f32 v68, v68, v76
    v_add_f32 v69, v69, v77
    v_add_f32 v70, v70, v78
    v_add_f32 v71, v71, v79
    v_add_f32 v72, v72, v80
    v_add_f32 v73, v73, v81
    v_add_f32 v74, v74, v82
    v_add_f32 v75, v75, v83
    s_waitcnt vmcnt(11)
    v_lshlrev_b32 v76, 16, v136
    v_and_b32 v77, 0xffff0000, v136
    v_lshlrev_b32 v78, 16, v137
    v_and_b32 v79, 0xffff0000, v137
    v_lshlrev_b32 v80, 16, v138
    v_and_b32 v81, 0xffff0000, v138
    v_lshlrev_b32 v82, 16, v139
    v_and_b32 v83, 0xffff0000, v139
    v_add_f32 v68, v68, v76
    v_add_f32 v69, v69, v77
    v_add_f32 v70, v70, v78
    v_add_f32 v71, v71, v79
    v_add_f32 v72, v72, v80
    v_add_f32 v73, v73, v81
    v_add_f32 v74, v74, v82
    v_add_f32 v75, v75, v83
    s_waitcnt vmcnt(10)
    v_lshlrev_b32 v76, 16, v140
    v_and_b32 v77, 0xffff0000, v140
    v_lshlrev_b32 v78, 16, v141
    v_and_b32 v79, 0xffff0000, v141
    v_lshlrev_b32 v80, 16, v142
    v_and_b32 v81, 0xffff0000, v142
    v_lshlrev_b32 v82, 16, v143
    v_and_b32 v83, 0xffff0000, v143
    v_add_f32 v68, v68, v76
    v_add_f32 v69, v69, v77
    v_add_f32 v70, v70, v78
    v_add_f32 v71, v71, v79
    v_add_f32 v72, v72, v80
    v_add_f32 v73, v73, v81
    v_add_f32 v74, v74, v82
    v_add_f32 v75, v75, v83
    s_waitcnt vmcnt(9)
    v_lshlrev_b32 v76, 16, v144
    v_and_b32 v77, 0xffff0000, v144
    v_lshlrev_b32 v78, 16, v145
    v_and_b32 v79, 0xffff0000, v145
    v_lshlrev_b32 v80, 16, v146
    v_and_b32 v81, 0xffff0000, v146
    v_lshlrev_b32 v82, 16, v147
    v_and_b32 v83, 0xffff0000, v147
    v_add_f32 v68, v68, v76
    v_add_f32 v69, v69, v77
    v_add_f32 v70, v70, v78
    v_add_f32 v71, v71, v79
    v_add_f32 v72, v72, v80
    v_add_f32 v73, v73, v81
    v_add_f32 v74, v74, v82
    v_add_f32 v75, v75, v83
    s_waitcnt vmcnt(8)
    v_lshlrev_b32 v76, 16, v148
    v_and_b32 v77, 0xffff0000, v148
    v_lshlrev_b32 v78, 16, v149
    v_and_b32 v79, 0xffff0000, v149
    v_lshlrev_b32 v80, 16, v150
    v_and_b32 v81, 0xffff0000, v150
    v_lshlrev_b32 v82, 16, v151
    v_and_b32 v83, 0xffff0000, v151
    v_add_f32 v68, v68, v76
    v_add_f32 v69, v69, v77
    v_add_f32 v70, v70, v78
    v_add_f32 v71, v71, v79
    v_add_f32 v72, v72, v80
    v_add_f32 v73, v73, v81
    v_add_f32 v74, v74, v82
    v_add_f32 v75, v75, v83
    s_waitcnt vmcnt(7)
    v_lshlrev_b32 v76, 16, v152
    v_and_b32 v77, 0xffff0000, v152
    v_lshlrev_b32 v78, 16, v153
    v_and_b32 v79, 0xffff0000, v153
    v_lshlrev_b32 v80, 16, v154
    v_and_b32 v81, 0xffff0000, v154
    v_lshlrev_b32 v82, 16, v155
    v_and_b32 v83, 0xffff0000, v155
    v_add_f32 v68, v68, v76
    v_add_f32 v69, v69, v77
    v_add_f32 v70, v70, v78
    v_add_f32 v71, v71, v79
    v_add_f32 v72, v72, v80
    v_add_f32 v73, v73, v81
    v_add_f32 v74, v74, v82
    v_add_f32 v75, v75, v83
    s_waitcnt vmcnt(6)
    v_lshlrev_b32 v76, 16, v156
    v_and_b32 v77, 0xffff0000, v156
    v_lshlrev_b32 v78, 16, v157
    v_and_b32 v79, 0xffff0000, v157
    v_lshlrev_b32 v80, 16, v158
    v_and_b32 v81, 0xffff0000, v158
    v_lshlrev_b32 v82, 16, v159
    v_and_b32 v83, 0xffff0000, v159
    v_add_f32 v68, v68, v76
    v_add_f32 v69, v69, v77
    v_add_f32 v70, v70, v78
    v_add_f32 v71, v71, v79
    v_add_f32 v72, v72, v80
    v_add_f32 v73, v73, v81
    v_add_f32 v74, v74, v82
    v_add_f32 v75, v75, v83
    s_waitcnt vmcnt(5)
    v_lshlrev_b32 v76, 16, v160
    v_and_b32 v77, 0xffff0000, v160
    v_lshlrev_b32 v78, 16, v161
    v_and_b32 v79, 0xffff0000, v161
    v_lshlrev_b32 v80, 16, v162
    v_and_b32 v81, 0xffff0000, v162
    v_lshlrev_b32 v82, 16, v163
    v_and_b32 v83, 0xffff0000, v163
    v_add_f32 v68, v68, v76
    v_add_f32 v69, v69, v77
    v_add_f32 v70, v70, v78
    v_add_f32 v71, v71, v79
    v_add_f32 v72, v72, v80
    v_add_f32 v73, v73, v81
    v_add_f32 v74, v74, v82
    v_add_f32 v75, v75, v83
    s_waitcnt vmcnt(4)
    v_lshlrev_b32 v76, 16, v164
    v_and_b32 v77, 0xffff0000, v164
    v_lshlrev_b32 v78, 16, v165
    v_and_b32 v79, 0xffff0000, v165
    v_lshlrev_b32 v80, 16, v166
    v_and_b32 v81, 0xffff0000, v166
    v_lshlrev_b32 v82, 16, v167
    v_and_b32 v83, 0xffff0000, v167
    v_add_f32 v68, v68, v76
    v_add_f32 v69, v69, v77
    v_add_f32 v70, v70, v78
    v_add_f32 v71, v71, v79
    v_add_f32 v72, v72, v80
    v_add_f32 v73, v73, v81
    v_add_f32 v74, v74, v82
    v_add_f32 v75, v75, v83
    s_waitcnt vmcnt(3)
    v_lshlrev_b32 v76, 16, v168
    v_and_b32 v77, 0xffff0000, v168
    v_lshlrev_b32 v78, 16, v169
    v_and_b32 v79, 0xffff0000, v169
    v_lshlrev_b32 v80, 16, v170
    v_and_b32 v81, 0xffff0000, v170
    v_lshlrev_b32 v82, 16, v171
    v_and_b32 v83, 0xffff0000, v171
    v_add_f32 v68, v68, v76
    v_add_f32 v69, v69, v77
    v_add_f32 v70, v70, v78
    v_add_f32 v71, v71, v79
    v_add_f32 v72, v72, v80
    v_add_f32 v73, v73, v81
    v_add_f32 v74, v74, v82
    v_add_f32 v75, v75, v83
    s_waitcnt vmcnt(2)
    v_lshlrev_b32 v76, 16, v172
    v_and_b32 v77, 0xffff0000, v172
    v_lshlrev_b32 v78, 16, v173
    v_and_b32 v79, 0xffff0000, v173
    v_lshlrev_b32 v80, 16, v174
    v_and_b32 v81, 0xffff0000, v174
    v_lshlrev_b32 v82, 16, v175
    v_and_b32 v83, 0xffff0000, v175
    v_add_f32 v68, v68, v76
    v_add_f32 v69, v69, v77
    v_add_f32 v70, v70, v78
    v_add_f32 v71, v71, v79
    v_add_f32 v72, v72, v80
    v_add_f32 v73, v73, v81
    v_add_f32 v74, v74, v82
    v_add_f32 v75, v75, v83
    s_waitcnt vmcnt(1)
    v_lshlrev_b32 v76, 16, v176
    v_and_b32 v77, 0xffff0000, v176
    v_lshlrev_b32 v78, 16, v177
    v_and_b32 v79, 0xffff0000, v177
    v_lshlrev_b32 v80, 16, v178
    v_and_b32 v81, 0xffff0000, v178
    v_lshlrev_b32 v82, 16, v179
    v_and_b32 v83, 0xffff0000, v179
    v_add_f32 v68, v68, v76
    v_add_f32 v69, v69, v77
    v_add_f32 v70, v70, v78
    v_add_f32 v71, v71, v79
    v_add_f32 v72, v72, v80
    v_add_f32 v73, v73, v81
    v_add_f32 v74, v74, v82
    v_add_f32 v75, v75, v83
    s_waitcnt vmcnt(0)
    v_add_f32_dpp v180, v180, v180 row_ror:4 row_mask:0xf bank_mask:0xf
    v_add_f32_dpp v181, v181, v181 row_ror:4 row_mask:0xf bank_mask:0xf
    v_add_f32_dpp v182, v182, v182 row_ror:4 row_mask:0xf bank_mask:0xf
    v_add_f32_dpp v183, v183, v183 row_ror:4 row_mask:0xf bank_mask:0xf
    s_nop 1
    v_add_f32_dpp v180, v180, v180 row_ror:8 row_mask:0xf bank_mask:0xf
    v_add_f32_dpp v181, v181, v181 row_ror:8 row_mask:0xf bank_mask:0xf
    v_add_f32_dpp v182, v182, v182 row_ror:8 row_mask:0xf bank_mask:0xf
    v_add_f32_dpp v183, v183, v183 row_ror:8 row_mask:0xf bank_mask:0xf
    s_nop 1
    v_mov_b32 v198, v180
    v_mov_b32 v199, v181
    v_mov_b32 v200, v182
    v_mov_b32 v201, v183
    s_nop 1
    v_permlane16_swap_b32 v180, v198
    v_permlane16_swap_b32 v181, v199
    v_permlane16_swap_b32 v182, v200
    v_permlane16_swap_b32 v183, v201
    s_nop 1
    v_add_f32 v180, v180, v198
    v_add_f32 v181, v181, v199
    v_add_f32 v182, v182, v200
    v_add_f32 v183, v183, v201
    v_mov_b32 v198, v180
    v_mov_b32 v199, v181
    v_mov_b32 v200, v182
    v_mov_b32 v201, v183
    s_nop 1
    v_permlane32_swap_b32 v180, v198
    v_permlane32_swap_b32 v181, v199
    v_permlane32_swap_b32 v182, v200
    v_permlane32_swap_b32 v183, v201
    s_nop 1
    v_add_f32 v180, v180, v198
    v_add_f32 v181, v181, v199
    v_add_f32 v182, v182, v200
    v_add_f32 v183, v183, v201
    v_pk_add_f32 v[198:199], v[68:69], v[70:71]
    v_pk_add_f32 v[200:201], v[72:73], v[74:75]
    v_pk_add_f32 v[198:199], v[198:199], v[180:181]
    v_pk_add_f32 v[200:201], v[200:201], v[182:183]
    v_pk_add_f32 v[198:199], v[198:199], v[200:201]
    v_cmp_u_f32 vcc, v198, v199
    s_cbranch_vccz k1_got
    s_sub_u32 s30, s30, 1
    s_cmp_eq_u32 s30, 0
    s_cbranch_scc1 k1_got
    s_mov_b32 s17, 0
    buffer_load_dwordx4 v[116:119], v222, s[40:43], s17 offen sc1
    s_mov_b32 s17, 131072
    buffer_load_dwordx4 v[120:123], v222, s[40:43], s17 offen sc1
    s_mov_b32 s17, 262144
    buffer_load_dwordx4 v[124:127], v222, s[40:43], s17 offen sc1
    s_mov_b32 s17, 393216
    buffer_load_dwordx4 v[128:131], v222, s[40:43], s17 offen sc1
    s_mov_b32 s17, 524288
    buffer_load_dwordx4 v[132:135], v222, s[40:43], s17 offen sc1
    s_mov_b32 s17, 655360
    buffer_load_dwordx4 v[136:139], v222, s[40:43], s17 offen sc1
    s_mov_b32 s17, 786432
    buffer_load_dwordx4 v[140:143], v222, s[40:43], s17 offen sc1
    s_mov_b32 s17, 917504
    buffer_load_dwordx4 v[144:147], v222, s[40:43], s17 offen sc1
    s_mov_b32 s17, 1048576
    buffer_load_dwordx4 v[148:151], v222, s[40:43], s17 offen sc1
    s_mov_b32 s17, 1179648
    buffer_load_dwordx4 v[152:155], v222, s[40:43], s17 offen sc1
    s_mov_b32 s17, 1310720
    buffer_load_dwordx4 v[156:159], v222, s[40:43], s17 offen sc1
    s_mov_b32 s17, 1441792
    buffer_load_dwordx4 v[160:163], v222, s[40:43], s17 offen sc1
    s_mov_b32 s17, 1572864
    buffer_load_dwordx4 v[164:167], v222, s[40:43], s17 offen sc1
    s_mov_b32 s17, 1703936
    buffer_load_dwordx4 v[168:171], v222, s[40:43], s17 offen sc1
    s_mov_b32 s17, 1835008
    buffer_load_dwordx4 v[172:175], v222, s[40:43], s17 offen sc1
    s_mov_b32 s17, 1966080
    buffer_load_dwordx4 v[176:179], v222, s[40:43], s17 offen sc1
    buffer_load_dwordx4 v[180:183], v224, s[44:47], 0 offen sc1
    s_branch k1_poll
k1_got:
    v_cvt_pk_bf16_f32 v60, v68, v69
    v_cvt_pk_bf16_f32 v61, v70, v71
    v_cvt_pk_bf16_f32 v62, v72, v73
    v_cvt_pk_bf16_f32 v63, v74, v75
    ds_write_b128 v225, v[60:63]
    v_cvt_pk_bf16_f32 v64, v180, v181
    v_cvt_pk_bf16_f32 v65, v182, v183
    ds_write_b64 v226, v[64:65]
    s_waitcnt lgkmcnt(0)
    s_barrier
    v_add_u32 v220, 65536, v220
    ds_read_b128 v[68:71], v220 offset:0
    ds_read_b128 v[84:87], v227 offset:0
    ds_read_b128 v[72:75], v220 offset:1024
    ds_read_b128 v[88:91], v227 offset:16
    ds_read_b128 v[76:79], v220 offset:2048
    ds_read_b128 v[92:95], v227 offset:64
    ds_read_b128 v[80:83], v220 offset:3072
    ds_read_b128 v[96:99], v227 offset:80
    s_waitcnt lgkmcnt(0)
    v_mfma_f32_32x32x16_bf16 v[132:147], v[84:87], v[204:207], 0
    v_mfma_f32_32x32x16_bf16 v[100:115], v[68:71], v[204:207], 0
    v_mfma_f32_32x32x16_bf16 v[148:163], v[92:95], v[212:215], 0
    v_mfma_f32_32x32x16_bf16 v[116:131], v[76:79], v[212:215], 0
    v_mfma_f32_32x32x16_bf16 v[132:147], v[88:91], v[208:211], v[132:147]
    v_mfma_f32_32x32x16_bf16 v[100:115], v[72:75], v[208:211], v[100:115]
    v_mfma_f32_32x32x16_bf16 v[148:163], v[96:99], v[216:219], v[148:163]
    v_mfma_f32_32x32x16_bf16 v[116:131], v[80:83], v[216:219], v[116:131]
    s_lshl_b32 s16, s21, 12
    s_nop 15
    v_add_f32 v132, 0x358637bd, v132
    v_rcp_f32 v132, v132
    v_add_f32 v148, 0x358637bd, v148
    v_rcp_f32 v148, v148
    s_nop 0
    v_pk_mul_f32 v[100:101], v[100:101], v[132:133] op_sel_hi:[1,0]
    v_pk_mul_f32 v[102:103], v[102:103], v[132:133] op_sel_hi:[1,0]
    v_pk_mul_f32 v[104:105], v[104:105], v[132:133] op_sel_hi:[1,0]
    v_pk_mul_f32 v[106:107], v[106:107], v[132:133] op_sel_hi:[1,0]
    v_pk_mul_f32 v[108:109], v[108:109], v[132:133] op_sel_hi:[1,0]
    v_pk_mul_f32 v[110:111], v[110:111], v[132:133] op_sel_hi:[1,0]
    v_pk_mul_f32 v[112:113], v[112:113], v[132:133] op_sel_hi:[1,0]
    v_pk_mul_f32 v[114:115], v[114:115], v[132:133] op_sel_hi:[1,0]
    v_cvt_pk_bf16_f32 v164, v100, v101
    v_cvt_pk_bf16_f32 v165, v102, v103
    v_cvt_pk_bf16_f32 v166, v104, v105
    v_cvt_pk_bf16_f32 v167, v106, v107
    v_cvt_pk_bf16_f32 v168, v108, v109
    v_cvt_pk_bf16_f32 v169, v110, v111
    v_cvt_pk_bf16_f32 v170, v112, v113
    v_cvt_pk_bf16_f32 v171, v114, v115
    buffer_store_dwordx4 v[164:167], v188, s[36:39], s16 offen offset:0 sc1
    buffer_store_dwordx4 v[168:171], v188, s[36:39], s16 offen offset:1024 sc1
    v_pk_mul_f32 v[116:117], v[116:117], v[148:149] op_sel_hi:[1,0]
    v_pk_mul_f32 v[118:119], v[118:119], v[148:149] op_sel_hi:[1,0]
    v_pk_mul_f32 v[120:121], v[120:121], v[148:149] op_sel_hi:[1,0]
    v_pk_mul_f32 v[122:123], v[122:123], v[148:149] op_sel_hi:[1,0]
    v_pk_mul_f32 v[124:125], v[124:125], v[148:149] op_sel_hi:[1,0]
    v_pk_mul_f32 v[126:127], v[126:127], v[148:149] op_sel_hi:[1,0]
    v_pk_mul_f32 v[128:129], v[128:129], v[148:149] op_sel_hi:[1,0]
    v_pk_mul_f32 v[130:131], v[130:131], v[148:149] op_sel_hi:[1,0]
    v_cvt_pk_bf16_f32 v172, v116, v117
    v_cvt_pk_bf16_f32 v173, v118, v119
    v_cvt_pk_bf16_f32 v174, v120, v121
    v_cvt_pk_bf16_f32 v175, v122, v123
    v_cvt_pk_bf16_f32 v176, v124, v125
    v_cvt_pk_bf16_f32 v177, v126, v127
    v_cvt_pk_bf16_f32 v178, v128, v129
    v_cvt_pk_bf16_f32 v179, v130, v131
    buffer_store_dwordx4 v[172:175], v188, s[36:39], s16 offen offset:2048 sc1
    buffer_store_dwordx4 v[176:179], v188, s[36:39], s16 offen offset:3072 sc1
k1_done:
    s_endpgm
k1_pf:
    s_load_dwordx2 s[48:49], s[0:1], 16
    s_load_dwordx4 s[52:55], s[0:1], 32
    s_load_dwordx2 s[56:57], s[0:1], 48
    s_lshl_b32 s16, s2, 12
    v_lshl_add_u32 v4, v2, 6, s16
    s_waitcnt lgkmcnt(0)
    s_mov_b32 s8, s48
    s_mov_b32 s9, s49
    s_mov_b32 s10, 2097152
    s_mov_b32 s11, 0x00020000
    s_mov_b32 s12, s52
    s_mov_b32 s13, s53
    s_mov_b32 s14, 7340032
    s_mov_b32 s15, 0x00020000
    s_mov_b32 s16, s54
    s_mov_b32 s17, s55
    s_mov_b32 s18, 7340032
    s_mov_b32 s19, 0x00020000
    s_mov_b32 s24, s56
    s_mov_b32 s25, s57
    s_mov_b32 s26, 7340032
    s_mov_b32 s27, 0x00020000
    s_add_u32 s32, s6, 20971520
    s_addc_u32 s33, s7, 0
    s_mov_b32 s34, 8388608
    s_mov_b32 s35, 0x00020000
    v_mov_b32 v8, -1
    v_mov_b32 v9, -1
    v_mov_b32 v10, -1
    v_mov_b32 v11, -1
    v_lshlrev_b32 v6, 4, v2
    s_lshl_b32 s29, s2, 14
    s_lshl_b32 s30, s2, 10
    s_add_u32 s30, s30, 6291456
    s_lshl_b32 s31, s2, 9
    s_add_u32 s31, s31, 7340032
    s_mov_b32 s40, s4
    s_mov_b32 s41, s5
    s_mov_b32 s42, 6291456
    s_mov_b32 s43, 0x00020000
    s_barrier
    s_barrier
    s_barrier
    s_barrier
    s_barrier
    s_barrier
    s_barrier
    s_barrier
    s_barrier
    s_barrier
    s_barrier
    s_barrier
    buffer_store_dwordx4 v[8:11], v6, s[32:35], s29 offen offset:0 sc1
    buffer_store_dwordx4 v[8:11], v6, s[32:35], s29 offen offset:1024 sc1
    buffer_store_dwordx4 v[8:11], v6, s[32:35], s29 offen offset:2048 sc1
    buffer_store_dwordx4 v[8:11], v6, s[32:35], s29 offen offset:3072 sc1
    s_add_u32 s29, s29, 4096
    s_barrier
    buffer_store_dwordx4 v[8:11], v6, s[32:35], s29 offen offset:0 sc1
    buffer_store_dwordx4 v[8:11], v6, s[32:35], s29 offen offset:1024 sc1
    buffer_store_dwordx4 v[8:11], v6, s[32:35], s29 offen offset:2048 sc1
    buffer_store_dwordx4 v[8:11], v6, s[32:35], s29 offen offset:3072 sc1
    s_add_u32 s29, s29, 4096
    s_mov_b32 s28, 0
    buffer_load_dword v5, v4, s[12:15], s28 offen
    s_barrier
    buffer_store_dwordx4 v[8:11], v6, s[32:35], s29 offen offset:0 sc1
    buffer_store_dwordx4 v[8:11], v6, s[32:35], s29 offen offset:1024 sc1
    buffer_store_dwordx4 v[8:11], v6, s[32:35], s29 offen offset:2048 sc1
    buffer_store_dwordx4 v[8:11], v6, s[32:35], s29 offen offset:3072 sc1
    s_add_u32 s29, s29, 4096
    s_mov_b32 s28, 0
    buffer_load_dword v5, v4, s[16:19], s28 offen
    s_barrier
    buffer_store_dwordx4 v[8:11], v6, s[32:35], s29 offen offset:0 sc1
    buffer_store_dwordx4 v[8:11], v6, s[32:35], s29 offen offset:1024 sc1
    buffer_store_dwordx4 v[8:11], v6, s[32:35], s29 offen offset:2048 sc1
    buffer_store_dwordx4 v[8:11], v6, s[32:35], s29 offen offset:3072 sc1
    s_add_u32 s29, s29, 4096
    s_mov_b32 s28, 1048576
    buffer_load_dword v5, v4, s[12:15], s28 offen
    s_barrier
    buffer_store_dwordx4 v[8:11], v6, s[32:35], s30 offen sc1
    s_mov_b32 exec_hi, 0
    buffer_store_dwordx4 v[8:11], v6, s[32:35], s31 offen sc1
    s_mov_b32 exec_hi, -1
    s_mov_b32 s28, 1048576
    buffer_load_dword v5, v4, s[16:19], s28 offen
    s_barrier
    s_mov_b32 s28, 0
    buffer_load_dword v5, v4, s[8:11], s28 offen
    s_barrier
    s_mov_b32 s28, 1048576
    buffer_load_dword v5, v4, s[8:11], s28 offen
    s_waitcnt vmcnt(0) lgkmcnt(0)
    s_endpgm
.globl k34_kernel
.p2align 8
.type k34_kernel,@function
k34_kernel:
    s_cmp_ge_u32 s2, 256
    s_cbranch_scc1 k4_done
    v_and_b32 v2, 63, v0
    v_lshrrev_b32 v1, 6, v0
    s_nop 0
    v_readfirstlane_b32 s3, v1
    s_load_dwordx2 s[4:5], s[0:1], 16
    s_load_dwordx2 s[6:7], s[0:1], 72
    s_load_dwordx2 s[34:35], s[0:1], 0
    s_load_dwordx4 s[44:47], s[0:1], 32
    s_load_dwordx2 s[48:49], s[0:1], 48
    s_cmp_ge_u32 s3, 4
    s_cbranch_scc1 k34_help
    s_and_b32 s16, s2, 7
    s_lshr_b32 s17, s2, 3
    s_lshr_b32 s18, s16, 1
    s_lshl_b32 s18, s18, 2
    s_and_b32 s19, s17, 3
    s_add_u32 s20, s18, s19
    s_and_b32 s18, s16, 1
    s_lshl_b32 s18, s18, 3
    s_lshr_b32 s19, s17, 2
    s_add_u32 s21, s18, s19
    s_lshl_b32 s22, s20, 2
    s_add_u32 s22, s22, s3
    s_mul_i32 s16, s22, 65536
    v_lshlrev_b32 v212, 4, v2
    v_add_u32 v212, s16, v212
    s_mul_i32 s16, s22, 65536
    s_lshl_b32 s17, s21, 12
    s_add_u32 s16, s16, s17
    v_lshlrev_b32 v217, 4, v2
    v_add_u32 v217, s16, v217
    v_and_b32 v218, 31, v2
    v_lshlrev_b32 v218, 11, v218
    v_lshrrev_b32 v3, 5, v2
    v_lshl_add_u32 v218, v3, 4, v218
    s_lshl_b32 s16, s22, 16
    s_lshl_b32 s17, s21, 7
    s_add_u32 s16, s16, s17
    v_add_u32 v218, s16, v218
    v_lshrrev_b32 v213, 5, v2
    v_lshlrev_b32 v213, 8, v213
    v_bfe_u32 v3, v2, 2, 2
    v_lshl_add_u32 v213, v3, 6, v213
    v_bfe_u32 v3, v2, 4, 1
    v_lshl_add_u32 v213, v3, 5, v213
    v_and_b32 v3, 3, v2
    v_lshl_add_u32 v213, v3, 3, v213
    v_bfe_u32 v3, v2, 2, 3
    s_mov_b32 s16, 2048
    v_mul_lo_u32 v215, v3, s16
    v_lshrrev_b32 v3, 5, v2
    v_lshl_add_u32 v215, v3, 6, v215
    v_and_b32 v3, 3, v2
    v_lshl_add_u32 v215, v3, 4, v215
    s_mul_i32 s16, s3, 32768
    s_lshl_b32 s17, s21, 7
    s_add_u32 s16, s16, s17
    v_add_u32 v215, s16, v215
    v_add_u32 v216, 16384, v215
    s_lshl_b32 s23, s3, 11
    s_add_u32 s23, s23, 86400
    v_add_u32 v213, 86400, v213
    s_waitcnt lgkmcnt(0)
    s_add_u32 s8, s6, 16777216
    s_addc_u32 s9, s7, 0
    s_mov_b32 s10, 4194304
    s_mov_b32 s11, 0x00020000
    s_mov_b32 s12, s4
    s_mov_b32 s13, s5
    s_mov_b32 s14, 2097152
    s_mov_b32 s15, 0x00020000
    s_add_u32 s36, s6, 20971520
    s_addc_u32 s37, s7, 0
    s_mov_b32 s38, 4194304
    s_mov_b32 s39, 0x00020000
    s_mov_b32 s40, s34
    s_mov_b32 s41, s35
    s_mov_b32 s42, 4194304
    s_mov_b32 s43, 0x00020000
    s_mov_b32 s25, 0
    s_add_u32 m0, s23, 0
    s_nop 0
    buffer_load_dwordx4 v215, s[12:15], s25 offen lds
    s_add_u32 m0, s23, 1024
    s_nop 0
    buffer_load_dwordx4 v216, s[12:15], s25 offen lds
    s_mov_b32 s24, 0
    buffer_load_dwordx4 v[52:55], v212, s[8:11], s24 offen offset:0
    buffer_load_dwordx4 v[56:59], v212, s[8:11], s24 offen offset:1024
    buffer_load_dwordx4 v[60:63], v212, s[8:11], s24 offen offset:2048
    buffer_load_dwordx4 v[64:67], v212, s[8:11], s24 offen offset:3072
    s_mov_b32 s25, 131072
    s_add_u32 m0, s23, 8192
    s_nop 0
    buffer_load_dwordx4 v215, s[12:15], s25 offen lds
    s_add_u32 m0, s23, 9216
    s_nop 0
    buffer_load_dwordx4 v216, s[12:15], s25 offen lds
    s_mov_b32 s24, 4096
    buffer_load_dwordx4 v[68:71], v212, s[8:11], s24 offen offset:0
    buffer_load_dwordx4 v[72:75], v212, s[8:11], s24 offen offset:1024
    buffer_load_dwordx4 v[76:79], v212, s[8:11], s24 offen offset:2048
    buffer_load_dwordx4 v[80:83], v212, s[8:11], s24 offen offset:3072
    buffer_load_dwordx4 v[36:39], v218, s[40:43], 0 offen offset:0
    buffer_load_dwordx4 v[40:43], v218, s[40:43], 0 offen offset:32
    buffer_load_dwordx4 v[44:47], v218, s[40:43], 0 offen offset:64
    buffer_load_dwordx4 v[48:51], v218, s[40:43], 0 offen offset:96
    s_waitcnt vmcnt(14)
    s_barrier
    v_mov_b32 v214, v213
    ds_read_b64_tr_b16 v[180:181], v214 offset:0
    ds_read_b64_tr_b16 v[182:183], v214 offset:1024
    ds_read_b64_tr_b16 v[184:185], v214 offset:512
    ds_read_b64_tr_b16 v[186:187], v214 offset:1536
    ds_read_b64_tr_b16 v[188:189], v214 offset:2048
    ds_read_b64_tr_b16 v[190:191], v214 offset:3072
    ds_read_b64_tr_b16 v[192:193], v214 offset:2560
    ds_read_b64_tr_b16 v[194:195], v214 offset:3584
    ds_read_b64_tr_b16 v[196:197], v214 offset:4096
    ds_read_b64_tr_b16 v[198:199], v214 offset:5120
    ds_read_b64_tr_b16 v[200:201], v214 offset:4608
    ds_read_b64_tr_b16 v[202:203], v214 offset:5632
    ds_read_b64_tr_b16 v[204:205], v214 offset:6144
    ds_read_b64_tr_b16 v[206:207], v214 offset:7168
    ds_read_b64_tr_b16 v[208:209], v214 offset:6656
    ds_read_b64_tr_b16 v[210:211], v214 offset:7680
    s_waitcnt lgkmcnt(14)
    s_waitcnt vmcnt(13)
    v_mfma_f32_32x32x16_bf16 v[4:19], v[180:183], v[52:55], 0
    s_waitcnt vmcnt(8)
    s_barrier
    v_add_u32 v214, 8192, v213
    ds_read_b64_tr_b16 v[180:181], v214 offset:0
    ds_read_b64_tr_b16 v[182:183], v214 offset:1024
    s_mov_b32 s25, 262144
    s_add_u32 m0, s23, 16384
    s_nop 0
    buffer_load_dwordx4 v215, s[12:15], s25 offen lds
    s_add_u32 m0, s23, 17408
    s_nop 0
    buffer_load_dwordx4 v216, s[12:15], s25 offen lds
    s_waitcnt lgkmcnt(14)
    v_mfma_f32_32x32x16_bf16 v[20:35], v[184:187], v[52:55], 0
    ds_read_b64_tr_b16 v[184:185], v214 offset:512
    ds_read_b64_tr_b16 v[186:187], v214 offset:1536
    s_mov_b32 s24, 8192
    buffer_load_dwordx4 v[84:87], v212, s[8:11], s24 offen offset:0
    buffer_load_dwordx4 v[88:91], v212, s[8:11], s24 offen offset:1024
    s_waitcnt lgkmcnt(14)
    v_mfma_f32_32x32x16_bf16 v[4:19], v[188:191], v[56:59], v[4:19]
    ds_read_b64_tr_b16 v[188:189], v214 offset:2048
    ds_read_b64_tr_b16 v[190:191], v214 offset:3072
    buffer_load_dwordx4 v[92:95], v212, s[8:11], s24 offen offset:2048
    buffer_load_dwordx4 v[96:99], v212, s[8:11], s24 offen offset:3072
    s_waitcnt lgkmcnt(14)
    v_mfma_f32_32x32x16_bf16 v[20:35], v[192:195], v[56:59], v[20:35]
    ds_read_b64_tr_b16 v[192:193], v214 offset:2560
    ds_read_b64_tr_b16 v[194:195], v214 offset:3584
    s_mov_b32 s25, 393216
    s_add_u32 m0, s23, 24576
    s_nop 0
    buffer_load_dwordx4 v215, s[12:15], s25 offen lds
    s_add_u32 m0, s23, 25600
    s_nop 0
    buffer_load_dwordx4 v216, s[12:15], s25 offen lds
    s_waitcnt lgkmcnt(14)
    v_mfma_f32_32x32x16_bf16 v[4:19], v[196:199], v[60:63], v[4:19]
    ds_read_b64_tr_b16 v[196:197], v214 offset:4096
    ds_read_b64_tr_b16 v[198:199], v214 offset:5120
    s_mov_b32 s24, 12288
    buffer_load_dwordx4 v[100:103], v212, s[8:11], s24 offen offset:0
    buffer_load_dwordx4 v[104:107], v212, s[8:11], s24 offen offset:1024
    s_waitcnt lgkmcnt(14)
    v_mfma_f32_32x32x16_bf16 v[20:35], v[200:203], v[60:63], v[20:35]
    ds_read_b64_tr_b16 v[200:201], v214 offset:4608
    ds_read_b64_tr_b16 v[202:203], v214 offset:5632
    buffer_load_dwordx4 v[108:111], v212, s[8:11], s24 offen offset:2048
    buffer_load_dwordx4 v[112:115], v212, s[8:11], s24 offen offset:3072
    s_waitcnt lgkmcnt(14)
    v_mfma_f32_32x32x16_bf16 v[4:19], v[204:207], v[64:67], v[4:19]
    ds_read_b64_tr_b16 v[204:205], v214 offset:6144
    ds_read_b64_tr_b16 v[206:207], v214 offset:7168
    s_mov_b32 s25, 524288
    s_add_u32 m0, s23, 32768
    s_nop 0
    buffer_load_dwordx4 v215, s[12:15], s25 offen lds
    s_add_u32 m0, s23, 33792
    s_nop 0
    buffer_load_dwordx4 v216, s[12:15], s25 offen lds
    s_waitcnt lgkmcnt(14)
    v_mfma_f32_32x32x16_bf16 v[20:35], v[208:211], v[64:67], v[20:35]
    ds_read_b64_tr_b16 v[208:209], v214 offset:6656
    ds_read_b64_tr_b16 v[210:211], v214 offset:7680
    s_mov_b32 s24, 16384
    buffer_load_dwordx4 v[116:119], v212, s[8:11], s24 offen offset:0
    buffer_load_dwordx4 v[120:123], v212, s[8:11], s24 offen offset:1024
    s_waitcnt lgkmcnt(14)
    s_waitcnt vmcnt(23)
    v_mfma_f32_32x32x16_bf16 v[4:19], v[180:183], v[68:71], v[4:19]
    s_waitcnt vmcnt(14)
    s_barrier
    v_add_u32 v214, 16384, v213
    ds_read_b64_tr_b16 v[180:181], v214 offset:0
    ds_read_b64_tr_b16 v[182:183], v214 offset:1024
    buffer_load_dwordx4 v[124:127], v212, s[8:11], s24 offen offset:2048
    buffer_load_dwordx4 v[128:131], v212, s[8:11], s24 offen offset:3072
    s_waitcnt lgkmcnt(14)
    v_mfma_f32_32x32x16_bf16 v[20:35], v[184:187], v[68:71], v[20:35]
    ds_read_b64_tr_b16 v[184:185], v214 offset:512
    ds_read_b64_tr_b16 v[186:187], v214 offset:1536
    s_mov_b32 s25, 655360
    s_add_u32 m0, s23, 40960
    s_nop 0
    buffer_load_dwordx4 v215, s[12:15], s25 offen lds
    s_add_u32 m0, s23, 41984
    s_nop 0
    buffer_load_dwordx4 v216, s[12:15], s25 offen lds
    s_waitcnt lgkmcnt(14)
    v_mfma_f32_32x32x16_bf16 v[4:19], v[188:191], v[72:75], v[4:19]
    ds_read_b64_tr_b16 v[188:189], v214 offset:2048
    ds_read_b64_tr_b16 v[190:191], v214 offset:3072
    s_mov_b32 s24, 20480
    buffer_load_dwordx4 v[132:135], v212, s[8:11], s24 offen offset:0
    buffer_load_dwordx4 v[136:139], v212, s[8:11], s24 offen offset:1024
    s_waitcnt lgkmcnt(14)
    v_mfma_f32_32x32x16_bf16 v[20:35], v[192:195], v[72:75], v[20:35]
    ds_read_b64_tr_b16 v[192:193], v214 offset:2560
    ds_read_b64_tr_b16 v[194:195], v214 offset:3584
    buffer_load_dwordx4 v[140:143], v212, s[8:11], s24 offen offset:2048
    buffer_load_dwordx4 v[144:147], v212, s[8:11], s24 offen offset:3072
    s_waitcnt lgkmcnt(14)
    v_mfma_f32_32x32x16_bf16 v[4:19], v[196:199], v[76:79], v[4:19]
    ds_read_b64_tr_b16 v[196:197], v214 offset:4096
    ds_read_b64_tr_b16 v[198:199], v214 offset:5120
    s_mov_b32 s25, 786432
    s_add_u32 m0, s23, 49152
    s_nop 0
    buffer_load_dwordx4 v215, s[12:15], s25 offen lds
    s_add_u32 m0, s23, 50176
    s_nop 0
    buffer_load_dwordx4 v216, s[12:15], s25 offen lds
    s_waitcnt lgkmcnt(14)
    v_mfma_f32_32x32x16_bf16 v[20:35], v[200:203], v[76:79], v[20:35]
    ds_read_b64_tr_b16 v[200:201], v214 offset:4608
    ds_read_b64_tr_b16 v[202:203], v214 offset:5632
    s_mov_b32 s24, 24576
    buffer_load_dwordx4 v[148:151], v212, s[8:11], s24 offen offset:0
    buffer_load_dwordx4 v[152:155], v212, s[8:11], s24 offen offset:1024
    s_waitcnt lgkmcnt(14)
    v_mfma_f32_32x32x16_bf16 v[4:19], v[204:207], v[80:83], v[4:19]
    ds_read_b64_tr_b16 v[204:205], v214 offset:6144
    ds_read_b64_tr_b16 v[206:207], v214 offset:7168
    buffer_load_dwordx4 v[156:159], v212, s[8:11], s24 offen offset:2048
    buffer_load_dwordx4 v[160:163], v212, s[8:11], s24 offen offset:3072
    s_waitcnt lgkmcnt(14)
    v_mfma_f32_32x32x16_bf16 v[20:35], v[208:211], v[80:83], v[20:35]
    ds_read_b64_tr_b16 v[208:209], v214 offset:6656
    ds_read_b64_tr_b16 v[210:211], v214 offset:7680
    s_mov_b32 s24, 28672
    buffer_load_dwordx4 v[164:167], v212, s[8:11], s24 offen offset:0
    buffer_load_dwordx4 v[168:171], v212, s[8:11], s24 offen offset:1024
    s_waitcnt lgkmcnt(14)
    s_waitcnt vmcnt(29)
    v_mfma_f32_32x32x16_bf16 v[4:19], v[180:183], v[84:87], v[4:19]
    s_waitcnt vmcnt(24)
    s_barrier
    v_add_u32 v214, 24576, v213
    ds_read_b64_tr_b16 v[180:181], v214 offset:0
    ds_read_b64_tr_b16 v[182:183], v214 offset:1024
    buffer_load_dwordx4 v[172:175], v212, s[8:11], s24 offen offset:2048
    buffer_load_dwordx4 v[176:179], v212, s[8:11], s24 offen offset:3072
    s_waitcnt lgkmcnt(14)
    v_mfma_f32_32x32x16_bf16 v[20:35], v[184:187], v[84:87], v[20:35]
    ds_read_b64_tr_b16 v[184:185], v214 offset:512
    ds_read_b64_tr_b16 v[186:187], v214 offset:1536
    s_mov_b32 s25, 917504
    s_add_u32 m0, s23, 57344
    s_nop 0
    buffer_load_dwordx4 v215, s[12:15], s25 offen lds
    s_add_u32 m0, s23, 58368
    s_nop 0
    buffer_load_dwordx4 v216, s[12:15], s25 offen lds
    s_waitcnt lgkmcnt(14)
    v_mfma_f32_32x32x16_bf16 v[4:19], v[188:191], v[88:91], v[4:19]
    ds_read_b64_tr_b16 v[188:189], v214 offset:2048
    ds_read_b64_tr_b16 v[190:191], v214 offset:3072
    s_mov_b32 s24, 32768
    buffer_load_dwordx4 v[52:55], v212, s[8:11], s24 offen offset:0
    buffer_load_dwordx4 v[56:59], v212, s[8:11], s24 offen offset:1024
    s_waitcnt lgkmcnt(14)
    v_mfma_f32_32x32x16_bf16 v[20:35], v[192:195], v[88:91], v[20:35]
    ds_read_b64_tr_b16 v[192:193], v214 offset:2560
    ds_read_b64_tr_b16 v[194:195], v214 offset:3584
    buffer_load_dwordx4 v[60:63], v212, s[8:11], s24 offen offset:2048
    buffer_load_dwordx4 v[64:67], v212, s[8:11], s24 offen offset:3072
    s_waitcnt lgkmcnt(14)
    v_mfma_f32_32x32x16_bf16 v[4:19], v[196:199], v[92:95], v[4:19]
    ds_read_b64_tr_b16 v[196:197], v214 offset:4096
    ds_read_b64_tr_b16 v[198:199], v214 offset:5120
    s_mov_b32 s25, 1048576
    s_add_u32 m0, s23, 0
    s_nop 0
    buffer_load_dwordx4 v215, s[12:15], s25 offen lds
    s_add_u32 m0, s23, 1024
    s_nop 0
    buffer_load_dwordx4 v216, s[12:15], s25 offen lds
    s_waitcnt lgkmcnt(14)
    v_mfma_f32_32x32x16_bf16 v[20:35], v[200:203], v[92:95], v[20:35]
    ds_read_b64_tr_b16 v[200:201], v214 offset:4608
    ds_read_b64_tr_b16 v[202:203], v214 offset:5632
    s_mov_b32 s24, 36864
    buffer_load_dwordx4 v[68:71], v212, s[8:11], s24 offen offset:0
    buffer_load_dwordx4 v[72:75], v212, s[8:11], s24 offen offset:1024
    s_waitcnt lgkmcnt(14)
    v_mfma_f32_32x32x16_bf16 v[4:19], v[204:207], v[96:99], v[4:19]
    ds_read_b64_tr_b16 v[204:205], v214 offset:6144
    ds_read_b64_tr_b16 v[206:207], v214 offset:7168
    buffer_load_dwordx4 v[76:79], v212, s[8:11], s24 offen offset:2048
    buffer_load_dwordx4 v[80:83], v212, s[8:11], s24 offen offset:3072
    s_waitcnt lgkmcnt(14)
    v_mfma_f32_32x32x16_bf16 v[20:35], v[208:211], v[96:99], v[20:35]
    ds_read_b64_tr_b16 v[208:209], v214 offset:6656
    ds_read_b64_tr_b16 v[210:211], v214 offset:7680
    s_mov_b32 s25, 1179648
    s_add_u32 m0, s23, 8192
    s_nop 0
    buffer_load_dwordx4 v215, s[12:15], s25 offen lds
    s_add_u32 m0, s23, 9216
    s_nop 0
    buffer_load_dwordx4 v216, s[12:15], s25 offen lds
    s_waitcnt lgkmcnt(14)
    s_waitcnt vmcnt(39)
    v_mfma_f32_32x32x16_bf16 v[4:19], v[180:183], v[100:103], v[4:19]
    s_waitcnt vmcnt(34)
    s_barrier
    v_add_u32 v214, 32768, v213
    ds_read_b64_tr_b16 v[180:181], v214 offset:0
    ds_read_b64_tr_b16 v[182:183], v214 offset:1024
    s_mov_b32 s24, 40960
    buffer_load_dwordx4 v[84:87], v212, s[8:11], s24 offen offset:0
    buffer_load_dwordx4 v[88:91], v212, s[8:11], s24 offen offset:1024
    s_waitcnt lgkmcnt(14)
    v_mfma_f32_32x32x16_bf16 v[20:35], v[184:187], v[100:103], v[20:35]
    ds_read_b64_tr_b16 v[184:185], v214 offset:512
    ds_read_b64_tr_b16 v[186:187], v214 offset:1536
    buffer_load_dwordx4 v[92:95], v212, s[8:11], s24 offen offset:2048
    buffer_load_dwordx4 v[96:99], v212, s[8:11], s24 offen offset:3072
    s_waitcnt lgkmcnt(14)
    v_mfma_f32_32x32x16_bf16 v[4:19], v[188:191], v[104:107], v[4:19]
    ds_read_b64_tr_b16 v[188:189], v214 offset:2048
    ds_read_b64_tr_b16 v[190:191], v214 offset:3072
    s_mov_b32 s25, 1310720
    s_add_u32 m0, s23, 16384
    s_nop 0
    buffer_load_dwordx4 v215, s[12:15], s25 offen lds
    s_add_u32 m0, s23, 17408
    s_nop 0
    buffer_load_dwordx4 v216, s[12:15], s25 offen lds
    s_waitcnt lgkmcnt(14)
    v_mfma_f32_32x32x16_bf16 v[20:35], v[192:195], v[104:107], v[20:35]
    ds_read_b64_tr_b16 v[192:193], v214 offset:2560
    ds_read_b64_tr_b16 v[194:195], v214 offset:3584
    s_mov_b32 s24, 45056
    buffer_load_dwordx4 v[100:103], v212, s[8:11], s24 offen offset:0
    s_waitcnt lgkmcnt(14)
    v_mfma_f32_32x32x16_bf16 v[4:19], v[196:199], v[108:111], v[4:19]
    ds_read_b64_tr_b16 v[196:197], v214 offset:4096
    ds_read_b64_tr_b16 v[198:199], v214 offset:5120
    buffer_load_dwordx4 v[104:107], v212, s[8:11], s24 offen offset:1024
    s_waitcnt lgkmcnt(14)
    v_mfma_f32_32x32x16_bf16 v[20:35], v[200:203], v[108:111], v[20:35]
    ds_read_b64_tr_b16 v[200:201], v214 offset:4608
    ds_read_b64_tr_b16 v[202:203], v214 offset:5632
    s_waitcnt lgkmcnt(14)
    v_mfma_f32_32x32x16_bf16 v[4:19], v[204:207], v[112:115], v[4:19]
    ds_read_b64_tr_b16 v[204:205], v214 offset:6144
    ds_read_b64_tr_b16 v[206:207], v214 offset:7168
    buffer_load_dwordx4 v[108:111], v212, s[8:11], s24 offen offset:2048
    s_waitcnt lgkmcnt(14)
    v_mfma_f32_32x32x16_bf16 v[20:35], v[208:211], v[112:115], v[20:35]
    ds_read_b64_tr_b16 v[208:209], v214 offset:6656
    ds_read_b64_tr_b16 v[210:211], v214 offset:7680
    s_waitcnt lgkmcnt(14)
    s_waitcnt vmcnt(42)
    v_mfma_f32_32x32x16_bf16 v[4:19], v[180:183], v[116:119], v[4:19]
    s_waitcnt vmcnt(37)
    s_barrier
    v_add_u32 v214, 40960, v213
    ds_read_b64_tr_b16 v[180:181], v214 offset:0
    ds_read_b64_tr_b16 v[182:183], v214 offset:1024
    buffer_load_dwordx4 v[112:115], v212, s[8:11], s24 offen offset:3072
    s_mov_b32 s25, 1441792
    s_add_u32 m0, s23, 24576
    s_nop 0
    buffer_load_dwordx4 v215, s[12:15], s25 offen lds
    s_waitcnt lgkmcnt(14)
    v_mfma_f32_32x32x16_bf16 v[20:35], v[184:187], v[116:119], v[20:35]
    ds_read_b64_tr_b16 v[184:185], v214 offset:512
    ds_read_b64_tr_b16 v[186:187], v214 offset:1536
    s_add_u32 m0, s23, 25600
    s_nop 0
    buffer_load_dwordx4 v216, s[12:15], s25 offen lds
    s_waitcnt lgkmcnt(14)
    v_mfma_f32_32x32x16_bf16 v[4:19], v[188:191], v[120:123], v[4:19]
    ds_read_b64_tr_b16 v[188:189], v214 offset:2048
    ds_read_b64_tr_b16 v[190:191], v214 offset:3072
    s_mov_b32 s24, 49152
    buffer_load_dwordx4 v[116:119], v212, s[8:11], s24 offen offset:0
    s_waitcnt lgkmcnt(14)
    v_mfma_f32_32x32x16_bf16 v[20:35], v[192:195], v[120:123], v[20:35]
    ds_read_b64_tr_b16 v[192:193], v214 offset:2560
    ds_read_b64_tr_b16 v[194:195], v214 offset:3584
    s_waitcnt lgkmcnt(14)
    v_mfma_f32_32x32x16_bf16 v[4:19], v[196:199], v[124:127], v[4:19]
    ds_read_b64_tr_b16 v[196:197], v214 offset:4096
    ds_read_b64_tr_b16 v[198:199], v214 offset:5120
    buffer_load_dwordx4 v[120:123], v212, s[8:11], s24 offen offset:1024
    s_waitcnt lgkmcnt(14)
    v_mfma_f32_32x32x16_bf16 v[20:35], v[200:203], v[124:127], v[20:35]
    ds_read_b64_tr_b16 v[200:201], v214 offset:4608
    ds_read_b64_tr_b16 v[202:203], v214 offset:5632
    s_waitcnt lgkmcnt(14)
    v_mfma_f32_32x32x16_bf16 v[4:19], v[204:207], v[128:131], v[4:19]
    ds_read_b64_tr_b16 v[204:205], v214 offset:6144
    ds_read_b64_tr_b16 v[206:207], v214 offset:7168
    buffer_load_dwordx4 v[124:127], v212, s[8:11], s24 offen offset:2048
    s_waitcnt lgkmcnt(14)
    v_mfma_f32_32x32x16_bf16 v[20:35], v[208:211], v[128:131], v[20:35]
    ds_read_b64_tr_b16 v[208:209], v214 offset:6656
    ds_read_b64_tr_b16 v[210:211], v214 offset:7680
    s_waitcnt lgkmcnt(14)
    s_waitcnt vmcnt(42)
    v_mfma_f32_32x32x16_bf16 v[4:19], v[180:183], v[132:135], v[4:19]
    s_waitcnt vmcnt(37)
    s_barrier
    v_add_u32 v214, 49152, v213
    ds_read_b64_tr_b16 v[180:181], v214 offset:0
    ds_read_b64_tr_b16 v[182:183], v214 offset:1024
    buffer_load_dwordx4 v[128:131], v212, s[8:11], s24 offen offset:3072
    s_mov_b32 s25, 1572864
    s_add_u32 m0, s23, 32768
    s_nop 0
    buffer_load_dwordx4 v215, s[12:15], s25 offen lds
    s_waitcnt lgkmcnt(14)
    v_mfma_f32_32x32x16_bf16 v[20:35], v[184:187], v[132:135], v[20:35]
    ds_read_b64_tr_b16 v[184:185], v214 offset:512
    ds_read_b64_tr_b16 v[186:187], v214 offset:1536
    s_add_u32 m0, s23, 33792
    s_nop 0
    buffer_load_dwordx4 v216, s[12:15], s25 offen lds
    s_waitcnt lgkmcnt(14)
    v_mfma_f32_32x32x16_bf16 v[4:19], v[188:191], v[136:139], v[4:19]
    ds_read_b64_tr_b16 v[188:189], v214 offset:2048
    ds_read_b64_tr_b16 v[190:191], v214 offset:3072
    s_mov_b32 s24, 53248
    buffer_load_dwordx4 v[132:135], v212, s[8:11], s24 offen offset:0
    s_waitcnt lgkmcnt(14)
    v_mfma_f32_32x32x16_bf16 v[20:35], v[192:195], v[136:139], v[20:35]
    ds_read_b64_tr_b16 v[192:193], v214 offset:2560
    ds_read_b64_tr_b16 v[194:195], v214 offset:3584
    s_waitcnt lgkmcnt(14)
    v_mfma_f32_32x32x16_bf16 v[4:19], v[196:199], v[140:143], v[4:19]
    ds_read_b64_tr_b16 v[196:197], v214 offset:4096
    ds_read_b64_tr_b16 v[198:199], v214 offset:5120
    buffer_load_dwordx4 v[136:139], v212, s[8:11], s24 offen offset:1024
    s_waitcnt lgkmcnt(14)
    v_mfma_f32_32x32x16_bf16 v[20:35], v[200:203], v[140:143], v[20:35]
    ds_read_b64_tr_b16 v[200:201], v214 offset:4608
    ds_read_b64_tr_b16 v[202:203], v214 offset:5632
    s_waitcnt lgkmcnt(14)
    v_mfma_f32_32x32x16_bf16 v[4:19], v[204:207], v[144:147], v[4:19]
    ds_read_b64_tr_b16 v[204:205], v214 offset:6144
    ds_read_b64_tr_b16 v[206:207], v214 offset:7168
    buffer_load_dwordx4 v[140:143], v212, s[8:11], s24 offen offset:2048
    s_waitcnt lgkmcnt(14)
    v_mfma_f32_32x32x16_bf16 v[20:35], v[208:211], v[144:147], v[20:35]
    ds_read_b64_tr_b16 v[208:209], v214 offset:6656
    ds_read_b64_tr_b16 v[210:211], v214 offset:7680
    s_waitcnt lgkmcnt(14)
    s_waitcnt vmcnt(42)
    v_mfma_f32_32x32x16_bf16 v[4:19], v[180:183], v[148:151], v[4:19]
    s_waitcnt vmcnt(33)
    s_barrier
    v_add_u32 v214, 57344, v213
    ds_read_b64_tr_b16 v[180:181], v214 offset:0
    ds_read_b64_tr_b16 v[182:183], v214 offset:1024
    buffer_load_dwordx4 v[144:147], v212, s[8:11], s24 offen offset:3072
    s_mov_b32 s25, 1703936
    s_add_u32 m0, s23, 40960
    s_nop 0
    buffer_load_dwordx4 v215, s[12:15], s25 offen lds
    s_waitcnt lgkmcnt(14)
    v_mfma_f32_32x32x16_bf16 v[20:35], v[184:187], v[148:151], v[20:35]
    ds_read_b64_tr_b16 v[184:185], v214 offset:512
    ds_read_b64_tr_b16 v[186:187], v214 offset:1536
    s_add_u32 m0, s23, 41984
    s_nop 0
    buffer_load_dwordx4 v216, s[12:15], s25 offen lds
    s_waitcnt lgkmcnt(14)
    v_mfma_f32_32x32x16_bf16 v[4:19], v[188:191], v[152:155], v[4:19]
    ds_read_b64_tr_b16 v[188:189], v214 offset:2048
    ds_read_b64_tr_b16 v[190:191], v214 offset:3072
    s_mov_b32 s24, 57344
    buffer_load_dwordx4 v[148:151], v212, s[8:11], s24 offen offset:0
    s_waitcnt lgkmcnt(14)
    v_mfma_f32_32x32x16_bf16 v[20:35], v[192:195], v[152:155], v[20:35]
    ds_read_b64_tr_b16 v[192:193], v214 offset:2560
    ds_read_b64_tr_b16 v[194:195], v214 offset:3584
    s_waitcnt lgkmcnt(14)
    v_mfma_f32_32x32x16_bf16 v[4:19], v[196:199], v[156:159], v[4:19]
    ds_read_b64_tr_b16 v[196:197], v214 offset:4096
    ds_read_b64_tr_b16 v[198:199], v214 offset:5120
    buffer_load_dwordx4 v[152:155], v212, s[8:11], s24 offen offset:1024
    s_waitcnt lgkmcnt(14)
    v_mfma_f32_32x32x16_bf16 v[20:35], v[200:203], v[156:159], v[20:35]
    ds_read_b64_tr_b16 v[200:201], v214 offset:4608
    ds_read_b64_tr_b16 v[202:203], v214 offset:5632
    s_waitcnt lgkmcnt(14)
    v_mfma_f32_32x32x16_bf16 v[4:19], v[204:207], v[160:163], v[4:19]
    ds_read_b64_tr_b16 v[204:205], v214 offset:6144
    ds_read_b64_tr_b16 v[206:207], v214 offset:7168
    buffer_load_dwordx4 v[156:159], v212, s[8:11], s24 offen offset:2048
    s_waitcnt lgkmcnt(14)
    v_mfma_f32_32x32x16_bf16 v[20:35], v[208:211], v[160:163], v[20:35]
    ds_read_b64_tr_b16 v[208:209], v214 offset:6656
    ds_read_b64_tr_b16 v[210:211], v214 offset:7680
    s_waitcnt lgkmcnt(14)
    v_mfma_f32_32x32x16_bf16 v[4:19], v[180:183], v[164:167], v[4:19]
    s_waitcnt vmcnt(33)
    s_barrier
    v_add_u32 v214, 0, v213
    ds_read_b64_tr_b16 v[180:181], v214 offset:0
    ds_read_b64_tr_b16 v[182:183], v214 offset:1024
    buffer_load_dwordx4 v[160:163], v212, s[8:11], s24 offen offset:3072
    s_mov_b32 s25, 1835008
    s_add_u32 m0, s23, 49152
    s_nop 0
    buffer_load_dwordx4 v215, s[12:15], s25 offen lds
    s_waitcnt lgkmcnt(14)
    v_mfma_f32_32x32x16_bf16 v[20:35], v[184:187], v[164:167], v[20:35]
    ds_read_b64_tr_b16 v[184:185], v214 offset:512
    ds_read_b64_tr_b16 v[186:187], v214 offset:1536
    s_add_u32 m0, s23, 50176
    s_nop 0
    buffer_load_dwordx4 v216, s[12:15], s25 offen lds
    s_waitcnt lgkmcnt(14)
    v_mfma_f32_32x32x16_bf16 v[4:19], v[188:191], v[168:171], v[4:19]
    ds_read_b64_tr_b16 v[188:189], v214 offset:2048
    ds_read_b64_tr_b16 v[190:191], v214 offset:3072
    s_mov_b32 s24, 61440
    buffer_load_dwordx4 v[164:167], v212, s[8:11], s24 offen offset:0
    s_waitcnt lgkmcnt(14)
    v_mfma_f32_32x32x16_bf16 v[20:35], v[192:195], v[168:171], v[20:35]
    ds_read_b64_tr_b16 v[192:193], v214 offset:2560
    ds_read_b64_tr_b16 v[194:195], v214 offset:3584
    s_waitcnt lgkmcnt(14)
    v_mfma_f32_32x32x16_bf16 v[4:19], v[196:199], v[172:175], v[4:19]
    ds_read_b64_tr_b16 v[196:197], v214 offset:4096
    ds_read_b64_tr_b16 v[198:199], v214 offset:5120
    buffer_load_dwordx4 v[168:171], v212, s[8:11], s24 offen offset:1024
    s_waitcnt lgkmcnt(14)
    v_mfma_f32_32x32x16_bf16 v[20:35], v[200:203], v[172:175], v[20:35]
    ds_read_b64_tr_b16 v[200:201], v214 offset:4608
    ds_read_b64_tr_b16 v[202:203], v214 offset:5632
    s_waitcnt lgkmcnt(14)
    v_mfma_f32_32x32x16_bf16 v[4:19], v[204:207], v[176:179], v[4:19]
    ds_read_b64_tr_b16 v[204:205], v214 offset:6144
    ds_read_b64_tr_b16 v[206:207], v214 offset:7168
    buffer_load_dwordx4 v[172:175], v212, s[8:11], s24 offen offset:2048
    s_waitcnt lgkmcnt(14)
    v_mfma_f32_32x32x16_bf16 v[20:35], v[208:211], v[176:179], v[20:35]
    ds_read_b64_tr_b16 v[208:209], v214 offset:6656
    ds_read_b64_tr_b16 v[210:211], v214 offset:7680
    s_waitcnt lgkmcnt(14)
    v_mfma_f32_32x32x16_bf16 v[4:19], v[180:183], v[52:55], v[4:19]
    s_waitcnt vmcnt(33)
    s_barrier
    v_add_u32 v214, 8192, v213
    ds_read_b64_tr_b16 v[180:181], v214 offset:0
    ds_read_b64_tr_b16 v[182:183], v214 offset:1024
    buffer_load_dwordx4 v[176:179], v212, s[8:11], s24 offen offset:3072
    s_mov_b32 s25, 1966080
    s_add_u32 m0, s23, 57344
    s_nop 0
    buffer_load_dwordx4 v215, s[12:15], s25 offen lds
    s_waitcnt lgkmcnt(14)
    v_mfma_f32_32x32x16_bf16 v[20:35], v[184:187], v[52:55], v[20:35]
    ds_read_b64_tr_b16 v[184:185], v214 offset:512
    ds_read_b64_tr_b16 v[186:187], v214 offset:1536
    s_add_u32 m0, s23, 58368
    s_nop 0
    buffer_load_dwordx4 v216, s[12:15], s25 offen lds
    s_waitcnt lgkmcnt(14)
    v_mfma_f32_32x32x16_bf16 v[4:19], v[188:191], v[56:59], v[4:19]
    ds_read_b64_tr_b16 v[188:189], v214 offset:2048
    ds_read_b64_tr_b16 v[190:191], v214 offset:3072
    s_waitcnt lgkmcnt(14)
    v_mfma_f32_32x32x16_bf16 v[20:35], v[192:195], v[56:59], v[20:35]
    ds_read_b64_tr_b16 v[192:193], v214 offset:2560
    ds_read_b64_tr_b16 v[194:195], v214 offset:3584
    s_waitcnt lgkmcnt(14)
    v_mfma_f32_32x32x16_bf16 v[4:19], v[196:199], v[60:63], v[4:19]
    ds_read_b64_tr_b16 v[196:197], v214 offset:4096
    ds_read_b64_tr_b16 v[198:199], v214 offset:5120
    s_waitcnt lgkmcnt(14)
    v_mfma_f32_32x32x16_bf16 v[20:35], v[200:203], v[60:63], v[20:35]
    ds_read_b64_tr_b16 v[200:201], v214 offset:4608
    ds_read_b64_tr_b16 v[202:203], v214 offset:5632
    s_waitcnt lgkmcnt(14)
    v_mfma_f32_32x32x16_bf16 v[4:19], v[204:207], v[64:67], v[4:19]
    ds_read_b64_tr_b16 v[204:205], v214 offset:6144
    ds_read_b64_tr_b16 v[206:207], v214 offset:7168
    s_waitcnt lgkmcnt(14)
    v_mfma_f32_32x32x16_bf16 v[20:35], v[208:211], v[64:67], v[20:35]
    ds_read_b64_tr_b16 v[208:209], v214 offset:6656
    ds_read_b64_tr_b16 v[210:211], v214 offset:7680
    s_waitcnt lgkmcnt(14)
    v_mfma_f32_32x32x16_bf16 v[4:19], v[180:183], v[68:71], v[4:19]
    s_waitcnt vmcnt(30)
    s_barrier
    v_add_u32 v214, 16384, v213
    ds_read_b64_tr_b16 v[180:181], v214 offset:0
    ds_read_b64_tr_b16 v[182:183], v214 offset:1024
    s_waitcnt lgkmcnt(14)
    v_mfma_f32_32x32x16_bf16 v[20:35], v[184:187], v[68:71], v[20:35]
    ds_read_b64_tr_b16 v[184:185], v214 offset:512
    ds_read_b64_tr_b16 v[186:187], v214 offset:1536
    s_waitcnt lgkmcnt(14)
    v_mfma_f32_32x32x16_bf16 v[4:19], v[188:191], v[72:75], v[4:19]
    ds_read_b64_tr_b16 v[188:189], v214 offset:2048
    ds_read_b64_tr_b16 v[190:191], v214 offset:3072
    s_waitcnt lgkmcnt(14)
    v_mfma_f32_32x32x16_bf16 v[20:35], v[192:195], v[72:75], v[20:35]
    ds_read_b64_tr_b16 v[192:193], v214 offset:2560
    ds_read_b64_tr_b16 v[194:195], v214 offset:3584
    s_waitcnt lgkmcnt(14)
    v_mfma_f32_32x32x16_bf16 v[4:19], v[196:199], v[76:79], v[4:19]
    ds_read_b64_tr_b16 v[196:197], v214 offset:4096
    ds_read_b64_tr_b16 v[198:199], v214 offset:5120
    s_waitcnt lgkmcnt(14)
    v_mfma_f32_32x32x16_bf16 v[20:35], v[200:203], v[76:79], v[20:35]
    ds_read_b64_tr_b16 v[200:201], v214 offset:4608
    ds_read_b64_tr_b16 v[202:203], v214 offset:5632
    s_waitcnt lgkmcnt(14)
    v_mfma_f32_32x32x16_bf16 v[4:19], v[204:207], v[80:83], v[4:19]
    ds_read_b64_tr_b16 v[204:205], v214 offset:6144
    ds_read_b64_tr_b16 v[206:207], v214 offset:7168
    s_waitcnt lgkmcnt(14)
    v_mfma_f32_32x32x16_bf16 v[20:35], v[208:211], v[80:83], v[20:35]
    ds_read_b64_tr_b16 v[208:209], v214 offset:6656
    ds_read_b64_tr_b16 v[210:211], v214 offset:7680
    s_waitcnt lgkmcnt(14)
    v_mfma_f32_32x32x16_bf16 v[4:19], v[180:183], v[84:87], v[4:19]
    s_waitcnt vmcnt(24)
    s_barrier
    v_add_u32 v214, 24576, v213
    ds_read_b64_tr_b16 v[180:181], v214 offset:0
    ds_read_b64_tr_b16 v[182:183], v214 offset:1024
    s_waitcnt lgkmcnt(14)
    v_mfma_f32_32x32x16_bf16 v[20:35], v[184:187], v[84:87], v[20:35]
    ds_read_b64_tr_b16 v[184:185], v214 offset:512
    ds_read_b64_tr_b16 v[186:187], v214 offset:1536
    s_waitcnt lgkmcnt(14)
    v_mfma_f32_32x32x16_bf16 v[4:19], v[188:191], v[88:91], v[4:19]
    ds_read_b64_tr_b16 v[188:189], v214 offset:2048
    ds_read_b64_tr_b16 v[190:191], v214 offset:3072
    s_waitcnt lgkmcnt(14)
    v_mfma_f32_32x32x16_bf16 v[20:35], v[192:195], v[88:91], v[20:35]
    ds_read_b64_tr_b16 v[192:193], v214 offset:2560
    ds_read_b64_tr_b16 v[194:195], v214 offset:3584
    s_waitcnt lgkmcnt(14)
    v_mfma_f32_32x32x16_bf16 v[4:19], v[196:199], v[92:95], v[4:19]
    ds_read_b64_tr_b16 v[196:197], v214 offset:4096
    ds_read_b64_tr_b16 v[198:199], v214 offset:5120
    s_waitcnt lgkmcnt(14)
    v_mfma_f32_32x32x16_bf16 v[20:35], v[200:203], v[92:95], v[20:35]
    ds_read_b64_tr_b16 v[200:201], v214 offset:4608
    ds_read_b64_tr_b16 v[202:203], v214 offset:5632
    s_waitcnt lgkmcnt(14)
    v_mfma_f32_32x32x16_bf16 v[4:19], v[204:207], v[96:99], v[4:19]
    ds_read_b64_tr_b16 v[204:205], v214 offset:6144
    ds_read_b64_tr_b16 v[206:207], v214 offset:7168
    s_waitcnt lgkmcnt(14)
    v_mfma_f32_32x32x16_bf16 v[20:35], v[208:211], v[96:99], v[20:35]
    ds_read_b64_tr_b16 v[208:209], v214 offset:6656
    ds_read_b64_tr_b16 v[210:211], v214 offset:7680
    s_waitcnt lgkmcnt(14)
    v_mfma_f32_32x32x16_bf16 v[4:19], v[180:183], v[100:103], v[4:19]
    s_waitcnt vmcnt(18)
    s_barrier
    v_add_u32 v214, 32768, v213
    ds_read_b64_tr_b16 v[180:181], v214 offset:0
    ds_read_b64_tr_b16 v[182:183], v214 offset:1024
    s_waitcnt lgkmcnt(14)
    v_mfma_f32_32x32x16_bf16 v[20:35], v[184:187], v[100:103], v[20:35]
    ds_read_b64_tr_b16 v[184:185], v214 offset:512
    ds_read_b64_tr_b16 v[186:187], v214 offset:1536
    s_waitcnt lgkmcnt(14)
    v_mfma_f32_32x32x16_bf16 v[4:19], v[188:191], v[104:107], v[4:19]
    ds_read_b64_tr_b16 v[188:189], v214 offset:2048
    ds_read_b64_tr_b16 v[190:191], v214 offset:3072
    s_waitcnt lgkmcnt(14)
    v_mfma_f32_32x32x16_bf16 v[20:35], v[192:195], v[104:107], v[20:35]
    ds_read_b64_tr_b16 v[192:193], v214 offset:2560
    ds_read_b64_tr_b16 v[194:195], v214 offset:3584
    s_waitcnt lgkmcnt(14)
    v_mfma_f32_32x32x16_bf16 v[4:19], v[196:199], v[108:111], v[4:19]
    ds_read_b64_tr_b16 v[196:197], v214 offset:4096
    ds_read_b64_tr_b16 v[198:199], v214 offset:5120
    s_waitcnt lgkmcnt(14)
    v_mfma_f32_32x32x16_bf16 v[20:35], v[200:203], v[108:111], v[20:35]
    ds_read_b64_tr_b16 v[200:201], v214 offset:4608
    ds_read_b64_tr_b16 v[202:203], v214 offset:5632
    s_waitcnt lgkmcnt(14)
    v_mfma_f32_32x32x16_bf16 v[4:19], v[204:207], v[112:115], v[4:19]
    ds_read_b64_tr_b16 v[204:205], v214 offset:6144
    ds_read_b64_tr_b16 v[206:207], v214 offset:7168
    s_waitcnt lgkmcnt(14)
    v_mfma_f32_32x32x16_bf16 v[20:35], v[208:211], v[112:115], v[20:35]
    ds_read_b64_tr_b16 v[208:209], v214 offset:6656
    ds_read_b64_tr_b16 v[210:211], v214 offset:7680
    s_and_b32 s76, s2, 7
    s_lshr_b32 s76, s76, 1
    s_lshl_b32 s76, s76, 3
    s_lshr_b32 s77, s2, 5
    s_add_u32 s76, s76, s77
    s_lshr_b32 s77, s3, 1
    s_mul_i32 s86, s77, 3584
    s_mul_i32 s77, s77, 114688
    s_mul_i32 s76, s76, 224
    s_add_u32 s77, s77, s76
    v_add_u32 v244, 0, v2
    v_mul_u32_u24 v245, 4682, v244
    v_lshrrev_b32 v245, 16, v245
    v_mul_u32_u24 v246, 14, v245
    v_sub_u32 v246, v244, v246
    v_mul_u32_u24 v245, 7168, v245
    v_lshl_add_u32 v245, v246, 4, v245
    v_add_u32 v248, s77, v245
    v_add_u32 v244, 64, v2
    v_mul_u32_u24 v245, 4682, v244
    v_lshrrev_b32 v245, 16, v245
    v_mul_u32_u24 v246, 14, v245
    v_sub_u32 v246, v244, v246
    v_mul_u32_u24 v245, 7168, v245
    v_lshl_add_u32 v245, v246, 4, v245
    v_add_u32 v249, s77, v245
    v_add_u32 v244, 128, v2
    v_mul_u32_u24 v245, 4682, v244
    v_lshrrev_b32 v245, 16, v245
    v_mul_u32_u24 v246, 14, v245
    v_sub_u32 v246, v244, v246
    v_mul_u32_u24 v245, 7168, v245
    v_lshl_add_u32 v245, v246, 4, v245
    v_add_u32 v250, s77, v245
    v_add_u32 v244, 192, v2
    v_mul_u32_u24 v245, 4682, v244
    v_lshrrev_b32 v245, 16, v245
    v_mul_u32_u24 v246, 14, v245
    v_sub_u32 v246, v244, v246
    v_mul_u32_u24 v245, 7168, v245
    v_lshl_add_u32 v245, v246, 4, v245
    v_add_u32 v251, s77, v245
    s_and_b32 s76, s3, 1
    s_mul_i32 s77, s76, 14464
    s_add_u32 s86, s86, s77
    s_cmp_eq_u32 s76, 0
    s_cselect_b32 s92, s44, s46
    s_cselect_b32 s93, s45, s47
    s_mov_b32 s94, 7340032
    s_mov_b32 s95, 0x00020000
    s_waitcnt lgkmcnt(14)
    v_mfma_f32_32x32x16_bf16 v[4:19], v[180:183], v[116:119], v[4:19]
    s_waitcnt vmcnt(12)
    s_barrier
    v_add_u32 v214, 40960, v213
    ds_read_b64_tr_b16 v[180:181], v214 offset:0
    ds_read_b64_tr_b16 v[182:183], v214 offset:1024
    s_mov_b32 s87, 0
    s_add_u32 m0, s86, 0
    s_nop 0
    buffer_load_dwordx4 v248, s[92:95], s87 offen lds
    s_add_u32 m0, s86, 1024
    s_nop 0
    buffer_load_dwordx4 v249, s[92:95], s87 offen lds
    s_waitcnt lgkmcnt(14)
    v_mfma_f32_32x32x16_bf16 v[20:35], v[184:187], v[116:119], v[20:35]
    ds_read_b64_tr_b16 v[184:185], v214 offset:512
    ds_read_b64_tr_b16 v[186:187], v214 offset:1536
    s_add_u32 m0, s86, 2048
    s_nop 0
    buffer_load_dwordx4 v250, s[92:95], s87 offen lds
    s_add_u32 m0, s86, 3072
    s_mov_b32 exec_hi, 0
    buffer_load_dwordx4 v251, s[92:95], s87 offen lds
    s_mov_b32 exec_hi, -1
    s_waitcnt lgkmcnt(14)
    v_mfma_f32_32x32x16_bf16 v[4:19], v[188:191], v[120:123], v[4:19]
    ds_read_b64_tr_b16 v[188:189], v214 offset:2048
    ds_read_b64_tr_b16 v[190:191], v214 offset:3072
    s_mov_b32 s87, 458752
    s_add_u32 m0, s86, 28800
    s_nop 0
    buffer_load_dwordx4 v248, s[92:95], s87 offen lds
    s_add_u32 m0, s86, 29824
    s_nop 0
    buffer_load_dwordx4 v249, s[92:95], s87 offen lds
    s_waitcnt lgkmcnt(14)
    v_mfma_f32_32x32x16_bf16 v[20:35], v[192:195], v[120:123], v[20:35]
    ds_read_b64_tr_b16 v[192:193], v214 offset:2560
    ds_read_b64_tr_b16 v[194:195], v214 offset:3584
    s_add_u32 m0, s86, 30848
    s_nop 0
    buffer_load_dwordx4 v250, s[92:95], s87 offen lds
    s_add_u32 m0, s86, 31872
    s_mov_b32 exec_hi, 0
    buffer_load_dwordx4 v251, s[92:95], s87 offen lds
    s_mov_b32 exec_hi, -1
    s_waitcnt lgkmcnt(14)
    v_mfma_f32_32x32x16_bf16 v[4:19], v[196:199], v[124:127], v[4:19]
    ds_read_b64_tr_b16 v[196:197], v214 offset:4096
    ds_read_b64_tr_b16 v[198:199], v214 offset:5120
    s_mov_b32 s87, 917504
    s_add_u32 m0, s86, 57600
    s_nop 0
    buffer_load_dwordx4 v248, s[92:95], s87 offen lds
    s_add_u32 m0, s86, 58624
    s_nop 0
    buffer_load_dwordx4 v249, s[92:95], s87 offen lds
    s_waitcnt lgkmcnt(14)
    v_mfma_f32_32x32x16_bf16 v[20:35], v[200:203], v[124:127], v[20:35]
    ds_read_b64_tr_b16 v[200:201], v214 offset:4608
    ds_read_b64_tr_b16 v[202:203], v214 offset:5632
    s_add_u32 m0, s86, 59648
    s_nop 0
    buffer_load_dwordx4 v250, s[92:95], s87 offen lds
    s_add_u32 m0, s86, 60672
    s_mov_b32 exec_hi, 0
    buffer_load_dwordx4 v251, s[92:95], s87 offen lds
    s_mov_b32 exec_hi, -1
    s_waitcnt lgkmcnt(14)
    v_mfma_f32_32x32x16_bf16 v[4:19], v[204:207], v[128:131], v[4:19]
    ds_read_b64_tr_b16 v[204:205], v214 offset:6144
    ds_read_b64_tr_b16 v[206:207], v214 offset:7168
    s_waitcnt lgkmcnt(14)
    v_mfma_f32_32x32x16_bf16 v[20:35], v[208:211], v[128:131], v[20:35]
    ds_read_b64_tr_b16 v[208:209], v214 offset:6656
    ds_read_b64_tr_b16 v[210:211], v214 offset:7680
    s_waitcnt lgkmcnt(14)
    v_mfma_f32_32x32x16_bf16 v[4:19], v[180:183], v[132:135], v[4:19]
    s_waitcnt vmcnt(18)
    s_barrier
    v_add_u32 v214, 49152, v213
    ds_read_b64_tr_b16 v[180:181], v214 offset:0
    ds_read_b64_tr_b16 v[182:183], v214 offset:1024
    s_waitcnt lgkmcnt(14)
    v_mfma_f32_32x32x16_bf16 v[20:35], v[184:187], v[132:135], v[20:35]
    ds_read_b64_tr_b16 v[184:185], v214 offset:512
    ds_read_b64_tr_b16 v[186:187], v214 offset:1536
    s_waitcnt lgkmcnt(14)
    v_mfma_f32_32x32x16_bf16 v[4:19], v[188:191], v[136:139], v[4:19]
    ds_read_b64_tr_b16 v[188:189], v214 offset:2048
    ds_read_b64_tr_b16 v[190:191], v214 offset:3072
    s_waitcnt lgkmcnt(14)
    v_mfma_f32_32x32x16_bf16 v[20:35], v[192:195], v[136:139], v[20:35]
    ds_read_b64_tr_b16 v[192:193], v214 offset:2560
    ds_read_b64_tr_b16 v[194:195], v214 offset:3584
    s_waitcnt lgkmcnt(14)
    v_mfma_f32_32x32x16_bf16 v[4:19], v[196:199], v[140:143], v[4:19]
    ds_read_b64_tr_b16 v[196:197], v214 offset:4096
    ds_read_b64_tr_b16 v[198:199], v214 offset:5120
    s_waitcnt lgkmcnt(14)
    v_mfma_f32_32x32x16_bf16 v[20:35], v[200:203], v[140:143], v[20:35]
    ds_read_b64_tr_b16 v[200:201], v214 offset:4608
    ds_read_b64_tr_b16 v[202:203], v214 offset:5632
    s_waitcnt lgkmcnt(14)
    v_mfma_f32_32x32x16_bf16 v[4:19], v[204:207], v[144:147], v[4:19]
    ds_read_b64_tr_b16 v[204:205], v214 offset:6144
    ds_read_b64_tr_b16 v[206:207], v214 offset:7168
    s_waitcnt lgkmcnt(14)
    v_mfma_f32_32x32x16_bf16 v[20:35], v[208:211], v[144:147], v[20:35]
    ds_read_b64_tr_b16 v[208:209], v214 offset:6656
    ds_read_b64_tr_b16 v[210:211], v214 offset:7680
    s_waitcnt lgkmcnt(14)
    v_mfma_f32_32x32x16_bf16 v[4:19], v[180:183], v[148:151], v[4:19]
    s_waitcnt vmcnt(12)
    s_barrier
    v_add_u32 v214, 57344, v213
    ds_read_b64_tr_b16 v[180:181], v214 offset:0
    ds_read_b64_tr_b16 v[182:183], v214 offset:1024
    s_waitcnt lgkmcnt(14)
    v_mfma_f32_32x32x16_bf16 v[20:35], v[184:187], v[148:151], v[20:35]
    ds_read_b64_tr_b16 v[184:185], v214 offset:512
    ds_read_b64_tr_b16 v[186:187], v214 offset:1536
    s_waitcnt lgkmcnt(14)
    v_mfma_f32_32x32x16_bf16 v[4:19], v[188:191], v[152:155], v[4:19]
    ds_read_b64_tr_b16 v[188:189], v214 offset:2048
    ds_read_b64_tr_b16 v[190:191], v214 offset:3072
    s_waitcnt lgkmcnt(14)
    v_mfma_f32_32x32x16_bf16 v[20:35], v[192:195], v[152:155], v[20:35]
    ds_read_b64_tr_b16 v[192:193], v214 offset:2560
    ds_read_b64_tr_b16 v[194:195], v214 offset:3584
    s_waitcnt lgkmcnt(14)
    v_mfma_f32_32x32x16_bf16 v[4:19], v[196:199], v[156:159], v[4:19]
    ds_read_b64_tr_b16 v[196:197], v214 offset:4096
    ds_read_b64_tr_b16 v[198:199], v214 offset:5120
    s_waitcnt lgkmcnt(14)
    v_mfma_f32_32x32x16_bf16 v[20:35], v[200:203], v[156:159], v[20:35]
    ds_read_b64_tr_b16 v[200:201], v214 offset:4608
    ds_read_b64_tr_b16 v[202:203], v214 offset:5632
    s_waitcnt lgkmcnt(14)
    v_mfma_f32_32x32x16_bf16 v[4:19], v[204:207], v[160:163], v[4:19]
    ds_read_b64_tr_b16 v[204:205], v214 offset:6144
    ds_read_b64_tr_b16 v[206:207], v214 offset:7168
    s_waitcnt lgkmcnt(14)
    v_mfma_f32_32x32x16_bf16 v[20:35], v[208:211], v[160:163], v[20:35]
    ds_read_b64_tr_b16 v[208:209], v214 offset:6656
    ds_read_b64_tr_b16 v[210:211], v214 offset:7680
    s_waitcnt lgkmcnt(14)
    v_mfma_f32_32x32x16_bf16 v[4:19], v[180:183], v[164:167], v[4:19]
    s_waitcnt lgkmcnt(12)
    v_mfma_f32_32x32x16_bf16 v[20:35], v[184:187], v[164:167], v[20:35]
    s_waitcnt lgkmcnt(10)
    v_mfma_f32_32x32x16_bf16 v[4:19], v[188:191], v[168:171], v[4:19]
    s_waitcnt lgkmcnt(8)
    v_mfma_f32_32x32x16_bf16 v[20:35], v[192:195], v[168:171], v[20:35]
    s_waitcnt lgkmcnt(6)
    v_mfma_f32_32x32x16_bf16 v[4:19], v[196:199], v[172:175], v[4:19]
    s_waitcnt lgkmcnt(4)
    v_mfma_f32_32x32x16_bf16 v[20:35], v[200:203], v[172:175], v[20:35]
    s_waitcnt lgkmcnt(2)
    v_mfma_f32_32x32x16_bf16 v[4:19], v[204:207], v[176:179], v[4:19]
    s_waitcnt lgkmcnt(0)
    v_mfma_f32_32x32x16_bf16 v[20:35], v[208:211], v[176:179], v[20:35]
    s_waitcnt lgkmcnt(0)
    s_nop 15
    v_permlane32_swap_b32 v36, v38
    v_permlane32_swap_b32 v37, v39
    v_permlane32_swap_b32 v40, v42
    v_permlane32_swap_b32 v41, v43
    v_permlane32_swap_b32 v44, v46
    v_permlane32_swap_b32 v45, v47
    v_permlane32_swap_b32 v48, v50
    v_permlane32_swap_b32 v49, v51
    s_nop 1
    v_lshlrev_b32 v84, 16, v36
    v_and_b32 v85, 0xffff0000, v36
    v_add_f32 v4, v4, v84
    v_add_f32 v5, v5, v85
    v_lshlrev_b32 v84, 16, v37
    v_and_b32 v85, 0xffff0000, v37
    v_add_f32 v6, v6, v84
    v_add_f32 v7, v7, v85
    v_lshlrev_b32 v84, 16, v38
    v_and_b32 v85, 0xffff0000, v38
    v_add_f32 v8, v8, v84
    v_add_f32 v9, v9, v85
    v_lshlrev_b32 v84, 16, v39
    v_and_b32 v85, 0xffff0000, v39
    v_add_f32 v10, v10, v84
    v_add_f32 v11, v11, v85
    v_lshlrev_b32 v84, 16, v40
    v_and_b32 v85, 0xffff0000, v40
    v_add_f32 v12, v12, v84
    v_add_f32 v13, v13, v85
    v_lshlrev_b32 v84, 16, v41
    v_and_b32 v85, 0xffff0000, v41
    v_add_f32 v14, v14, v84
    v_add_f32 v15, v15, v85
    v_lshlrev_b32 v84, 16, v42
    v_and_b32 v85, 0xffff0000, v42
    v_add_f32 v16, v16, v84
    v_add_f32 v17, v17, v85
    v_lshlrev_b32 v84, 16, v43
    v_and_b32 v85, 0xffff0000, v43
    v_add_f32 v18, v18, v84
    v_add_f32 v19, v19, v85
    v_lshlrev_b32 v84, 16, v44
    v_and_b32 v85, 0xffff0000, v44
    v_add_f32 v20, v20, v84
    v_add_f32 v21, v21, v85
    v_lshlrev_b32 v84, 16, v45
    v_and_b32 v85, 0xffff0000, v45
    v_add_f32 v22, v22, v84
    v_add_f32 v23, v23, v85
    v_lshlrev_b32 v84, 16, v46
    v_and_b32 v85, 0xffff0000, v46
    v_add_f32 v24, v24, v84
    v_add_f32 v25, v25, v85
    v_lshlrev_b32 v84, 16, v47
    v_and_b32 v85, 0xffff0000, v47
    v_add_f32 v26, v26, v84
    v_add_f32 v27, v27, v85
    v_lshlrev_b32 v84, 16, v48
    v_and_b32 v85, 0xffff0000, v48
    v_add_f32 v28, v28, v84
    v_add_f32 v29, v29, v85
    v_lshlrev_b32 v84, 16, v49
    v_and_b32 v85, 0xffff0000, v49
    v_add_f32 v30, v30, v84
    v_add_f32 v31, v31, v85
    v_lshlrev_b32 v84, 16, v50
    v_and_b32 v85, 0xffff0000, v50
    v_add_f32 v32, v32, v84
    v_add_f32 v33, v33, v85
    v_lshlrev_b32 v84, 16, v51
    v_and_b32 v85, 0xffff0000, v51
    v_add_f32 v34, v34, v84
    v_add_f32 v35, v35, v85
    v_cvt_pk_bf16_f32 v88, v4, v5
    v_cvt_pk_bf16_f32 v89, v6, v7
    v_cvt_pk_bf16_f32 v90, v8, v9
    v_cvt_pk_bf16_f32 v91, v10, v11
    v_cvt_pk_bf16_f32 v92, v12, v13
    v_cvt_pk_bf16_f32 v93, v14, v15
    v_cvt_pk_bf16_f32 v94, v16, v17
    v_cvt_pk_bf16_f32 v95, v18, v19
    v_cvt_pk_bf16_f32 v96, v20, v21
    v_cvt_pk_bf16_f32 v97, v22, v23
    v_cvt_pk_bf16_f32 v98, v24, v25
    v_cvt_pk_bf16_f32 v99, v26, v27
    v_cvt_pk_bf16_f32 v100, v28, v29
    v_cvt_pk_bf16_f32 v101, v30, v31
    v_cvt_pk_bf16_f32 v102, v32, v33
    v_cvt_pk_bf16_f32 v103, v34, v35
    buffer_store_dwordx4 v[88:91], v217, s[36:39], 0 offen offset:0 sc1
    buffer_store_dwordx4 v[92:95], v217, s[36:39], 0 offen offset:1024 sc1
    buffer_store_dwordx4 v[96:99], v217, s[36:39], 0 offen offset:2048 sc1
    buffer_store_dwordx4 v[100:103], v217, s[36:39], 0 offen offset:3072 sc1
    v_mov_b32 v104, 0
    v_mov_b32 v105, 0
    v_lshlrev_b32 v84, 16, v88
    v_and_b32 v85, 0xffff0000, v88
    v_add_f32 v104, v104, v84
    v_fma_f32 v105, v84, v84, v105
    v_add_f32 v104, v104, v85
    v_fma_f32 v105, v85, v85, v105
    v_lshlrev_b32 v84, 16, v89
    v_and_b32 v85, 0xffff0000, v89
    v_add_f32 v104, v104, v84
    v_fma_f32 v105, v84, v84, v105
    v_add_f32 v104, v104, v85
    v_fma_f32 v105, v85, v85, v105
    v_lshlrev_b32 v84, 16, v90
    v_and_b32 v85, 0xffff0000, v90
    v_add_f32 v104, v104, v84
    v_fma_f32 v105, v84, v84, v105
    v_add_f32 v104, v104, v85
    v_fma_f32 v105, v85, v85, v105
    v_lshlrev_b32 v84, 16, v91
    v_and_b32 v85, 0xffff0000, v91
    v_add_f32 v104, v104, v84
    v_fma_f32 v105, v84, v84, v105
    v_add_f32 v104, v104, v85
    v_fma_f32 v105, v85, v85, v105
    v_lshlrev_b32 v84, 16, v92
    v_and_b32 v85, 0xffff0000, v92
    v_add_f32 v104, v104, v84
    v_fma_f32 v105, v84, v84, v105
    v_add_f32 v104, v104, v85
    v_fma_f32 v105, v85, v85, v105
    v_lshlrev_b32 v84, 16, v93
    v_and_b32 v85, 0xffff0000, v93
    v_add_f32 v104, v104, v84
    v_fma_f32 v105, v84, v84, v105
    v_add_f32 v104, v104, v85
    v_fma_f32 v105, v85, v85, v105
    v_lshlrev_b32 v84, 16, v94
    v_and_b32 v85, 0xffff0000, v94
    v_add_f32 v104, v104, v84
    v_fma_f32 v105, v84, v84, v105
    v_add_f32 v104, v104, v85
    v_fma_f32 v105, v85, v85, v105
    v_lshlrev_b32 v84, 16, v95
    v_and_b32 v85, 0xffff0000, v95
    v_add_f32 v104, v104, v84
    v_fma_f32 v105, v84, v84, v105
    v_add_f32 v104, v104, v85
    v_fma_f32 v105, v85, v85, v105
    v_lshlrev_b32 v84, 16, v96
    v_and_b32 v85, 0xffff0000, v96
    v_add_f32 v104, v104, v84
    v_fma_f32 v105, v84, v84, v105
    v_add_f32 v104, v104, v85
    v_fma_f32 v105, v85, v85, v105
    v_lshlrev_b32 v84, 16, v97
    v_and_b32 v85, 0xffff0000, v97
    v_add_f32 v104, v104, v84
    v_fma_f32 v105, v84, v84, v105
    v_add_f32 v104, v104, v85
    v_fma_f32 v105, v85, v85, v105
    v_lshlrev_b32 v84, 16, v98
    v_and_b32 v85, 0xffff0000, v98
    v_add_f32 v104, v104, v84
    v_fma_f32 v105, v84, v84, v105
    v_add_f32 v104, v104, v85
    v_fma_f32 v105, v85, v85, v105
    v_lshlrev_b32 v84, 16, v99
    v_and_b32 v85, 0xffff0000, v99
    v_add_f32 v104, v104, v84
    v_fma_f32 v105, v84, v84, v105
    v_add_f32 v104, v104, v85
    v_fma_f32 v105, v85, v85, v105
    v_lshlrev_b32 v84, 16, v100
    v_and_b32 v85, 0xffff0000, v100
    v_add_f32 v104, v104, v84
    v_fma_f32 v105, v84, v84, v105
    v_add_f32 v104, v104, v85
    v_fma_f32 v105, v85, v85, v105
    v_lshlrev_b32 v84, 16, v101
    v_and_b32 v85, 0xffff0000, v101
    v_add_f32 v104, v104, v84
    v_fma_f32 v105, v84, v84, v105
    v_add_f32 v104, v104, v85
    v_fma_f32 v105, v85, v85, v105
    v_lshlrev_b32 v84, 16, v102
    v_and_b32 v85, 0xffff0000, v102
    v_add_f32 v104, v104, v84
    v_fma_f32 v105, v84, v84, v105
    v_add_f32 v104, v104, v85
    v_fma_f32 v105, v85, v85, v105
    v_lshlrev_b32 v84, 16, v103
    v_and_b32 v85, 0xffff0000, v103
    v_add_f32 v104, v104, v84
    v_fma_f32 v105, v84, v84, v105
    v_add_f32 v104, v104, v85
    v_fma_f32 v105, v85, v85, v105
    v_mov_b32 v106, v104
    v_mov_b32 v107, v105
    s_nop 1
    v_permlane32_swap_b32 v104, v106
    v_permlane32_swap_b32 v105, v107
    s_nop 1
    v_add_f32 v104, v104, v106
    v_add_f32 v105, v105, v107
    s_add_u32 s44, s6, 27262976
    s_addc_u32 s45, s7, 0
    s_mov_b32 s46, 262144
    s_mov_b32 s47, 0x00020000
    v_and_b32 v84, 31, v2
    v_lshlrev_b32 v84, 3, v84
    s_lshl_b32 s16, s22, 8
    s_lshl_b32 s17, s21, 14
    s_add_u32 s16, s16, s17
    s_mov_b32 exec_hi, 0
    buffer_store_dwordx2 v[104:105], v84, s[44:47], s16 offen sc1
    s_mov_b32 exec_hi, -1
    s_branch k34_go
k34_help:
    s_waitcnt lgkmcnt(0)
    s_and_b32 s76, s2, 7
    s_lshr_b32 s76, s76, 1
    s_lshl_b32 s76, s76, 3
    s_lshr_b32 s77, s2, 5
    s_add_u32 s76, s76, s77
    s_lshr_b32 s77, s3, 1
    s_mul_i32 s86, s77, 3584
    s_mul_i32 s77, s77, 114688
    s_mul_i32 s76, s76, 224
    s_add_u32 s77, s77, s76
    v_add_u32 v244, 0, v2
    v_mul_u32_u24 v245, 4682, v244
    v_lshrrev_b32 v245, 16, v245
    v_mul_u32_u24 v246, 14, v245
    v_sub_u32 v246, v244, v246
    v_mul_u32_u24 v245, 7168, v245
    v_lshl_add_u32 v245, v246, 4, v245
    v_add_u32 v248, s77, v245
    v_add_u32 v244, 64, v2
    v_mul_u32_u24 v245, 4682, v244
    v_lshrrev_b32 v245, 16, v245
    v_mul_u32_u24 v246, 14, v245
    v_sub_u32 v246, v244, v246
    v_mul_u32_u24 v245, 7168, v245
    v_lshl_add_u32 v245, v246, 4, v245
    v_add_u32 v249, s77, v245
    v_add_u32 v244, 128, v2
    v_mul_u32_u24 v245, 4682, v244
    v_lshrrev_b32 v245, 16, v245
    v_mul_u32_u24 v246, 14, v245
    v_sub_u32 v246, v244, v246
    v_mul_u32_u24 v245, 7168, v245
    v_lshl_add_u32 v245, v246, 4, v245
    v_add_u32 v250, s77, v245
    v_add_u32 v244, 192, v2
    v_mul_u32_u24 v245, 4682, v244
    v_lshrrev_b32 v245, 16, v245
    v_mul_u32_u24 v246, 14, v245
    v_sub_u32 v246, v244, v246
    v_mul_u32_u24 v245, 7168, v245
    v_lshl_add_u32 v245, v246, 4, v245
    v_add_u32 v251, s77, v245
    s_and_b32 s76, s3, 1
    s_mul_i32 s77, s76, 14464
    s_add_u32 s86, s86, s77
    s_cmp_eq_u32 s76, 0
    s_cselect_b32 s92, s44, s46
    s_cselect_b32 s93, s45, s47
    s_mov_b32 s94, 7340032
    s_mov_b32 s95, 0x00020000
    s_sub_u32 s53, s3, 4
    s_sub_u32 s17, s2, 112
    s_cmp_ge_u32 s2, 112
    s_cselect_b32 s17, s17, s2
    s_cselect_b32 s50, 1, 0
    s_cselect_b32 s4, s46, s44
    s_cselect_b32 s5, s47, s45
    s_lshr_b32 s51, s17, 2
    s_and_b32 s52, s2, 3
    v_lshrrev_b32 v4, 4, v2
    v_mul_u32_u24 v4, 7168, v4
    v_and_b32 v3, 15, v2
    v_lshl_add_u32 v4, v3, 4, v4
    s_lshl_b32 s19, s52, 2
    s_add_u32 s19, s19, s53
    s_mul_i32 s19, s19, 458752
    s_lshl_b32 s18, s51, 8
    s_add_u32 s19, s19, s18
    s_cmp_ge_u32 s2, 224
    s_cselect_b32 s19, 2130706432, s19
    v_add_u32 v4, s19, v4
    s_mov_b32 s56, s4
    s_mov_b32 s57, s5
    s_mov_b32 s58, 7340032
    s_mov_b32 s59, 0x00020000
    s_mul_i32 s79, s50, 3584
    s_lshl_b32 s18, s51, 7
    s_add_u32 s79, s79, s18
    s_lshl_b32 s79, s79, 4
    s_lshl_b32 s18, s52, 2
    s_add_u32 s79, s79, s18
    v_and_b32 v16, 15, v2
    v_and_b32 v17, 1, v2
    v_lshlrev_b32 v17, 4, v17
    v_mov_b32 v18, 0x3f80
    v_lshlrev_b32 v17, v17, v18
    v_lshrrev_b32 v16, 1, v16
    v_cmp_eq_u32 vcc, 0, v16
    v_cndmask_b32 v8, 0, v17, vcc
    v_cmp_eq_u32 vcc, 1, v16
    v_cndmask_b32 v9, 0, v17, vcc
    v_cmp_eq_u32 vcc, 2, v16
    v_cndmask_b32 v10, 0, v17, vcc
    v_cmp_eq_u32 vcc, 3, v16
    v_cndmask_b32 v11, 0, v17, vcc
    v_and_b32 v5, 15, v2
    v_lshlrev_b32 v5, 5, v5
    v_bfe_u32 v16, v2, 4, 1
    v_lshl_add_u32 v5, v16, 4, v5
    s_lshl_b32 s16, s53, 9
    s_add_u32 s16, s16, 151936
    v_add_u32 v5, s16, v5
    s_barrier
    s_barrier
    s_barrier
    s_barrier
    s_barrier
    s_barrier
    s_barrier
    s_barrier
    s_barrier
    s_barrier
    s_barrier
    s_mov_b32 s87, 0
    s_add_u32 m0, s86, 0
    s_nop 0
    buffer_load_dwordx4 v248, s[92:95], s87 offen lds
    s_add_u32 m0, s86, 1024
    s_nop 0
    buffer_load_dwordx4 v249, s[92:95], s87 offen lds
    s_add_u32 m0, s86, 2048
    s_nop 0
    buffer_load_dwordx4 v250, s[92:95], s87 offen lds
    s_add_u32 m0, s86, 3072
    s_mov_b32 exec_hi, 0
    buffer_load_dwordx4 v251, s[92:95], s87 offen lds
    s_mov_b32 exec_hi, -1
    s_mov_b32 s87, 458752
    s_add_u32 m0, s86, 28800
    s_nop 0
    buffer_load_dwordx4 v248, s[92:95], s87 offen lds
    s_add_u32 m0, s86, 29824
    s_nop 0
    buffer_load_dwordx4 v249, s[92:95], s87 offen lds
    s_add_u32 m0, s86, 30848
    s_nop 0
    buffer_load_dwordx4 v250, s[92:95], s87 offen lds
    s_add_u32 m0, s86, 31872
    s_mov_b32 exec_hi, 0
    buffer_load_dwordx4 v251, s[92:95], s87 offen lds
    s_mov_b32 exec_hi, -1
    s_mov_b32 s87, 917504
    s_add_u32 m0, s86, 57600
    s_nop 0
    buffer_load_dwordx4 v248, s[92:95], s87 offen lds
    s_add_u32 m0, s86, 58624
    s_nop 0
    buffer_load_dwordx4 v249, s[92:95], s87 offen lds
    s_add_u32 m0, s86, 59648
    s_nop 0
    buffer_load_dwordx4 v250, s[92:95], s87 offen lds
    s_add_u32 m0, s86, 60672
    s_mov_b32 exec_hi, 0
    buffer_load_dwordx4 v251, s[92:95], s87 offen lds
    s_mov_b32 exec_hi, -1
    s_barrier
    s_mov_b32 s33, 0
    buffer_load_dwordx4 v[20:23], v4, s[56:59], s33 offen
    s_mov_b32 s33, 28672
    buffer_load_dwordx4 v[24:27], v4, s[56:59], s33 offen
    s_mov_b32 s33, 57344
    buffer_load_dwordx4 v[28:31], v4, s[56:59], s33 offen
    s_mov_b32 s33, 86016
    buffer_load_dwordx4 v[32:35], v4, s[56:59], s33 offen
    s_barrier
    s_mov_b32 s33, 114688
    buffer_load_dwordx4 v[36:39], v4, s[56:59], s33 offen
    s_mov_b32 s33, 143360
    buffer_load_dwordx4 v[40:43], v4, s[56:59], s33 offen
    s_mov_b32 s33, 172032
    buffer_load_dwordx4 v[44:47], v4, s[56:59], s33 offen
    s_mov_b32 s33, 200704
    buffer_load_dwordx4 v[48:51], v4, s[56:59], s33 offen
    s_barrier
    s_mov_b32 s33, 229376
    buffer_load_dwordx4 v[52:55], v4, s[56:59], s33 offen
    s_mov_b32 s33, 258048
    buffer_load_dwordx4 v[56:59], v4, s[56:59], s33 offen
    s_mov_b32 s33, 286720
    buffer_load_dwordx4 v[60:63], v4, s[56:59], s33 offen
    s_mov_b32 s33, 315392
    buffer_load_dwordx4 v[64:67], v4, s[56:59], s33 offen
    s_barrier
    s_mov_b32 s33, 344064
    buffer_load_dwordx4 v[68:71], v4, s[56:59], s33 offen
    s_mov_b32 s33, 372736
    buffer_load_dwordx4 v[72:75], v4, s[56:59], s33 offen
    s_mov_b32 s33, 401408
    buffer_load_dwordx4 v[76:79], v4, s[56:59], s33 offen
    s_mov_b32 s33, 430080
    buffer_load_dwordx4 v[80:83], v4, s[56:59], s33 offen
    s_barrier
    s_waitcnt vmcnt(15)
    v_mfma_f32_16x16x32_bf16 v[12:15], v[8:11], v[20:23], 0
    s_waitcnt vmcnt(14)
    v_mfma_f32_16x16x32_bf16 v[12:15], v[8:11], v[24:27], v[12:15]
    s_waitcnt vmcnt(13)
    v_mfma_f32_16x16x32_bf16 v[12:15], v[8:11], v[28:31], v[12:15]
    s_waitcnt vmcnt(12)
    v_mfma_f32_16x16x32_bf16 v[12:15], v[8:11], v[32:35], v[12:15]
    s_waitcnt vmcnt(11)
    v_mfma_f32_16x16x32_bf16 v[12:15], v[8:11], v[36:39], v[12:15]
    s_waitcnt vmcnt(10)
    v_mfma_f32_16x16x32_bf16 v[12:15], v[8:11], v[40:43], v[12:15]
    s_waitcnt vmcnt(9)
    v_mfma_f32_16x16x32_bf16 v[12:15], v[8:11], v[44:47], v[12:15]
    s_waitcnt vmcnt(8)
    v_mfma_f32_16x16x32_bf16 v[12:15], v[8:11], v[48:51], v[12:15]
    s_waitcnt vmcnt(7)
    v_mfma_f32_16x16x32_bf16 v[12:15], v[8:11], v[52:55], v[12:15]
    s_waitcnt vmcnt(6)
    v_mfma_f32_16x16x32_bf16 v[12:15], v[8:11], v[56:59], v[12:15]
    s_waitcnt vmcnt(5)
    v_mfma_f32_16x16x32_bf16 v[12:15], v[8:11], v[60:63], v[12:15]
    s_waitcnt vmcnt(4)
    v_mfma_f32_16x16x32_bf16 v[12:15], v[8:11], v[64:67], v[12:15]
    s_waitcnt vmcnt(3)
    v_mfma_f32_16x16x32_bf16 v[12:15], v[8:11], v[68:71], v[12:15]
    s_waitcnt vmcnt(2)
    v_mfma_f32_16x16x32_bf16 v[12:15], v[8:11], v[72:75], v[12:15]
    s_waitcnt vmcnt(1)
    v_mfma_f32_16x16x32_bf16 v[12:15], v[8:11], v[76:79], v[12:15]
    s_waitcnt vmcnt(0)
    v_mfma_f32_16x16x32_bf16 v[12:15], v[8:11], v[80:83], v[12:15]
    s_nop 15
    s_mov_b32 exec_hi, 0
    ds_write_b128 v5, v[12:15]
    s_mov_b32 exec_hi, -1
    s_waitcnt lgkmcnt(0)
k34_go:
    s_and_b32 s16, s2, 7
    s_lshr_b32 s17, s2, 3
    s_and_b32 s18, s16, 1
    s_lshl_b32 s18, s18, 2
    s_and_b32 s19, s17, 3
    s_add_u32 s20, s18, s19
    s_lshr_b32 s18, s16, 1
    s_lshl_b32 s18, s18, 3
    s_lshr_b32 s19, s17, 2
    s_add_u32 s21, s18, s19
    s_lshl_b32 s22, s20, 3
    s_add_u32 s22, s22, s3
    s_mul_i32 s16, s22, 65536
    v_lshlrev_b32 v220, 4, v2
    v_add_u32 v220, s16, v220
    v_lshrrev_b32 v3, 5, v2
    v_bfe_u32 v221, v2, 2, 2
    v_lshl_add_u32 v3, v3, 2, v221
    v_mul_u32_u24 v221, 224, v3
    v_bfe_u32 v3, v2, 4, 1
    v_mul_u32_u24 v3, 14464, v3
    v_add_u32 v221, v221, v3
    v_and_b32 v3, 3, v2
    v_lshl_add_u32 v221, v3, 3, v221
    s_add_u32 s8, s6, 20971520
    s_addc_u32 s9, s7, 0
    s_mov_b32 s10, 4194304
    s_mov_b32 s11, 0x00020000
    s_mov_b32 s78, 20000
    s_mov_b32 s24, 0
    buffer_load_dwordx4 v[116:119], v220, s[8:11], s24 offen offset:0 sc1
    buffer_load_dwordx4 v[120:123], v220, s[8:11], s24 offen offset:1024 sc1
    buffer_load_dwordx4 v[124:127], v220, s[8:11], s24 offen offset:2048 sc1
    buffer_load_dwordx4 v[128:131], v220, s[8:11], s24 offen offset:3072 sc1
    s_mov_b32 s24, 4096
    buffer_load_dwordx4 v[132:135], v220, s[8:11], s24 offen offset:0 sc1
    buffer_load_dwordx4 v[136:139], v220, s[8:11], s24 offen offset:1024 sc1
    buffer_load_dwordx4 v[140:143], v220, s[8:11], s24 offen offset:2048 sc1
    buffer_load_dwordx4 v[144:147], v220, s[8:11], s24 offen offset:3072 sc1
    s_add_u32 s40, s6, 27262976
    s_addc_u32 s41, s7, 0
    s_mov_b32 s42, 262144
    s_mov_b32 s43, 0x00020000
    s_add_u32 s44, s6, 33554432
    s_addc_u32 s45, s7, 0
    s_mov_b32 s46, 14680064
    s_mov_b32 s47, 0x00020000
    v_and_b32 v229, 31, v2
    v_lshlrev_b32 v229, 3, v229
    v_lshrrev_b32 v3, 5, v2
    v_lshl_add_u32 v229, v3, 14, v229
    s_lshl_b32 s16, s22, 8
    v_add_u32 v229, s16, v229
    s_add_u32 s56, s6, 28311552
    s_addc_u32 s57, s7, 0
    s_mov_b32 s58, 114688
    s_mov_b32 s59, 0x00020000
    v_bfe_u32 v3, v2, 4, 1
    v_mul_u32_u24 v3, 57344, v3
    v_and_b32 v231, 15, v2
    v_lshl_add_u32 v231, v231, 4, v3
    s_mul_i32 s16, s21, 1792
    v_add_u32 v231, s16, v231
    s_mov_b32 s52, s48
    s_mov_b32 s53, s49
    s_mov_b32 s54, 7340032
    s_mov_b32 s55, 0x00020000
    s_lshl_b32 s16, s2, 12
    v_lshl_add_u32 v234, v0, 3, s16
    s_waitcnt vmcnt(16)
    s_barrier
    s_sub_u32 s16, s3, 4
    s_cmp_ge_u32 s16, 2
    s_cbranch_scc1 k34_nocs
    s_cmp_ge_u32 s2, 224
    s_cbranch_scc1 k34_nocs
    v_subrev_u32 v9, 256, v0
    v_lshlrev_b32 v8, 2, v9
    v_add_u32 v8, 151936, v8
    ds_read_b32 v4, v8 offset:0
    ds_read_b32 v5, v8 offset:512
    ds_read_b32 v6, v8 offset:1024
    ds_read_b32 v7, v8 offset:1536
    v_lshlrev_b32 v9, 4, v9
    s_waitcnt lgkmcnt(0)
    v_add_f32 v4, v4, v5
    v_add_f32 v6, v6, v7
    v_add_f32 v4, v4, v6
    buffer_store_dword v4, v9, s[56:59], s79 offen sc1
    k34_nocs:
    v_mov_b32 v222, v221
    ds_read_b64_tr_b16 v[148:149], v222 offset:0
    ds_read_b64_tr_b16 v[150:151], v222 offset:1792
    ds_read_b64_tr_b16 v[152:153], v222 offset:32
    ds_read_b64_tr_b16 v[154:155], v222 offset:1824
    ds_read_b64_tr_b16 v[156:157], v222 offset:64
    ds_read_b64_tr_b16 v[158:159], v222 offset:1856
    ds_read_b64_tr_b16 v[160:161], v222 offset:96
    ds_read_b64_tr_b16 v[162:163], v222 offset:1888
    ds_read_b64_tr_b16 v[164:165], v222 offset:128
    ds_read_b64_tr_b16 v[166:167], v222 offset:1920
    ds_read_b64_tr_b16 v[168:169], v222 offset:160
    ds_read_b64_tr_b16 v[170:171], v222 offset:1952
    ds_read_b64_tr_b16 v[172:173], v222 offset:192
    ds_read_b64_tr_b16 v[174:175], v222 offset:1984
    s_waitcnt vmcnt(4)
    v_max3_u32 v233, v116, v117, v118
    v_max3_u32 v233, v233, v119, v120
    v_max3_u32 v233, v233, v121, v122
    v_max3_u32 v233, v233, v123, v124
    v_max3_u32 v233, v233, v125, v126
    v_max3_u32 v233, v233, v127, v128
    v_max3_u32 v233, v233, v129, v130
    v_max_u32 v233, v233, v131
    v_cmp_eq_u32 vcc, -1, v233
    s_cbranch_vccnz k4_slow_0
    k4_back_0:
    s_waitcnt lgkmcnt(12)
    v_mfma_f32_32x32x16_bf16 v[4:19], v[148:151], v[116:119], 0
    ds_read_b64_tr_b16 v[148:149], v222 offset:3584
    ds_read_b64_tr_b16 v[150:151], v222 offset:5376
    s_mov_b32 s87, 1376256
    s_add_u32 m0, s86, 86400
    s_nop 0
    buffer_load_dwordx4 v248, s[92:95], s87 offen lds
    s_add_u32 m0, s86, 87424
    s_nop 0
    buffer_load_dwordx4 v249, s[92:95], s87 offen lds
    s_waitcnt lgkmcnt(12)
    v_mfma_f32_32x32x16_bf16 v[20:35], v[152:155], v[116:119], 0
    ds_read_b64_tr_b16 v[152:153], v222 offset:3616
    ds_read_b64_tr_b16 v[154:155], v222 offset:5408
    s_add_u32 m0, s86, 88448
    s_nop 0
    buffer_load_dwordx4 v250, s[92:95], s87 offen lds
    s_add_u32 m0, s86, 89472
    s_mov_b32 exec_hi, 0
    buffer_load_dwordx4 v251, s[92:95], s87 offen lds
    s_mov_b32 exec_hi, -1
    s_waitcnt lgkmcnt(12)
    v_mfma_f32_32x32x16_bf16 v[36:51], v[156:159], v[116:119], 0
    ds_read_b64_tr_b16 v[156:157], v222 offset:3648
    ds_read_b64_tr_b16 v[158:159], v222 offset:5440
    s_waitcnt lgkmcnt(12)
    v_mfma_f32_32x32x16_bf16 v[52:67], v[160:163], v[116:119], 0
    ds_read_b64_tr_b16 v[160:161], v222 offset:3680
    ds_read_b64_tr_b16 v[162:163], v222 offset:5472
    s_waitcnt lgkmcnt(12)
    v_mfma_f32_32x32x16_bf16 v[68:83], v[164:167], v[116:119], 0
    ds_read_b64_tr_b16 v[164:165], v222 offset:3712
    ds_read_b64_tr_b16 v[166:167], v222 offset:5504
    s_waitcnt lgkmcnt(12)
    v_mfma_f32_32x32x16_bf16 v[84:99], v[168:171], v[116:119], 0
    ds_read_b64_tr_b16 v[168:169], v222 offset:3744
    ds_read_b64_tr_b16 v[170:171], v222 offset:5536
    s_waitcnt lgkmcnt(12)
    v_mfma_f32_32x32x16_bf16 v[100:115], v[172:175], v[116:119], 0
    ds_read_b64_tr_b16 v[172:173], v222 offset:3776
    ds_read_b64_tr_b16 v[174:175], v222 offset:5568
    s_waitcnt lgkmcnt(12)
    v_mfma_f32_32x32x16_bf16 v[4:19], v[148:151], v[120:123], v[4:19]
    ds_read_b64_tr_b16 v[148:149], v222 offset:7168
    ds_read_b64_tr_b16 v[150:151], v222 offset:8960
    s_mov_b32 s24, 8192
    buffer_load_dwordx4 v[116:119], v220, s[8:11], s24 offen offset:0 sc1
    s_waitcnt lgkmcnt(12)
    v_mfma_f32_32x32x16_bf16 v[20:35], v[152:155], v[120:123], v[20:35]
    ds_read_b64_tr_b16 v[152:153], v222 offset:7200
    ds_read_b64_tr_b16 v[154:155], v222 offset:8992
    s_waitcnt lgkmcnt(12)
    v_mfma_f32_32x32x16_bf16 v[36:51], v[156:159], v[120:123], v[36:51]
    ds_read_b64_tr_b16 v[156:157], v222 offset:7232
    ds_read_b64_tr_b16 v[158:159], v222 offset:9024
    s_waitcnt lgkmcnt(12)
    v_mfma_f32_32x32x16_bf16 v[52:67], v[160:163], v[120:123], v[52:67]
    ds_read_b64_tr_b16 v[160:161], v222 offset:7264
    ds_read_b64_tr_b16 v[162:163], v222 offset:9056
    s_waitcnt lgkmcnt(12)
    v_mfma_f32_32x32x16_bf16 v[68:83], v[164:167], v[120:123], v[68:83]
    ds_read_b64_tr_b16 v[164:165], v222 offset:7296
    ds_read_b64_tr_b16 v[166:167], v222 offset:9088
    s_waitcnt lgkmcnt(12)
    v_mfma_f32_32x32x16_bf16 v[84:99], v[168:171], v[120:123], v[84:99]
    ds_read_b64_tr_b16 v[168:169], v222 offset:7328
    ds_read_b64_tr_b16 v[170:171], v222 offset:9120
    s_waitcnt lgkmcnt(12)
    v_mfma_f32_32x32x16_bf16 v[100:115], v[172:175], v[120:123], v[100:115]
    ds_read_b64_tr_b16 v[172:173], v222 offset:7360
    ds_read_b64_tr_b16 v[174:175], v222 offset:9152
    s_waitcnt lgkmcnt(12)
    v_mfma_f32_32x32x16_bf16 v[4:19], v[148:151], v[124:127], v[4:19]
    ds_read_b64_tr_b16 v[148:149], v222 offset:10752
    ds_read_b64_tr_b16 v[150:151], v222 offset:12544
    buffer_load_dwordx4 v[120:123], v220, s[8:11], s24 offen offset:1024 sc1
    s_waitcnt lgkmcnt(12)
    v_mfma_f32_32x32x16_bf16 v[20:35], v[152:155], v[124:127], v[20:35]
    ds_read_b64_tr_b16 v[152:153], v222 offset:10784
    ds_read_b64_tr_b16 v[154:155], v222 offset:12576
    s_waitcnt lgkmcnt(12)
    v_mfma_f32_32x32x16_bf16 v[36:51], v[156:159], v[124:127], v[36:51]
    ds_read_b64_tr_b16 v[156:157], v222 offset:10816
    ds_read_b64_tr_b16 v[158:159], v222 offset:12608
    s_waitcnt lgkmcnt(12)
    v_mfma_f32_32x32x16_bf16 v[52:67], v[160:163], v[124:127], v[52:67]
    ds_read_b64_tr_b16 v[160:161], v222 offset:10848
    ds_read_b64_tr_b16 v[162:163], v222 offset:12640
    s_waitcnt lgkmcnt(12)
    v_mfma_f32_32x32x16_bf16 v[68:83], v[164:167], v[124:127], v[68:83]
    ds_read_b64_tr_b16 v[164:165], v222 offset:10880
    ds_read_b64_tr_b16 v[166:167], v222 offset:12672
    s_waitcnt lgkmcnt(12)
    v_mfma_f32_32x32x16_bf16 v[84:99], v[168:171], v[124:127], v[84:99]
    ds_read_b64_tr_b16 v[168:169], v222 offset:10912
    ds_read_b64_tr_b16 v[170:171], v222 offset:12704
    s_waitcnt lgkmcnt(12)
    v_mfma_f32_32x32x16_bf16 v[100:115], v[172:175], v[124:127], v[100:115]
    ds_read_b64_tr_b16 v[172:173], v222 offset:10944
    ds_read_b64_tr_b16 v[174:175], v222 offset:12736
    s_waitcnt lgkmcnt(12)
    v_mfma_f32_32x32x16_bf16 v[4:19], v[148:151], v[128:131], v[4:19]
    buffer_load_dwordx4 v[124:127], v220, s[8:11], s24 offen offset:2048 sc1
    s_waitcnt lgkmcnt(10)
    v_mfma_f32_32x32x16_bf16 v[20:35], v[152:155], v[128:131], v[20:35]
    s_barrier
    v_add_u32 v222, 28800, v221
    ds_read_b64_tr_b16 v[148:149], v222 offset:0
    ds_read_b64_tr_b16 v[150:151], v222 offset:1792
    ds_read_b64_tr_b16 v[152:153], v222 offset:32
    ds_read_b64_tr_b16 v[154:155], v222 offset:1824
    s_mov_b32 s87, 1835008
    s_add_u32 m0, s86, 115200
    s_nop 0
    buffer_load_dwordx4 v248, s[92:95], s87 offen lds
    s_add_u32 m0, s86, 116224
    s_nop 0
    buffer_load_dwordx4 v249, s[92:95], s87 offen lds
    s_waitcnt lgkmcnt(12)
    v_mfma_f32_32x32x16_bf16 v[36:51], v[156:159], v[128:131], v[36:51]
    ds_read_b64_tr_b16 v[156:157], v222 offset:64
    ds_read_b64_tr_b16 v[158:159], v222 offset:1856
    s_add_u32 m0, s86, 117248
    s_nop 0
    buffer_load_dwordx4 v250, s[92:95], s87 offen lds
    s_add_u32 m0, s86, 118272
    s_mov_b32 exec_hi, 0
    buffer_load_dwordx4 v251, s[92:95], s87 offen lds
    s_mov_b32 exec_hi, -1
    s_waitcnt lgkmcnt(12)
    v_mfma_f32_32x32x16_bf16 v[52:67], v[160:163], v[128:131], v[52:67]
    ds_read_b64_tr_b16 v[160:161], v222 offset:96
    ds_read_b64_tr_b16 v[162:163], v222 offset:1888
    s_waitcnt lgkmcnt(12)
    v_mfma_f32_32x32x16_bf16 v[68:83], v[164:167], v[128:131], v[68:83]
    ds_read_b64_tr_b16 v[164:165], v222 offset:128
    ds_read_b64_tr_b16 v[166:167], v222 offset:1920
    s_waitcnt lgkmcnt(12)
    v_mfma_f32_32x32x16_bf16 v[84:99], v[168:171], v[128:131], v[84:99]
    ds_read_b64_tr_b16 v[168:169], v222 offset:160
    ds_read_b64_tr_b16 v[170:171], v222 offset:1952
    s_waitcnt lgkmcnt(12)
    v_mfma_f32_32x32x16_bf16 v[100:115], v[172:175], v[128:131], v[100:115]
    ds_read_b64_tr_b16 v[172:173], v222 offset:192
    ds_read_b64_tr_b16 v[174:175], v222 offset:1984
    s_waitcnt vmcnt(11)
    v_max3_u32 v233, v132, v133, v134
    v_max3_u32 v233, v233, v135, v136
    v_max3_u32 v233, v233, v137, v138
    v_max3_u32 v233, v233, v139, v140
    v_max3_u32 v233, v233, v141, v142
    v_max3_u32 v233, v233, v143, v144
    v_max3_u32 v233, v233, v145, v146
    v_max_u32 v233, v233, v147
    v_cmp_eq_u32 vcc, -1, v233
    s_cbranch_vccnz k4_slow_1
    k4_back_1:
    s_waitcnt lgkmcnt(12)
    v_mfma_f32_32x32x16_bf16 v[4:19], v[148:151], v[132:135], v[4:19]
    ds_read_b64_tr_b16 v[148:149], v222 offset:3584
    ds_read_b64_tr_b16 v[150:151], v222 offset:5376
    buffer_load_dwordx4 v[128:131], v220, s[8:11], s24 offen offset:3072 sc1
    s_waitcnt lgkmcnt(12)
    v_mfma_f32_32x32x16_bf16 v[20:35], v[152:155], v[132:135], v[20:35]
    ds_read_b64_tr_b16 v[152:153], v222 offset:3616
    ds_read_b64_tr_b16 v[154:155], v222 offset:5408
    s_waitcnt lgkmcnt(12)
    v_mfma_f32_32x32x16_bf16 v[36:51], v[156:159], v[132:135], v[36:51]
    ds_read_b64_tr_b16 v[156:157], v222 offset:3648
    ds_read_b64_tr_b16 v[158:159], v222 offset:5440
    s_waitcnt lgkmcnt(12)
    v_mfma_f32_32x32x16_bf16 v[52:67], v[160:163], v[132:135], v[52:67]
    ds_read_b64_tr_b16 v[160:161], v222 offset:3680
    ds_read_b64_tr_b16 v[162:163], v222 offset:5472
    s_waitcnt lgkmcnt(12)
    v_mfma_f32_32x32x16_bf16 v[68:83], v[164:167], v[132:135], v[68:83]
    ds_read_b64_tr_b16 v[164:165], v222 offset:3712
    ds_read_b64_tr_b16 v[166:167], v222 offset:5504
    s_waitcnt lgkmcnt(12)
    v_mfma_f32_32x32x16_bf16 v[84:99], v[168:171], v[132:135], v[84:99]
    ds_read_b64_tr_b16 v[168:169], v222 offset:3744
    ds_read_b64_tr_b16 v[170:171], v222 offset:5536
    s_waitcnt lgkmcnt(12)
    v_mfma_f32_32x32x16_bf16 v[100:115], v[172:175], v[132:135], v[100:115]
    ds_read_b64_tr_b16 v[172:173], v222 offset:3776
    ds_read_b64_tr_b16 v[174:175], v222 offset:5568
    s_waitcnt lgkmcnt(12)
    v_mfma_f32_32x32x16_bf16 v[4:19], v[148:151], v[136:139], v[4:19]
    ds_read_b64_tr_b16 v[148:149], v222 offset:7168
    ds_read_b64_tr_b16 v[150:151], v222 offset:8960
    s_mov_b32 s24, 12288
    buffer_load_dwordx4 v[132:135], v220, s[8:11], s24 offen offset:0 sc1
    s_waitcnt lgkmcnt(12)
    v_mfma_f32_32x32x16_bf16 v[20:35], v[152:155], v[136:139], v[20:35]
    ds_read_b64_tr_b16 v[152:153], v222 offset:7200
    ds_read_b64_tr_b16 v[154:155], v222 offset:8992
    s_waitcnt lgkmcnt(12)
    v_mfma_f32_32x32x16_bf16 v[36:51], v[156:159], v[136:139], v[36:51]
    ds_read_b64_tr_b16 v[156:157], v222 offset:7232
    ds_read_b64_tr_b16 v[158:159], v222 offset:9024
    s_waitcnt lgkmcnt(12)
    v_mfma_f32_32x32x16_bf16 v[52:67], v[160:163], v[136:139], v[52:67]
    ds_read_b64_tr_b16 v[160:161], v222 offset:7264
    ds_read_b64_tr_b16 v[162:163], v222 offset:9056
    s_waitcnt lgkmcnt(12)
    v_mfma_f32_32x32x16_bf16 v[68:83], v[164:167], v[136:139], v[68:83]
    ds_read_b64_tr_b16 v[164:165], v222 offset:7296
    ds_read_b64_tr_b16 v[166:167], v222 offset:9088
    s_waitcnt lgkmcnt(12)
    v_mfma_f32_32x32x16_bf16 v[84:99], v[168:171], v[136:139], v[84:99]
    ds_read_b64_tr_b16 v[168:169], v222 offset:7328
    ds_read_b64_tr_b16 v[170:171], v222 offset:9120
    s_waitcnt lgkmcnt(12)
    v_mfma_f32_32x32x16_bf16 v[100:115], v[172:175], v[136:139], v[100:115]
    ds_read_b64_tr_b16 v[172:173], v222 offset:7360
    ds_read_b64_tr_b16 v[174:175], v222 offset:9152
    s_waitcnt lgkmcnt(12)
    v_mfma_f32_32x32x16_bf16 v[4:19], v[148:151], v[140:143], v[4:19]
    ds_read_b64_tr_b16 v[148:149], v222 offset:10752
    ds_read_b64_tr_b16 v[150:151], v222 offset:12544
    buffer_load_dwordx4 v[136:139], v220, s[8:11], s24 offen offset:1024 sc1
    s_waitcnt lgkmcnt(12)
    v_mfma_f32_32x32x16_bf16 v[20:35], v[152:155], v[140:143], v[20:35]
    ds_read_b64_tr_b16 v[152:153], v222 offset:10784
    ds_read_b64_tr_b16 v[154:155], v222 offset:12576
    s_waitcnt lgkmcnt(12)
    v_mfma_f32_32x32x16_bf16 v[36:51], v[156:159], v[140:143], v[36:51]
    ds_read_b64_tr_b16 v[156:157], v222 offset:10816
    ds_read_b64_tr_b16 v[158:159], v222 offset:12608
    s_waitcnt lgkmcnt(12)
    v_mfma_f32_32x32x16_bf16 v[52:67], v[160:163], v[140:143], v[52:67]
    ds_read_b64_tr_b16 v[160:161], v222 offset:10848
    ds_read_b64_tr_b16 v[162:163], v222 offset:12640
    s_waitcnt lgkmcnt(12)
    v_mfma_f32_32x32x16_bf16 v[68:83], v[164:167], v[140:143], v[68:83]
    ds_read_b64_tr_b16 v[164:165], v222 offset:10880
    ds_read_b64_tr_b16 v[166:167], v222 offset:12672
    s_waitcnt lgkmcnt(12)
    v_mfma_f32_32x32x16_bf16 v[84:99], v[168:171], v[140:143], v[84:99]
    ds_read_b64_tr_b16 v[168:169], v222 offset:10912
    ds_read_b64_tr_b16 v[170:171], v222 offset:12704
    s_waitcnt lgkmcnt(12)
    v_mfma_f32_32x32x16_bf16 v[100:115], v[172:175], v[140:143], v[100:115]
    ds_read_b64_tr_b16 v[172:173], v222 offset:10944
    ds_read_b64_tr_b16 v[174:175], v222 offset:12736
    s_waitcnt lgkmcnt(12)
    v_mfma_f32_32x32x16_bf16 v[4:19], v[148:151], v[144:147], v[4:19]
    buffer_load_dwordx4 v[140:143], v220, s[8:11], s24 offen offset:2048 sc1
    s_waitcnt lgkmcnt(10)
    v_mfma_f32_32x32x16_bf16 v[20:35], v[152:155], v[144:147], v[20:35]
    s_barrier
    v_add_u32 v222, 57600, v221
    ds_read_b64_tr_b16 v[148:149], v222 offset:0
    ds_read_b64_tr_b16 v[150:151], v222 offset:1792
    ds_read_b64_tr_b16 v[152:153], v222 offset:32
    ds_read_b64_tr_b16 v[154:155], v222 offset:1824
    s_mov_b32 s87, 2293760
    s_add_u32 m0, s86, 0
    s_nop 0
    buffer_load_dwordx4 v248, s[92:95], s87 offen lds
    s_add_u32 m0, s86, 1024
    s_nop 0
    buffer_load_dwordx4 v249, s[92:95], s87 offen lds
    s_waitcnt lgkmcnt(12)
    v_mfma_f32_32x32x16_bf16 v[36:51], v[156:159], v[144:147], v[36:51]
    ds_read_b64_tr_b16 v[156:157], v222 offset:64
    ds_read_b64_tr_b16 v[158:159], v222 offset:1856
    s_add_u32 m0, s86, 2048
    s_nop 0
    buffer_load_dwordx4 v250, s[92:95], s87 offen lds
    s_add_u32 m0, s86, 3072
    s_mov_b32 exec_hi, 0
    buffer_load_dwordx4 v251, s[92:95], s87 offen lds
    s_mov_b32 exec_hi, -1
    s_waitcnt lgkmcnt(12)
    v_mfma_f32_32x32x16_bf16 v[52:67], v[160:163], v[144:147], v[52:67]
    ds_read_b64_tr_b16 v[160:161], v222 offset:96
    ds_read_b64_tr_b16 v[162:163], v222 offset:1888
    s_waitcnt lgkmcnt(12)
    v_mfma_f32_32x32x16_bf16 v[68:83], v[164:167], v[144:147], v[68:83]
    ds_read_b64_tr_b16 v[164:165], v222 offset:128
    ds_read_b64_tr_b16 v[166:167], v222 offset:1920
    s_waitcnt lgkmcnt(12)
    v_mfma_f32_32x32x16_bf16 v[84:99], v[168:171], v[144:147], v[84:99]
    ds_read_b64_tr_b16 v[168:169], v222 offset:160
    ds_read_b64_tr_b16 v[170:171], v222 offset:1952
    s_waitcnt lgkmcnt(12)
    v_mfma_f32_32x32x16_bf16 v[100:115], v[172:175], v[144:147], v[100:115]
    ds_read_b64_tr_b16 v[172:173], v222 offset:192
    ds_read_b64_tr_b16 v[174:175], v222 offset:1984
    s_waitcnt vmcnt(7)
    v_max3_u32 v233, v116, v117, v118
    v_max3_u32 v233, v233, v119, v120
    v_max3_u32 v233, v233, v121, v122
    v_max3_u32 v233, v233, v123, v124
    v_max3_u32 v233, v233, v125, v126
    v_max3_u32 v233, v233, v127, v128
    v_max3_u32 v233, v233, v129, v130
    v_max_u32 v233, v233, v131
    v_cmp_eq_u32 vcc, -1, v233
    s_cbranch_vccnz k4_slow_2
    k4_back_2:
    s_waitcnt lgkmcnt(12)
    v_mfma_f32_32x32x16_bf16 v[4:19], v[148:151], v[116:119], v[4:19]
    ds_read_b64_tr_b16 v[148:149], v222 offset:3584
    ds_read_b64_tr_b16 v[150:151], v222 offset:5376
    s_mov_b32 s33, 0
    buffer_load_dword v235, v234, s[52:55], s33 offen
    buffer_load_dwordx4 v[144:147], v220, s[8:11], s24 offen offset:3072 sc1
    s_waitcnt lgkmcnt(12)
    v_mfma_f32_32x32x16_bf16 v[20:35], v[152:155], v[116:119], v[20:35]
    ds_read_b64_tr_b16 v[152:153], v222 offset:3616
    ds_read_b64_tr_b16 v[154:155], v222 offset:5408
    s_waitcnt lgkmcnt(12)
    v_mfma_f32_32x32x16_bf16 v[36:51], v[156:159], v[116:119], v[36:51]
    ds_read_b64_tr_b16 v[156:157], v222 offset:3648
    ds_read_b64_tr_b16 v[158:159], v222 offset:5440
    s_waitcnt lgkmcnt(12)
    v_mfma_f32_32x32x16_bf16 v[52:67], v[160:163], v[116:119], v[52:67]
    ds_read_b64_tr_b16 v[160:161], v222 offset:3680
    ds_read_b64_tr_b16 v[162:163], v222 offset:5472
    s_waitcnt lgkmcnt(12)
    v_mfma_f32_32x32x16_bf16 v[68:83], v[164:167], v[116:119], v[68:83]
    ds_read_b64_tr_b16 v[164:165], v222 offset:3712
    ds_read_b64_tr_b16 v[166:167], v222 offset:5504
    s_waitcnt lgkmcnt(12)
    v_mfma_f32_32x32x16_bf16 v[84:99], v[168:171], v[116:119], v[84:99]
    ds_read_b64_tr_b16 v[168:169], v222 offset:3744
    ds_read_b64_tr_b16 v[170:171], v222 offset:5536
    s_waitcnt lgkmcnt(12)
    v_mfma_f32_32x32x16_bf16 v[100:115], v[172:175], v[116:119], v[100:115]
    ds_read_b64_tr_b16 v[172:173], v222 offset:3776
    ds_read_b64_tr_b16 v[174:175], v222 offset:5568
    s_waitcnt lgkmcnt(12)
    v_mfma_f32_32x32x16_bf16 v[4:19], v[148:151], v[120:123], v[4:19]
    ds_read_b64_tr_b16 v[148:149], v222 offset:7168
    ds_read_b64_tr_b16 v[150:151], v222 offset:8960
    s_mov_b32 s24, 16384
    buffer_load_dwordx4 v[116:119], v220, s[8:11], s24 offen offset:0 sc1
    s_waitcnt lgkmcnt(12)
    v_mfma_f32_32x32x16_bf16 v[20:35], v[152:155], v[120:123], v[20:35]
    ds_read_b64_tr_b16 v[152:153], v222 offset:7200
    ds_read_b64_tr_b16 v[154:155], v222 offset:8992
    s_waitcnt lgkmcnt(12)
    v_mfma_f32_32x32x16_bf16 v[36:51], v[156:159], v[120:123], v[36:51]
    ds_read_b64_tr_b16 v[156:157], v222 offset:7232
    ds_read_b64_tr_b16 v[158:159], v222 offset:9024
    s_waitcnt lgkmcnt(12)
    v_mfma_f32_32x32x16_bf16 v[52:67], v[160:163], v[120:123], v[52:67]
    ds_read_b64_tr_b16 v[160:161], v222 offset:7264
    ds_read_b64_tr_b16 v[162:163], v222 offset:9056
    s_waitcnt lgkmcnt(12)
    v_mfma_f32_32x32x16_bf16 v[68:83], v[164:167], v[120:123], v[68:83]
    ds_read_b64_tr_b16 v[164:165], v222 offset:7296
    ds_read_b64_tr_b16 v[166:167], v222 offset:9088
    s_waitcnt lgkmcnt(12)
    v_mfma_f32_32x32x16_bf16 v[84:99], v[168:171], v[120:123], v[84:99]
    ds_read_b64_tr_b16 v[168:169], v222 offset:7328
    ds_read_b64_tr_b16 v[170:171], v222 offset:9120
    s_waitcnt lgkmcnt(12)
    v_mfma_f32_32x32x16_bf16 v[100:115], v[172:175], v[120:123], v[100:115]
    ds_read_b64_tr_b16 v[172:173], v222 offset:7360
    ds_read_b64_tr_b16 v[174:175], v222 offset:9152
    s_waitcnt lgkmcnt(12)
    v_mfma_f32_32x32x16_bf16 v[4:19], v[148:151], v[124:127], v[4:19]
    ds_read_b64_tr_b16 v[148:149], v222 offset:10752
    ds_read_b64_tr_b16 v[150:151], v222 offset:12544
    buffer_load_dwordx4 v[120:123], v220, s[8:11], s24 offen offset:1024 sc1
    s_waitcnt lgkmcnt(12)
    v_mfma_f32_32x32x16_bf16 v[20:35], v[152:155], v[124:127], v[20:35]
    ds_read_b64_tr_b16 v[152:153], v222 offset:10784
    ds_read_b64_tr_b16 v[154:155], v222 offset:12576
    s_waitcnt lgkmcnt(12)
    v_mfma_f32_32x32x16_bf16 v[36:51], v[156:159], v[124:127], v[36:51]
    ds_read_b64_tr_b16 v[156:157], v222 offset:10816
    ds_read_b64_tr_b16 v[158:159], v222 offset:12608
    s_waitcnt lgkmcnt(12)
    v_mfma_f32_32x32x16_bf16 v[52:67], v[160:163], v[124:127], v[52:67]
    ds_read_b64_tr_b16 v[160:161], v222 offset:10848
    ds_read_b64_tr_b16 v[162:163], v222 offset:12640
    s_waitcnt lgkmcnt(12)
    v_mfma_f32_32x32x16_bf16 v[68:83], v[164:167], v[124:127], v[68:83]
    ds_read_b64_tr_b16 v[164:165], v222 offset:10880
    ds_read_b64_tr_b16 v[166:167], v222 offset:12672
    s_waitcnt lgkmcnt(12)
    v_mfma_f32_32x32x16_bf16 v[84:99], v[168:171], v[124:127], v[84:99]
    ds_read_b64_tr_b16 v[168:169], v222 offset:10912
    ds_read_b64_tr_b16 v[170:171], v222 offset:12704
    s_waitcnt lgkmcnt(12)
    v_mfma_f32_32x32x16_bf16 v[100:115], v[172:175], v[124:127], v[100:115]
    ds_read_b64_tr_b16 v[172:173], v222 offset:10944
    ds_read_b64_tr_b16 v[174:175], v222 offset:12736
    s_waitcnt lgkmcnt(12)
    v_mfma_f32_32x32x16_bf16 v[4:19], v[148:151], v[128:131], v[4:19]
    buffer_load_dwordx4 v[124:127], v220, s[8:11], s24 offen offset:2048 sc1
    s_waitcnt lgkmcnt(10)
    v_mfma_f32_32x32x16_bf16 v[20:35], v[152:155], v[128:131], v[20:35]
    s_barrier
    v_add_u32 v222, 86400, v221
    ds_read_b64_tr_b16 v[148:149], v222 offset:0
    ds_read_b64_tr_b16 v[150:151], v222 offset:1792
    ds_read_b64_tr_b16 v[152:153], v222 offset:32
    ds_read_b64_tr_b16 v[154:155], v222 offset:1824
    s_mov_b32 s87, 2752512
    s_add_u32 m0, s86, 28800
    s_nop 0
    buffer_load_dwordx4 v248, s[92:95], s87 offen lds
    s_add_u32 m0, s86, 29824
    s_nop 0
    buffer_load_dwordx4 v249, s[92:95], s87 offen lds
    s_waitcnt lgkmcnt(12)
    v_mfma_f32_32x32x16_bf16 v[36:51], v[156:159], v[128:131], v[36:51]
    ds_read_b64_tr_b16 v[156:157], v222 offset:64
    ds_read_b64_tr_b16 v[158:159], v222 offset:1856
    s_add_u32 m0, s86, 30848
    s_nop 0
    buffer_load_dwordx4 v250, s[92:95], s87 offen lds
    s_add_u32 m0, s86, 31872
    s_mov_b32 exec_hi, 0
    buffer_load_dwordx4 v251, s[92:95], s87 offen lds
    s_mov_b32 exec_hi, -1
    s_waitcnt lgkmcnt(12)
    v_mfma_f32_32x32x16_bf16 v[52:67], v[160:163], v[128:131], v[52:67]
    ds_read_b64_tr_b16 v[160:161], v222 offset:96
    ds_read_b64_tr_b16 v[162:163], v222 offset:1888
    s_waitcnt lgkmcnt(12)
    v_mfma_f32_32x32x16_bf16 v[68:83], v[164:167], v[128:131], v[68:83]
    ds_read_b64_tr_b16 v[164:165], v222 offset:128
    ds_read_b64_tr_b16 v[166:167], v222 offset:1920
    s_waitcnt lgkmcnt(12)
    v_mfma_f32_32x32x16_bf16 v[84:99], v[168:171], v[128:131], v[84:99]
    ds_read_b64_tr_b16 v[168:169], v222 offset:160
    ds_read_b64_tr_b16 v[170:171], v222 offset:1952
    s_waitcnt lgkmcnt(12)
    v_mfma_f32_32x32x16_bf16 v[100:115], v[172:175], v[128:131], v[100:115]
    ds_read_b64_tr_b16 v[172:173], v222 offset:192
    ds_read_b64_tr_b16 v[174:175], v222 offset:1984
    s_waitcnt vmcnt(7)
    v_max3_u32 v233, v132, v133, v134
    v_max3_u32 v233, v233, v135, v136
    v_max3_u32 v233, v233, v137, v138
    v_max3_u32 v233, v233, v139, v140
    v_max3_u32 v233, v233, v141, v142
    v_max3_u32 v233, v233, v143, v144
    v_max3_u32 v233, v233, v145, v146
    v_max_u32 v233, v233, v147
    v_cmp_eq_u32 vcc, -1, v233
    s_cbranch_vccnz k4_slow_3
    k4_back_3:
    s_waitcnt lgkmcnt(12)
    v_mfma_f32_32x32x16_bf16 v[4:19], v[148:151], v[132:135], v[4:19]
    ds_read_b64_tr_b16 v[148:149], v222 offset:3584
    ds_read_b64_tr_b16 v[150:151], v222 offset:5376
    s_mov_b32 s33, 1048576
    buffer_load_dword v235, v234, s[52:55], s33 offen
    buffer_load_dwordx4 v[128:131], v220, s[8:11], s24 offen offset:3072 sc1
    s_waitcnt lgkmcnt(12)
    v_mfma_f32_32x32x16_bf16 v[20:35], v[152:155], v[132:135], v[20:35]
    ds_read_b64_tr_b16 v[152:153], v222 offset:3616
    ds_read_b64_tr_b16 v[154:155], v222 offset:5408
    s_waitcnt lgkmcnt(12)
    v_mfma_f32_32x32x16_bf16 v[36:51], v[156:159], v[132:135], v[36:51]
    ds_read_b64_tr_b16 v[156:157], v222 offset:3648
    ds_read_b64_tr_b16 v[158:159], v222 offset:5440
    s_waitcnt lgkmcnt(12)
    v_mfma_f32_32x32x16_bf16 v[52:67], v[160:163], v[132:135], v[52:67]
    ds_read_b64_tr_b16 v[160:161], v222 offset:3680
    ds_read_b64_tr_b16 v[162:163], v222 offset:5472
    s_waitcnt lgkmcnt(12)
    v_mfma_f32_32x32x16_bf16 v[68:83], v[164:167], v[132:135], v[68:83]
    ds_read_b64_tr_b16 v[164:165], v222 offset:3712
    ds_read_b64_tr_b16 v[166:167], v222 offset:5504
    s_waitcnt lgkmcnt(12)
    v_mfma_f32_32x32x16_bf16 v[84:99], v[168:171], v[132:135], v[84:99]
    ds_read_b64_tr_b16 v[168:169], v222 offset:3744
    ds_read_b64_tr_b16 v[170:171], v222 offset:5536
    s_waitcnt lgkmcnt(12)
    v_mfma_f32_32x32x16_bf16 v[100:115], v[172:175], v[132:135], v[100:115]
    ds_read_b64_tr_b16 v[172:173], v222 offset:3776
    ds_read_b64_tr_b16 v[174:175], v222 offset:5568
    s_waitcnt lgkmcnt(12)
    v_mfma_f32_32x32x16_bf16 v[4:19], v[148:151], v[136:139], v[4:19]
    ds_read_b64_tr_b16 v[148:149], v222 offset:7168
    ds_read_b64_tr_b16 v[150:151], v222 offset:8960
    s_mov_b32 s24, 20480
    buffer_load_dwordx4 v[132:135], v220, s[8:11], s24 offen offset:0 sc1
    s_waitcnt lgkmcnt(12)
    v_mfma_f32_32x32x16_bf16 v[20:35], v[152:155], v[136:139], v[20:35]
    ds_read_b64_tr_b16 v[152:153], v222 offset:7200
    ds_read_b64_tr_b16 v[154:155], v222 offset:8992
    s_waitcnt lgkmcnt(12)
    v_mfma_f32_32x32x16_bf16 v[36:51], v[156:159], v[136:139], v[36:51]
    ds_read_b64_tr_b16 v[156:157], v222 offset:7232
    ds_read_b64_tr_b16 v[158:159], v222 offset:9024
    s_waitcnt lgkmcnt(12)
    v_mfma_f32_32x32x16_bf16 v[52:67], v[160:163], v[136:139], v[52:67]
    ds_read_b64_tr_b16 v[160:161], v222 offset:7264
    ds_read_b64_tr_b16 v[162:163], v222 offset:9056
    s_waitcnt lgkmcnt(12)
    v_mfma_f32_32x32x16_bf16 v[68:83], v[164:167], v[136:139], v[68:83]
    ds_read_b64_tr_b16 v[164:165], v222 offset:7296
    ds_read_b64_tr_b16 v[166:167], v222 offset:9088
    s_waitcnt lgkmcnt(12)
    v_mfma_f32_32x32x16_bf16 v[84:99], v[168:171], v[136:139], v[84:99]
    ds_read_b64_tr_b16 v[168:169], v222 offset:7328
    ds_read_b64_tr_b16 v[170:171], v222 offset:9120
    s_waitcnt lgkmcnt(12)
    v_mfma_f32_32x32x16_bf16 v[100:115], v[172:175], v[136:139], v[100:115]
    ds_read_b64_tr_b16 v[172:173], v222 offset:7360
    ds_read_b64_tr_b16 v[174:175], v222 offset:9152
    s_waitcnt lgkmcnt(12)
    v_mfma_f32_32x32x16_bf16 v[4:19], v[148:151], v[140:143], v[4:19]
    ds_read_b64_tr_b16 v[148:149], v222 offset:10752
    ds_read_b64_tr_b16 v[150:151], v222 offset:12544
    buffer_load_dwordx4 v[136:139], v220, s[8:11], s24 offen offset:1024 sc1
    s_waitcnt lgkmcnt(12)
    v_mfma_f32_32x32x16_bf16 v[20:35], v[152:155], v[140:143], v[20:35]
    ds_read_b64_tr_b16 v[152:153], v222 offset:10784
    ds_read_b64_tr_b16 v[154:155], v222 offset:12576
    s_waitcnt lgkmcnt(12)
    v_mfma_f32_32x32x16_bf16 v[36:51], v[156:159], v[140:143], v[36:51]
    ds_read_b64_tr_b16 v[156:157], v222 offset:10816
    ds_read_b64_tr_b16 v[158:159], v222 offset:12608
    s_waitcnt lgkmcnt(12)
    v_mfma_f32_32x32x16_bf16 v[52:67], v[160:163], v[140:143], v[52:67]
    ds_read_b64_tr_b16 v[160:161], v222 offset:10848
    ds_read_b64_tr_b16 v[162:163], v222 offset:12640
    s_waitcnt lgkmcnt(12)
    v_mfma_f32_32x32x16_bf16 v[68:83], v[164:167], v[140:143], v[68:83]
    ds_read_b64_tr_b16 v[164:165], v222 offset:10880
    ds_read_b64_tr_b16 v[166:167], v222 offset:12672
    s_waitcnt lgkmcnt(12)
    v_mfma_f32_32x32x16_bf16 v[84:99], v[168:171], v[140:143], v[84:99]
    ds_read_b64_tr_b16 v[168:169], v222 offset:10912
    ds_read_b64_tr_b16 v[170:171], v222 offset:12704
    s_waitcnt lgkmcnt(12)
    v_mfma_f32_32x32x16_bf16 v[100:115], v[172:175], v[140:143], v[100:115]
    ds_read_b64_tr_b16 v[172:173], v222 offset:10944
    ds_read_b64_tr_b16 v[174:175], v222 offset:12736
    s_waitcnt lgkmcnt(12)
    v_mfma_f32_32x32x16_bf16 v[4:19], v[148:151], v[144:147], v[4:19]
    buffer_load_dwordx4 v[140:143], v220, s[8:11], s24 offen offset:2048 sc1
    s_waitcnt lgkmcnt(10)
    v_mfma_f32_32x32x16_bf16 v[20:35], v[152:155], v[144:147], v[20:35]
    s_barrier
    v_add_u32 v222, 115200, v221
    ds_read_b64_tr_b16 v[148:149], v222 offset:0
    ds_read_b64_tr_b16 v[150:151], v222 offset:1792
    ds_read_b64_tr_b16 v[152:153], v222 offset:32
    ds_read_b64_tr_b16 v[154:155], v222 offset:1824
    s_mov_b32 s87, 3211264
    s_add_u32 m0, s86, 57600
    s_nop 0
    buffer_load_dwordx4 v248, s[92:95], s87 offen lds
    s_add_u32 m0, s86, 58624
    s_nop 0
    buffer_load_dwordx4 v249, s[92:95], s87 offen lds
    s_waitcnt lgkmcnt(12)
    v_mfma_f32_32x32x16_bf16 v[36:51], v[156:159], v[144:147], v[36:51]
    ds_read_b64_tr_b16 v[156:157], v222 offset:64
    ds_read_b64_tr_b16 v[158:159], v222 offset:1856
    s_add_u32 m0, s86, 59648
    s_nop 0
    buffer_load_dwordx4 v250, s[92:95], s87 offen lds
    s_add_u32 m0, s86, 60672
    s_mov_b32 exec_hi, 0
    buffer_load_dwordx4 v251, s[92:95], s87 offen lds
    s_mov_b32 exec_hi, -1
    s_waitcnt lgkmcnt(12)
    v_mfma_f32_32x32x16_bf16 v[52:67], v[160:163], v[144:147], v[52:67]
    ds_read_b64_tr_b16 v[160:161], v222 offset:96
    ds_read_b64_tr_b16 v[162:163], v222 offset:1888
    s_waitcnt lgkmcnt(12)
    v_mfma_f32_32x32x16_bf16 v[68:83], v[164:167], v[144:147], v[68:83]
    ds_read_b64_tr_b16 v[164:165], v222 offset:128
    ds_read_b64_tr_b16 v[166:167], v222 offset:1920
    s_waitcnt lgkmcnt(12)
    v_mfma_f32_32x32x16_bf16 v[84:99], v[168:171], v[144:147], v[84:99]
    ds_read_b64_tr_b16 v[168:169], v222 offset:160
    ds_read_b64_tr_b16 v[170:171], v222 offset:1952
    s_waitcnt lgkmcnt(12)
    v_mfma_f32_32x32x16_bf16 v[100:115], v[172:175], v[144:147], v[100:115]
    ds_read_b64_tr_b16 v[172:173], v222 offset:192
    ds_read_b64_tr_b16 v[174:175], v222 offset:1984
    s_waitcnt vmcnt(7)
    v_max3_u32 v233, v116, v117, v118
    v_max3_u32 v233, v233, v119, v120
    v_max3_u32 v233, v233, v121, v122
    v_max3_u32 v233, v233, v123, v124
    v_max3_u32 v233, v233, v125, v126
    v_max3_u32 v233, v233, v127, v128
    v_max3_u32 v233, v233, v129, v130
    v_max_u32 v233, v233, v131
    v_cmp_eq_u32 vcc, -1, v233
    s_cbranch_vccnz k4_slow_4
    k4_back_4:
    s_waitcnt lgkmcnt(12)
    v_mfma_f32_32x32x16_bf16 v[4:19], v[148:151], v[116:119], v[4:19]
    ds_read_b64_tr_b16 v[148:149], v222 offset:3584
    ds_read_b64_tr_b16 v[150:151], v222 offset:5376
    s_mov_b32 s33, 2097152
    buffer_load_dword v235, v234, s[52:55], s33 offen
    buffer_load_dwordx4 v[144:147], v220, s[8:11], s24 offen offset:3072 sc1
    s_waitcnt lgkmcnt(12)
    v_mfma_f32_32x32x16_bf16 v[20:35], v[152:155], v[116:119], v[20:35]
    ds_read_b64_tr_b16 v[152:153], v222 offset:3616
    ds_read_b64_tr_b16 v[154:155], v222 offset:5408
    s_waitcnt lgkmcnt(12)
    v_mfma_f32_32x32x16_bf16 v[36:51], v[156:159], v[116:119], v[36:51]
    ds_read_b64_tr_b16 v[156:157], v222 offset:3648
    ds_read_b64_tr_b16 v[158:159], v222 offset:5440
    s_waitcnt lgkmcnt(12)
    v_mfma_f32_32x32x16_bf16 v[52:67], v[160:163], v[116:119], v[52:67]
    ds_read_b64_tr_b16 v[160:161], v222 offset:3680
    ds_read_b64_tr_b16 v[162:163], v222 offset:5472
    s_waitcnt lgkmcnt(12)
    v_mfma_f32_32x32x16_bf16 v[68:83], v[164:167], v[116:119], v[68:83]
    ds_read_b64_tr_b16 v[164:165], v222 offset:3712
    ds_read_b64_tr_b16 v[166:167], v222 offset:5504
    s_waitcnt lgkmcnt(12)
    v_mfma_f32_32x32x16_bf16 v[84:99], v[168:171], v[116:119], v[84:99]
    ds_read_b64_tr_b16 v[168:169], v222 offset:3744
    ds_read_b64_tr_b16 v[170:171], v222 offset:5536
    s_waitcnt lgkmcnt(12)
    v_mfma_f32_32x32x16_bf16 v[100:115], v[172:175], v[116:119], v[100:115]
    ds_read_b64_tr_b16 v[172:173], v222 offset:3776
    ds_read_b64_tr_b16 v[174:175], v222 offset:5568
    s_waitcnt lgkmcnt(12)
    v_mfma_f32_32x32x16_bf16 v[4:19], v[148:151], v[120:123], v[4:19]
    ds_read_b64_tr_b16 v[148:149], v222 offset:7168
    ds_read_b64_tr_b16 v[150:151], v222 offset:8960
    s_mov_b32 s24, 24576
    buffer_load_dwordx4 v[116:119], v220, s[8:11], s24 offen offset:0 sc1
    s_waitcnt lgkmcnt(12)
    v_mfma_f32_32x32x16_bf16 v[20:35], v[152:155], v[120:123], v[20:35]
    ds_read_b64_tr_b16 v[152:153], v222 offset:7200
    ds_read_b64_tr_b16 v[154:155], v222 offset:8992
    s_waitcnt lgkmcnt(12)
    v_mfma_f32_32x32x16_bf16 v[36:51], v[156:159], v[120:123], v[36:51]
    ds_read_b64_tr_b16 v[156:157], v222 offset:7232
    ds_read_b64_tr_b16 v[158:159], v222 offset:9024
    s_waitcnt lgkmcnt(12)
    v_mfma_f32_32x32x16_bf16 v[52:67], v[160:163], v[120:123], v[52:67]
    ds_read_b64_tr_b16 v[160:161], v222 offset:7264
    ds_read_b64_tr_b16 v[162:163], v222 offset:9056
    s_waitcnt lgkmcnt(12)
    v_mfma_f32_32x32x16_bf16 v[68:83], v[164:167], v[120:123], v[68:83]
    ds_read_b64_tr_b16 v[164:165], v222 offset:7296
    ds_read_b64_tr_b16 v[166:167], v222 offset:9088
    s_waitcnt lgkmcnt(12)
    v_mfma_f32_32x32x16_bf16 v[84:99], v[168:171], v[120:123], v[84:99]
    ds_read_b64_tr_b16 v[168:169], v222 offset:7328
    ds_read_b64_tr_b16 v[170:171], v222 offset:9120
    s_waitcnt lgkmcnt(12)
    v_mfma_f32_32x32x16_bf16 v[100:115], v[172:175], v[120:123], v[100:115]
    ds_read_b64_tr_b16 v[172:173], v222 offset:7360
    ds_read_b64_tr_b16 v[174:175], v222 offset:9152
    s_waitcnt lgkmcnt(12)
    v_mfma_f32_32x32x16_bf16 v[4:19], v[148:151], v[124:127], v[4:19]
    ds_read_b64_tr_b16 v[148:149], v222 offset:10752
    ds_read_b64_tr_b16 v[150:151], v222 offset:12544
    buffer_load_dwordx4 v[120:123], v220, s[8:11], s24 offen offset:1024 sc1
    s_waitcnt lgkmcnt(12)
    v_mfma_f32_32x32x16_bf16 v[20:35], v[152:155], v[124:127], v[20:35]
    ds_read_b64_tr_b16 v[152:153], v222 offset:10784
    ds_read_b64_tr_b16 v[154:155], v222 offset:12576
    s_waitcnt lgkmcnt(12)
    v_mfma_f32_32x32x16_bf16 v[36:51], v[156:159], v[124:127], v[36:51]
    ds_read_b64_tr_b16 v[156:157], v222 offset:10816
    ds_read_b64_tr_b16 v[158:159], v222 offset:12608
    s_waitcnt lgkmcnt(12)
    v_mfma_f32_32x32x16_bf16 v[52:67], v[160:163], v[124:127], v[52:67]
    ds_read_b64_tr_b16 v[160:161], v222 offset:10848
    ds_read_b64_tr_b16 v[162:163], v222 offset:12640
    s_waitcnt lgkmcnt(12)
    v_mfma_f32_32x32x16_bf16 v[68:83], v[164:167], v[124:127], v[68:83]
    ds_read_b64_tr_b16 v[164:165], v222 offset:10880
    ds_read_b64_tr_b16 v[166:167], v222 offset:12672
    s_waitcnt lgkmcnt(12)
    v_mfma_f32_32x32x16_bf16 v[84:99], v[168:171], v[124:127], v[84:99]
    ds_read_b64_tr_b16 v[168:169], v222 offset:10912
    ds_read_b64_tr_b16 v[170:171], v222 offset:12704
    s_waitcnt lgkmcnt(12)
    v_mfma_f32_32x32x16_bf16 v[100:115], v[172:175], v[124:127], v[100:115]
    ds_read_b64_tr_b16 v[172:173], v222 offset:10944
    ds_read_b64_tr_b16 v[174:175], v222 offset:12736
    s_waitcnt lgkmcnt(12)
    v_mfma_f32_32x32x16_bf16 v[4:19], v[148:151], v[128:131], v[4:19]
    buffer_load_dwordx4 v[124:127], v220, s[8:11], s24 offen offset:2048 sc1
    s_waitcnt lgkmcnt(10)
    v_mfma_f32_32x32x16_bf16 v[20:35], v[152:155], v[128:131], v[20:35]
    s_barrier
    v_add_u32 v222, 0, v221
    ds_read_b64_tr_b16 v[148:149], v222 offset:0
    ds_read_b64_tr_b16 v[150:151], v222 offset:1792
    ds_read_b64_tr_b16 v[152:153], v222 offset:32
    ds_read_b64_tr_b16 v[154:155], v222 offset:1824
    s_mov_b32 s87, 3670016
    s_add_u32 m0, s86, 86400
    s_nop 0
    buffer_load_dwordx4 v248, s[92:95], s87 offen lds
    s_add_u32 m0, s86, 87424
    s_nop 0
    buffer_load_dwordx4 v249, s[92:95], s87 offen lds
    s_waitcnt lgkmcnt(12)
    v_mfma_f32_32x32x16_bf16 v[36:51], v[156:159], v[128:131], v[36:51]
    ds_read_b64_tr_b16 v[156:157], v222 offset:64
    ds_read_b64_tr_b16 v[158:159], v222 offset:1856
    s_add_u32 m0, s86, 88448
    s_nop 0
    buffer_load_dwordx4 v250, s[92:95], s87 offen lds
    s_add_u32 m0, s86, 89472
    s_mov_b32 exec_hi, 0
    buffer_load_dwordx4 v251, s[92:95], s87 offen lds
    s_mov_b32 exec_hi, -1
    s_waitcnt lgkmcnt(12)
    v_mfma_f32_32x32x16_bf16 v[52:67], v[160:163], v[128:131], v[52:67]
    ds_read_b64_tr_b16 v[160:161], v222 offset:96
    ds_read_b64_tr_b16 v[162:163], v222 offset:1888
    s_waitcnt lgkmcnt(12)
    v_mfma_f32_32x32x16_bf16 v[68:83], v[164:167], v[128:131], v[68:83]
    ds_read_b64_tr_b16 v[164:165], v222 offset:128
    ds_read_b64_tr_b16 v[166:167], v222 offset:1920
    s_waitcnt lgkmcnt(12)
    v_mfma_f32_32x32x16_bf16 v[84:99], v[168:171], v[128:131], v[84:99]
    ds_read_b64_tr_b16 v[168:169], v222 offset:160
    ds_read_b64_tr_b16 v[170:171], v222 offset:1952
    s_waitcnt lgkmcnt(12)
    v_mfma_f32_32x32x16_bf16 v[100:115], v[172:175], v[128:131], v[100:115]
    ds_read_b64_tr_b16 v[172:173], v222 offset:192
    ds_read_b64_tr_b16 v[174:175], v222 offset:1984
    s_waitcnt vmcnt(7)
    v_max3_u32 v233, v132, v133, v134
    v_max3_u32 v233, v233, v135, v136
    v_max3_u32 v233, v233, v137, v138
    v_max3_u32 v233, v233, v139, v140
    v_max3_u32 v233, v233, v141, v142
    v_max3_u32 v233, v233, v143, v144
    v_max3_u32 v233, v233, v145, v146
    v_max_u32 v233, v233, v147
    v_cmp_eq_u32 vcc, -1, v233
    s_cbranch_vccnz k4_slow_5
    k4_back_5:
    s_waitcnt lgkmcnt(12)
    v_mfma_f32_32x32x16_bf16 v[4:19], v[148:151], v[132:135], v[4:19]
    ds_read_b64_tr_b16 v[148:149], v222 offset:3584
    ds_read_b64_tr_b16 v[150:151], v222 offset:5376
    s_mov_b32 s33, 3145728
    buffer_load_dword v235, v234, s[52:55], s33 offen
    s_mov_b32 s33, 0
    buffer_load_dwordx2 v[176:177], v229, s[40:43], s33 offen sc1
    s_waitcnt lgkmcnt(12)
    v_mfma_f32_32x32x16_bf16 v[20:35], v[152:155], v[132:135], v[20:35]
    ds_read_b64_tr_b16 v[152:153], v222 offset:3616
    ds_read_b64_tr_b16 v[154:155], v222 offset:5408
    s_mov_b32 s33, 32768
    buffer_load_dwordx2 v[178:179], v229, s[40:43], s33 offen sc1
    s_mov_b32 s33, 65536
    buffer_load_dwordx2 v[180:181], v229, s[40:43], s33 offen sc1
    s_waitcnt lgkmcnt(12)
    v_mfma_f32_32x32x16_bf16 v[36:51], v[156:159], v[132:135], v[36:51]
    ds_read_b64_tr_b16 v[156:157], v222 offset:3648
    ds_read_b64_tr_b16 v[158:159], v222 offset:5440
    s_mov_b32 s33, 98304
    buffer_load_dwordx2 v[182:183], v229, s[40:43], s33 offen sc1
    s_mov_b32 s33, 131072
    buffer_load_dwordx2 v[184:185], v229, s[40:43], s33 offen sc1
    s_waitcnt lgkmcnt(12)
    v_mfma_f32_32x32x16_bf16 v[52:67], v[160:163], v[132:135], v[52:67]
    ds_read_b64_tr_b16 v[160:161], v222 offset:3680
    ds_read_b64_tr_b16 v[162:163], v222 offset:5472
    s_mov_b32 s33, 163840
    buffer_load_dwordx2 v[186:187], v229, s[40:43], s33 offen sc1
    s_mov_b32 s33, 196608
    buffer_load_dwordx2 v[188:189], v229, s[40:43], s33 offen sc1
    s_waitcnt lgkmcnt(12)
    v_mfma_f32_32x32x16_bf16 v[68:83], v[164:167], v[132:135], v[68:83]
    ds_read_b64_tr_b16 v[164:165], v222 offset:3712
    ds_read_b64_tr_b16 v[166:167], v222 offset:5504
    s_mov_b32 s33, 229376
    buffer_load_dwordx2 v[190:191], v229, s[40:43], s33 offen sc1
    buffer_load_dwordx4 v[192:195], v231, s[56:59], 0 offen offset:0 sc1
    s_waitcnt lgkmcnt(12)
    v_mfma_f32_32x32x16_bf16 v[84:99], v[168:171], v[132:135], v[84:99]
    ds_read_b64_tr_b16 v[168:169], v222 offset:3744
    ds_read_b64_tr_b16 v[170:171], v222 offset:5536
    buffer_load_dwordx4 v[196:199], v231, s[56:59], 0 offen offset:256 sc1
    buffer_load_dwordx4 v[200:203], v231, s[56:59], 0 offen offset:512 sc1
    s_waitcnt lgkmcnt(12)
    v_mfma_f32_32x32x16_bf16 v[100:115], v[172:175], v[132:135], v[100:115]
    ds_read_b64_tr_b16 v[172:173], v222 offset:3776
    ds_read_b64_tr_b16 v[174:175], v222 offset:5568
    buffer_load_dwordx4 v[204:207], v231, s[56:59], 0 offen offset:768 sc1
    buffer_load_dwordx4 v[208:211], v231, s[56:59], 0 offen offset:1024 sc1
    s_waitcnt lgkmcnt(12)
    v_mfma_f32_32x32x16_bf16 v[4:19], v[148:151], v[136:139], v[4:19]
    ds_read_b64_tr_b16 v[148:149], v222 offset:7168
    ds_read_b64_tr_b16 v[150:151], v222 offset:8960
    buffer_load_dwordx4 v[212:215], v231, s[56:59], 0 offen offset:1280 sc1
    buffer_load_dwordx4 v[216:219], v231, s[56:59], 0 offen offset:1536 sc1
    s_waitcnt lgkmcnt(12)
    v_mfma_f32_32x32x16_bf16 v[20:35], v[152:155], v[136:139], v[20:35]
    ds_read_b64_tr_b16 v[152:153], v222 offset:7200
    ds_read_b64_tr_b16 v[154:155], v222 offset:8992
    buffer_load_dwordx4 v[128:131], v220, s[8:11], s24 offen offset:3072 sc1
    s_mov_b32 s24, 28672
    buffer_load_dwordx4 v[132:135], v220, s[8:11], s24 offen offset:0 sc1
    s_waitcnt lgkmcnt(12)
    v_mfma_f32_32x32x16_bf16 v[36:51], v[156:159], v[136:139], v[36:51]
    ds_read_b64_tr_b16 v[156:157], v222 offset:7232
    ds_read_b64_tr_b16 v[158:159], v222 offset:9024
    s_waitcnt lgkmcnt(12)
    v_mfma_f32_32x32x16_bf16 v[52:67], v[160:163], v[136:139], v[52:67]
    ds_read_b64_tr_b16 v[160:161], v222 offset:7264
    ds_read_b64_tr_b16 v[162:163], v222 offset:9056
    s_waitcnt lgkmcnt(12)
    v_mfma_f32_32x32x16_bf16 v[68:83], v[164:167], v[136:139], v[68:83]
    ds_read_b64_tr_b16 v[164:165], v222 offset:7296
    ds_read_b64_tr_b16 v[166:167], v222 offset:9088
    s_waitcnt lgkmcnt(12)
    v_mfma_f32_32x32x16_bf16 v[84:99], v[168:171], v[136:139], v[84:99]
    ds_read_b64_tr_b16 v[168:169], v222 offset:7328
    ds_read_b64_tr_b16 v[170:171], v222 offset:9120
    s_waitcnt lgkmcnt(12)
    v_mfma_f32_32x32x16_bf16 v[100:115], v[172:175], v[136:139], v[100:115]
    ds_read_b64_tr_b16 v[172:173], v222 offset:7360
    ds_read_b64_tr_b16 v[174:175], v222 offset:9152
    s_waitcnt lgkmcnt(12)
    v_mfma_f32_32x32x16_bf16 v[4:19], v[148:151], v[140:143], v[4:19]
    ds_read_b64_tr_b16 v[148:149], v222 offset:10752
    ds_read_b64_tr_b16 v[150:151], v222 offset:12544
    buffer_load_dwordx4 v[136:139], v220, s[8:11], s24 offen offset:1024 sc1
    s_waitcnt lgkmcnt(12)
    v_mfma_f32_32x32x16_bf16 v[20:35], v[152:155], v[140:143], v[20:35]
    ds_read_b64_tr_b16 v[152:153], v222 offset:10784
    ds_read_b64_tr_b16 v[154:155], v222 offset:12576
    s_waitcnt lgkmcnt(12)
    v_mfma_f32_32x32x16_bf16 v[36:51], v[156:159], v[140:143], v[36:51]
    ds_read_b64_tr_b16 v[156:157], v222 offset:10816
    ds_read_b64_tr_b16 v[158:159], v222 offset:12608
    s_waitcnt lgkmcnt(12)
    v_mfma_f32_32x32x16_bf16 v[52:67], v[160:163], v[140:143], v[52:67]
    ds_read_b64_tr_b16 v[160:161], v222 offset:10848
    ds_read_b64_tr_b16 v[162:163], v222 offset:12640
    s_waitcnt lgkmcnt(12)
    v_mfma_f32_32x32x16_bf16 v[68:83], v[164:167], v[140:143], v[68:83]
    ds_read_b64_tr_b16 v[164:165], v222 offset:10880
    ds_read_b64_tr_b16 v[166:167], v222 offset:12672
    s_waitcnt lgkmcnt(12)
    v_mfma_f32_32x32x16_bf16 v[84:99], v[168:171], v[140:143], v[84:99]
    ds_read_b64_tr_b16 v[168:169], v222 offset:10912
    ds_read_b64_tr_b16 v[170:171], v222 offset:12704
    s_waitcnt lgkmcnt(12)
    v_mfma_f32_32x32x16_bf16 v[100:115], v[172:175], v[140:143], v[100:115]
    ds_read_b64_tr_b16 v[172:173], v222 offset:10944
    ds_read_b64_tr_b16 v[174:175], v222 offset:12736
    s_waitcnt lgkmcnt(12)
    v_mfma_f32_32x32x16_bf16 v[4:19], v[148:151], v[144:147], v[4:19]
    buffer_load_dwordx4 v[140:143], v220, s[8:11], s24 offen offset:2048 sc1
    s_waitcnt lgkmcnt(10)
    v_mfma_f32_32x32x16_bf16 v[20:35], v[152:155], v[144:147], v[20:35]
    s_barrier
    v_add_u32 v222, 28800, v221
    ds_read_b64_tr_b16 v[148:149], v222 offset:0
    ds_read_b64_tr_b16 v[150:151], v222 offset:1792
    ds_read_b64_tr_b16 v[152:153], v222 offset:32
    ds_read_b64_tr_b16 v[154:155], v222 offset:1824
    s_mov_b32 s87, 4128768
    s_add_u32 m0, s86, 115200
    s_nop 0
    buffer_load_dwordx4 v248, s[92:95], s87 offen lds
    s_add_u32 m0, s86, 116224
    s_nop 0
    buffer_load_dwordx4 v249, s[92:95], s87 offen lds
    s_waitcnt lgkmcnt(12)
    v_mfma_f32_32x32x16_bf16 v[36:51], v[156:159], v[144:147], v[36:51]
    ds_read_b64_tr_b16 v[156:157], v222 offset:64
    ds_read_b64_tr_b16 v[158:159], v222 offset:1856
    s_add_u32 m0, s86, 117248
    s_nop 0
    buffer_load_dwordx4 v250, s[92:95], s87 offen lds
    s_add_u32 m0, s86, 118272
    s_mov_b32 exec_hi, 0
    buffer_load_dwordx4 v251, s[92:95], s87 offen lds
    s_mov_b32 exec_hi, -1
    s_waitcnt lgkmcnt(12)
    v_mfma_f32_32x32x16_bf16 v[52:67], v[160:163], v[144:147], v[52:67]
    ds_read_b64_tr_b16 v[160:161], v222 offset:96
    ds_read_b64_tr_b16 v[162:163], v222 offset:1888
    s_waitcnt lgkmcnt(12)
    v_mfma_f32_32x32x16_bf16 v[68:83], v[164:167], v[144:147], v[68:83]
    ds_read_b64_tr_b16 v[164:165], v222 offset:128
    ds_read_b64_tr_b16 v[166:167], v222 offset:1920
    s_waitcnt lgkmcnt(12)
    v_mfma_f32_32x32x16_bf16 v[84:99], v[168:171], v[144:147], v[84:99]
    ds_read_b64_tr_b16 v[168:169], v222 offset:160
    ds_read_b64_tr_b16 v[170:171], v222 offset:1952
    s_waitcnt lgkmcnt(12)
    v_mfma_f32_32x32x16_bf16 v[100:115], v[172:175], v[144:147], v[100:115]
    ds_read_b64_tr_b16 v[172:173], v222 offset:192
    ds_read_b64_tr_b16 v[174:175], v222 offset:1984
    s_waitcnt vmcnt(7)
    v_max3_u32 v233, v116, v117, v118
    v_max3_u32 v233, v233, v119, v120
    v_max3_u32 v233, v233, v121, v122
    v_max3_u32 v233, v233, v123, v124
    v_max3_u32 v233, v233, v125, v126
    v_max3_u32 v233, v233, v127, v128
    v_max3_u32 v233, v233, v129, v130
    v_max_u32 v233, v233, v131
    v_cmp_eq_u32 vcc, -1, v233
    s_cbranch_vccnz k4_slow_6
    k4_back_6:
    s_waitcnt lgkmcnt(12)
    v_mfma_f32_32x32x16_bf16 v[4:19], v[148:151], v[116:119], v[4:19]
    ds_read_b64_tr_b16 v[148:149], v222 offset:3584
    ds_read_b64_tr_b16 v[150:151], v222 offset:5376
    s_mov_b32 s33, 4194304
    buffer_load_dword v235, v234, s[52:55], s33 offen
    buffer_load_dwordx4 v[144:147], v220, s[8:11], s24 offen offset:3072 sc1
    s_waitcnt lgkmcnt(12)
    v_mfma_f32_32x32x16_bf16 v[20:35], v[152:155], v[116:119], v[20:35]
    ds_read_b64_tr_b16 v[152:153], v222 offset:3616
    ds_read_b64_tr_b16 v[154:155], v222 offset:5408
    s_waitcnt lgkmcnt(12)
    v_mfma_f32_32x32x16_bf16 v[36:51], v[156:159], v[116:119], v[36:51]
    ds_read_b64_tr_b16 v[156:157], v222 offset:3648
    ds_read_b64_tr_b16 v[158:159], v222 offset:5440
    s_waitcnt lgkmcnt(12)
    v_mfma_f32_32x32x16_bf16 v[52:67], v[160:163], v[116:119], v[52:67]
    ds_read_b64_tr_b16 v[160:161], v222 offset:3680
    ds_read_b64_tr_b16 v[162:163], v222 offset:5472
    s_waitcnt lgkmcnt(12)
    v_mfma_f32_32x32x16_bf16 v[68:83], v[164:167], v[116:119], v[68:83]
    ds_read_b64_tr_b16 v[164:165], v222 offset:3712
    ds_read_b64_tr_b16 v[166:167], v222 offset:5504
    s_waitcnt lgkmcnt(12)
    v_mfma_f32_32x32x16_bf16 v[84:99], v[168:171], v[116:119], v[84:99]
    ds_read_b64_tr_b16 v[168:169], v222 offset:3744
    ds_read_b64_tr_b16 v[170:171], v222 offset:5536
    s_waitcnt lgkmcnt(12)
    v_mfma_f32_32x32x16_bf16 v[100:115], v[172:175], v[116:119], v[100:115]
    ds_read_b64_tr_b16 v[172:173], v222 offset:3776
    ds_read_b64_tr_b16 v[174:175], v222 offset:5568
    s_waitcnt lgkmcnt(12)
    v_mfma_f32_32x32x16_bf16 v[4:19], v[148:151], v[120:123], v[4:19]
    ds_read_b64_tr_b16 v[148:149], v222 offset:7168
    ds_read_b64_tr_b16 v[150:151], v222 offset:8960
    s_mov_b32 s24, 32768
    buffer_load_dwordx4 v[116:119], v220, s[8:11], s24 offen offset:0 sc1
    s_waitcnt lgkmcnt(12)
    v_mfma_f32_32x32x16_bf16 v[20:35], v[152:155], v[120:123], v[20:35]
    ds_read_b64_tr_b16 v[152:153], v222 offset:7200
    ds_read_b64_tr_b16 v[154:155], v222 offset:8992
    s_waitcnt lgkmcnt(12)
    v_mfma_f32_32x32x16_bf16 v[36:51], v[156:159], v[120:123], v[36:51]
    ds_read_b64_tr_b16 v[156:157], v222 offset:7232
    ds_read_b64_tr_b16 v[158:159], v222 offset:9024
    s_waitcnt lgkmcnt(12)
    v_mfma_f32_32x32x16_bf16 v[52:67], v[160:163], v[120:123], v[52:67]
    ds_read_b64_tr_b16 v[160:161], v222 offset:7264
    ds_read_b64_tr_b16 v[162:163], v222 offset:9056
    s_waitcnt lgkmcnt(12)
    v_mfma_f32_32x32x16_bf16 v[68:83], v[164:167], v[120:123], v[68:83]
    ds_read_b64_tr_b16 v[164:165], v222 offset:7296
    ds_read_b64_tr_b16 v[166:167], v222 offset:9088
    s_waitcnt lgkmcnt(12)
    v_mfma_f32_32x32x16_bf16 v[84:99], v[168:171], v[120:123], v[84:99]
    ds_read_b64_tr_b16 v[168:169], v222 offset:7328
    ds_read_b64_tr_b16 v[170:171], v222 offset:9120
    s_waitcnt lgkmcnt(12)
    v_mfma_f32_32x32x16_bf16 v[100:115], v[172:175], v[120:123], v[100:115]
    ds_read_b64_tr_b16 v[172:173], v222 offset:7360
    ds_read_b64_tr_b16 v[174:175], v222 offset:9152
    s_waitcnt lgkmcnt(12)
    v_mfma_f32_32x32x16_bf16 v[4:19], v[148:151], v[124:127], v[4:19]
    ds_read_b64_tr_b16 v[148:149], v222 offset:10752
    ds_read_b64_tr_b16 v[150:151], v222 offset:12544
    buffer_load_dwordx4 v[120:123], v220, s[8:11], s24 offen offset:1024 sc1
    s_waitcnt lgkmcnt(12)
    v_mfma_f32_32x32x16_bf16 v[20:35], v[152:155], v[124:127], v[20:35]
    ds_read_b64_tr_b16 v[152:153], v222 offset:10784
    ds_read_b64_tr_b16 v[154:155], v222 offset:12576
    s_waitcnt lgkmcnt(12)
    v_mfma_f32_32x32x16_bf16 v[36:51], v[156:159], v[124:127], v[36:51]
    ds_read_b64_tr_b16 v[156:157], v222 offset:10816
    ds_read_b64_tr_b16 v[158:159], v222 offset:12608
    s_waitcnt lgkmcnt(12)
    v_mfma_f32_32x32x16_bf16 v[52:67], v[160:163], v[124:127], v[52:67]
    ds_read_b64_tr_b16 v[160:161], v222 offset:10848
    ds_read_b64_tr_b16 v[162:163], v222 offset:12640
    s_waitcnt lgkmcnt(12)
    v_mfma_f32_32x32x16_bf16 v[68:83], v[164:167], v[124:127], v[68:83]
    ds_read_b64_tr_b16 v[164:165], v222 offset:10880
    ds_read_b64_tr_b16 v[166:167], v222 offset:12672
    s_waitcnt lgkmcnt(12)
    v_mfma_f32_32x32x16_bf16 v[84:99], v[168:171], v[124:127], v[84:99]
    ds_read_b64_tr_b16 v[168:169], v222 offset:10912
    ds_read_b64_tr_b16 v[170:171], v222 offset:12704
    s_waitcnt lgkmcnt(12)
    v_mfma_f32_32x32x16_bf16 v[100:115], v[172:175], v[124:127], v[100:115]
    ds_read_b64_tr_b16 v[172:173], v222 offset:10944
    ds_read_b64_tr_b16 v[174:175], v222 offset:12736
    s_waitcnt lgkmcnt(12)
    v_mfma_f32_32x32x16_bf16 v[4:19], v[148:151], v[128:131], v[4:19]
    buffer_load_dwordx4 v[124:127], v220, s[8:11], s24 offen offset:2048 sc1
    s_waitcnt lgkmcnt(10)
    v_mfma_f32_32x32x16_bf16 v[20:35], v[152:155], v[128:131], v[20:35]
    s_barrier
    v_add_u32 v222, 57600, v221
    ds_read_b64_tr_b16 v[148:149], v222 offset:0
    ds_read_b64_tr_b16 v[150:151], v222 offset:1792
    ds_read_b64_tr_b16 v[152:153], v222 offset:32
    ds_read_b64_tr_b16 v[154:155], v222 offset:1824
    s_mov_b32 s87, 4587520
    s_add_u32 m0, s86, 0
    s_nop 0
    buffer_load_dwordx4 v248, s[92:95], s87 offen lds
    s_add_u32 m0, s86, 1024
    s_nop 0
    buffer_load_dwordx4 v249, s[92:95], s87 offen lds
    s_waitcnt lgkmcnt(12)
    v_mfma_f32_32x32x16_bf16 v[36:51], v[156:159], v[128:131], v[36:51]
    ds_read_b64_tr_b16 v[156:157], v222 offset:64
    ds_read_b64_tr_b16 v[158:159], v222 offset:1856
    s_add_u32 m0, s86, 2048
    s_nop 0
    buffer_load_dwordx4 v250, s[92:95], s87 offen lds
    s_add_u32 m0, s86, 3072
    s_mov_b32 exec_hi, 0
    buffer_load_dwordx4 v251, s[92:95], s87 offen lds
    s_mov_b32 exec_hi, -1
    s_waitcnt lgkmcnt(12)
    v_mfma_f32_32x32x16_bf16 v[52:67], v[160:163], v[128:131], v[52:67]
    ds_read_b64_tr_b16 v[160:161], v222 offset:96
    ds_read_b64_tr_b16 v[162:163], v222 offset:1888
    s_waitcnt lgkmcnt(12)
    v_mfma_f32_32x32x16_bf16 v[68:83], v[164:167], v[128:131], v[68:83]
    ds_read_b64_tr_b16 v[164:165], v222 offset:128
    ds_read_b64_tr_b16 v[166:167], v222 offset:1920
    s_waitcnt lgkmcnt(12)
    v_mfma_f32_32x32x16_bf16 v[84:99], v[168:171], v[128:131], v[84:99]
    ds_read_b64_tr_b16 v[168:169], v222 offset:160
    ds_read_b64_tr_b16 v[170:171], v222 offset:1952
    s_waitcnt lgkmcnt(12)
    v_mfma_f32_32x32x16_bf16 v[100:115], v[172:175], v[128:131], v[100:115]
    ds_read_b64_tr_b16 v[172:173], v222 offset:192
    ds_read_b64_tr_b16 v[174:175], v222 offset:1984
    s_waitcnt vmcnt(7)
    v_max3_u32 v233, v132, v133, v134
    v_max3_u32 v233, v233, v135, v136
    v_max3_u32 v233, v233, v137, v138
    v_max3_u32 v233, v233, v139, v140
    v_max3_u32 v233, v233, v141, v142
    v_max3_u32 v233, v233, v143, v144
    v_max3_u32 v233, v233, v145, v146
    v_max_u32 v233, v233, v147
    v_cmp_eq_u32 vcc, -1, v233
    s_cbranch_vccnz k4_slow_7
    k4_back_7:
    s_waitcnt lgkmcnt(12)
    v_mfma_f32_32x32x16_bf16 v[4:19], v[148:151], v[132:135], v[4:19]
    ds_read_b64_tr_b16 v[148:149], v222 offset:3584
    ds_read_b64_tr_b16 v[150:151], v222 offset:5376
    s_mov_b32 s33, 5242880
    buffer_load_dword v235, v234, s[52:55], s33 offen
    buffer_load_dwordx4 v[128:131], v220, s[8:11], s24 offen offset:3072 sc1
    s_waitcnt lgkmcnt(12)
    v_mfma_f32_32x32x16_bf16 v[20:35], v[152:155], v[132:135], v[20:35]
    ds_read_b64_tr_b16 v[152:153], v222 offset:3616
    ds_read_b64_tr_b16 v[154:155], v222 offset:5408
    s_waitcnt lgkmcnt(12)
    v_mfma_f32_32x32x16_bf16 v[36:51], v[156:159], v[132:135], v[36:51]
    ds_read_b64_tr_b16 v[156:157], v222 offset:3648
    ds_read_b64_tr_b16 v[158:159], v222 offset:5440
    s_waitcnt lgkmcnt(12)
    v_mfma_f32_32x32x16_bf16 v[52:67], v[160:163], v[132:135], v[52:67]
    ds_read_b64_tr_b16 v[160:161], v222 offset:3680
    ds_read_b64_tr_b16 v[162:163], v222 offset:5472
    s_waitcnt lgkmcnt(12)
    v_mfma_f32_32x32x16_bf16 v[68:83], v[164:167], v[132:135], v[68:83]
    ds_read_b64_tr_b16 v[164:165], v222 offset:3712
    ds_read_b64_tr_b16 v[166:167], v222 offset:5504
    s_waitcnt lgkmcnt(12)
    v_mfma_f32_32x32x16_bf16 v[84:99], v[168:171], v[132:135], v[84:99]
    ds_read_b64_tr_b16 v[168:169], v222 offset:3744
    ds_read_b64_tr_b16 v[170:171], v222 offset:5536
    s_waitcnt lgkmcnt(12)
    v_mfma_f32_32x32x16_bf16 v[100:115], v[172:175], v[132:135], v[100:115]
    ds_read_b64_tr_b16 v[172:173], v222 offset:3776
    ds_read_b64_tr_b16 v[174:175], v222 offset:5568
    s_waitcnt lgkmcnt(12)
    v_mfma_f32_32x32x16_bf16 v[4:19], v[148:151], v[136:139], v[4:19]
    ds_read_b64_tr_b16 v[148:149], v222 offset:7168
    ds_read_b64_tr_b16 v[150:151], v222 offset:8960
    s_mov_b32 s24, 36864
    buffer_load_dwordx4 v[132:135], v220, s[8:11], s24 offen offset:0 sc1
    s_waitcnt lgkmcnt(12)
    v_mfma_f32_32x32x16_bf16 v[20:35], v[152:155], v[136:139], v[20:35]
    ds_read_b64_tr_b16 v[152:153], v222 offset:7200
    ds_read_b64_tr_b16 v[154:155], v222 offset:8992
    s_waitcnt lgkmcnt(12)
    v_mfma_f32_32x32x16_bf16 v[36:51], v[156:159], v[136:139], v[36:51]
    ds_read_b64_tr_b16 v[156:157], v222 offset:7232
    ds_read_b64_tr_b16 v[158:159], v222 offset:9024
    s_waitcnt lgkmcnt(12)
    v_mfma_f32_32x32x16_bf16 v[52:67], v[160:163], v[136:139], v[52:67]
    ds_read_b64_tr_b16 v[160:161], v222 offset:7264
    ds_read_b64_tr_b16 v[162:163], v222 offset:9056
    s_waitcnt lgkmcnt(12)
    v_mfma_f32_32x32x16_bf16 v[68:83], v[164:167], v[136:139], v[68:83]
    ds_read_b64_tr_b16 v[164:165], v222 offset:7296
    ds_read_b64_tr_b16 v[166:167], v222 offset:9088
    s_waitcnt lgkmcnt(12)
    v_mfma_f32_32x32x16_bf16 v[84:99], v[168:171], v[136:139], v[84:99]
    ds_read_b64_tr_b16 v[168:169], v222 offset:7328
    ds_read_b64_tr_b16 v[170:171], v222 offset:9120
    s_waitcnt lgkmcnt(12)
    v_mfma_f32_32x32x16_bf16 v[100:115], v[172:175], v[136:139], v[100:115]
    ds_read_b64_tr_b16 v[172:173], v222 offset:7360
    ds_read_b64_tr_b16 v[174:175], v222 offset:9152
    s_waitcnt lgkmcnt(12)
    v_mfma_f32_32x32x16_bf16 v[4:19], v[148:151], v[140:143], v[4:19]
    ds_read_b64_tr_b16 v[148:149], v222 offset:10752
    ds_read_b64_tr_b16 v[150:151], v222 offset:12544
    buffer_load_dwordx4 v[136:139], v220, s[8:11], s24 offen offset:1024 sc1
    s_waitcnt lgkmcnt(12)
    v_mfma_f32_32x32x16_bf16 v[20:35], v[152:155], v[140:143], v[20:35]
    ds_read_b64_tr_b16 v[152:153], v222 offset:10784
    ds_read_b64_tr_b16 v[154:155], v222 offset:12576
    s_waitcnt lgkmcnt(12)
    v_mfma_f32_32x32x16_bf16 v[36:51], v[156:159], v[140:143], v[36:51]
    ds_read_b64_tr_b16 v[156:157], v222 offset:10816
    ds_read_b64_tr_b16 v[158:159], v222 offset:12608
    s_waitcnt lgkmcnt(12)
    v_mfma_f32_32x32x16_bf16 v[52:67], v[160:163], v[140:143], v[52:67]
    ds_read_b64_tr_b16 v[160:161], v222 offset:10848
    ds_read_b64_tr_b16 v[162:163], v222 offset:12640
    s_waitcnt lgkmcnt(12)
    v_mfma_f32_32x32x16_bf16 v[68:83], v[164:167], v[140:143], v[68:83]
    ds_read_b64_tr_b16 v[164:165], v222 offset:10880
    ds_read_b64_tr_b16 v[166:167], v222 offset:12672
    s_waitcnt lgkmcnt(12)
    v_mfma_f32_32x32x16_bf16 v[84:99], v[168:171], v[140:143], v[84:99]
    ds_read_b64_tr_b16 v[168:169], v222 offset:10912
    ds_read_b64_tr_b16 v[170:171], v222 offset:12704
    s_waitcnt lgkmcnt(12)
    v_mfma_f32_32x32x16_bf16 v[100:115], v[172:175], v[140:143], v[100:115]
    ds_read_b64_tr_b16 v[172:173], v222 offset:10944
    ds_read_b64_tr_b16 v[174:175], v222 offset:12736
    s_waitcnt lgkmcnt(12)
    v_mfma_f32_32x32x16_bf16 v[4:19], v[148:151], v[144:147], v[4:19]
    buffer_load_dwordx4 v[140:143], v220, s[8:11], s24 offen offset:2048 sc1
    s_waitcnt lgkmcnt(10)
    v_mfma_f32_32x32x16_bf16 v[20:35], v[152:155], v[144:147], v[20:35]
    s_barrier
    v_add_u32 v222, 86400, v221
    ds_read_b64_tr_b16 v[148:149], v222 offset:0
    ds_read_b64_tr_b16 v[150:151], v222 offset:1792
    ds_read_b64_tr_b16 v[152:153], v222 offset:32
    ds_read_b64_tr_b16 v[154:155], v222 offset:1824
    s_mov_b32 s87, 5046272
    s_add_u32 m0, s86, 28800
    s_nop 0
    buffer_load_dwordx4 v248, s[92:95], s87 offen lds
    s_add_u32 m0, s86, 29824
    s_nop 0
    buffer_load_dwordx4 v249, s[92:95], s87 offen lds
    s_waitcnt lgkmcnt(12)
    v_mfma_f32_32x32x16_bf16 v[36:51], v[156:159], v[144:147], v[36:51]
    ds_read_b64_tr_b16 v[156:157], v222 offset:64
    ds_read_b64_tr_b16 v[158:159], v222 offset:1856
    s_add_u32 m0, s86, 30848
    s_nop 0
    buffer_load_dwordx4 v250, s[92:95], s87 offen lds
    s_add_u32 m0, s86, 31872
    s_mov_b32 exec_hi, 0
    buffer_load_dwordx4 v251, s[92:95], s87 offen lds
    s_mov_b32 exec_hi, -1
    s_waitcnt lgkmcnt(12)
    v_mfma_f32_32x32x16_bf16 v[52:67], v[160:163], v[144:147], v[52:67]
    ds_read_b64_tr_b16 v[160:161], v222 offset:96
    ds_read_b64_tr_b16 v[162:163], v222 offset:1888
    s_waitcnt lgkmcnt(12)
    v_mfma_f32_32x32x16_bf16 v[68:83], v[164:167], v[144:147], v[68:83]
    ds_read_b64_tr_b16 v[164:165], v222 offset:128
    ds_read_b64_tr_b16 v[166:167], v222 offset:1920
    s_waitcnt lgkmcnt(12)
    v_mfma_f32_32x32x16_bf16 v[84:99], v[168:171], v[144:147], v[84:99]
    ds_read_b64_tr_b16 v[168:169], v222 offset:160
    ds_read_b64_tr_b16 v[170:171], v222 offset:1952
    s_waitcnt lgkmcnt(12)
    v_mfma_f32_32x32x16_bf16 v[100:115], v[172:175], v[144:147], v[100:115]
    ds_read_b64_tr_b16 v[172:173], v222 offset:192
    ds_read_b64_tr_b16 v[174:175], v222 offset:1984
    s_waitcnt vmcnt(7)
    v_max3_u32 v233, v116, v117, v118
    v_max3_u32 v233, v233, v119, v120
    v_max3_u32 v233, v233, v121, v122
    v_max3_u32 v233, v233, v123, v124
    v_max3_u32 v233, v233, v125, v126
    v_max3_u32 v233, v233, v127, v128
    v_max3_u32 v233, v233, v129, v130
    v_max_u32 v233, v233, v131
    v_cmp_eq_u32 vcc, -1, v233
    s_cbranch_vccnz k4_slow_8
    k4_back_8:
    v_max3_u32 v233, v176, v177, v178
    v_max3_u32 v233, v233, v179, v180
    v_max3_u32 v233, v233, v181, v182
    v_max3_u32 v233, v233, v183, v184
    v_max3_u32 v233, v233, v185, v186
    v_max3_u32 v233, v233, v187, v188
    v_max3_u32 v233, v233, v189, v190
    v_max3_u32 v233, v233, v191, v192
    v_max3_u32 v233, v233, v193, v194
    v_max3_u32 v233, v233, v195, v196
    v_max3_u32 v233, v233, v197, v198
    v_max3_u32 v233, v233, v199, v200
    v_max3_u32 v233, v233, v201, v202
    v_max3_u32 v233, v233, v203, v204
    v_max3_u32 v233, v233, v205, v206
    v_max3_u32 v233, v233, v207, v208
    v_max3_u32 v233, v233, v209, v210
    v_max3_u32 v233, v233, v211, v212
    v_max3_u32 v233, v233, v213, v214
    v_max3_u32 v233, v233, v215, v216
    v_max3_u32 v233, v233, v217, v218
    v_max_u32 v233, v233, v219
    v_cmp_eq_u32 vcc, -1, v233
    s_cbranch_vccnz k4_slow_s
    k4_back_s:
    v_add_f32 v176, v176, v184
    v_add_f32 v177, v177, v185
    v_add_f32 v178, v178, v186
    v_add_f32 v179, v179, v187
    v_add_f32 v180, v180, v188
    v_add_f32 v181, v181, v189
    v_add_f32 v182, v182, v190
    v_add_f32 v183, v183, v191
    v_add_f32 v176, v176, v180
    v_add_f32 v177, v177, v181
    v_add_f32 v178, v178, v182
    v_add_f32 v179, v179, v183
    v_add_f32 v176, v176, v178
    v_add_f32 v177, v177, v179
    v_mov_b32 v178, v176
    v_mov_b32 v179, v177
    s_nop 1
    v_permlane32_swap_b32 v176, v178
    v_permlane32_swap_b32 v177, v179
    s_nop 1
    v_add_f32 v176, v176, v178
    v_add_f32 v177, v177, v179
    v_mul_f32 v176, 0xba800000, v176
    v_mul_f32 v177, 0x3a800000, v177
    v_fma_f32 v177, -v176, v176, v177
    v_max_f32 v177, 0, v177
    v_add_f32 v232, 0x3727c5ac, v177
    v_rsq_f32 v177, v232
    v_cmp_gt_u32 vcc, 32, v2
    v_cndmask_b32 v176, 0, v176, vcc
    v_cvt_pk_bf16_f32 v181, v176, 0
    v_lshlrev_b32 v178, 16, v181
    v_sub_f32 v178, v176, v178
    v_cvt_pk_bf16_f32 v180, v176, v178
    v_mov_b32 v182, 0
    v_mov_b32 v183, 0
    v_mul_f32 v228, 0xc0135761, v177
    v_mul_f32 v230, v177, v177
    v_mul_f32 v230, v230, v177
    v_mul_f32 v230, 0xbdd2d3e8, v230
    v_mov_b32 v186, 0
    v_mov_b32 v187, 0
    v_mov_b32 v190, 0
    v_mov_b32 v191, 0
    v_add_f32 v192, v192, v193
    v_add_f32 v194, v194, v195
    v_add_f32 v192, v192, v194
    v_cvt_pk_bf16_f32 v184, v192, v192
    v_and_b32 v178, 0xffff0000, v184
    v_sub_f32 v178, v192, v178
    v_cvt_pk_bf16_f32 v185, v178, 0
    s_nop 1
    v_mfma_f32_32x32x16_bf16 v[4:19], v[184:187], v[180:183], v[4:19]
    v_add_f32 v196, v196, v197
    v_add_f32 v198, v198, v199
    v_add_f32 v196, v196, v198
    v_cvt_pk_bf16_f32 v188, v196, v196
    v_and_b32 v178, 0xffff0000, v188
    v_sub_f32 v178, v196, v178
    v_cvt_pk_bf16_f32 v189, v178, 0
    s_nop 1
    v_mfma_f32_32x32x16_bf16 v[20:35], v[188:191], v[180:183], v[20:35]
    v_add_f32 v200, v200, v201
    v_add_f32 v202, v202, v203
    v_add_f32 v200, v200, v202
    v_cvt_pk_bf16_f32 v184, v200, v200
    v_and_b32 v178, 0xffff0000, v184
    v_sub_f32 v178, v200, v178
    v_cvt_pk_bf16_f32 v185, v178, 0
    s_nop 1
    v_mfma_f32_32x32x16_bf16 v[36:51], v[184:187], v[180:183], v[36:51]
    v_add_f32 v204, v204, v205
    v_add_f32 v206, v206, v207
    v_add_f32 v204, v204, v206
    v_cvt_pk_bf16_f32 v188, v204, v204
    v_and_b32 v178, 0xffff0000, v188
    v_sub_f32 v178, v204, v178
    v_cvt_pk_bf16_f32 v189, v178, 0
    s_nop 1
    v_mfma_f32_32x32x16_bf16 v[52:67], v[188:191], v[180:183], v[52:67]
    v_add_f32 v208, v208, v209
    v_add_f32 v210, v210, v211
    v_add_f32 v208, v208, v210
    v_cvt_pk_bf16_f32 v184, v208, v208
    v_and_b32 v178, 0xffff0000, v184
    v_sub_f32 v178, v208, v178
    v_cvt_pk_bf16_f32 v185, v178, 0
    s_nop 1
    v_mfma_f32_32x32x16_bf16 v[68:83], v[184:187], v[180:183], v[68:83]
    v_add_f32 v212, v212, v213
    v_add_f32 v214, v214, v215
    v_add_f32 v212, v212, v214
    v_cvt_pk_bf16_f32 v188, v212, v212
    v_and_b32 v178, 0xffff0000, v188
    v_sub_f32 v178, v212, v178
    v_cvt_pk_bf16_f32 v189, v178, 0
    s_nop 1
    v_mfma_f32_32x32x16_bf16 v[84:99], v[188:191], v[180:183], v[84:99]
    v_add_f32 v216, v216, v217
    v_add_f32 v218, v218, v219
    v_add_f32 v216, v216, v218
    v_cvt_pk_bf16_f32 v184, v216, v216
    v_and_b32 v178, 0xffff0000, v184
    v_sub_f32 v178, v216, v178
    v_cvt_pk_bf16_f32 v185, v178, 0
    s_nop 1
    v_mfma_f32_32x32x16_bf16 v[100:115], v[184:187], v[180:183], v[100:115]
    s_waitcnt lgkmcnt(12)
    v_mfma_f32_32x32x16_bf16 v[4:19], v[148:151], v[116:119], v[4:19]
    ds_read_b64_tr_b16 v[148:149], v222 offset:3584
    ds_read_b64_tr_b16 v[150:151], v222 offset:5376
    s_mov_b32 s33, 6291456
    buffer_load_dword v235, v234, s[52:55], s33 offen
    buffer_load_dwordx4 v[144:147], v220, s[8:11], s24 offen offset:3072 sc1
    s_waitcnt lgkmcnt(12)
    v_mfma_f32_32x32x16_bf16 v[20:35], v[152:155], v[116:119], v[20:35]
    ds_read_b64_tr_b16 v[152:153], v222 offset:3616
    ds_read_b64_tr_b16 v[154:155], v222 offset:5408
    s_waitcnt lgkmcnt(12)
    v_mfma_f32_32x32x16_bf16 v[36:51], v[156:159], v[116:119], v[36:51]
    ds_read_b64_tr_b16 v[156:157], v222 offset:3648
    ds_read_b64_tr_b16 v[158:159], v222 offset:5440
    s_waitcnt lgkmcnt(12)
    v_mfma_f32_32x32x16_bf16 v[52:67], v[160:163], v[116:119], v[52:67]
    ds_read_b64_tr_b16 v[160:161], v222 offset:3680
    ds_read_b64_tr_b16 v[162:163], v222 offset:5472
    s_waitcnt lgkmcnt(12)
    v_mfma_f32_32x32x16_bf16 v[68:83], v[164:167], v[116:119], v[68:83]
    ds_read_b64_tr_b16 v[164:165], v222 offset:3712
    ds_read_b64_tr_b16 v[166:167], v222 offset:5504
    s_waitcnt lgkmcnt(12)
    v_mfma_f32_32x32x16_bf16 v[84:99], v[168:171], v[116:119], v[84:99]
    ds_read_b64_tr_b16 v[168:169], v222 offset:3744
    ds_read_b64_tr_b16 v[170:171], v222 offset:5536
    s_waitcnt lgkmcnt(12)
    v_mfma_f32_32x32x16_bf16 v[100:115], v[172:175], v[116:119], v[100:115]
    ds_read_b64_tr_b16 v[172:173], v222 offset:3776
    ds_read_b64_tr_b16 v[174:175], v222 offset:5568
    s_waitcnt lgkmcnt(12)
    v_mfma_f32_32x32x16_bf16 v[4:19], v[148:151], v[120:123], v[4:19]
    ds_read_b64_tr_b16 v[148:149], v222 offset:7168
    ds_read_b64_tr_b16 v[150:151], v222 offset:8960
    s_mov_b32 s24, 40960
    buffer_load_dwordx4 v[116:119], v220, s[8:11], s24 offen offset:0 sc1
    s_waitcnt lgkmcnt(12)
    v_mfma_f32_32x32x16_bf16 v[20:35], v[152:155], v[120:123], v[20:35]
    ds_read_b64_tr_b16 v[152:153], v222 offset:7200
    ds_read_b64_tr_b16 v[154:155], v222 offset:8992
    s_waitcnt lgkmcnt(12)
    v_mfma_f32_32x32x16_bf16 v[36:51], v[156:159], v[120:123], v[36:51]
    ds_read_b64_tr_b16 v[156:157], v222 offset:7232
    ds_read_b64_tr_b16 v[158:159], v222 offset:9024
    s_waitcnt lgkmcnt(12)
    v_mfma_f32_32x32x16_bf16 v[52:67], v[160:163], v[120:123], v[52:67]
    ds_read_b64_tr_b16 v[160:161], v222 offset:7264
    ds_read_b64_tr_b16 v[162:163], v222 offset:9056
    s_waitcnt lgkmcnt(12)
    v_mfma_f32_32x32x16_bf16 v[68:83], v[164:167], v[120:123], v[68:83]
    ds_read_b64_tr_b16 v[164:165], v222 offset:7296
    ds_read_b64_tr_b16 v[166:167], v222 offset:9088
    s_waitcnt lgkmcnt(12)
    v_mfma_f32_32x32x16_bf16 v[84:99], v[168:171], v[120:123], v[84:99]
    ds_read_b64_tr_b16 v[168:169], v222 offset:7328
    ds_read_b64_tr_b16 v[170:171], v222 offset:9120
    s_waitcnt lgkmcnt(12)
    v_mfma_f32_32x32x16_bf16 v[100:115], v[172:175], v[120:123], v[100:115]
    ds_read_b64_tr_b16 v[172:173], v222 offset:7360
    ds_read_b64_tr_b16 v[174:175], v222 offset:9152
    s_waitcnt lgkmcnt(12)
    v_mfma_f32_32x32x16_bf16 v[4:19], v[148:151], v[124:127], v[4:19]
    ds_read_b64_tr_b16 v[148:149], v222 offset:10752
    ds_read_b64_tr_b16 v[150:151], v222 offset:12544
    buffer_load_dwordx4 v[120:123], v220, s[8:11], s24 offen offset:1024 sc1
    s_waitcnt lgkmcnt(12)
    v_mfma_f32_32x32x16_bf16 v[20:35], v[152:155], v[124:127], v[20:35]
    ds_read_b64_tr_b16 v[152:153], v222 offset:10784
    ds_read_b64_tr_b16 v[154:155], v222 offset:12576
    s_waitcnt lgkmcnt(12)
    v_mfma_f32_32x32x16_bf16 v[36:51], v[156:159], v[124:127], v[36:51]
    ds_read_b64_tr_b16 v[156:157], v222 offset:10816
    ds_read_b64_tr_b16 v[158:159], v222 offset:12608
    s_waitcnt lgkmcnt(12)
    v_mfma_f32_32x32x16_bf16 v[52:67], v[160:163], v[124:127], v[52:67]
    ds_read_b64_tr_b16 v[160:161], v222 offset:10848
    ds_read_b64_tr_b16 v[162:163], v222 offset:12640
    s_waitcnt lgkmcnt(12)
    v_mfma_f32_32x32x16_bf16 v[68:83], v[164:167], v[124:127], v[68:83]
    ds_read_b64_tr_b16 v[164:165], v222 offset:10880
    ds_read_b64_tr_b16 v[166:167], v222 offset:12672
    s_waitcnt lgkmcnt(12)
    v_mfma_f32_32x32x16_bf16 v[84:99], v[168:171], v[124:127], v[84:99]
    ds_read_b64_tr_b16 v[168:169], v222 offset:10912
    ds_read_b64_tr_b16 v[170:171], v222 offset:12704
    s_waitcnt lgkmcnt(12)
    v_mfma_f32_32x32x16_bf16 v[100:115], v[172:175], v[124:127], v[100:115]
    ds_read_b64_tr_b16 v[172:173], v222 offset:10944
    ds_read_b64_tr_b16 v[174:175], v222 offset:12736
    s_waitcnt lgkmcnt(12)
    v_mfma_f32_32x32x16_bf16 v[4:19], v[148:151], v[128:131], v[4:19]
    buffer_load_dwordx4 v[124:127], v220, s[8:11], s24 offen offset:2048 sc1
    s_waitcnt lgkmcnt(10)
    v_mfma_f32_32x32x16_bf16 v[20:35], v[152:155], v[128:131], v[20:35]
    s_barrier
    v_add_u32 v222, 115200, v221
    ds_read_b64_tr_b16 v[148:149], v222 offset:0
    ds_read_b64_tr_b16 v[150:151], v222 offset:1792
    ds_read_b64_tr_b16 v[152:153], v222 offset:32
    ds_read_b64_tr_b16 v[154:155], v222 offset:1824
    s_mov_b32 s87, 5505024
    s_add_u32 m0, s86, 57600
    s_nop 0
    buffer_load_dwordx4 v248, s[92:95], s87 offen lds
    s_add_u32 m0, s86, 58624
    s_nop 0
    buffer_load_dwordx4 v249, s[92:95], s87 offen lds
    s_waitcnt lgkmcnt(12)
    v_mfma_f32_32x32x16_bf16 v[36:51], v[156:159], v[128:131], v[36:51]
    ds_read_b64_tr_b16 v[156:157], v222 offset:64
    ds_read_b64_tr_b16 v[158:159], v222 offset:1856
    s_add_u32 m0, s86, 59648
    s_nop 0
    buffer_load_dwordx4 v250, s[92:95], s87 offen lds
    s_add_u32 m0, s86, 60672
    s_mov_b32 exec_hi, 0
    buffer_load_dwordx4 v251, s[92:95], s87 offen lds
    s_mov_b32 exec_hi, -1
    s_waitcnt lgkmcnt(12)
    v_mfma_f32_32x32x16_bf16 v[52:67], v[160:163], v[128:131], v[52:67]
    ds_read_b64_tr_b16 v[160:161], v222 offset:96
    ds_read_b64_tr_b16 v[162:163], v222 offset:1888
    s_waitcnt lgkmcnt(12)
    v_mfma_f32_32x32x16_bf16 v[68:83], v[164:167], v[128:131], v[68:83]
    ds_read_b64_tr_b16 v[164:165], v222 offset:128
    ds_read_b64_tr_b16 v[166:167], v222 offset:1920
    s_waitcnt lgkmcnt(12)
    v_mfma_f32_32x32x16_bf16 v[84:99], v[168:171], v[128:131], v[84:99]
    ds_read_b64_tr_b16 v[168:169], v222 offset:160
    ds_read_b64_tr_b16 v[170:171], v222 offset:1952
    s_waitcnt lgkmcnt(12)
    v_mfma_f32_32x32x16_bf16 v[100:115], v[172:175], v[128:131], v[100:115]
    ds_read_b64_tr_b16 v[172:173], v222 offset:192
    ds_read_b64_tr_b16 v[174:175], v222 offset:1984
    s_waitcnt vmcnt(7)
    v_max3_u32 v233, v132, v133, v134
    v_max3_u32 v233, v233, v135, v136
    v_max3_u32 v233, v233, v137, v138
    v_max3_u32 v233, v233, v139, v140
    v_max3_u32 v233, v233, v141, v142
    v_max3_u32 v233, v233, v143, v144
    v_max3_u32 v233, v233, v145, v146
    v_max_u32 v233, v233, v147
    v_cmp_eq_u32 vcc, -1, v233
    s_cbranch_vccnz k4_slow_9
    k4_back_9:
    s_waitcnt lgkmcnt(12)
    v_mfma_f32_32x32x16_bf16 v[4:19], v[148:151], v[132:135], v[4:19]
    ds_read_b64_tr_b16 v[148:149], v222 offset:3584
    ds_read_b64_tr_b16 v[150:151], v222 offset:5376
    s_mov_b32 s33, 7340032
    buffer_load_dword v235, v234, s[52:55], s33 offen
    buffer_load_dwordx4 v[128:131], v220, s[8:11], s24 offen offset:3072 sc1
    s_waitcnt lgkmcnt(12)
    v_mfma_f32_32x32x16_bf16 v[20:35], v[152:155], v[132:135], v[20:35]
    ds_read_b64_tr_b16 v[152:153], v222 offset:3616
    ds_read_b64_tr_b16 v[154:155], v222 offset:5408
    s_waitcnt lgkmcnt(12)
    v_mfma_f32_32x32x16_bf16 v[36:51], v[156:159], v[132:135], v[36:51]
    ds_read_b64_tr_b16 v[156:157], v222 offset:3648
    ds_read_b64_tr_b16 v[158:159], v222 offset:5440
    s_waitcnt lgkmcnt(12)
    v_mfma_f32_32x32x16_bf16 v[52:67], v[160:163], v[132:135], v[52:67]
    ds_read_b64_tr_b16 v[160:161], v222 offset:3680
    ds_read_b64_tr_b16 v[162:163], v222 offset:5472
    s_waitcnt lgkmcnt(12)
    v_mfma_f32_32x32x16_bf16 v[68:83], v[164:167], v[132:135], v[68:83]
    ds_read_b64_tr_b16 v[164:165], v222 offset:3712
    ds_read_b64_tr_b16 v[166:167], v222 offset:5504
    s_waitcnt lgkmcnt(12)
    v_mfma_f32_32x32x16_bf16 v[84:99], v[168:171], v[132:135], v[84:99]
    ds_read_b64_tr_b16 v[168:169], v222 offset:3744
    ds_read_b64_tr_b16 v[170:171], v222 offset:5536
    s_waitcnt lgkmcnt(12)
    v_mfma_f32_32x32x16_bf16 v[100:115], v[172:175], v[132:135], v[100:115]
    ds_read_b64_tr_b16 v[172:173], v222 offset:3776
    ds_read_b64_tr_b16 v[174:175], v222 offset:5568
    s_waitcnt lgkmcnt(12)
    v_mfma_f32_32x32x16_bf16 v[4:19], v[148:151], v[136:139], v[4:19]
    ds_read_b64_tr_b16 v[148:149], v222 offset:7168
    ds_read_b64_tr_b16 v[150:151], v222 offset:8960
    s_mov_b32 s24, 45056
    buffer_load_dwordx4 v[132:135], v220, s[8:11], s24 offen offset:0 sc1
    s_waitcnt lgkmcnt(12)
    v_mfma_f32_32x32x16_bf16 v[20:35], v[152:155], v[136:139], v[20:35]
    ds_read_b64_tr_b16 v[152:153], v222 offset:7200
    ds_read_b64_tr_b16 v[154:155], v222 offset:8992
    s_waitcnt lgkmcnt(12)
    v_mfma_f32_32x32x16_bf16 v[36:51], v[156:159], v[136:139], v[36:51]
    ds_read_b64_tr_b16 v[156:157], v222 offset:7232
    ds_read_b64_tr_b16 v[158:159], v222 offset:9024
    s_waitcnt lgkmcnt(12)
    v_mfma_f32_32x32x16_bf16 v[52:67], v[160:163], v[136:139], v[52:67]
    ds_read_b64_tr_b16 v[160:161], v222 offset:7264
    ds_read_b64_tr_b16 v[162:163], v222 offset:9056
    s_waitcnt lgkmcnt(12)
    v_mfma_f32_32x32x16_bf16 v[68:83], v[164:167], v[136:139], v[68:83]
    ds_read_b64_tr_b16 v[164:165], v222 offset:7296
    ds_read_b64_tr_b16 v[166:167], v222 offset:9088
    s_waitcnt lgkmcnt(12)
    v_mfma_f32_32x32x16_bf16 v[84:99], v[168:171], v[136:139], v[84:99]
    ds_read_b64_tr_b16 v[168:169], v222 offset:7328
    ds_read_b64_tr_b16 v[170:171], v222 offset:9120
    s_waitcnt lgkmcnt(12)
    v_mfma_f32_32x32x16_bf16 v[100:115], v[172:175], v[136:139], v[100:115]
    ds_read_b64_tr_b16 v[172:173], v222 offset:7360
    ds_read_b64_tr_b16 v[174:175], v222 offset:9152
    s_waitcnt lgkmcnt(12)
    v_mfma_f32_32x32x16_bf16 v[4:19], v[148:151], v[140:143], v[4:19]
    ds_read_b64_tr_b16 v[148:149], v222 offset:10752
    ds_read_b64_tr_b16 v[150:151], v222 offset:12544
    buffer_load_dwordx4 v[136:139], v220, s[8:11], s24 offen offset:1024 sc1
    s_waitcnt lgkmcnt(12)
    v_mfma_f32_32x32x16_bf16 v[20:35], v[152:155], v[140:143], v[20:35]
    ds_read_b64_tr_b16 v[152:153], v222 offset:10784
    ds_read_b64_tr_b16 v[154:155], v222 offset:12576
    s_waitcnt lgkmcnt(12)
    v_mfma_f32_32x32x16_bf16 v[36:51], v[156:159], v[140:143], v[36:51]
    ds_read_b64_tr_b16 v[156:157], v222 offset:10816
    ds_read_b64_tr_b16 v[158:159], v222 offset:12608
    s_waitcnt lgkmcnt(12)
    v_mfma_f32_32x32x16_bf16 v[52:67], v[160:163], v[140:143], v[52:67]
    ds_read_b64_tr_b16 v[160:161], v222 offset:10848
    ds_read_b64_tr_b16 v[162:163], v222 offset:12640
    s_waitcnt lgkmcnt(12)
    v_mfma_f32_32x32x16_bf16 v[68:83], v[164:167], v[140:143], v[68:83]
    ds_read_b64_tr_b16 v[164:165], v222 offset:10880
    ds_read_b64_tr_b16 v[166:167], v222 offset:12672
    s_waitcnt lgkmcnt(12)
    v_mfma_f32_32x32x16_bf16 v[84:99], v[168:171], v[140:143], v[84:99]
    ds_read_b64_tr_b16 v[168:169], v222 offset:10912
    ds_read_b64_tr_b16 v[170:171], v222 offset:12704
    s_waitcnt lgkmcnt(12)
    v_mfma_f32_32x32x16_bf16 v[100:115], v[172:175], v[140:143], v[100:115]
    ds_read_b64_tr_b16 v[172:173], v222 offset:10944
    ds_read_b64_tr_b16 v[174:175], v222 offset:12736
    s_waitcnt lgkmcnt(12)
    v_mfma_f32_32x32x16_bf16 v[4:19], v[148:151], v[144:147], v[4:19]
    buffer_load_dwordx4 v[140:143], v220, s[8:11], s24 offen offset:2048 sc1
    s_waitcnt lgkmcnt(10)
    v_mfma_f32_32x32x16_bf16 v[20:35], v[152:155], v[144:147], v[20:35]
    s_barrier
    v_add_u32 v222, 0, v221
    ds_read_b64_tr_b16 v[148:149], v222 offset:0
    ds_read_b64_tr_b16 v[150:151], v222 offset:1792
    ds_read_b64_tr_b16 v[152:153], v222 offset:32
    ds_read_b64_tr_b16 v[154:155], v222 offset:1824
    s_mov_b32 s87, 5963776
    s_add_u32 m0, s86, 86400
    s_nop 0
    buffer_load_dwordx4 v248, s[92:95], s87 offen lds
    s_add_u32 m0, s86, 87424
    s_nop 0
    buffer_load_dwordx4 v249, s[92:95], s87 offen lds
    s_waitcnt lgkmcnt(12)
    v_mfma_f32_32x32x16_bf16 v[36:51], v[156:159], v[144:147], v[36:51]
    ds_read_b64_tr_b16 v[156:157], v222 offset:64
    ds_read_b64_tr_b16 v[158:159], v222 offset:1856
    s_add_u32 m0, s86, 88448
    s_nop 0
    buffer_load_dwordx4 v250, s[92:95], s87 offen lds
    s_add_u32 m0, s86, 89472
    s_mov_b32 exec_hi, 0
    buffer_load_dwordx4 v251, s[92:95], s87 offen lds
    s_mov_b32 exec_hi, -1
    s_waitcnt lgkmcnt(12)
    v_mfma_f32_32x32x16_bf16 v[52:67], v[160:163], v[144:147], v[52:67]
    ds_read_b64_tr_b16 v[160:161], v222 offset:96
    ds_read_b64_tr_b16 v[162:163], v222 offset:1888
    s_waitcnt lgkmcnt(12)
    v_mfma_f32_32x32x16_bf16 v[68:83], v[164:167], v[144:147], v[68:83]
    ds_read_b64_tr_b16 v[164:165], v222 offset:128
    ds_read_b64_tr_b16 v[166:167], v222 offset:1920
    s_waitcnt lgkmcnt(12)
    v_mfma_f32_32x32x16_bf16 v[84:99], v[168:171], v[144:147], v[84:99]
    ds_read_b64_tr_b16 v[168:169], v222 offset:160
    ds_read_b64_tr_b16 v[170:171], v222 offset:1952
    s_waitcnt lgkmcnt(12)
    v_mfma_f32_32x32x16_bf16 v[100:115], v[172:175], v[144:147], v[100:115]
    ds_read_b64_tr_b16 v[172:173], v222 offset:192
    ds_read_b64_tr_b16 v[174:175], v222 offset:1984
    s_waitcnt vmcnt(7)
    v_max3_u32 v233, v116, v117, v118
    v_max3_u32 v233, v233, v119, v120
    v_max3_u32 v233, v233, v121, v122
    v_max3_u32 v233, v233, v123, v124
    v_max3_u32 v233, v233, v125, v126
    v_max3_u32 v233, v233, v127, v128
    v_max3_u32 v233, v233, v129, v130
    v_max_u32 v233, v233, v131
    v_cmp_eq_u32 vcc, -1, v233
    s_cbranch_vccnz k4_slow_10
    k4_back_10:
    s_add_u32 s28, s6, 50331648
    s_addc_u32 s29, s7, 0
    s_mov_b32 s30, 4194304
    s_mov_b32 s31, 0x00020000
    v_mov_b32 v192, -1
    v_mov_b32 v193, -1
    v_mov_b32 v194, -1
    v_mov_b32 v195, -1
    s_lshl_b32 s33, s2, 14
    v_lshrrev_b32 v196, 6, v0
    v_lshlrev_b32 v196, 11, v196
    v_lshl_add_u32 v196, v2, 4, v196
    v_add_u32 v196, s33, v196
    s_waitcnt lgkmcnt(12)
    v_mfma_f32_32x32x16_bf16 v[4:19], v[148:151], v[116:119], v[4:19]
    ds_read_b64_tr_b16 v[148:149], v222 offset:3584
    ds_read_b64_tr_b16 v[150:151], v222 offset:5376
    buffer_store_dwordx4 v[192:195], v196, s[28:31], 0 offen offset:0 sc1
    buffer_store_dwordx4 v[192:195], v196, s[28:31], 0 offen offset:1024 sc1
    s_waitcnt lgkmcnt(12)
    v_mfma_f32_32x32x16_bf16 v[20:35], v[152:155], v[116:119], v[20:35]
    ds_read_b64_tr_b16 v[152:153], v222 offset:3616
    ds_read_b64_tr_b16 v[154:155], v222 offset:5408
    buffer_load_dwordx4 v[144:147], v220, s[8:11], s24 offen offset:3072 sc1
    s_waitcnt lgkmcnt(12)
    v_mfma_f32_32x32x16_bf16 v[36:51], v[156:159], v[116:119], v[36:51]
    ds_read_b64_tr_b16 v[156:157], v222 offset:3648
    ds_read_b64_tr_b16 v[158:159], v222 offset:5440
    s_waitcnt lgkmcnt(12)
    v_mfma_f32_32x32x16_bf16 v[52:67], v[160:163], v[116:119], v[52:67]
    ds_read_b64_tr_b16 v[160:161], v222 offset:3680
    ds_read_b64_tr_b16 v[162:163], v222 offset:5472
    s_waitcnt lgkmcnt(12)
    v_mfma_f32_32x32x16_bf16 v[68:83], v[164:167], v[116:119], v[68:83]
    ds_read_b64_tr_b16 v[164:165], v222 offset:3712
    ds_read_b64_tr_b16 v[166:167], v222 offset:5504
    s_waitcnt lgkmcnt(12)
    v_mfma_f32_32x32x16_bf16 v[84:99], v[168:171], v[116:119], v[84:99]
    ds_read_b64_tr_b16 v[168:169], v222 offset:3744
    ds_read_b64_tr_b16 v[170:171], v222 offset:5536
    s_waitcnt lgkmcnt(12)
    v_mfma_f32_32x32x16_bf16 v[100:115], v[172:175], v[116:119], v[100:115]
    ds_read_b64_tr_b16 v[172:173], v222 offset:3776
    ds_read_b64_tr_b16 v[174:175], v222 offset:5568
    s_waitcnt lgkmcnt(12)
    v_mfma_f32_32x32x16_bf16 v[4:19], v[148:151], v[120:123], v[4:19]
    ds_read_b64_tr_b16 v[148:149], v222 offset:7168
    ds_read_b64_tr_b16 v[150:151], v222 offset:8960
    s_mov_b32 s24, 49152
    buffer_load_dwordx4 v[116:119], v220, s[8:11], s24 offen offset:0 sc1
    s_waitcnt lgkmcnt(12)
    v_mfma_f32_32x32x16_bf16 v[20:35], v[152:155], v[120:123], v[20:35]
    ds_read_b64_tr_b16 v[152:153], v222 offset:7200
    ds_read_b64_tr_b16 v[154:155], v222 offset:8992
    s_waitcnt lgkmcnt(12)
    v_mfma_f32_32x32x16_bf16 v[36:51], v[156:159], v[120:123], v[36:51]
    ds_read_b64_tr_b16 v[156:157], v222 offset:7232
    ds_read_b64_tr_b16 v[158:159], v222 offset:9024
    s_waitcnt lgkmcnt(12)
    v_mfma_f32_32x32x16_bf16 v[52:67], v[160:163], v[120:123], v[52:67]
    ds_read_b64_tr_b16 v[160:161], v222 offset:7264
    ds_read_b64_tr_b16 v[162:163], v222 offset:9056
    s_waitcnt lgkmcnt(12)
    v_mfma_f32_32x32x16_bf16 v[68:83], v[164:167], v[120:123], v[68:83]
    ds_read_b64_tr_b16 v[164:165], v222 offset:7296
    ds_read_b64_tr_b16 v[166:167], v222 offset:9088
    s_waitcnt lgkmcnt(12)
    v_mfma_f32_32x32x16_bf16 v[84:99], v[168:171], v[120:123], v[84:99]
    ds_read_b64_tr_b16 v[168:169], v222 offset:7328
    ds_read_b64_tr_b16 v[170:171], v222 offset:9120
    s_waitcnt lgkmcnt(12)
    v_mfma_f32_32x32x16_bf16 v[100:115], v[172:175], v[120:123], v[100:115]
    ds_read_b64_tr_b16 v[172:173], v222 offset:7360
    ds_read_b64_tr_b16 v[174:175], v222 offset:9152
    s_waitcnt lgkmcnt(12)
    v_mfma_f32_32x32x16_bf16 v[4:19], v[148:151], v[124:127], v[4:19]
    ds_read_b64_tr_b16 v[148:149], v222 offset:10752
    ds_read_b64_tr_b16 v[150:151], v222 offset:12544
    buffer_load_dwordx4 v[120:123], v220, s[8:11], s24 offen offset:1024 sc1
    s_waitcnt lgkmcnt(12)
    v_mfma_f32_32x32x16_bf16 v[20:35], v[152:155], v[124:127], v[20:35]
    ds_read_b64_tr_b16 v[152:153], v222 offset:10784
    ds_read_b64_tr_b16 v[154:155], v222 offset:12576
    s_waitcnt lgkmcnt(12)
    v_mfma_f32_32x32x16_bf16 v[36:51], v[156:159], v[124:127], v[36:51]
    ds_read_b64_tr_b16 v[156:157], v222 offset:10816
    ds_read_b64_tr_b16 v[158:159], v222 offset:12608
    s_waitcnt lgkmcnt(12)
    v_mfma_f32_32x32x16_bf16 v[52:67], v[160:163], v[124:127], v[52:67]
    ds_read_b64_tr_b16 v[160:161], v222 offset:10848
    ds_read_b64_tr_b16 v[162:163], v222 offset:12640
    s_waitcnt lgkmcnt(12)
    v_mfma_f32_32x32x16_bf16 v[68:83], v[164:167], v[124:127], v[68:83]
    ds_read_b64_tr_b16 v[164:165], v222 offset:10880
    ds_read_b64_tr_b16 v[166:167], v222 offset:12672
    s_waitcnt lgkmcnt(12)
    v_mfma_f32_32x32x16_bf16 v[84:99], v[168:171], v[124:127], v[84:99]
    ds_read_b64_tr_b16 v[168:169], v222 offset:10912
    ds_read_b64_tr_b16 v[170:171], v222 offset:12704
    s_waitcnt lgkmcnt(12)
    v_mfma_f32_32x32x16_bf16 v[100:115], v[172:175], v[124:127], v[100:115]
    ds_read_b64_tr_b16 v[172:173], v222 offset:10944
    ds_read_b64_tr_b16 v[174:175], v222 offset:12736
    s_waitcnt lgkmcnt(12)
    v_mfma_f32_32x32x16_bf16 v[4:19], v[148:151], v[128:131], v[4:19]
    buffer_load_dwordx4 v[124:127], v220, s[8:11], s24 offen offset:2048 sc1
    s_waitcnt lgkmcnt(10)
    v_mfma_f32_32x32x16_bf16 v[20:35], v[152:155], v[128:131], v[20:35]
    s_barrier
    v_add_u32 v222, 28800, v221
    ds_read_b64_tr_b16 v[148:149], v222 offset:0
    ds_read_b64_tr_b16 v[150:151], v222 offset:1792
    ds_read_b64_tr_b16 v[152:153], v222 offset:32
    ds_read_b64_tr_b16 v[154:155], v222 offset:1824
    s_mov_b32 s87, 6422528
    s_add_u32 m0, s86, 115200
    s_nop 0
    buffer_load_dwordx4 v248, s[92:95], s87 offen lds
    s_add_u32 m0, s86, 116224
    s_nop 0
    buffer_load_dwordx4 v249, s[92:95], s87 offen lds
    s_waitcnt lgkmcnt(12)
    v_mfma_f32_32x32x16_bf16 v[36:51], v[156:159], v[128:131], v[36:51]
    ds_read_b64_tr_b16 v[156:157], v222 offset:64
    ds_read_b64_tr_b16 v[158:159], v222 offset:1856
    s_add_u32 m0, s86, 117248
    s_nop 0
    buffer_load_dwordx4 v250, s[92:95], s87 offen lds
    s_add_u32 m0, s86, 118272
    s_mov_b32 exec_hi, 0
    buffer_load_dwordx4 v251, s[92:95], s87 offen lds
    s_mov_b32 exec_hi, -1
    s_waitcnt lgkmcnt(12)
    v_mfma_f32_32x32x16_bf16 v[52:67], v[160:163], v[128:131], v[52:67]
    ds_read_b64_tr_b16 v[160:161], v222 offset:96
    ds_read_b64_tr_b16 v[162:163], v222 offset:1888
    s_waitcnt lgkmcnt(12)
    v_mfma_f32_32x32x16_bf16 v[68:83], v[164:167], v[128:131], v[68:83]
    ds_read_b64_tr_b16 v[164:165], v222 offset:128
    ds_read_b64_tr_b16 v[166:167], v222 offset:1920
    s_waitcnt lgkmcnt(12)
    v_mfma_f32_32x32x16_bf16 v[84:99], v[168:171], v[128:131], v[84:99]
    ds_read_b64_tr_b16 v[168:169], v222 offset:160
    ds_read_b64_tr_b16 v[170:171], v222 offset:1952
    s_waitcnt lgkmcnt(12)
    v_mfma_f32_32x32x16_bf16 v[100:115], v[172:175], v[128:131], v[100:115]
    ds_read_b64_tr_b16 v[172:173], v222 offset:192
    ds_read_b64_tr_b16 v[174:175], v222 offset:1984
    s_waitcnt vmcnt(7)
    v_max3_u32 v233, v132, v133, v134
    v_max3_u32 v233, v233, v135, v136
    v_max3_u32 v233, v233, v137, v138
    v_max3_u32 v233, v233, v139, v140
    v_max3_u32 v233, v233, v141, v142
    v_max3_u32 v233, v233, v143, v144
    v_max3_u32 v233, v233, v145, v146
    v_max_u32 v233, v233, v147
    v_cmp_eq_u32 vcc, -1, v233
    s_cbranch_vccnz k4_slow_11
    k4_back_11:
    s_waitcnt lgkmcnt(12)
    v_mfma_f32_32x32x16_bf16 v[4:19], v[148:151], v[132:135], v[4:19]
    ds_read_b64_tr_b16 v[148:149], v222 offset:3584
    ds_read_b64_tr_b16 v[150:151], v222 offset:5376
    buffer_load_dwordx4 v[128:131], v220, s[8:11], s24 offen offset:3072 sc1
    s_waitcnt lgkmcnt(12)
    v_mfma_f32_32x32x16_bf16 v[20:35], v[152:155], v[132:135], v[20:35]
    ds_read_b64_tr_b16 v[152:153], v222 offset:3616
    ds_read_b64_tr_b16 v[154:155], v222 offset:5408
    s_waitcnt lgkmcnt(12)
    v_mfma_f32_32x32x16_bf16 v[36:51], v[156:159], v[132:135], v[36:51]
    ds_read_b64_tr_b16 v[156:157], v222 offset:3648
    ds_read_b64_tr_b16 v[158:159], v222 offset:5440
    s_waitcnt lgkmcnt(12)
    v_mfma_f32_32x32x16_bf16 v[52:67], v[160:163], v[132:135], v[52:67]
    ds_read_b64_tr_b16 v[160:161], v222 offset:3680
    ds_read_b64_tr_b16 v[162:163], v222 offset:5472
    s_waitcnt lgkmcnt(12)
    v_mfma_f32_32x32x16_bf16 v[68:83], v[164:167], v[132:135], v[68:83]
    ds_read_b64_tr_b16 v[164:165], v222 offset:3712
    ds_read_b64_tr_b16 v[166:167], v222 offset:5504
    s_waitcnt lgkmcnt(12)
    v_mfma_f32_32x32x16_bf16 v[84:99], v[168:171], v[132:135], v[84:99]
    ds_read_b64_tr_b16 v[168:169], v222 offset:3744
    ds_read_b64_tr_b16 v[170:171], v222 offset:5536
    s_waitcnt lgkmcnt(12)
    v_mfma_f32_32x32x16_bf16 v[100:115], v[172:175], v[132:135], v[100:115]
    ds_read_b64_tr_b16 v[172:173], v222 offset:3776
    ds_read_b64_tr_b16 v[174:175], v222 offset:5568
    s_waitcnt lgkmcnt(12)
    v_mfma_f32_32x32x16_bf16 v[4:19], v[148:151], v[136:139], v[4:19]
    ds_read_b64_tr_b16 v[148:149], v222 offset:7168
    ds_read_b64_tr_b16 v[150:151], v222 offset:8960
    s_mov_b32 s24, 53248
    buffer_load_dwordx4 v[132:135], v220, s[8:11], s24 offen offset:0 sc1
    s_waitcnt lgkmcnt(12)
    v_mfma_f32_32x32x16_bf16 v[20:35], v[152:155], v[136:139], v[20:35]
    ds_read_b64_tr_b16 v[152:153], v222 offset:7200
    ds_read_b64_tr_b16 v[154:155], v222 offset:8992
    s_waitcnt lgkmcnt(12)
    v_mfma_f32_32x32x16_bf16 v[36:51], v[156:159], v[136:139], v[36:51]
    ds_read_b64_tr_b16 v[156:157], v222 offset:7232
    ds_read_b64_tr_b16 v[158:159], v222 offset:9024
    s_waitcnt lgkmcnt(12)
    v_mfma_f32_32x32x16_bf16 v[52:67], v[160:163], v[136:139], v[52:67]
    ds_read_b64_tr_b16 v[160:161], v222 offset:7264
    ds_read_b64_tr_b16 v[162:163], v222 offset:9056
    s_waitcnt lgkmcnt(12)
    v_mfma_f32_32x32x16_bf16 v[68:83], v[164:167], v[136:139], v[68:83]
    ds_read_b64_tr_b16 v[164:165], v222 offset:7296
    ds_read_b64_tr_b16 v[166:167], v222 offset:9088
    s_waitcnt lgkmcnt(12)
    v_mfma_f32_32x32x16_bf16 v[84:99], v[168:171], v[136:139], v[84:99]
    ds_read_b64_tr_b16 v[168:169], v222 offset:7328
    ds_read_b64_tr_b16 v[170:171], v222 offset:9120
    s_waitcnt lgkmcnt(12)
    v_mfma_f32_32x32x16_bf16 v[100:115], v[172:175], v[136:139], v[100:115]
    ds_read_b64_tr_b16 v[172:173], v222 offset:7360
    ds_read_b64_tr_b16 v[174:175], v222 offset:9152
    s_waitcnt lgkmcnt(12)
    v_mfma_f32_32x32x16_bf16 v[4:19], v[148:151], v[140:143], v[4:19]
    ds_read_b64_tr_b16 v[148:149], v222 offset:10752
    ds_read_b64_tr_b16 v[150:151], v222 offset:12544
    buffer_load_dwordx4 v[136:139], v220, s[8:11], s24 offen offset:1024 sc1
    s_waitcnt lgkmcnt(12)
    v_mfma_f32_32x32x16_bf16 v[20:35], v[152:155], v[140:143], v[20:35]
    ds_read_b64_tr_b16 v[152:153], v222 offset:10784
    ds_read_b64_tr_b16 v[154:155], v222 offset:12576
    s_waitcnt lgkmcnt(12)
    v_mfma_f32_32x32x16_bf16 v[36:51], v[156:159], v[140:143], v[36:51]
    ds_read_b64_tr_b16 v[156:157], v222 offset:10816
    ds_read_b64_tr_b16 v[158:159], v222 offset:12608
    s_waitcnt lgkmcnt(12)
    v_mfma_f32_32x32x16_bf16 v[52:67], v[160:163], v[140:143], v[52:67]
    ds_read_b64_tr_b16 v[160:161], v222 offset:10848
    ds_read_b64_tr_b16 v[162:163], v222 offset:12640
    s_waitcnt lgkmcnt(12)
    v_mfma_f32_32x32x16_bf16 v[68:83], v[164:167], v[140:143], v[68:83]
    ds_read_b64_tr_b16 v[164:165], v222 offset:10880
    ds_read_b64_tr_b16 v[166:167], v222 offset:12672
    s_waitcnt lgkmcnt(12)
    v_mfma_f32_32x32x16_bf16 v[84:99], v[168:171], v[140:143], v[84:99]
    ds_read_b64_tr_b16 v[168:169], v222 offset:10912
    ds_read_b64_tr_b16 v[170:171], v222 offset:12704
    s_waitcnt lgkmcnt(12)
    v_mfma_f32_32x32x16_bf16 v[100:115], v[172:175], v[140:143], v[100:115]
    ds_read_b64_tr_b16 v[172:173], v222 offset:10944
    ds_read_b64_tr_b16 v[174:175], v222 offset:12736
    s_waitcnt lgkmcnt(12)
    v_mfma_f32_32x32x16_bf16 v[4:19], v[148:151], v[144:147], v[4:19]
    buffer_load_dwordx4 v[140:143], v220, s[8:11], s24 offen offset:2048 sc1
    s_waitcnt lgkmcnt(10)
    v_mfma_f32_32x32x16_bf16 v[20:35], v[152:155], v[144:147], v[20:35]
    s_barrier
    v_add_u32 v222, 57600, v221
    ds_read_b64_tr_b16 v[148:149], v222 offset:0
    ds_read_b64_tr_b16 v[150:151], v222 offset:1792
    ds_read_b64_tr_b16 v[152:153], v222 offset:32
    ds_read_b64_tr_b16 v[154:155], v222 offset:1824
    s_mov_b32 s87, 6881280
    s_add_u32 m0, s86, 0
    s_nop 0
    buffer_load_dwordx4 v248, s[92:95], s87 offen lds
    s_add_u32 m0, s86, 1024
    s_nop 0
    buffer_load_dwordx4 v249, s[92:95], s87 offen lds
    s_waitcnt lgkmcnt(12)
    v_mfma_f32_32x32x16_bf16 v[36:51], v[156:159], v[144:147], v[36:51]
    ds_read_b64_tr_b16 v[156:157], v222 offset:64
    ds_read_b64_tr_b16 v[158:159], v222 offset:1856
    s_add_u32 m0, s86, 2048
    s_nop 0
    buffer_load_dwordx4 v250, s[92:95], s87 offen lds
    s_add_u32 m0, s86, 3072
    s_mov_b32 exec_hi, 0
    buffer_load_dwordx4 v251, s[92:95], s87 offen lds
    s_mov_b32 exec_hi, -1
    s_waitcnt lgkmcnt(12)
    v_mfma_f32_32x32x16_bf16 v[52:67], v[160:163], v[144:147], v[52:67]
    ds_read_b64_tr_b16 v[160:161], v222 offset:96
    ds_read_b64_tr_b16 v[162:163], v222 offset:1888
    s_waitcnt lgkmcnt(12)
    v_mfma_f32_32x32x16_bf16 v[68:83], v[164:167], v[144:147], v[68:83]
    ds_read_b64_tr_b16 v[164:165], v222 offset:128
    ds_read_b64_tr_b16 v[166:167], v222 offset:1920
    s_waitcnt lgkmcnt(12)
    v_mfma_f32_32x32x16_bf16 v[84:99], v[168:171], v[144:147], v[84:99]
    ds_read_b64_tr_b16 v[168:169], v222 offset:160
    ds_read_b64_tr_b16 v[170:171], v222 offset:1952
    s_waitcnt lgkmcnt(12)
    v_mfma_f32_32x32x16_bf16 v[100:115], v[172:175], v[144:147], v[100:115]
    ds_read_b64_tr_b16 v[172:173], v222 offset:192
    ds_read_b64_tr_b16 v[174:175], v222 offset:1984
    s_waitcnt vmcnt(7)
    v_max3_u32 v233, v116, v117, v118
    v_max3_u32 v233, v233, v119, v120
    v_max3_u32 v233, v233, v121, v122
    v_max3_u32 v233, v233, v123, v124
    v_max3_u32 v233, v233, v125, v126
    v_max3_u32 v233, v233, v127, v128
    v_max3_u32 v233, v233, v129, v130
    v_max_u32 v233, v233, v131
    v_cmp_eq_u32 vcc, -1, v233
    s_cbranch_vccnz k4_slow_12
    k4_back_12:
    s_waitcnt lgkmcnt(12)
    v_mfma_f32_32x32x16_bf16 v[4:19], v[148:151], v[116:119], v[4:19]
    ds_read_b64_tr_b16 v[148:149], v222 offset:3584
    ds_read_b64_tr_b16 v[150:151], v222 offset:5376
    buffer_load_dwordx4 v[144:147], v220, s[8:11], s24 offen offset:3072 sc1
    s_waitcnt lgkmcnt(12)
    v_mfma_f32_32x32x16_bf16 v[20:35], v[152:155], v[116:119], v[20:35]
    ds_read_b64_tr_b16 v[152:153], v222 offset:3616
    ds_read_b64_tr_b16 v[154:155], v222 offset:5408
    s_waitcnt lgkmcnt(12)
    v_mfma_f32_32x32x16_bf16 v[36:51], v[156:159], v[116:119], v[36:51]
    ds_read_b64_tr_b16 v[156:157], v222 offset:3648
    ds_read_b64_tr_b16 v[158:159], v222 offset:5440
    s_waitcnt lgkmcnt(12)
    v_mfma_f32_32x32x16_bf16 v[52:67], v[160:163], v[116:119], v[52:67]
    ds_read_b64_tr_b16 v[160:161], v222 offset:3680
    ds_read_b64_tr_b16 v[162:163], v222 offset:5472
    s_waitcnt lgkmcnt(12)
    v_mfma_f32_32x32x16_bf16 v[68:83], v[164:167], v[116:119], v[68:83]
    ds_read_b64_tr_b16 v[164:165], v222 offset:3712
    ds_read_b64_tr_b16 v[166:167], v222 offset:5504
    s_waitcnt lgkmcnt(12)
    v_mfma_f32_32x32x16_bf16 v[84:99], v[168:171], v[116:119], v[84:99]
    ds_read_b64_tr_b16 v[168:169], v222 offset:3744
    ds_read_b64_tr_b16 v[170:171], v222 offset:5536
    s_waitcnt lgkmcnt(12)
    v_mfma_f32_32x32x16_bf16 v[100:115], v[172:175], v[116:119], v[100:115]
    ds_read_b64_tr_b16 v[172:173], v222 offset:3776
    ds_read_b64_tr_b16 v[174:175], v222 offset:5568
    s_waitcnt lgkmcnt(12)
    v_mfma_f32_32x32x16_bf16 v[4:19], v[148:151], v[120:123], v[4:19]
    ds_read_b64_tr_b16 v[148:149], v222 offset:7168
    ds_read_b64_tr_b16 v[150:151], v222 offset:8960
    s_mov_b32 s24, 57344
    buffer_load_dwordx4 v[116:119], v220, s[8:11], s24 offen offset:0 sc1
    s_waitcnt lgkmcnt(12)
    v_mfma_f32_32x32x16_bf16 v[20:35], v[152:155], v[120:123], v[20:35]
    ds_read_b64_tr_b16 v[152:153], v222 offset:7200
    ds_read_b64_tr_b16 v[154:155], v222 offset:8992
    s_waitcnt lgkmcnt(12)
    v_mfma_f32_32x32x16_bf16 v[36:51], v[156:159], v[120:123], v[36:51]
    ds_read_b64_tr_b16 v[156:157], v222 offset:7232
    ds_read_b64_tr_b16 v[158:159], v222 offset:9024
    s_waitcnt lgkmcnt(12)
    v_mfma_f32_32x32x16_bf16 v[52:67], v[160:163], v[120:123], v[52:67]
    ds_read_b64_tr_b16 v[160:161], v222 offset:7264
    ds_read_b64_tr_b16 v[162:163], v222 offset:9056
    s_waitcnt lgkmcnt(12)
    v_mfma_f32_32x32x16_bf16 v[68:83], v[164:167], v[120:123], v[68:83]
    ds_read_b64_tr_b16 v[164:165], v222 offset:7296
    ds_read_b64_tr_b16 v[166:167], v222 offset:9088
    s_waitcnt lgkmcnt(12)
    v_mfma_f32_32x32x16_bf16 v[84:99], v[168:171], v[120:123], v[84:99]
    ds_read_b64_tr_b16 v[168:169], v222 offset:7328
    ds_read_b64_tr_b16 v[170:171], v222 offset:9120
    s_waitcnt lgkmcnt(12)
    v_mfma_f32_32x32x16_bf16 v[100:115], v[172:175], v[120:123], v[100:115]
    ds_read_b64_tr_b16 v[172:173], v222 offset:7360
    ds_read_b64_tr_b16 v[174:175], v222 offset:9152
    s_waitcnt lgkmcnt(12)
    v_mfma_f32_32x32x16_bf16 v[4:19], v[148:151], v[124:127], v[4:19]
    ds_read_b64_tr_b16 v[148:149], v222 offset:10752
    ds_read_b64_tr_b16 v[150:151], v222 offset:12544
    buffer_load_dwordx4 v[120:123], v220, s[8:11], s24 offen offset:1024 sc1
    s_waitcnt lgkmcnt(12)
    v_mfma_f32_32x32x16_bf16 v[20:35], v[152:155], v[124:127], v[20:35]
    ds_read_b64_tr_b16 v[152:153], v222 offset:10784
    ds_read_b64_tr_b16 v[154:155], v222 offset:12576
    s_waitcnt lgkmcnt(12)
    v_mfma_f32_32x32x16_bf16 v[36:51], v[156:159], v[124:127], v[36:51]
    ds_read_b64_tr_b16 v[156:157], v222 offset:10816
    ds_read_b64_tr_b16 v[158:159], v222 offset:12608
    s_waitcnt lgkmcnt(12)
    v_mfma_f32_32x32x16_bf16 v[52:67], v[160:163], v[124:127], v[52:67]
    ds_read_b64_tr_b16 v[160:161], v222 offset:10848
    ds_read_b64_tr_b16 v[162:163], v222 offset:12640
    s_waitcnt lgkmcnt(12)
    v_mfma_f32_32x32x16_bf16 v[68:83], v[164:167], v[124:127], v[68:83]
    ds_read_b64_tr_b16 v[164:165], v222 offset:10880
    ds_read_b64_tr_b16 v[166:167], v222 offset:12672
    s_waitcnt lgkmcnt(12)
    v_mfma_f32_32x32x16_bf16 v[84:99], v[168:171], v[124:127], v[84:99]
    ds_read_b64_tr_b16 v[168:169], v222 offset:10912
    ds_read_b64_tr_b16 v[170:171], v222 offset:12704
    s_waitcnt lgkmcnt(12)
    v_mfma_f32_32x32x16_bf16 v[100:115], v[172:175], v[124:127], v[100:115]
    ds_read_b64_tr_b16 v[172:173], v222 offset:10944
    ds_read_b64_tr_b16 v[174:175], v222 offset:12736
    s_waitcnt lgkmcnt(12)
    v_mfma_f32_32x32x16_bf16 v[4:19], v[148:151], v[128:131], v[4:19]
    buffer_load_dwordx4 v[124:127], v220, s[8:11], s24 offen offset:2048 sc1
    s_waitcnt lgkmcnt(10)
    v_mfma_f32_32x32x16_bf16 v[20:35], v[152:155], v[128:131], v[20:35]
    s_waitcnt vmcnt(4)
    s_barrier
    s_cmp_ge_u32 s3, 4
    s_cbranch_scc1 k4_noprio
    s_setprio 3
    k4_noprio:
    v_add_u32 v222, 86400, v221
    ds_read_b64_tr_b16 v[148:149], v222 offset:0
    ds_read_b64_tr_b16 v[150:151], v222 offset:1792
    ds_read_b64_tr_b16 v[152:153], v222 offset:32
    ds_read_b64_tr_b16 v[154:155], v222 offset:1824
    s_waitcnt lgkmcnt(12)
    v_mfma_f32_32x32x16_bf16 v[36:51], v[156:159], v[128:131], v[36:51]
    ds_read_b64_tr_b16 v[156:157], v222 offset:64
    ds_read_b64_tr_b16 v[158:159], v222 offset:1856
    s_waitcnt lgkmcnt(12)
    v_mfma_f32_32x32x16_bf16 v[52:67], v[160:163], v[128:131], v[52:67]
    ds_read_b64_tr_b16 v[160:161], v222 offset:96
    ds_read_b64_tr_b16 v[162:163], v222 offset:1888
    s_waitcnt lgkmcnt(12)
    v_mfma_f32_32x32x16_bf16 v[68:83], v[164:167], v[128:131], v[68:83]
    ds_read_b64_tr_b16 v[164:165], v222 offset:128
    ds_read_b64_tr_b16 v[166:167], v222 offset:1920
    s_waitcnt lgkmcnt(12)
    v_mfma_f32_32x32x16_bf16 v[84:99], v[168:171], v[128:131], v[84:99]
    ds_read_b64_tr_b16 v[168:169], v222 offset:160
    ds_read_b64_tr_b16 v[170:171], v222 offset:1952
    s_waitcnt lgkmcnt(12)
    v_mfma_f32_32x32x16_bf16 v[100:115], v[172:175], v[128:131], v[100:115]
    ds_read_b64_tr_b16 v[172:173], v222 offset:192
    ds_read_b64_tr_b16 v[174:175], v222 offset:1984
    s_waitcnt vmcnt(3)
    v_max3_u32 v233, v132, v133, v134
    v_max3_u32 v233, v233, v135, v136
    v_max3_u32 v233, v233, v137, v138
    v_max3_u32 v233, v233, v139, v140
    v_max3_u32 v233, v233, v141, v142
    v_max3_u32 v233, v233, v143, v144
    v_max3_u32 v233, v233, v145, v146
    v_max_u32 v233, v233, v147
    v_cmp_eq_u32 vcc, -1, v233
    s_cbranch_vccnz k4_slow_13
    k4_back_13:
    s_waitcnt lgkmcnt(12)
    v_mfma_f32_32x32x16_bf16 v[4:19], v[148:151], v[132:135], v[4:19]
    ds_read_b64_tr_b16 v[148:149], v222 offset:3584
    ds_read_b64_tr_b16 v[150:151], v222 offset:5376
    buffer_load_dwordx4 v[128:131], v220, s[8:11], s24 offen offset:3072 sc1
    s_waitcnt lgkmcnt(12)
    v_mfma_f32_32x32x16_bf16 v[20:35], v[152:155], v[132:135], v[20:35]
    ds_read_b64_tr_b16 v[152:153], v222 offset:3616
    ds_read_b64_tr_b16 v[154:155], v222 offset:5408
    s_waitcnt lgkmcnt(12)
    v_mfma_f32_32x32x16_bf16 v[36:51], v[156:159], v[132:135], v[36:51]
    ds_read_b64_tr_b16 v[156:157], v222 offset:3648
    ds_read_b64_tr_b16 v[158:159], v222 offset:5440
    s_waitcnt lgkmcnt(12)
    v_mfma_f32_32x32x16_bf16 v[52:67], v[160:163], v[132:135], v[52:67]
    ds_read_b64_tr_b16 v[160:161], v222 offset:3680
    ds_read_b64_tr_b16 v[162:163], v222 offset:5472
    s_waitcnt lgkmcnt(12)
    v_mfma_f32_32x32x16_bf16 v[68:83], v[164:167], v[132:135], v[68:83]
    ds_read_b64_tr_b16 v[164:165], v222 offset:3712
    ds_read_b64_tr_b16 v[166:167], v222 offset:5504
    s_waitcnt lgkmcnt(12)
    v_mfma_f32_32x32x16_bf16 v[84:99], v[168:171], v[132:135], v[84:99]
    ds_read_b64_tr_b16 v[168:169], v222 offset:3744
    ds_read_b64_tr_b16 v[170:171], v222 offset:5536
    s_waitcnt lgkmcnt(12)
    v_mfma_f32_32x32x16_bf16 v[100:115], v[172:175], v[132:135], v[100:115]
    ds_read_b64_tr_b16 v[172:173], v222 offset:3776
    ds_read_b64_tr_b16 v[174:175], v222 offset:5568
    s_waitcnt lgkmcnt(12)
    v_mfma_f32_32x32x16_bf16 v[4:19], v[148:151], v[136:139], v[4:19]
    ds_read_b64_tr_b16 v[148:149], v222 offset:7168
    ds_read_b64_tr_b16 v[150:151], v222 offset:8960
    s_mov_b32 s24, 61440
    buffer_load_dwordx4 v[132:135], v220, s[8:11], s24 offen offset:0 sc1
    s_waitcnt lgkmcnt(12)
    v_mfma_f32_32x32x16_bf16 v[20:35], v[152:155], v[136:139], v[20:35]
    ds_read_b64_tr_b16 v[152:153], v222 offset:7200
    ds_read_b64_tr_b16 v[154:155], v222 offset:8992
    s_waitcnt lgkmcnt(12)
    v_mfma_f32_32x32x16_bf16 v[36:51], v[156:159], v[136:139], v[36:51]
    ds_read_b64_tr_b16 v[156:157], v222 offset:7232
    ds_read_b64_tr_b16 v[158:159], v222 offset:9024
    s_waitcnt lgkmcnt(12)
    v_mfma_f32_32x32x16_bf16 v[52:67], v[160:163], v[136:139], v[52:67]
    ds_read_b64_tr_b16 v[160:161], v222 offset:7264
    ds_read_b64_tr_b16 v[162:163], v222 offset:9056
    s_waitcnt lgkmcnt(12)
    v_mfma_f32_32x32x16_bf16 v[68:83], v[164:167], v[136:139], v[68:83]
    ds_read_b64_tr_b16 v[164:165], v222 offset:7296
    ds_read_b64_tr_b16 v[166:167], v222 offset:9088
    s_waitcnt lgkmcnt(12)
    v_mfma_f32_32x32x16_bf16 v[84:99], v[168:171], v[136:139], v[84:99]
    ds_read_b64_tr_b16 v[168:169], v222 offset:7328
    ds_read_b64_tr_b16 v[170:171], v222 offset:9120
    s_waitcnt lgkmcnt(12)
    v_mfma_f32_32x32x16_bf16 v[100:115], v[172:175], v[136:139], v[100:115]
    ds_read_b64_tr_b16 v[172:173], v222 offset:7360
    ds_read_b64_tr_b16 v[174:175], v222 offset:9152
    s_waitcnt lgkmcnt(12)
    v_mfma_f32_32x32x16_bf16 v[4:19], v[148:151], v[140:143], v[4:19]
    ds_read_b64_tr_b16 v[148:149], v222 offset:10752
    ds_read_b64_tr_b16 v[150:151], v222 offset:12544
    buffer_load_dwordx4 v[136:139], v220, s[8:11], s24 offen offset:1024 sc1
    s_waitcnt lgkmcnt(12)
    v_mfma_f32_32x32x16_bf16 v[20:35], v[152:155], v[140:143], v[20:35]
    ds_read_b64_tr_b16 v[152:153], v222 offset:10784
    ds_read_b64_tr_b16 v[154:155], v222 offset:12576
    s_waitcnt lgkmcnt(12)
    v_mfma_f32_32x32x16_bf16 v[36:51], v[156:159], v[140:143], v[36:51]
    ds_read_b64_tr_b16 v[156:157], v222 offset:10816
    ds_read_b64_tr_b16 v[158:159], v222 offset:12608
    s_waitcnt lgkmcnt(12)
    v_mfma_f32_32x32x16_bf16 v[52:67], v[160:163], v[140:143], v[52:67]
    ds_read_b64_tr_b16 v[160:161], v222 offset:10848
    ds_read_b64_tr_b16 v[162:163], v222 offset:12640
    s_waitcnt lgkmcnt(12)
    v_mfma_f32_32x32x16_bf16 v[68:83], v[164:167], v[140:143], v[68:83]
    ds_read_b64_tr_b16 v[164:165], v222 offset:10880
    ds_read_b64_tr_b16 v[166:167], v222 offset:12672
    s_waitcnt lgkmcnt(12)
    v_mfma_f32_32x32x16_bf16 v[84:99], v[168:171], v[140:143], v[84:99]
    ds_read_b64_tr_b16 v[168:169], v222 offset:10912
    ds_read_b64_tr_b16 v[170:171], v222 offset:12704
    s_waitcnt lgkmcnt(12)
    v_mfma_f32_32x32x16_bf16 v[100:115], v[172:175], v[140:143], v[100:115]
    ds_read_b64_tr_b16 v[172:173], v222 offset:10944
    ds_read_b64_tr_b16 v[174:175], v222 offset:12736
    s_waitcnt lgkmcnt(12)
    v_mfma_f32_32x32x16_bf16 v[4:19], v[148:151], v[144:147], v[4:19]
    buffer_load_dwordx4 v[140:143], v220, s[8:11], s24 offen offset:2048 sc1
    s_waitcnt lgkmcnt(10)
    v_mfma_f32_32x32x16_bf16 v[20:35], v[152:155], v[144:147], v[20:35]
    v_add_u32 v222, 115200, v221
    ds_read_b64_tr_b16 v[148:149], v222 offset:0
    ds_read_b64_tr_b16 v[150:151], v222 offset:1792
    ds_read_b64_tr_b16 v[152:153], v222 offset:32
    ds_read_b64_tr_b16 v[154:155], v222 offset:1824
    s_waitcnt lgkmcnt(12)
    v_mfma_f32_32x32x16_bf16 v[36:51], v[156:159], v[144:147], v[36:51]
    ds_read_b64_tr_b16 v[156:157], v222 offset:64
    ds_read_b64_tr_b16 v[158:159], v222 offset:1856
    s_waitcnt lgkmcnt(12)
    v_mfma_f32_32x32x16_bf16 v[52:67], v[160:163], v[144:147], v[52:67]
    ds_read_b64_tr_b16 v[160:161], v222 offset:96
    ds_read_b64_tr_b16 v[162:163], v222 offset:1888
    s_waitcnt lgkmcnt(12)
    v_mfma_f32_32x32x16_bf16 v[68:83], v[164:167], v[144:147], v[68:83]
    ds_read_b64_tr_b16 v[164:165], v222 offset:128
    ds_read_b64_tr_b16 v[166:167], v222 offset:1920
    s_waitcnt lgkmcnt(12)
    v_mfma_f32_32x32x16_bf16 v[84:99], v[168:171], v[144:147], v[84:99]
    ds_read_b64_tr_b16 v[168:169], v222 offset:160
    ds_read_b64_tr_b16 v[170:171], v222 offset:1952
    s_waitcnt lgkmcnt(12)
    v_mfma_f32_32x32x16_bf16 v[100:115], v[172:175], v[144:147], v[100:115]
    ds_read_b64_tr_b16 v[172:173], v222 offset:192
    ds_read_b64_tr_b16 v[174:175], v222 offset:1984
    s_waitcnt vmcnt(3)
    v_max3_u32 v233, v116, v117, v118
    v_max3_u32 v233, v233, v119, v120
    v_max3_u32 v233, v233, v121, v122
    v_max3_u32 v233, v233, v123, v124
    v_max3_u32 v233, v233, v125, v126
    v_max3_u32 v233, v233, v127, v128
    v_max3_u32 v233, v233, v129, v130
    v_max_u32 v233, v233, v131
    v_cmp_eq_u32 vcc, -1, v233
    s_cbranch_vccnz k4_slow_14
    k4_back_14:
    s_waitcnt lgkmcnt(12)
    v_mfma_f32_32x32x16_bf16 v[4:19], v[148:151], v[116:119], v[4:19]
    ds_read_b64_tr_b16 v[148:149], v222 offset:3584
    ds_read_b64_tr_b16 v[150:151], v222 offset:5376
    buffer_load_dwordx4 v[144:147], v220, s[8:11], s24 offen offset:3072 sc1
    s_waitcnt lgkmcnt(12)
    v_mfma_f32_32x32x16_bf16 v[20:35], v[152:155], v[116:119], v[20:35]
    ds_read_b64_tr_b16 v[152:153], v222 offset:3616
    ds_read_b64_tr_b16 v[154:155], v222 offset:5408
    s_waitcnt lgkmcnt(12)
    v_mfma_f32_32x32x16_bf16 v[36:51], v[156:159], v[116:119], v[36:51]
    ds_read_b64_tr_b16 v[156:157], v222 offset:3648
    ds_read_b64_tr_b16 v[158:159], v222 offset:5440
    s_waitcnt lgkmcnt(12)
    v_mfma_f32_32x32x16_bf16 v[52:67], v[160:163], v[116:119], v[52:67]
    ds_read_b64_tr_b16 v[160:161], v222 offset:3680
    ds_read_b64_tr_b16 v[162:163], v222 offset:5472
    s_waitcnt lgkmcnt(12)
    v_mfma_f32_32x32x16_bf16 v[68:83], v[164:167], v[116:119], v[68:83]
    ds_read_b64_tr_b16 v[164:165], v222 offset:3712
    ds_read_b64_tr_b16 v[166:167], v222 offset:5504
    s_waitcnt lgkmcnt(12)
    v_mfma_f32_32x32x16_bf16 v[84:99], v[168:171], v[116:119], v[84:99]
    ds_read_b64_tr_b16 v[168:169], v222 offset:3744
    ds_read_b64_tr_b16 v[170:171], v222 offset:5536
    s_waitcnt lgkmcnt(12)
    v_mfma_f32_32x32x16_bf16 v[100:115], v[172:175], v[116:119], v[100:115]
    ds_read_b64_tr_b16 v[172:173], v222 offset:3776
    ds_read_b64_tr_b16 v[174:175], v222 offset:5568
    s_waitcnt lgkmcnt(12)
    v_mfma_f32_32x32x16_bf16 v[4:19], v[148:151], v[120:123], v[4:19]
    ds_read_b64_tr_b16 v[148:149], v222 offset:7168
    ds_read_b64_tr_b16 v[150:151], v222 offset:8960
    s_waitcnt lgkmcnt(12)
    v_mfma_f32_32x32x16_bf16 v[20:35], v[152:155], v[120:123], v[20:35]
    ds_read_b64_tr_b16 v[152:153], v222 offset:7200
    ds_read_b64_tr_b16 v[154:155], v222 offset:8992
    s_waitcnt lgkmcnt(12)
    v_mfma_f32_32x32x16_bf16 v[36:51], v[156:159], v[120:123], v[36:51]
    ds_read_b64_tr_b16 v[156:157], v222 offset:7232
    ds_read_b64_tr_b16 v[158:159], v222 offset:9024
    s_waitcnt lgkmcnt(12)
    v_mfma_f32_32x32x16_bf16 v[52:67], v[160:163], v[120:123], v[52:67]
    ds_read_b64_tr_b16 v[160:161], v222 offset:7264
    ds_read_b64_tr_b16 v[162:163], v222 offset:9056
    s_waitcnt lgkmcnt(12)
    v_mfma_f32_32x32x16_bf16 v[68:83], v[164:167], v[120:123], v[68:83]
    ds_read_b64_tr_b16 v[164:165], v222 offset:7296
    ds_read_b64_tr_b16 v[166:167], v222 offset:9088
    s_waitcnt lgkmcnt(12)
    v_mfma_f32_32x32x16_bf16 v[84:99], v[168:171], v[120:123], v[84:99]
    ds_read_b64_tr_b16 v[168:169], v222 offset:7328
    ds_read_b64_tr_b16 v[170:171], v222 offset:9120
    s_waitcnt lgkmcnt(12)
    v_mfma_f32_32x32x16_bf16 v[100:115], v[172:175], v[120:123], v[100:115]
    ds_read_b64_tr_b16 v[172:173], v222 offset:7360
    ds_read_b64_tr_b16 v[174:175], v222 offset:9152
    s_waitcnt lgkmcnt(12)
    v_mfma_f32_32x32x16_bf16 v[4:19], v[148:151], v[124:127], v[4:19]
    ds_read_b64_tr_b16 v[148:149], v222 offset:10752
    ds_read_b64_tr_b16 v[150:151], v222 offset:12544
    s_waitcnt lgkmcnt(12)
    v_mfma_f32_32x32x16_bf16 v[20:35], v[152:155], v[124:127], v[20:35]
    ds_read_b64_tr_b16 v[152:153], v222 offset:10784
    ds_read_b64_tr_b16 v[154:155], v222 offset:12576
    s_waitcnt lgkmcnt(12)
    v_mfma_f32_32x32x16_bf16 v[36:51], v[156:159], v[124:127], v[36:51]
    ds_read_b64_tr_b16 v[156:157], v222 offset:10816
    ds_read_b64_tr_b16 v[158:159], v222 offset:12608
    s_waitcnt lgkmcnt(12)
    v_mfma_f32_32x32x16_bf16 v[52:67], v[160:163], v[124:127], v[52:67]
    ds_read_b64_tr_b16 v[160:161], v222 offset:10848
    ds_read_b64_tr_b16 v[162:163], v222 offset:12640
    s_waitcnt lgkmcnt(12)
    v_mfma_f32_32x32x16_bf16 v[68:83], v[164:167], v[124:127], v[68:83]
    ds_read_b64_tr_b16 v[164:165], v222 offset:10880
    ds_read_b64_tr_b16 v[166:167], v222 offset:12672
    s_waitcnt lgkmcnt(12)
    v_mfma_f32_32x32x16_bf16 v[84:99], v[168:171], v[124:127], v[84:99]
    ds_read_b64_tr_b16 v[168:169], v222 offset:10912
    ds_read_b64_tr_b16 v[170:171], v222 offset:12704
    s_waitcnt lgkmcnt(12)
    v_mfma_f32_32x32x16_bf16 v[100:115], v[172:175], v[124:127], v[100:115]
    ds_read_b64_tr_b16 v[172:173], v222 offset:10944
    ds_read_b64_tr_b16 v[174:175], v222 offset:12736
    s_waitcnt lgkmcnt(12)
    v_mfma_f32_32x32x16_bf16 v[4:19], v[148:151], v[128:131], v[4:19]
    s_waitcnt lgkmcnt(10)
    v_mfma_f32_32x32x16_bf16 v[20:35], v[152:155], v[128:131], v[20:35]
    v_add_u32 v222, 0, v221
    ds_read_b64_tr_b16 v[148:149], v222 offset:0
    ds_read_b64_tr_b16 v[150:151], v222 offset:1792
    ds_read_b64_tr_b16 v[152:153], v222 offset:32
    ds_read_b64_tr_b16 v[154:155], v222 offset:1824
    s_waitcnt lgkmcnt(12)
    v_mfma_f32_32x32x16_bf16 v[36:51], v[156:159], v[128:131], v[36:51]
    ds_read_b64_tr_b16 v[156:157], v222 offset:64
    ds_read_b64_tr_b16 v[158:159], v222 offset:1856
    s_waitcnt lgkmcnt(12)
    v_mfma_f32_32x32x16_bf16 v[52:67], v[160:163], v[128:131], v[52:67]
    ds_read_b64_tr_b16 v[160:161], v222 offset:96
    ds_read_b64_tr_b16 v[162:163], v222 offset:1888
    s_waitcnt lgkmcnt(12)
    v_mfma_f32_32x32x16_bf16 v[68:83], v[164:167], v[128:131], v[68:83]
    ds_read_b64_tr_b16 v[164:165], v222 offset:128
    ds_read_b64_tr_b16 v[166:167], v222 offset:1920
    s_waitcnt lgkmcnt(12)
    v_mfma_f32_32x32x16_bf16 v[84:99], v[168:171], v[128:131], v[84:99]
    ds_read_b64_tr_b16 v[168:169], v222 offset:160
    ds_read_b64_tr_b16 v[170:171], v222 offset:1952
    s_waitcnt lgkmcnt(12)
    v_mfma_f32_32x32x16_bf16 v[100:115], v[172:175], v[128:131], v[100:115]
    ds_read_b64_tr_b16 v[172:173], v222 offset:192
    ds_read_b64_tr_b16 v[174:175], v222 offset:1984
    s_waitcnt vmcnt(0)
    v_max3_u32 v233, v132, v133, v134
    v_max3_u32 v233, v233, v135, v136
    v_max3_u32 v233, v233, v137, v138
    v_max3_u32 v233, v233, v139, v140
    v_max3_u32 v233, v233, v141, v142
    v_max3_u32 v233, v233, v143, v144
    v_max3_u32 v233, v233, v145, v146
    v_max_u32 v233, v233, v147
    v_cmp_eq_u32 vcc, -1, v233
    s_cbranch_vccnz k4_slow_15
    k4_back_15:
    s_waitcnt lgkmcnt(12)
    v_mfma_f32_32x32x16_bf16 v[4:19], v[148:151], v[132:135], v[4:19]
    ds_read_b64_tr_b16 v[148:149], v222 offset:3584
    ds_read_b64_tr_b16 v[150:151], v222 offset:5376
    s_waitcnt lgkmcnt(12)
    v_mfma_f32_32x32x16_bf16 v[20:35], v[152:155], v[132:135], v[20:35]
    ds_read_b64_tr_b16 v[152:153], v222 offset:3616
    ds_read_b64_tr_b16 v[154:155], v222 offset:5408
    s_waitcnt lgkmcnt(12)
    v_mfma_f32_32x32x16_bf16 v[36:51], v[156:159], v[132:135], v[36:51]
    ds_read_b64_tr_b16 v[156:157], v222 offset:3648
    ds_read_b64_tr_b16 v[158:159], v222 offset:5440
    s_waitcnt lgkmcnt(12)
    v_mfma_f32_32x32x16_bf16 v[52:67], v[160:163], v[132:135], v[52:67]
    ds_read_b64_tr_b16 v[160:161], v222 offset:3680
    ds_read_b64_tr_b16 v[162:163], v222 offset:5472
    s_waitcnt lgkmcnt(12)
    v_mfma_f32_32x32x16_bf16 v[68:83], v[164:167], v[132:135], v[68:83]
    ds_read_b64_tr_b16 v[164:165], v222 offset:3712
    ds_read_b64_tr_b16 v[166:167], v222 offset:5504
    s_waitcnt lgkmcnt(12)
    v_mfma_f32_32x32x16_bf16 v[84:99], v[168:171], v[132:135], v[84:99]
    ds_read_b64_tr_b16 v[168:169], v222 offset:3744
    ds_read_b64_tr_b16 v[170:171], v222 offset:5536
    s_waitcnt lgkmcnt(12)
    v_mfma_f32_32x32x16_bf16 v[100:115], v[172:175], v[132:135], v[100:115]
    ds_read_b64_tr_b16 v[172:173], v222 offset:3776
    ds_read_b64_tr_b16 v[174:175], v222 offset:5568
    s_waitcnt lgkmcnt(12)
    v_mfma_f32_32x32x16_bf16 v[4:19], v[148:151], v[136:139], v[4:19]
    ds_read_b64_tr_b16 v[148:149], v222 offset:7168
    ds_read_b64_tr_b16 v[150:151], v222 offset:8960
    s_waitcnt lgkmcnt(12)
    v_mfma_f32_32x32x16_bf16 v[20:35], v[152:155], v[136:139], v[20:35]
    ds_read_b64_tr_b16 v[152:153], v222 offset:7200
    ds_read_b64_tr_b16 v[154:155], v222 offset:8992
    s_waitcnt lgkmcnt(12)
    v_mfma_f32_32x32x16_bf16 v[36:51], v[156:159], v[136:139], v[36:51]
    ds_read_b64_tr_b16 v[156:157], v222 offset:7232
    ds_read_b64_tr_b16 v[158:159], v222 offset:9024
    s_waitcnt lgkmcnt(12)
    v_mfma_f32_32x32x16_bf16 v[52:67], v[160:163], v[136:139], v[52:67]
    ds_read_b64_tr_b16 v[160:161], v222 offset:7264
    ds_read_b64_tr_b16 v[162:163], v222 offset:9056
    s_waitcnt lgkmcnt(12)
    v_mfma_f32_32x32x16_bf16 v[68:83], v[164:167], v[136:139], v[68:83]
    ds_read_b64_tr_b16 v[164:165], v222 offset:7296
    ds_read_b64_tr_b16 v[166:167], v222 offset:9088
    s_waitcnt lgkmcnt(12)
    v_mfma_f32_32x32x16_bf16 v[84:99], v[168:171], v[136:139], v[84:99]
    ds_read_b64_tr_b16 v[168:169], v222 offset:7328
    ds_read_b64_tr_b16 v[170:171], v222 offset:9120
    s_waitcnt lgkmcnt(12)
    v_mfma_f32_32x32x16_bf16 v[100:115], v[172:175], v[136:139], v[100:115]
    ds_read_b64_tr_b16 v[172:173], v222 offset:7360
    ds_read_b64_tr_b16 v[174:175], v222 offset:9152
    s_waitcnt lgkmcnt(12)
    v_mfma_f32_32x32x16_bf16 v[4:19], v[148:151], v[140:143], v[4:19]
    ds_read_b64_tr_b16 v[148:149], v222 offset:10752
    ds_read_b64_tr_b16 v[150:151], v222 offset:12544
    s_waitcnt lgkmcnt(12)
    v_mfma_f32_32x32x16_bf16 v[20:35], v[152:155], v[140:143], v[20:35]
    ds_read_b64_tr_b16 v[152:153], v222 offset:10784
    ds_read_b64_tr_b16 v[154:155], v222 offset:12576
    s_waitcnt lgkmcnt(12)
    v_mfma_f32_32x32x16_bf16 v[36:51], v[156:159], v[140:143], v[36:51]
    ds_read_b64_tr_b16 v[156:157], v222 offset:10816
    ds_read_b64_tr_b16 v[158:159], v222 offset:12608
    s_waitcnt lgkmcnt(12)
    v_mfma_f32_32x32x16_bf16 v[52:67], v[160:163], v[140:143], v[52:67]
    ds_read_b64_tr_b16 v[160:161], v222 offset:10848
    ds_read_b64_tr_b16 v[162:163], v222 offset:12640
    s_waitcnt lgkmcnt(12)
    v_mfma_f32_32x32x16_bf16 v[68:83], v[164:167], v[140:143], v[68:83]
    ds_read_b64_tr_b16 v[164:165], v222 offset:10880
    ds_read_b64_tr_b16 v[166:167], v222 offset:12672
    s_waitcnt lgkmcnt(12)
    v_mfma_f32_32x32x16_bf16 v[84:99], v[168:171], v[140:143], v[84:99]
    ds_read_b64_tr_b16 v[168:169], v222 offset:10912
    ds_read_b64_tr_b16 v[170:171], v222 offset:12704
    s_waitcnt lgkmcnt(12)
    v_mfma_f32_32x32x16_bf16 v[100:115], v[172:175], v[140:143], v[100:115]
    ds_read_b64_tr_b16 v[172:173], v222 offset:10944
    ds_read_b64_tr_b16 v[174:175], v222 offset:12736
    s_waitcnt lgkmcnt(12)
    v_mfma_f32_32x32x16_bf16 v[4:19], v[148:151], v[144:147], v[4:19]
    s_waitcnt lgkmcnt(10)
    v_mfma_f32_32x32x16_bf16 v[20:35], v[152:155], v[144:147], v[20:35]
    s_waitcnt lgkmcnt(8)
    v_mfma_f32_32x32x16_bf16 v[36:51], v[156:159], v[144:147], v[36:51]
    s_waitcnt lgkmcnt(6)
    v_mfma_f32_32x32x16_bf16 v[52:67], v[160:163], v[144:147], v[52:67]
    s_waitcnt lgkmcnt(4)
    v_mfma_f32_32x32x16_bf16 v[68:83], v[164:167], v[144:147], v[68:83]
    s_waitcnt lgkmcnt(2)
    v_mfma_f32_32x32x16_bf16 v[84:99], v[168:171], v[144:147], v[84:99]
    s_waitcnt lgkmcnt(0)
    v_mfma_f32_32x32x16_bf16 v[100:115], v[172:175], v[144:147], v[100:115]
    s_waitcnt vmcnt(0) lgkmcnt(0)
    s_nop 15
    s_mul_i32 s18, s22, 224
    s_mul_i32 s19, s21, 7
    s_add_u32 s18, s18, s19
    s_lshl_b32 s18, s18, 10
    v_lshlrev_b32 v116, 4, v2
    v_add_u32 v116, s18, v116
    s_mov_b32 s19, 4096
    v_mul_f32 v176, v4, v4
    v_mul_f32 v177, v5, v5
    v_mul_f32 v178, v6, v6
    v_mul_f32 v179, v7, v7
    v_mul_f32 v180, v8, v8
    v_mul_f32 v181, v9, v9
    v_mul_f32 v182, v10, v10
    v_mul_f32 v183, v11, v11
    v_fma_f32 v176, v176, v230, v228
    v_fma_f32 v177, v177, v230, v228
    v_fma_f32 v178, v178, v230, v228
    v_fma_f32 v179, v179, v230, v228
    v_fma_f32 v180, v180, v230, v228
    v_fma_f32 v181, v181, v230, v228
    v_fma_f32 v182, v182, v230, v228
    v_fma_f32 v183, v183, v230, v228
    v_mul_f32 v176, v176, v4
    v_mul_f32 v177, v177, v5
    v_mul_f32 v178, v178, v6
    v_mul_f32 v179, v179, v7
    v_mul_f32 v180, v180, v8
    v_mul_f32 v181, v181, v9
    v_mul_f32 v182, v182, v10
    v_mul_f32 v183, v183, v11
    v_exp_f32 v176, v176
    v_exp_f32 v177, v177
    v_exp_f32 v178, v178
    v_exp_f32 v179, v179
    v_exp_f32 v180, v180
    v_exp_f32 v181, v181
    v_exp_f32 v182, v182
    v_exp_f32 v183, v183
    v_mul_f32 v4, v4, v12
    v_mul_f32 v5, v5, v13
    v_mul_f32 v6, v6, v14
    v_mul_f32 v7, v7, v15
    v_mul_f32 v8, v8, v16
    v_mul_f32 v9, v9, v17
    v_mul_f32 v10, v10, v18
    v_mul_f32 v11, v11, v19
    v_fma_f32 v176, v176, v232, v232
    v_fma_f32 v177, v177, v232, v232
    v_fma_f32 v178, v178, v232, v232
    v_fma_f32 v179, v179, v232, v232
    v_fma_f32 v180, v180, v232, v232
    v_fma_f32 v181, v181, v232, v232
    v_fma_f32 v182, v182, v232, v232
    v_fma_f32 v183, v183, v232, v232
    v_rcp_f32 v176, v176
    v_rcp_f32 v177, v177
    v_rcp_f32 v178, v178
    v_rcp_f32 v179, v179
    v_rcp_f32 v180, v180
    v_rcp_f32 v181, v181
    v_rcp_f32 v182, v182
    v_rcp_f32 v183, v183
    s_nop 0
    v_mul_f32 v4, v4, v176
    v_mul_f32 v5, v5, v177
    v_mul_f32 v6, v6, v178
    v_mul_f32 v7, v7, v179
    v_mul_f32 v8, v8, v180
    v_mul_f32 v9, v9, v181
    v_mul_f32 v10, v10, v182
    v_mul_f32 v11, v11, v183
    v_cvt_pk_bf16_f32 v184, v4, v5
    v_cvt_pk_bf16_f32 v185, v6, v7
    v_cvt_pk_bf16_f32 v186, v8, v9
    v_cvt_pk_bf16_f32 v187, v10, v11
    buffer_store_dwordx4 v[184:187], v116, s[44:47], 0 offen offset:0 sc1
    v_mul_f32 v176, v20, v20
    v_mul_f32 v177, v21, v21
    v_mul_f32 v178, v22, v22
    v_mul_f32 v179, v23, v23
    v_mul_f32 v180, v24, v24
    v_mul_f32 v181, v25, v25
    v_mul_f32 v182, v26, v26
    v_mul_f32 v183, v27, v27
    v_fma_f32 v176, v176, v230, v228
    v_fma_f32 v177, v177, v230, v228
    v_fma_f32 v178, v178, v230, v228
    v_fma_f32 v179, v179, v230, v228
    v_fma_f32 v180, v180, v230, v228
    v_fma_f32 v181, v181, v230, v228
    v_fma_f32 v182, v182, v230, v228
    v_fma_f32 v183, v183, v230, v228
    v_mul_f32 v176, v176, v20
    v_mul_f32 v177, v177, v21
    v_mul_f32 v178, v178, v22
    v_mul_f32 v179, v179, v23
    v_mul_f32 v180, v180, v24
    v_mul_f32 v181, v181, v25
    v_mul_f32 v182, v182, v26
    v_mul_f32 v183, v183, v27
    v_exp_f32 v176, v176
    v_exp_f32 v177, v177
    v_exp_f32 v178, v178
    v_exp_f32 v179, v179
    v_exp_f32 v180, v180
    v_exp_f32 v181, v181
    v_exp_f32 v182, v182
    v_exp_f32 v183, v183
    v_mul_f32 v20, v20, v28
    v_mul_f32 v21, v21, v29
    v_mul_f32 v22, v22, v30
    v_mul_f32 v23, v23, v31
    v_mul_f32 v24, v24, v32
    v_mul_f32 v25, v25, v33
    v_mul_f32 v26, v26, v34
    v_mul_f32 v27, v27, v35
    v_fma_f32 v176, v176, v232, v232
    v_fma_f32 v177, v177, v232, v232
    v_fma_f32 v178, v178, v232, v232
    v_fma_f32 v179, v179, v232, v232
    v_fma_f32 v180, v180, v232, v232
    v_fma_f32 v181, v181, v232, v232
    v_fma_f32 v182, v182, v232, v232
    v_fma_f32 v183, v183, v232, v232
    v_rcp_f32 v176, v176
    v_rcp_f32 v177, v177
    v_rcp_f32 v178, v178
    v_rcp_f32 v179, v179
    v_rcp_f32 v180, v180
    v_rcp_f32 v181, v181
    v_rcp_f32 v182, v182
    v_rcp_f32 v183, v183
    s_nop 0
    v_mul_f32 v20, v20, v176
    v_mul_f32 v21, v21, v177
    v_mul_f32 v22, v22, v178
    v_mul_f32 v23, v23, v179
    v_mul_f32 v24, v24, v180
    v_mul_f32 v25, v25, v181
    v_mul_f32 v26, v26, v182
    v_mul_f32 v27, v27, v183
    v_cvt_pk_bf16_f32 v188, v20, v21
    v_cvt_pk_bf16_f32 v189, v22, v23
    v_cvt_pk_bf16_f32 v190, v24, v25
    v_cvt_pk_bf16_f32 v191, v26, v27
    buffer_store_dwordx4 v[188:191], v116, s[44:47], 0 offen offset:1024 sc1
    v_mul_f32 v176, v36, v36
    v_mul_f32 v177, v37, v37
    v_mul_f32 v178, v38, v38
    v_mul_f32 v179, v39, v39
    v_mul_f32 v180, v40, v40
    v_mul_f32 v181, v41, v41
    v_mul_f32 v182, v42, v42
    v_mul_f32 v183, v43, v43
    v_fma_f32 v176, v176, v230, v228
    v_fma_f32 v177, v177, v230, v228
    v_fma_f32 v178, v178, v230, v228
    v_fma_f32 v179, v179, v230, v228
    v_fma_f32 v180, v180, v230, v228
    v_fma_f32 v181, v181, v230, v228
    v_fma_f32 v182, v182, v230, v228
    v_fma_f32 v183, v183, v230, v228
    v_mul_f32 v176, v176, v36
    v_mul_f32 v177, v177, v37
    v_mul_f32 v178, v178, v38
    v_mul_f32 v179, v179, v39
    v_mul_f32 v180, v180, v40
    v_mul_f32 v181, v181, v41
    v_mul_f32 v182, v182, v42
    v_mul_f32 v183, v183, v43
    v_exp_f32 v176, v176
    v_exp_f32 v177, v177
    v_exp_f32 v178, v178
    v_exp_f32 v179, v179
    v_exp_f32 v180, v180
    v_exp_f32 v181, v181
    v_exp_f32 v182, v182
    v_exp_f32 v183, v183
    v_mul_f32 v36, v36, v44
    v_mul_f32 v37, v37, v45
    v_mul_f32 v38, v38, v46
    v_mul_f32 v39, v39, v47
    v_mul_f32 v40, v40, v48
    v_mul_f32 v41, v41, v49
    v_mul_f32 v42, v42, v50
    v_mul_f32 v43, v43, v51
    v_fma_f32 v176, v176, v232, v232
    v_fma_f32 v177, v177, v232, v232
    v_fma_f32 v178, v178, v232, v232
    v_fma_f32 v179, v179, v232, v232
    v_fma_f32 v180, v180, v232, v232
    v_fma_f32 v181, v181, v232, v232
    v_fma_f32 v182, v182, v232, v232
    v_fma_f32 v183, v183, v232, v232
    v_rcp_f32 v176, v176
    v_rcp_f32 v177, v177
    v_rcp_f32 v178, v178
    v_rcp_f32 v179, v179
    v_rcp_f32 v180, v180
    v_rcp_f32 v181, v181
    v_rcp_f32 v182, v182
    v_rcp_f32 v183, v183
    s_nop 0
    v_mul_f32 v36, v36, v176
    v_mul_f32 v37, v37, v177
    v_mul_f32 v38, v38, v178
    v_mul_f32 v39, v39, v179
    v_mul_f32 v40, v40, v180
    v_mul_f32 v41, v41, v181
    v_mul_f32 v42, v42, v182
    v_mul_f32 v43, v43, v183
    v_cvt_pk_bf16_f32 v184, v36, v37
    v_cvt_pk_bf16_f32 v185, v38, v39
    v_cvt_pk_bf16_f32 v186, v40, v41
    v_cvt_pk_bf16_f32 v187, v42, v43
    buffer_store_dwordx4 v[184:187], v116, s[44:47], 0 offen offset:2048 sc1
    v_mul_f32 v176, v52, v52
    v_mul_f32 v177, v53, v53
    v_mul_f32 v178, v54, v54
    v_mul_f32 v179, v55, v55
    v_mul_f32 v180, v56, v56
    v_mul_f32 v181, v57, v57
    v_mul_f32 v182, v58, v58
    v_mul_f32 v183, v59, v59
    v_fma_f32 v176, v176, v230, v228
    v_fma_f32 v177, v177, v230, v228
    v_fma_f32 v178, v178, v230, v228
    v_fma_f32 v179, v179, v230, v228
    v_fma_f32 v180, v180, v230, v228
    v_fma_f32 v181, v181, v230, v228
    v_fma_f32 v182, v182, v230, v228
    v_fma_f32 v183, v183, v230, v228
    v_mul_f32 v176, v176, v52
    v_mul_f32 v177, v177, v53
    v_mul_f32 v178, v178, v54
    v_mul_f32 v179, v179, v55
    v_mul_f32 v180, v180, v56
    v_mul_f32 v181, v181, v57
    v_mul_f32 v182, v182, v58
    v_mul_f32 v183, v183, v59
    v_exp_f32 v176, v176
    v_exp_f32 v177, v177
    v_exp_f32 v178, v178
    v_exp_f32 v179, v179
    v_exp_f32 v180, v180
    v_exp_f32 v181, v181
    v_exp_f32 v182, v182
    v_exp_f32 v183, v183
    v_mul_f32 v52, v52, v60
    v_mul_f32 v53, v53, v61
    v_mul_f32 v54, v54, v62
    v_mul_f32 v55, v55, v63
    v_mul_f32 v56, v56, v64
    v_mul_f32 v57, v57, v65
    v_mul_f32 v58, v58, v66
    v_mul_f32 v59, v59, v67
    v_fma_f32 v176, v176, v232, v232
    v_fma_f32 v177, v177, v232, v232
    v_fma_f32 v178, v178, v232, v232
    v_fma_f32 v179, v179, v232, v232
    v_fma_f32 v180, v180, v232, v232
    v_fma_f32 v181, v181, v232, v232
    v_fma_f32 v182, v182, v232, v232
    v_fma_f32 v183, v183, v232, v232
    v_rcp_f32 v176, v176
    v_rcp_f32 v177, v177
    v_rcp_f32 v178, v178
    v_rcp_f32 v179, v179
    v_rcp_f32 v180, v180
    v_rcp_f32 v181, v181
    v_rcp_f32 v182, v182
    v_rcp_f32 v183, v183
    s_nop 0
    v_mul_f32 v52, v52, v176
    v_mul_f32 v53, v53, v177
    v_mul_f32 v54, v54, v178
    v_mul_f32 v55, v55, v179
    v_mul_f32 v56, v56, v180
    v_mul_f32 v57, v57, v181
    v_mul_f32 v58, v58, v182
    v_mul_f32 v59, v59, v183
    v_cvt_pk_bf16_f32 v188, v52, v53
    v_cvt_pk_bf16_f32 v189, v54, v55
    v_cvt_pk_bf16_f32 v190, v56, v57
    v_cvt_pk_bf16_f32 v191, v58, v59
    buffer_store_dwordx4 v[188:191], v116, s[44:47], 0 offen offset:3072 sc1
    v_mul_f32 v176, v68, v68
    v_mul_f32 v177, v69, v69
    v_mul_f32 v178, v70, v70
    v_mul_f32 v179, v71, v71
    v_mul_f32 v180, v72, v72
    v_mul_f32 v181, v73, v73
    v_mul_f32 v182, v74, v74
    v_mul_f32 v183, v75, v75
    v_fma_f32 v176, v176, v230, v228
    v_fma_f32 v177, v177, v230, v228
    v_fma_f32 v178, v178, v230, v228
    v_fma_f32 v179, v179, v230, v228
    v_fma_f32 v180, v180, v230, v228
    v_fma_f32 v181, v181, v230, v228
    v_fma_f32 v182, v182, v230, v228
    v_fma_f32 v183, v183, v230, v228
    v_mul_f32 v176, v176, v68
    v_mul_f32 v177, v177, v69
    v_mul_f32 v178, v178, v70
    v_mul_f32 v179, v179, v71
    v_mul_f32 v180, v180, v72
    v_mul_f32 v181, v181, v73
    v_mul_f32 v182, v182, v74
    v_mul_f32 v183, v183, v75
    v_exp_f32 v176, v176
    v_exp_f32 v177, v177
    v_exp_f32 v178, v178
    v_exp_f32 v179, v179
    v_exp_f32 v180, v180
    v_exp_f32 v181, v181
    v_exp_f32 v182, v182
    v_exp_f32 v183, v183
    v_mul_f32 v68, v68, v76
    v_mul_f32 v69, v69, v77
    v_mul_f32 v70, v70, v78
    v_mul_f32 v71, v71, v79
    v_mul_f32 v72, v72, v80
    v_mul_f32 v73, v73, v81
    v_mul_f32 v74, v74, v82
    v_mul_f32 v75, v75, v83
    v_fma_f32 v176, v176, v232, v232
    v_fma_f32 v177, v177, v232, v232
    v_fma_f32 v178, v178, v232, v232
    v_fma_f32 v179, v179, v232, v232
    v_fma_f32 v180, v180, v232, v232
    v_fma_f32 v181, v181, v232, v232
    v_fma_f32 v182, v182, v232, v232
    v_fma_f32 v183, v183, v232, v232
    v_rcp_f32 v176, v176
    v_rcp_f32 v177, v177
    v_rcp_f32 v178, v178
    v_rcp_f32 v179, v179
    v_rcp_f32 v180, v180
    v_rcp_f32 v181, v181
    v_rcp_f32 v182, v182
    v_rcp_f32 v183, v183
    s_nop 0
    v_mul_f32 v68, v68, v176
    v_mul_f32 v69, v69, v177
    v_mul_f32 v70, v70, v178
    v_mul_f32 v71, v71, v179
    v_mul_f32 v72, v72, v180
    v_mul_f32 v73, v73, v181
    v_mul_f32 v74, v74, v182
    v_mul_f32 v75, v75, v183
    v_cvt_pk_bf16_f32 v184, v68, v69
    v_cvt_pk_bf16_f32 v185, v70, v71
    v_cvt_pk_bf16_f32 v186, v72, v73
    v_cvt_pk_bf16_f32 v187, v74, v75
    buffer_store_dwordx4 v[184:187], v116, s[44:47], s19 offen offset:0 sc1
    v_mul_f32 v176, v84, v84
    v_mul_f32 v177, v85, v85
    v_mul_f32 v178, v86, v86
    v_mul_f32 v179, v87, v87
    v_mul_f32 v180, v88, v88
    v_mul_f32 v181, v89, v89
    v_mul_f32 v182, v90, v90
    v_mul_f32 v183, v91, v91
    v_fma_f32 v176, v176, v230, v228
    v_fma_f32 v177, v177, v230, v228
    v_fma_f32 v178, v178, v230, v228
    v_fma_f32 v179, v179, v230, v228
    v_fma_f32 v180, v180, v230, v228
    v_fma_f32 v181, v181, v230, v228
    v_fma_f32 v182, v182, v230, v228
    v_fma_f32 v183, v183, v230, v228
    v_mul_f32 v176, v176, v84
    v_mul_f32 v177, v177, v85
    v_mul_f32 v178, v178, v86
    v_mul_f32 v179, v179, v87
    v_mul_f32 v180, v180, v88
    v_mul_f32 v181, v181, v89
    v_mul_f32 v182, v182, v90
    v_mul_f32 v183, v183, v91
    v_exp_f32 v176, v176
    v_exp_f32 v177, v177
    v_exp_f32 v178, v178
    v_exp_f32 v179, v179
    v_exp_f32 v180, v180
    v_exp_f32 v181, v181
    v_exp_f32 v182, v182
    v_exp_f32 v183, v183
    v_mul_f32 v84, v84, v92
    v_mul_f32 v85, v85, v93
    v_mul_f32 v86, v86, v94
    v_mul_f32 v87, v87, v95
    v_mul_f32 v88, v88, v96
    v_mul_f32 v89, v89, v97
    v_mul_f32 v90, v90, v98
    v_mul_f32 v91, v91, v99
    v_fma_f32 v176, v176, v232, v232
    v_fma_f32 v177, v177, v232, v232
    v_fma_f32 v178, v178, v232, v232
    v_fma_f32 v179, v179, v232, v232
    v_fma_f32 v180, v180, v232, v232
    v_fma_f32 v181, v181, v232, v232
    v_fma_f32 v182, v182, v232, v232
    v_fma_f32 v183, v183, v232, v232
    v_rcp_f32 v176, v176
    v_rcp_f32 v177, v177
    v_rcp_f32 v178, v178
    v_rcp_f32 v179, v179
    v_rcp_f32 v180, v180
    v_rcp_f32 v181, v181
    v_rcp_f32 v182, v182
    v_rcp_f32 v183, v183
    s_nop 0
    v_mul_f32 v84, v84, v176
    v_mul_f32 v85, v85, v177
    v_mul_f32 v86, v86, v178
    v_mul_f32 v87, v87, v179
    v_mul_f32 v88, v88, v180
    v_mul_f32 v89, v89, v181
    v_mul_f32 v90, v90, v182
    v_mul_f32 v91, v91, v183
    v_cvt_pk_bf16_f32 v188, v84, v85
    v_cvt_pk_bf16_f32 v189, v86, v87
    v_cvt_pk_bf16_f32 v190, v88, v89
    v_cvt_pk_bf16_f32 v191, v90, v91
    buffer_store_dwordx4 v[188:191], v116, s[44:47], s19 offen offset:1024 sc1
    v_mul_f32 v176, v100, v100
    v_mul_f32 v177, v101, v101
    v_mul_f32 v178, v102, v102
    v_mul_f32 v179, v103, v103
    v_mul_f32 v180, v104, v104
    v_mul_f32 v181, v105, v105
    v_mul_f32 v182, v106, v106
    v_mul_f32 v183, v107, v107
    v_fma_f32 v176, v176, v230, v228
    v_fma_f32 v177, v177, v230, v228
    v_fma_f32 v178, v178, v230, v228
    v_fma_f32 v179, v179, v230, v228
    v_fma_f32 v180, v180, v230, v228
    v_fma_f32 v181, v181, v230, v228
    v_fma_f32 v182, v182, v230, v228
    v_fma_f32 v183, v183, v230, v228
    v_mul_f32 v176, v176, v100
    v_mul_f32 v177, v177, v101
    v_mul_f32 v178, v178, v102
    v_mul_f32 v179, v179, v103
    v_mul_f32 v180, v180, v104
    v_mul_f32 v181, v181, v105
    v_mul_f32 v182, v182, v106
    v_mul_f32 v183, v183, v107
    v_exp_f32 v176, v176
    v_exp_f32 v177, v177
    v_exp_f32 v178, v178
    v_exp_f32 v179, v179
    v_exp_f32 v180, v180
    v_exp_f32 v181, v181
    v_exp_f32 v182, v182
    v_exp_f32 v183, v183
    v_mul_f32 v100, v100, v108
    v_mul_f32 v101, v101, v109
    v_mul_f32 v102, v102, v110
    v_mul_f32 v103, v103, v111
    v_mul_f32 v104, v104, v112
    v_mul_f32 v105, v105, v113
    v_mul_f32 v106, v106, v114
    v_mul_f32 v107, v107, v115
    v_fma_f32 v176, v176, v232, v232
    v_fma_f32 v177, v177, v232, v232
    v_fma_f32 v178, v178, v232, v232
    v_fma_f32 v179, v179, v232, v232
    v_fma_f32 v180, v180, v232, v232
    v_fma_f32 v181, v181, v232, v232
    v_fma_f32 v182, v182, v232, v232
    v_fma_f32 v183, v183, v232, v232
    v_rcp_f32 v176, v176
    v_rcp_f32 v177, v177
    v_rcp_f32 v178, v178
    v_rcp_f32 v179, v179
    v_rcp_f32 v180, v180
    v_rcp_f32 v181, v181
    v_rcp_f32 v182, v182
    v_rcp_f32 v183, v183
    s_nop 0
    v_mul_f32 v100, v100, v176
    v_mul_f32 v101, v101, v177
    v_mul_f32 v102, v102, v178
    v_mul_f32 v103, v103, v179
    v_mul_f32 v104, v104, v180
    v_mul_f32 v105, v105, v181
    v_mul_f32 v106, v106, v182
    v_mul_f32 v107, v107, v183
    v_cvt_pk_bf16_f32 v184, v100, v101
    v_cvt_pk_bf16_f32 v185, v102, v103
    v_cvt_pk_bf16_f32 v186, v104, v105
    v_cvt_pk_bf16_f32 v187, v106, v107
    buffer_store_dwordx4 v[184:187], v116, s[44:47], s19 offen offset:2048 sc1
k4_done:
    s_endpgm
k4_slow_0:
    s_mov_b32 s33, 0
    buffer_load_dwordx4 v[116:119], v220, s[8:11], s33 offen offset:0 sc1
    buffer_load_dwordx4 v[120:123], v220, s[8:11], s33 offen offset:1024 sc1
    buffer_load_dwordx4 v[124:127], v220, s[8:11], s33 offen offset:2048 sc1
    buffer_load_dwordx4 v[128:131], v220, s[8:11], s33 offen offset:3072 sc1
    s_waitcnt vmcnt(0)
    v_max3_u32 v233, v116, v117, v118
    v_max3_u32 v233, v233, v119, v120
    v_max3_u32 v233, v233, v121, v122
    v_max3_u32 v233, v233, v123, v124
    v_max3_u32 v233, v233, v125, v126
    v_max3_u32 v233, v233, v127, v128
    v_max3_u32 v233, v233, v129, v130
    v_max_u32 v233, v233, v131
    v_cmp_eq_u32 vcc, -1, v233
    s_cbranch_vccz k4_back_0
    s_sleep 32
    s_sub_u32 s78, s78, 1
    s_cmp_gt_i32 s78, 0
    s_cbranch_scc1 k4_slow_0
    s_branch k4_back_0
k4_slow_1:
    s_mov_b32 s33, 4096
    buffer_load_dwordx4 v[132:135], v220, s[8:11], s33 offen offset:0 sc1
    buffer_load_dwordx4 v[136:139], v220, s[8:11], s33 offen offset:1024 sc1
    buffer_load_dwordx4 v[140:143], v220, s[8:11], s33 offen offset:2048 sc1
    buffer_load_dwordx4 v[144:147], v220, s[8:11], s33 offen offset:3072 sc1
    s_waitcnt vmcnt(0)
    v_max3_u32 v233, v132, v133, v134
    v_max3_u32 v233, v233, v135, v136
    v_max3_u32 v233, v233, v137, v138
    v_max3_u32 v233, v233, v139, v140
    v_max3_u32 v233, v233, v141, v142
    v_max3_u32 v233, v233, v143, v144
    v_max3_u32 v233, v233, v145, v146
    v_max_u32 v233, v233, v147
    v_cmp_eq_u32 vcc, -1, v233
    s_cbranch_vccz k4_back_1
    s_sleep 32
    s_sub_u32 s78, s78, 1
    s_cmp_gt_i32 s78, 0
    s_cbranch_scc1 k4_slow_1
    s_branch k4_back_1
k4_slow_2:
    s_mov_b32 s33, 8192
    buffer_load_dwordx4 v[116:119], v220, s[8:11], s33 offen offset:0 sc1
    buffer_load_dwordx4 v[120:123], v220, s[8:11], s33 offen offset:1024 sc1
    buffer_load_dwordx4 v[124:127], v220, s[8:11], s33 offen offset:2048 sc1
    buffer_load_dwordx4 v[128:131], v220, s[8:11], s33 offen offset:3072 sc1
    s_waitcnt vmcnt(0)
    v_max3_u32 v233, v116, v117, v118
    v_max3_u32 v233, v233, v119, v120
    v_max3_u32 v233, v233, v121, v122
    v_max3_u32 v233, v233, v123, v124
    v_max3_u32 v233, v233, v125, v126
    v_max3_u32 v233, v233, v127, v128
    v_max3_u32 v233, v233, v129, v130
    v_max_u32 v233, v233, v131
    v_cmp_eq_u32 vcc, -1, v233
    s_cbranch_vccz k4_back_2
    s_sleep 32
    s_sub_u32 s78, s78, 1
    s_cmp_gt_i32 s78, 0
    s_cbranch_scc1 k4_slow_2
    s_branch k4_back_2
k4_slow_3:
    s_mov_b32 s33, 12288
    buffer_load_dwordx4 v[132:135], v220, s[8:11], s33 offen offset:0 sc1
    buffer_load_dwordx4 v[136:139], v220, s[8:11], s33 offen offset:1024 sc1
    buffer_load_dwordx4 v[140:143], v220, s[8:11], s33 offen offset:2048 sc1
    buffer_load_dwordx4 v[144:147], v220, s[8:11], s33 offen offset:3072 sc1
    s_waitcnt vmcnt(0)
    v_max3_u32 v233, v132, v133, v134
    v_max3_u32 v233, v233, v135, v136
    v_max3_u32 v233, v233, v137, v138
    v_max3_u32 v233, v233, v139, v140
    v_max3_u32 v233, v233, v141, v142
    v_max3_u32 v233, v233, v143, v144
    v_max3_u32 v233, v233, v145, v146
    v_max_u32 v233, v233, v147
    v_cmp_eq_u32 vcc, -1, v233
    s_cbranch_vccz k4_back_3
    s_sleep 32
    s_sub_u32 s78, s78, 1
    s_cmp_gt_i32 s78, 0
    s_cbranch_scc1 k4_slow_3
    s_branch k4_back_3
k4_slow_4:
    s_mov_b32 s33, 16384
    buffer_load_dwordx4 v[116:119], v220, s[8:11], s33 offen offset:0 sc1
    buffer_load_dwordx4 v[120:123], v220, s[8:11], s33 offen offset:1024 sc1
    buffer_load_dwordx4 v[124:127], v220, s[8:11], s33 offen offset:2048 sc1
    buffer_load_dwordx4 v[128:131], v220, s[8:11], s33 offen offset:3072 sc1
    s_waitcnt vmcnt(0)
    v_max3_u32 v233, v116, v117, v118
    v_max3_u32 v233, v233, v119, v120
    v_max3_u32 v233, v233, v121, v122
    v_max3_u32 v233, v233, v123, v124
    v_max3_u32 v233, v233, v125, v126
    v_max3_u32 v233, v233, v127, v128
    v_max3_u32 v233, v233, v129, v130
    v_max_u32 v233, v233, v131
    v_cmp_eq_u32 vcc, -1, v233
    s_cbranch_vccz k4_back_4
    s_sleep 32
    s_sub_u32 s78, s78, 1
    s_cmp_gt_i32 s78, 0
    s_cbranch_scc1 k4_slow_4
    s_branch k4_back_4
k4_slow_5:
    s_mov_b32 s33, 20480
    buffer_load_dwordx4 v[132:135], v220, s[8:11], s33 offen offset:0 sc1
    buffer_load_dwordx4 v[136:139], v220, s[8:11], s33 offen offset:1024 sc1
    buffer_load_dwordx4 v[140:143], v220, s[8:11], s33 offen offset:2048 sc1
    buffer_load_dwordx4 v[144:147], v220, s[8:11], s33 offen offset:3072 sc1
    s_waitcnt vmcnt(0)
    v_max3_u32 v233, v132, v133, v134
    v_max3_u32 v233, v233, v135, v136
    v_max3_u32 v233, v233, v137, v138
    v_max3_u32 v233, v233, v139, v140
    v_max3_u32 v233, v233, v141, v142
    v_max3_u32 v233, v233, v143, v144
    v_max3_u32 v233, v233, v145, v146
    v_max_u32 v233, v233, v147
    v_cmp_eq_u32 vcc, -1, v233
    s_cbranch_vccz k4_back_5
    s_sleep 32
    s_sub_u32 s78, s78, 1
    s_cmp_gt_i32 s78, 0
    s_cbranch_scc1 k4_slow_5
    s_branch k4_back_5
k4_slow_6:
    s_mov_b32 s33, 24576
    buffer_load_dwordx4 v[116:119], v220, s[8:11], s33 offen offset:0 sc1
    buffer_load_dwordx4 v[120:123], v220, s[8:11], s33 offen offset:1024 sc1
    buffer_load_dwordx4 v[124:127], v220, s[8:11], s33 offen offset:2048 sc1
    buffer_load_dwordx4 v[128:131], v220, s[8:11], s33 offen offset:3072 sc1
    s_waitcnt vmcnt(0)
    v_max3_u32 v233, v116, v117, v118
    v_max3_u32 v233, v233, v119, v120
    v_max3_u32 v233, v233, v121, v122
    v_max3_u32 v233, v233, v123, v124
    v_max3_u32 v233, v233, v125, v126
    v_max3_u32 v233, v233, v127, v128
    v_max3_u32 v233, v233, v129, v130
    v_max_u32 v233, v233, v131
    v_cmp_eq_u32 vcc, -1, v233
    s_cbranch_vccz k4_back_6
    s_sleep 32
    s_sub_u32 s78, s78, 1
    s_cmp_gt_i32 s78, 0
    s_cbranch_scc1 k4_slow_6
    s_branch k4_back_6
k4_slow_7:
    s_mov_b32 s33, 28672
    buffer_load_dwordx4 v[132:135], v220, s[8:11], s33 offen offset:0 sc1
    buffer_load_dwordx4 v[136:139], v220, s[8:11], s33 offen offset:1024 sc1
    buffer_load_dwordx4 v[140:143], v220, s[8:11], s33 offen offset:2048 sc1
    buffer_load_dwordx4 v[144:147], v220, s[8:11], s33 offen offset:3072 sc1
    s_waitcnt vmcnt(0)
    v_max3_u32 v233, v132, v133, v134
    v_max3_u32 v233, v233, v135, v136
    v_max3_u32 v233, v233, v137, v138
    v_max3_u32 v233, v233, v139, v140
    v_max3_u32 v233, v233, v141, v142
    v_max3_u32 v233, v233, v143, v144
    v_max3_u32 v233, v233, v145, v146
    v_max_u32 v233, v233, v147
    v_cmp_eq_u32 vcc, -1, v233
    s_cbranch_vccz k4_back_7
    s_sleep 32
    s_sub_u32 s78, s78, 1
    s_cmp_gt_i32 s78, 0
    s_cbranch_scc1 k4_slow_7
    s_branch k4_back_7
k4_slow_8:
    s_mov_b32 s33, 32768
    buffer_load_dwordx4 v[116:119], v220, s[8:11], s33 offen offset:0 sc1
    buffer_load_dwordx4 v[120:123], v220, s[8:11], s33 offen offset:1024 sc1
    buffer_load_dwordx4 v[124:127], v220, s[8:11], s33 offen offset:2048 sc1
    buffer_load_dwordx4 v[128:131], v220, s[8:11], s33 offen offset:3072 sc1
    s_waitcnt vmcnt(0)
    v_max3_u32 v233, v116, v117, v118
    v_max3_u32 v233, v233, v119, v120
    v_max3_u32 v233, v233, v121, v122
    v_max3_u32 v233, v233, v123, v124
    v_max3_u32 v233, v233, v125, v126
    v_max3_u32 v233, v233, v127, v128
    v_max3_u32 v233, v233, v129, v130
    v_max_u32 v233, v233, v131
    v_cmp_eq_u32 vcc, -1, v233
    s_cbranch_vccz k4_back_8
    s_sleep 32
    s_sub_u32 s78, s78, 1
    s_cmp_gt_i32 s78, 0
    s_cbranch_scc1 k4_slow_8
    s_branch k4_back_8
k4_slow_s:
    s_mov_b32 s33, 0
    buffer_load_dwordx2 v[176:177], v229, s[40:43], s33 offen sc1
    s_mov_b32 s33, 32768
    buffer_load_dwordx2 v[178:179], v229, s[40:43], s33 offen sc1
    s_mov_b32 s33, 65536
    buffer_load_dwordx2 v[180:181], v229, s[40:43], s33 offen sc1
    s_mov_b32 s33, 98304
    buffer_load_dwordx2 v[182:183], v229, s[40:43], s33 offen sc1
    s_mov_b32 s33, 131072
    buffer_load_dwordx2 v[184:185], v229, s[40:43], s33 offen sc1
    s_mov_b32 s33, 163840
    buffer_load_dwordx2 v[186:187], v229, s[40:43], s33 offen sc1
    s_mov_b32 s33, 196608
    buffer_load_dwordx2 v[188:189], v229, s[40:43], s33 offen sc1
    s_mov_b32 s33, 229376
    buffer_load_dwordx2 v[190:191], v229, s[40:43], s33 offen sc1
    buffer_load_dwordx4 v[192:195], v231, s[56:59], 0 offen offset:0 sc1
    buffer_load_dwordx4 v[196:199], v231, s[56:59], 0 offen offset:256 sc1
    buffer_load_dwordx4 v[200:203], v231, s[56:59], 0 offen offset:512 sc1
    buffer_load_dwordx4 v[204:207], v231, s[56:59], 0 offen offset:768 sc1
    buffer_load_dwordx4 v[208:211], v231, s[56:59], 0 offen offset:1024 sc1
    buffer_load_dwordx4 v[212:215], v231, s[56:59], 0 offen offset:1280 sc1
    buffer_load_dwordx4 v[216:219], v231, s[56:59], 0 offen offset:1536 sc1
    s_waitcnt vmcnt(0)
    v_max3_u32 v233, v176, v177, v178
    v_max3_u32 v233, v233, v179, v180
    v_max3_u32 v233, v233, v181, v182
    v_max3_u32 v233, v233, v183, v184
    v_max3_u32 v233, v233, v185, v186
    v_max3_u32 v233, v233, v187, v188
    v_max3_u32 v233, v233, v189, v190
    v_max3_u32 v233, v233, v191, v192
    v_max3_u32 v233, v233, v193, v194
    v_max3_u32 v233, v233, v195, v196
    v_max3_u32 v233, v233, v197, v198
    v_max3_u32 v233, v233, v199, v200
    v_max3_u32 v233, v233, v201, v202
    v_max3_u32 v233, v233, v203, v204
    v_max3_u32 v233, v233, v205, v206
    v_max3_u32 v233, v233, v207, v208
    v_max3_u32 v233, v233, v209, v210
    v_max3_u32 v233, v233, v211, v212
    v_max3_u32 v233, v233, v213, v214
    v_max3_u32 v233, v233, v215, v216
    v_max3_u32 v233, v233, v217, v218
    v_max_u32 v233, v233, v219
    v_cmp_eq_u32 vcc, -1, v233
    s_cbranch_vccz k4_back_s
    s_sleep 8
    s_sub_u32 s78, s78, 1
    s_cmp_gt_i32 s78, 0
    s_cbranch_scc1 k4_slow_s
    s_branch k4_back_s
k4_slow_9:
    s_mov_b32 s33, 36864
    buffer_load_dwordx4 v[132:135], v220, s[8:11], s33 offen offset:0 sc1
    buffer_load_dwordx4 v[136:139], v220, s[8:11], s33 offen offset:1024 sc1
    buffer_load_dwordx4 v[140:143], v220, s[8:11], s33 offen offset:2048 sc1
    buffer_load_dwordx4 v[144:147], v220, s[8:11], s33 offen offset:3072 sc1
    s_waitcnt vmcnt(0)
    v_max3_u32 v233, v132, v133, v134
    v_max3_u32 v233, v233, v135, v136
    v_max3_u32 v233, v233, v137, v138
    v_max3_u32 v233, v233, v139, v140
    v_max3_u32 v233, v233, v141, v142
    v_max3_u32 v233, v233, v143, v144
    v_max3_u32 v233, v233, v145, v146
    v_max_u32 v233, v233, v147
    v_cmp_eq_u32 vcc, -1, v233
    s_cbranch_vccz k4_back_9
    s_sleep 32
    s_sub_u32 s78, s78, 1
    s_cmp_gt_i32 s78, 0
    s_cbranch_scc1 k4_slow_9
    s_branch k4_back_9
k4_slow_10:
    s_mov_b32 s33, 40960
    buffer_load_dwordx4 v[116:119], v220, s[8:11], s33 offen offset:0 sc1
    buffer_load_dwordx4 v[120:123], v220, s[8:11], s33 offen offset:1024 sc1
    buffer_load_dwordx4 v[124:127], v220, s[8:11], s33 offen offset:2048 sc1
    buffer_load_dwordx4 v[128:131], v220, s[8:11], s33 offen offset:3072 sc1
    s_waitcnt vmcnt(0)
    v_max3_u32 v233, v116, v117, v118
    v_max3_u32 v233, v233, v119, v120
    v_max3_u32 v233, v233, v121, v122
    v_max3_u32 v233, v233, v123, v124
    v_max3_u32 v233, v233, v125, v126
    v_max3_u32 v233, v233, v127, v128
    v_max3_u32 v233, v233, v129, v130
    v_max_u32 v233, v233, v131
    v_cmp_eq_u32 vcc, -1, v233
    s_cbranch_vccz k4_back_10
    s_sleep 32
    s_sub_u32 s78, s78, 1
    s_cmp_gt_i32 s78, 0
    s_cbranch_scc1 k4_slow_10
    s_branch k4_back_10
k4_slow_11:
    s_mov_b32 s33, 45056
    buffer_load_dwordx4 v[132:135], v220, s[8:11], s33 offen offset:0 sc1
    buffer_load_dwordx4 v[136:139], v220, s[8:11], s33 offen offset:1024 sc1
    buffer_load_dwordx4 v[140:143], v220, s[8:11], s33 offen offset:2048 sc1
    buffer_load_dwordx4 v[144:147], v220, s[8:11], s33 offen offset:3072 sc1
    s_waitcnt vmcnt(0)
    v_max3_u32 v233, v132, v133, v134
    v_max3_u32 v233, v233, v135, v136
    v_max3_u32 v233, v233, v137, v138
    v_max3_u32 v233, v233, v139, v140
    v_max3_u32 v233, v233, v141, v142
    v_max3_u32 v233, v233, v143, v144
    v_max3_u32 v233, v233, v145, v146
    v_max_u32 v233, v233, v147
    v_cmp_eq_u32 vcc, -1, v233
    s_cbranch_vccz k4_back_11
    s_sleep 32
    s_sub_u32 s78, s78, 1
    s_cmp_gt_i32 s78, 0
    s_cbranch_scc1 k4_slow_11
    s_branch k4_back_11
k4_slow_12:
    s_mov_b32 s33, 49152
    buffer_load_dwordx4 v[116:119], v220, s[8:11], s33 offen offset:0 sc1
    buffer_load_dwordx4 v[120:123], v220, s[8:11], s33 offen offset:1024 sc1
    buffer_load_dwordx4 v[124:127], v220, s[8:11], s33 offen offset:2048 sc1
    buffer_load_dwordx4 v[128:131], v220, s[8:11], s33 offen offset:3072 sc1
    s_waitcnt vmcnt(0)
    v_max3_u32 v233, v116, v117, v118
    v_max3_u32 v233, v233, v119, v120
    v_max3_u32 v233, v233, v121, v122
    v_max3_u32 v233, v233, v123, v124
    v_max3_u32 v233, v233, v125, v126
    v_max3_u32 v233, v233, v127, v128
    v_max3_u32 v233, v233, v129, v130
    v_max_u32 v233, v233, v131
    v_cmp_eq_u32 vcc, -1, v233
    s_cbranch_vccz k4_back_12
    s_sleep 32
    s_sub_u32 s78, s78, 1
    s_cmp_gt_i32 s78, 0
    s_cbranch_scc1 k4_slow_12
    s_branch k4_back_12
k4_slow_13:
    s_mov_b32 s33, 53248
    buffer_load_dwordx4 v[132:135], v220, s[8:11], s33 offen offset:0 sc1
    buffer_load_dwordx4 v[136:139], v220, s[8:11], s33 offen offset:1024 sc1
    buffer_load_dwordx4 v[140:143], v220, s[8:11], s33 offen offset:2048 sc1
    buffer_load_dwordx4 v[144:147], v220, s[8:11], s33 offen offset:3072 sc1
    s_waitcnt vmcnt(0)
    v_max3_u32 v233, v132, v133, v134
    v_max3_u32 v233, v233, v135, v136
    v_max3_u32 v233, v233, v137, v138
    v_max3_u32 v233, v233, v139, v140
    v_max3_u32 v233, v233, v141, v142
    v_max3_u32 v233, v233, v143, v144
    v_max3_u32 v233, v233, v145, v146
    v_max_u32 v233, v233, v147
    v_cmp_eq_u32 vcc, -1, v233
    s_cbranch_vccz k4_back_13
    s_sleep 32
    s_sub_u32 s78, s78, 1
    s_cmp_gt_i32 s78, 0
    s_cbranch_scc1 k4_slow_13
    s_branch k4_back_13
k4_slow_14:
    s_mov_b32 s33, 57344
    buffer_load_dwordx4 v[116:119], v220, s[8:11], s33 offen offset:0 sc1
    buffer_load_dwordx4 v[120:123], v220, s[8:11], s33 offen offset:1024 sc1
    buffer_load_dwordx4 v[124:127], v220, s[8:11], s33 offen offset:2048 sc1
    buffer_load_dwordx4 v[128:131], v220, s[8:11], s33 offen offset:3072 sc1
    s_waitcnt vmcnt(0)
    v_max3_u32 v233, v116, v117, v118
    v_max3_u32 v233, v233, v119, v120
    v_max3_u32 v233, v233, v121, v122
    v_max3_u32 v233, v233, v123, v124
    v_max3_u32 v233, v233, v125, v126
    v_max3_u32 v233, v233, v127, v128
    v_max3_u32 v233, v233, v129, v130
    v_max_u32 v233, v233, v131
    v_cmp_eq_u32 vcc, -1, v233
    s_cbranch_vccz k4_back_14
    s_sleep 32
    s_sub_u32 s78, s78, 1
    s_cmp_gt_i32 s78, 0
    s_cbranch_scc1 k4_slow_14
    s_branch k4_back_14
k4_slow_15:
    s_mov_b32 s33, 61440
    buffer_load_dwordx4 v[132:135], v220, s[8:11], s33 offen offset:0 sc1
    buffer_load_dwordx4 v[136:139], v220, s[8:11], s33 offen offset:1024 sc1
    buffer_load_dwordx4 v[140:143], v220, s[8:11], s33 offen offset:2048 sc1
    buffer_load_dwordx4 v[144:147], v220, s[8:11], s33 offen offset:3072 sc1
    s_waitcnt vmcnt(0)
    v_max3_u32 v233, v132, v133, v134
    v_max3_u32 v233, v233, v135, v136
    v_max3_u32 v233, v233, v137, v138
    v_max3_u32 v233, v233, v139, v140
    v_max3_u32 v233, v233, v141, v142
    v_max3_u32 v233, v233, v143, v144
    v_max3_u32 v233, v233, v145, v146
    v_max_u32 v233, v233, v147
    v_cmp_eq_u32 vcc, -1, v233
    s_cbranch_vccz k4_back_15
    s_sleep 32
    s_sub_u32 s78, s78, 1
    s_cmp_gt_i32 s78, 0
    s_cbranch_scc1 k4_slow_15
    s_branch k4_back_15
.globl k5_down_kernel
.p2align 8
.type k5_down_kernel,@function
k5_down_kernel:
    s_cmp_ge_u32 s2, 256
    s_cbranch_scc1 k5_done
    v_and_b32 v2, 63, v0
    v_lshrrev_b32 v1, 6, v0
    s_nop 0
    v_readfirstlane_b32 s3, v1
    s_load_dwordx2 s[4:5], s[0:1], 48
    s_load_dwordx2 s[6:7], s[0:1], 72
    s_load_dwordx2 s[34:35], s[0:1], 56
    s_and_b32 s16, s2, 7
    s_lshr_b32 s17, s2, 3
    s_and_b32 s26, s16, 1
    s_bfe_u32 s18, s16, 0x10001
    s_lshl_b32 s18, s18, 2
    s_and_b32 s19, s17, 3
    s_add_u32 s21, s18, s19
    s_lshr_b32 s18, s16, 2
    s_lshl_b32 s18, s18, 3
    s_lshr_b32 s19, s17, 2
    s_add_u32 s20, s18, s19
    s_lshl_b32 s22, s20, 2
    s_add_u32 s22, s22, s3
    s_lshl_b32 s27, s21, 1
    s_add_u32 s27, s27, s26
    s_mul_i32 s16, s22, 229376
    s_mul_i32 s17, s26, 114688
    s_add_u32 s16, s16, s17
    v_lshlrev_b32 v124, 4, v2
    v_add_u32 v116, s16, v124
    v_lshrrev_b32 v117, 5, v2
    v_lshlrev_b32 v117, 8, v117
    v_bfe_u32 v3, v2, 2, 2
    v_lshl_add_u32 v117, v3, 6, v117
    v_bfe_u32 v3, v2, 4, 1
    v_lshl_add_u32 v117, v3, 5, v117
    v_and_b32 v3, 3, v2
    v_lshl_add_u32 v117, v3, 3, v117
    v_bfe_u32 v3, v2, 2, 3
    s_mov_b32 s16, 2048
    v_mul_lo_u32 v119, v3, s16
    v_lshrrev_b32 v3, 5, v2
    v_lshl_add_u32 v119, v3, 6, v119
    v_and_b32 v3, 3, v2
    v_lshl_add_u32 v119, v3, 4, v119
    s_mul_i32 s16, s3, 32768
    s_mul_i32 s18, s26, 3670016
    s_add_u32 s16, s16, s18
    s_lshl_b32 s17, s27, 7
    s_add_u32 s18, s16, s17
    s_xor_b32 s17, s17, 128
    s_add_u32 s19, s16, s17
    v_add_u32 v121, s19, v119
    v_add_u32 v119, s18, v119
    v_add_u32 v120, 16384, v119
    v_add_u32 v122, 16384, v121
    s_lshl_b32 s23, s3, 11
    s_waitcnt lgkmcnt(0)
    s_add_u32 s8, s6, 33554432
    s_addc_u32 s9, s7, 0
    s_mov_b32 s10, 14680064
    s_mov_b32 s11, 0x00020000
    s_mov_b32 s12, s4
    s_mov_b32 s13, s5
    s_mov_b32 s14, 7340032
    s_mov_b32 s15, 0x00020000
    s_mov_b32 s25, 0
    s_add_u32 m0, s23, 8192
    s_nop 0
    buffer_load_dwordx4 v121, s[12:15], s25 offen lds
    s_add_u32 m0, s23, 9216
    s_nop 0
    buffer_load_dwordx4 v122, s[12:15], s25 offen lds
    s_mov_b32 s24, 0
    buffer_load_dwordx4 a[0:3], v116, s[8:11], s24 offen offset:0
    buffer_load_dwordx4 a[4:7], v116, s[8:11], s24 offen offset:1024
    buffer_load_dwordx4 a[8:11], v116, s[8:11], s24 offen offset:2048
    buffer_load_dwordx4 a[12:15], v116, s[8:11], s24 offen offset:3072
    s_mov_b32 s25, 131072
    s_add_u32 m0, s23, 24576
    s_nop 0
    buffer_load_dwordx4 v121, s[12:15], s25 offen lds
    s_add_u32 m0, s23, 25600
    s_nop 0
    buffer_load_dwordx4 v122, s[12:15], s25 offen lds
    s_mov_b32 s24, 4096
    buffer_load_dwordx4 a[16:19], v116, s[8:11], s24 offen offset:0
    buffer_load_dwordx4 a[20:23], v116, s[8:11], s24 offen offset:1024
    buffer_load_dwordx4 a[24:27], v116, s[8:11], s24 offen offset:2048
    buffer_load_dwordx4 a[28:31], v116, s[8:11], s24 offen offset:3072
    s_add_u32 s36, s6, 20971520
    s_addc_u32 s37, s7, 0
    s_mov_b32 s38, 4194304
    s_mov_b32 s39, 0x00020000
    s_mov_b32 s40, s34
    s_mov_b32 s41, s35
    s_mov_b32 s42, 4194304
    s_mov_b32 s43, 0x00020000
    s_add_u32 s44, s6, 50331648
    s_addc_u32 s45, s7, 0
    s_mov_b32 s46, 4194304
    s_mov_b32 s47, 0x00020000
    s_mul_i32 s16, s22, 65536
    s_lshl_b32 s17, s27, 12
    s_add_u32 s16, s16, s17
    v_add_u32 v123, s16, v124
    s_lshl_b32 s28, s20, 4
    s_add_u32 s28, s28, s27
    s_lshl_b32 s28, s28, 2
    s_add_u32 s28, s28, s3
    s_lshl_b32 s28, s28, 12
    s_xor_b32 s29, s28, 16384
    v_lshrrev_b32 v3, 3, v2
    v_lshlrev_b32 v125, 11, v3
    v_and_b32 v130, 7, v2
    v_lshl_add_u32 v125, v130, 4, v125
    v_xor_b32 v130, v130, v3
    v_lshlrev_b32 v130, 4, v130
    v_lshl_add_u32 v130, v3, 7, v130
    s_lshl_b32 s16, s3, 12
    s_add_u32 s16, s16, 0
    v_add_u32 v130, s16, v130
    v_lshrrev_b32 v3, 5, v2
    v_and_b32 v126, 7, v2
    v_xor_b32 v126, v126, v3
    v_lshlrev_b32 v126, 4, v126
    v_and_b32 v3, 31, v2
    v_lshl_add_u32 v126, v3, 7, v126
    v_add_u32 v126, s16, v126
    v_xor_b32 v127, 32, v126
    v_xor_b32 v128, 64, v126
    v_xor_b32 v129, 96, v126
    s_lshl_b32 s16, s22, 16
    s_lshl_b32 s17, s27, 7
    s_add_u32 s16, s16, s17
    v_add_u32 v125, s16, v125
    buffer_load_dwordx4 v[68:71], v123, s[36:39], 0 offen offset:0
    buffer_load_dwordx4 v[72:75], v123, s[36:39], 0 offen offset:1024
    buffer_load_dwordx4 v[76:79], v123, s[36:39], 0 offen offset:2048
    buffer_load_dwordx4 v[80:83], v123, s[36:39], 0 offen offset:3072
    s_waitcnt vmcnt(14)
    s_barrier
    v_mov_b32 v118, v117
    ds_read_b64_tr_b16 v[92:93], v118 offset:8192
    ds_read_b64_tr_b16 v[94:95], v118 offset:9216
    ds_read_b64_tr_b16 v[96:97], v118 offset:8704
    ds_read_b64_tr_b16 v[98:99], v118 offset:9728
    ds_read_b64_tr_b16 v[108:109], v118 offset:10240
    ds_read_b64_tr_b16 v[110:111], v118 offset:11264
    ds_read_b64_tr_b16 v[112:113], v118 offset:10752
    ds_read_b64_tr_b16 v[114:115], v118 offset:11776
    s_mov_b32 s25, 262144
    s_add_u32 m0, s23, 40960
    s_nop 0
    buffer_load_dwordx4 v121, s[12:15], s25 offen lds
    s_add_u32 m0, s23, 41984
    s_nop 0
    buffer_load_dwordx4 v122, s[12:15], s25 offen lds
    s_waitcnt lgkmcnt(6)
    s_waitcnt vmcnt(15)
    v_mfma_f32_32x32x16_bf16 v[36:51], v[92:95], a[0:3], 0
    ds_read_b64_tr_b16 v[92:93], v118 offset:12288
    ds_read_b64_tr_b16 v[94:95], v118 offset:13312
    s_mov_b32 s24, 8192
    buffer_load_dwordx4 a[32:35], v116, s[8:11], s24 offen offset:0
    buffer_load_dwordx4 a[36:39], v116, s[8:11], s24 offen offset:1024
    s_waitcnt lgkmcnt(6)
    v_mfma_f32_32x32x16_bf16 v[52:67], v[96:99], a[0:3], 0
    ds_read_b64_tr_b16 v[96:97], v118 offset:12800
    ds_read_b64_tr_b16 v[98:99], v118 offset:13824
    buffer_load_dwordx4 a[40:43], v116, s[8:11], s24 offen offset:2048
    buffer_load_dwordx4 a[44:47], v116, s[8:11], s24 offen offset:3072
    s_mov_b32 s25, 393216
    s_add_u32 m0, s23, 57344
    s_nop 0
    buffer_load_dwordx4 v121, s[12:15], s25 offen lds
    s_add_u32 m0, s23, 58368
    s_nop 0
    buffer_load_dwordx4 v122, s[12:15], s25 offen lds
    s_mov_b32 s24, 12288
    buffer_load_dwordx4 a[48:51], v116, s[8:11], s24 offen offset:0
    buffer_load_dwordx4 a[52:55], v116, s[8:11], s24 offen offset:1024
    s_waitcnt lgkmcnt(6)
    s_waitcnt vmcnt(22)
    v_mfma_f32_32x32x16_bf16 v[36:51], v[108:111], a[4:7], v[36:51]
    ds_read_b64_tr_b16 v[108:109], v118 offset:14336
    ds_read_b64_tr_b16 v[110:111], v118 offset:15360
    buffer_load_dwordx4 a[56:59], v116, s[8:11], s24 offen offset:2048
    buffer_load_dwordx4 a[60:63], v116, s[8:11], s24 offen offset:3072
    s_waitcnt lgkmcnt(6)
    v_mfma_f32_32x32x16_bf16 v[52:67], v[112:115], a[4:7], v[52:67]
    ds_read_b64_tr_b16 v[112:113], v118 offset:14848
    ds_read_b64_tr_b16 v[114:115], v118 offset:15872
    s_mov_b32 s25, 524288
    s_add_u32 m0, s23, 73728
    s_nop 0
    buffer_load_dwordx4 v121, s[12:15], s25 offen lds
    s_add_u32 m0, s23, 74752
    s_nop 0
    buffer_load_dwordx4 v122, s[12:15], s25 offen lds
    s_waitcnt vmcnt(22)
    s_barrier
    v_add_u32 v118, 16384, v117
    s_mov_b32 s24, 16384
    buffer_load_dwordx4 a[64:67], v116, s[8:11], s24 offen offset:0
    buffer_load_dwordx4 a[68:71], v116, s[8:11], s24 offen offset:1024
    buffer_load_dwordx4 a[72:75], v116, s[8:11], s24 offen offset:2048
    buffer_load_dwordx4 a[76:79], v116, s[8:11], s24 offen offset:3072
    s_waitcnt lgkmcnt(6)
    v_mfma_f32_32x32x16_bf16 v[36:51], v[92:95], a[8:11], v[36:51]
    ds_read_b64_tr_b16 v[92:93], v118 offset:8192
    ds_read_b64_tr_b16 v[94:95], v118 offset:9216
    s_mov_b32 s25, 655360
    s_add_u32 m0, s23, 90112
    s_nop 0
    buffer_load_dwordx4 v121, s[12:15], s25 offen lds
    s_add_u32 m0, s23, 91136
    s_nop 0
    buffer_load_dwordx4 v122, s[12:15], s25 offen lds
    s_waitcnt lgkmcnt(6)
    v_mfma_f32_32x32x16_bf16 v[52:67], v[96:99], a[8:11], v[52:67]
    ds_read_b64_tr_b16 v[96:97], v118 offset:8704
    ds_read_b64_tr_b16 v[98:99], v118 offset:9728
    s_mov_b32 s24, 20480
    buffer_load_dwordx4 a[80:83], v116, s[8:11], s24 offen offset:0
    buffer_load_dwordx4 a[84:87], v116, s[8:11], s24 offen offset:1024
    buffer_load_dwordx4 a[88:91], v116, s[8:11], s24 offen offset:2048
    buffer_load_dwordx4 a[92:95], v116, s[8:11], s24 offen offset:3072
    s_mov_b32 s25, 786432
    s_add_u32 m0, s23, 106496
    s_nop 0
    buffer_load_dwordx4 v121, s[12:15], s25 offen lds
    s_add_u32 m0, s23, 107520
    s_nop 0
    buffer_load_dwordx4 v122, s[12:15], s25 offen lds
    s_waitcnt lgkmcnt(6)
    v_mfma_f32_32x32x16_bf16 v[36:51], v[108:111], a[12:15], v[36:51]
    ds_read_b64_tr_b16 v[108:109], v118 offset:10240
    ds_read_b64_tr_b16 v[110:111], v118 offset:11264
    s_mov_b32 s24, 24576
    buffer_load_dwordx4 a[96:99], v116, s[8:11], s24 offen offset:0
    buffer_load_dwordx4 a[100:103], v116, s[8:11], s24 offen offset:1024
    s_waitcnt lgkmcnt(6)
    v_mfma_f32_32x32x16_bf16 v[52:67], v[112:115], a[12:15], v[52:67]
    ds_read_b64_tr_b16 v[112:113], v118 offset:10752
    ds_read_b64_tr_b16 v[114:115], v118 offset:11776
    buffer_load_dwordx4 a[104:107], v116, s[8:11], s24 offen offset:2048
    buffer_load_dwordx4 a[108:111], v116, s[8:11], s24 offen offset:3072
    s_mov_b32 s25, 917504
    s_add_u32 m0, s23, 122880
    s_nop 0
    buffer_load_dwordx4 v121, s[12:15], s25 offen lds
    s_add_u32 m0, s23, 123904
    s_nop 0
    buffer_load_dwordx4 v122, s[12:15], s25 offen lds
    s_mov_b32 s24, 28672
    buffer_load_dwordx4 a[112:115], v116, s[8:11], s24 offen offset:0
    buffer_load_dwordx4 a[116:119], v116, s[8:11], s24 offen offset:1024
    s_waitcnt lgkmcnt(6)
    s_waitcnt vmcnt(41)
    v_mfma_f32_32x32x16_bf16 v[36:51], v[92:95], a[16:19], v[36:51]
    ds_read_b64_tr_b16 v[92:93], v118 offset:12288
    ds_read_b64_tr_b16 v[94:95], v118 offset:13312
    buffer_load_dwordx4 a[120:123], v116, s[8:11], s24 offen offset:2048
    buffer_load_dwordx4 a[124:127], v116, s[8:11], s24 offen offset:3072
    s_waitcnt vmcnt(36)
    v_lshlrev_b32 v4, 16, v68
    v_and_b32 v5, 0xffff0000, v68
    s_waitcnt lgkmcnt(6)
    v_mfma_f32_32x32x16_bf16 v[52:67], v[96:99], a[16:19], v[52:67]
    ds_read_b64_tr_b16 v[96:97], v118 offset:12800
    ds_read_b64_tr_b16 v[98:99], v118 offset:13824
    s_mov_b32 s24, 32768
    buffer_load_dwordx4 a[128:131], v116, s[8:11], s24 offen offset:0
    buffer_load_dwordx4 a[132:135], v116, s[8:11], s24 offen offset:1024
    v_lshlrev_b32 v6, 16, v69
    v_and_b32 v7, 0xffff0000, v69
    buffer_load_dwordx4 a[136:139], v116, s[8:11], s24 offen offset:2048
    buffer_load_dwordx4 a[140:143], v116, s[8:11], s24 offen offset:3072
    s_mov_b32 s24, 36864
    buffer_load_dwordx4 a[144:147], v116, s[8:11], s24 offen offset:0
    buffer_load_dwordx4 a[148:151], v116, s[8:11], s24 offen offset:1024
    s_waitcnt lgkmcnt(6)
    v_mfma_f32_32x32x16_bf16 v[36:51], v[108:111], a[20:23], v[36:51]
    ds_read_b64_tr_b16 v[108:109], v118 offset:14336
    ds_read_b64_tr_b16 v[110:111], v118 offset:15360
    buffer_load_dwordx4 a[152:155], v116, s[8:11], s24 offen offset:2048
    buffer_load_dwordx4 a[156:159], v116, s[8:11], s24 offen offset:3072
    v_lshlrev_b32 v8, 16, v70
    v_and_b32 v9, 0xffff0000, v70
    s_waitcnt lgkmcnt(6)
    v_mfma_f32_32x32x16_bf16 v[52:67], v[112:115], a[20:23], v[52:67]
    ds_read_b64_tr_b16 v[112:113], v118 offset:14848
    ds_read_b64_tr_b16 v[114:115], v118 offset:15872
    s_mov_b32 s24, 40960
    buffer_load_dwordx4 a[160:163], v116, s[8:11], s24 offen offset:0
    buffer_load_dwordx4 a[164:167], v116, s[8:11], s24 offen offset:1024
    v_lshlrev_b32 v10, 16, v71
    v_and_b32 v11, 0xffff0000, v71
    s_waitcnt vmcnt(44)
    s_barrier
    v_add_u32 v118, 32768, v117
    buffer_load_dwordx4 a[168:171], v116, s[8:11], s24 offen offset:2048
    buffer_load_dwordx4 a[172:175], v116, s[8:11], s24 offen offset:3072
    s_mov_b32 s24, 45056
    buffer_load_dwordx4 a[176:179], v116, s[8:11], s24 offen offset:0
    buffer_load_dwordx4 a[180:183], v116, s[8:11], s24 offen offset:1024
    s_waitcnt lgkmcnt(6)
    v_mfma_f32_32x32x16_bf16 v[36:51], v[92:95], a[24:27], v[36:51]
    ds_read_b64_tr_b16 v[92:93], v118 offset:8192
    ds_read_b64_tr_b16 v[94:95], v118 offset:9216
    buffer_load_dwordx4 a[184:187], v116, s[8:11], s24 offen offset:2048
    buffer_load_dwordx4 a[188:191], v116, s[8:11], s24 offen offset:3072
    v_lshlrev_b32 v12, 16, v72
    v_and_b32 v13, 0xffff0000, v72
    s_waitcnt lgkmcnt(6)
    v_mfma_f32_32x32x16_bf16 v[52:67], v[96:99], a[24:27], v[52:67]
    ds_read_b64_tr_b16 v[96:97], v118 offset:8704
    ds_read_b64_tr_b16 v[98:99], v118 offset:9728
    s_mov_b32 s24, 49152
    buffer_load_dwordx4 a[192:195], v116, s[8:11], s24 offen offset:0
    buffer_load_dwordx4 a[196:199], v116, s[8:11], s24 offen offset:1024
    v_lshlrev_b32 v14, 16, v73
    v_and_b32 v15, 0xffff0000, v73
    buffer_load_dwordx4 a[200:203], v116, s[8:11], s24 offen offset:2048
    buffer_load_dwordx4 a[204:207], v116, s[8:11], s24 offen offset:3072
    s_mov_b32 s24, 53248
    buffer_load_dwordx4 a[208:211], v116, s[8:11], s24 offen offset:0
    buffer_load_dwordx4 a[212:215], v116, s[8:11], s24 offen offset:1024
    s_waitcnt lgkmcnt(6)
    v_mfma_f32_32x32x16_bf16 v[36:51], v[108:111], a[28:31], v[36:51]
    ds_read_b64_tr_b16 v[108:109], v118 offset:10240
    ds_read_b64_tr_b16 v[110:111], v118 offset:11264
    buffer_load_dwordx4 a[216:219], v116, s[8:11], s24 offen offset:2048
    buffer_load_dwordx4 a[220:223], v116, s[8:11], s24 offen offset:3072
    v_lshlrev_b32 v16, 16, v74
    v_and_b32 v17, 0xffff0000, v74
    s_waitcnt lgkmcnt(6)
    v_mfma_f32_32x32x16_bf16 v[52:67], v[112:115], a[28:31], v[52:67]
    ds_read_b64_tr_b16 v[112:113], v118 offset:10752
    ds_read_b64_tr_b16 v[114:115], v118 offset:11776
    v_lshlrev_b32 v18, 16, v75
    v_and_b32 v19, 0xffff0000, v75
    s_mov_b32 s25, 1048576
    s_add_u32 m0, s23, 139264
    s_nop 0
    buffer_load_dwordx4 v121, s[12:15], s25 offen lds
    s_add_u32 m0, s23, 140288
    s_nop 0
    buffer_load_dwordx4 v122, s[12:15], s25 offen lds
    s_waitcnt lgkmcnt(6)
    s_waitcnt vmcnt(59)
    v_mfma_f32_32x32x16_bf16 v[36:51], v[92:95], a[32:35], v[36:51]
    ds_read_b64_tr_b16 v[92:93], v118 offset:12288
    ds_read_b64_tr_b16 v[94:95], v118 offset:13312
    s_mov_b32 s25, 1179648
    s_add_u32 m0, s23, 8192
    s_nop 0
    buffer_load_dwordx4 v121, s[12:15], s25 offen lds
    s_add_u32 m0, s23, 9216
    s_nop 0
    s_waitcnt vmcnt(52)
    buffer_load_dwordx4 v122, s[12:15], s25 offen lds
    v_lshlrev_b32 v20, 16, v76
    v_and_b32 v21, 0xffff0000, v76
    s_waitcnt lgkmcnt(6)
    v_mfma_f32_32x32x16_bf16 v[52:67], v[96:99], a[32:35], v[52:67]
    ds_read_b64_tr_b16 v[96:97], v118 offset:12800
    ds_read_b64_tr_b16 v[98:99], v118 offset:13824
    v_lshlrev_b32 v22, 16, v77
    v_and_b32 v23, 0xffff0000, v77
    s_waitcnt lgkmcnt(6)
    v_mfma_f32_32x32x16_bf16 v[36:51], v[108:111], a[36:39], v[36:51]
    ds_read_b64_tr_b16 v[108:109], v118 offset:14336
    ds_read_b64_tr_b16 v[110:111], v118 offset:15360
    v_lshlrev_b32 v24, 16, v78
    v_and_b32 v25, 0xffff0000, v78
    s_waitcnt lgkmcnt(6)
    v_mfma_f32_32x32x16_bf16 v[52:67], v[112:115], a[36:39], v[52:67]
    ds_read_b64_tr_b16 v[112:113], v118 offset:14848
    ds_read_b64_tr_b16 v[114:115], v118 offset:15872
    v_lshlrev_b32 v26, 16, v79
    v_and_b32 v27, 0xffff0000, v79
    s_barrier
    v_add_u32 v118, 49152, v117
    s_mov_b32 s25, 1310720
    s_add_u32 m0, s23, 24576
    s_nop 0
    buffer_load_dwordx4 v121, s[12:15], s25 offen lds
    s_add_u32 m0, s23, 25600
    s_nop 0
    buffer_load_dwordx4 v122, s[12:15], s25 offen lds
    s_waitcnt lgkmcnt(6)
    v_mfma_f32_32x32x16_bf16 v[36:51], v[92:95], a[40:43], v[36:51]
    ds_read_b64_tr_b16 v[92:93], v118 offset:8192
    ds_read_b64_tr_b16 v[94:95], v118 offset:9216
    v_lshlrev_b32 v28, 16, v80
    v_and_b32 v29, 0xffff0000, v80
    s_waitcnt lgkmcnt(6)
    v_mfma_f32_32x32x16_bf16 v[52:67], v[96:99], a[40:43], v[52:67]
    ds_read_b64_tr_b16 v[96:97], v118 offset:8704
    ds_read_b64_tr_b16 v[98:99], v118 offset:9728
    v_lshlrev_b32 v30, 16, v81
    v_and_b32 v31, 0xffff0000, v81
    s_waitcnt lgkmcnt(6)
    v_mfma_f32_32x32x16_bf16 v[36:51], v[108:111], a[44:47], v[36:51]
    ds_read_b64_tr_b16 v[108:109], v118 offset:10240
    ds_read_b64_tr_b16 v[110:111], v118 offset:11264
    v_lshlrev_b32 v32, 16, v82
    v_and_b32 v33, 0xffff0000, v82
    s_waitcnt lgkmcnt(6)
    v_mfma_f32_32x32x16_bf16 v[52:67], v[112:115], a[44:47], v[52:67]
    ds_read_b64_tr_b16 v[112:113], v118 offset:10752
    ds_read_b64_tr_b16 v[114:115], v118 offset:11776
    v_lshlrev_b32 v34, 16, v83
    v_and_b32 v35, 0xffff0000, v83
    s_waitcnt lgkmcnt(6)
    v_mfma_f32_32x32x16_bf16 v[36:51], v[92:95], a[48:51], v[36:51]
    ds_read_b64_tr_b16 v[92:93], v118 offset:12288
    ds_read_b64_tr_b16 v[94:95], v118 offset:13312
    s_waitcnt lgkmcnt(6)
    v_mfma_f32_32x32x16_bf16 v[52:67], v[96:99], a[48:51], v[52:67]
    ds_read_b64_tr_b16 v[96:97], v118 offset:12800
    ds_read_b64_tr_b16 v[98:99], v118 offset:13824
    s_waitcnt lgkmcnt(6)
    v_mfma_f32_32x32x16_bf16 v[36:51], v[108:111], a[52:55], v[36:51]
    ds_read_b64_tr_b16 v[108:109], v118 offset:14336
    ds_read_b64_tr_b16 v[110:111], v118 offset:15360
    s_waitcnt lgkmcnt(6)
    v_mfma_f32_32x32x16_bf16 v[52:67], v[112:115], a[52:55], v[52:67]
    ds_read_b64_tr_b16 v[112:113], v118 offset:14848
    ds_read_b64_tr_b16 v[114:115], v118 offset:15872
    s_waitcnt vmcnt(52)
    s_barrier
    v_add_u32 v118, 65536, v117
    s_mov_b32 s25, 1441792
    s_add_u32 m0, s23, 40960
    s_nop 0
    buffer_load_dwordx4 v121, s[12:15], s25 offen lds
    s_add_u32 m0, s23, 41984
    s_nop 0
    buffer_load_dwordx4 v122, s[12:15], s25 offen lds
    s_waitcnt lgkmcnt(6)
    v_mfma_f32_32x32x16_bf16 v[36:51], v[92:95], a[56:59], v[36:51]
    ds_read_b64_tr_b16 v[92:93], v118 offset:8192
    ds_read_b64_tr_b16 v[94:95], v118 offset:9216
    s_waitcnt lgkmcnt(6)
    v_mfma_f32_32x32x16_bf16 v[52:67], v[96:99], a[56:59], v[52:67]
    ds_read_b64_tr_b16 v[96:97], v118 offset:8704
    ds_read_b64_tr_b16 v[98:99], v118 offset:9728
    s_waitcnt lgkmcnt(6)
    v_mfma_f32_32x32x16_bf16 v[36:51], v[108:111], a[60:63], v[36:51]
    ds_read_b64_tr_b16 v[108:109], v118 offset:10240
    ds_read_b64_tr_b16 v[110:111], v118 offset:11264
    s_waitcnt lgkmcnt(6)
    v_mfma_f32_32x32x16_bf16 v[52:67], v[112:115], a[60:63], v[52:67]
    ds_read_b64_tr_b16 v[112:113], v118 offset:10752
    ds_read_b64_tr_b16 v[114:115], v118 offset:11776
    s_waitcnt lgkmcnt(6)
    s_waitcnt vmcnt(53)
    v_mfma_f32_32x32x16_bf16 v[36:51], v[92:95], a[64:67], v[36:51]
    ds_read_b64_tr_b16 v[92:93], v118 offset:12288
    ds_read_b64_tr_b16 v[94:95], v118 offset:13312
    s_waitcnt lgkmcnt(6)
    v_mfma_f32_32x32x16_bf16 v[52:67], v[96:99], a[64:67], v[52:67]
    ds_read_b64_tr_b16 v[96:97], v118 offset:12800
    ds_read_b64_tr_b16 v[98:99], v118 offset:13824
    s_waitcnt lgkmcnt(6)
    s_waitcnt vmcnt(52)
    v_mfma_f32_32x32x16_bf16 v[36:51], v[108:111], a[68:71], v[36:51]
    ds_read_b64_tr_b16 v[108:109], v118 offset:14336
    ds_read_b64_tr_b16 v[110:111], v118 offset:15360
    s_waitcnt lgkmcnt(6)
    v_mfma_f32_32x32x16_bf16 v[52:67], v[112:115], a[68:71], v[52:67]
    ds_read_b64_tr_b16 v[112:113], v118 offset:14848
    ds_read_b64_tr_b16 v[114:115], v118 offset:15872
    s_waitcnt vmcnt(48)
    s_barrier
    v_add_u32 v118, 81920, v117
    s_mov_b32 s25, 1572864
    s_add_u32 m0, s23, 57344
    s_nop 0
    buffer_load_dwordx4 v121, s[12:15], s25 offen lds
    s_add_u32 m0, s23, 58368
    s_nop 0
    buffer_load_dwordx4 v122, s[12:15], s25 offen lds
    s_waitcnt lgkmcnt(6)
    v_mfma_f32_32x32x16_bf16 v[36:51], v[92:95], a[72:75], v[36:51]
    ds_read_b64_tr_b16 v[92:93], v118 offset:8192
    ds_read_b64_tr_b16 v[94:95], v118 offset:9216
    s_waitcnt lgkmcnt(6)
    v_mfma_f32_32x32x16_bf16 v[52:67], v[96:99], a[72:75], v[52:67]
    ds_read_b64_tr_b16 v[96:97], v118 offset:8704
    ds_read_b64_tr_b16 v[98:99], v118 offset:9728
    s_waitcnt lgkmcnt(6)
    v_mfma_f32_32x32x16_bf16 v[36:51], v[108:111], a[76:79], v[36:51]
    ds_read_b64_tr_b16 v[108:109], v118 offset:10240
    ds_read_b64_tr_b16 v[110:111], v118 offset:11264
    s_waitcnt lgkmcnt(6)
    v_mfma_f32_32x32x16_bf16 v[52:67], v[112:115], a[76:79], v[52:67]
    ds_read_b64_tr_b16 v[112:113], v118 offset:10752
    ds_read_b64_tr_b16 v[114:115], v118 offset:11776
    s_waitcnt lgkmcnt(6)
    s_waitcnt vmcnt(49)
    v_mfma_f32_32x32x16_bf16 v[36:51], v[92:95], a[80:83], v[36:51]
    ds_read_b64_tr_b16 v[92:93], v118 offset:12288
    ds_read_b64_tr_b16 v[94:95], v118 offset:13312
    s_waitcnt lgkmcnt(6)
    v_mfma_f32_32x32x16_bf16 v[52:67], v[96:99], a[80:83], v[52:67]
    ds_read_b64_tr_b16 v[96:97], v118 offset:12800
    ds_read_b64_tr_b16 v[98:99], v118 offset:13824
    s_waitcnt lgkmcnt(6)
    s_waitcnt vmcnt(48)
    v_mfma_f32_32x32x16_bf16 v[36:51], v[108:111], a[84:87], v[36:51]
    ds_read_b64_tr_b16 v[108:109], v118 offset:14336
    ds_read_b64_tr_b16 v[110:111], v118 offset:15360
    s_waitcnt lgkmcnt(6)
    v_mfma_f32_32x32x16_bf16 v[52:67], v[112:115], a[84:87], v[52:67]
    ds_read_b64_tr_b16 v[112:113], v118 offset:14848
    ds_read_b64_tr_b16 v[114:115], v118 offset:15872
    s_waitcnt vmcnt(44)
    s_barrier
    v_add_u32 v118, 98304, v117
    s_mov_b32 s25, 0
    s_add_u32 m0, s23, 131072
    s_nop 0
    buffer_load_dwordx4 v119, s[12:15], s25 offen lds
    s_add_u32 m0, s23, 132096
    s_nop 0
    buffer_load_dwordx4 v120, s[12:15], s25 offen lds
    s_mov_b32 s25, 1703936
    s_add_u32 m0, s23, 73728
    s_nop 0
    buffer_load_dwordx4 v121, s[12:15], s25 offen lds
    s_add_u32 m0, s23, 74752
    s_nop 0
    buffer_load_dwordx4 v122, s[12:15], s25 offen lds
    s_waitcnt lgkmcnt(6)
    v_mfma_f32_32x32x16_bf16 v[36:51], v[92:95], a[88:91], v[36:51]
    ds_read_b64_tr_b16 v[92:93], v118 offset:8192
    ds_read_b64_tr_b16 v[94:95], v118 offset:9216
    s_waitcnt lgkmcnt(6)
    v_mfma_f32_32x32x16_bf16 v[52:67], v[96:99], a[88:91], v[52:67]
    ds_read_b64_tr_b16 v[96:97], v118 offset:8704
    ds_read_b64_tr_b16 v[98:99], v118 offset:9728
    s_waitcnt lgkmcnt(6)
    v_mfma_f32_32x32x16_bf16 v[36:51], v[108:111], a[92:95], v[36:51]
    ds_read_b64_tr_b16 v[108:109], v118 offset:10240
    ds_read_b64_tr_b16 v[110:111], v118 offset:11264
    s_waitcnt lgkmcnt(6)
    v_mfma_f32_32x32x16_bf16 v[52:67], v[112:115], a[92:95], v[52:67]
    ds_read_b64_tr_b16 v[112:113], v118 offset:10752
    ds_read_b64_tr_b16 v[114:115], v118 offset:11776
    s_waitcnt lgkmcnt(6)
    s_waitcnt vmcnt(47)
    v_mfma_f32_32x32x16_bf16 v[36:51], v[92:95], a[96:99], v[36:51]
    ds_read_b64_tr_b16 v[92:93], v118 offset:12288
    ds_read_b64_tr_b16 v[94:95], v118 offset:13312
    s_waitcnt lgkmcnt(6)
    v_mfma_f32_32x32x16_bf16 v[52:67], v[96:99], a[96:99], v[52:67]
    ds_read_b64_tr_b16 v[96:97], v118 offset:12800
    ds_read_b64_tr_b16 v[98:99], v118 offset:13824
    s_waitcnt lgkmcnt(6)
    s_waitcnt vmcnt(46)
    v_mfma_f32_32x32x16_bf16 v[36:51], v[108:111], a[100:103], v[36:51]
    ds_read_b64_tr_b16 v[108:109], v118 offset:14336
    ds_read_b64_tr_b16 v[110:111], v118 offset:15360
    s_waitcnt lgkmcnt(6)
    v_mfma_f32_32x32x16_bf16 v[52:67], v[112:115], a[100:103], v[52:67]
    ds_read_b64_tr_b16 v[112:113], v118 offset:14848
    ds_read_b64_tr_b16 v[114:115], v118 offset:15872
    s_waitcnt vmcnt(42)
    s_barrier
    v_add_u32 v118, 114688, v117
    s_mov_b32 s25, 131072
    s_add_u32 m0, s23, 0
    s_nop 0
    buffer_load_dwordx4 v119, s[12:15], s25 offen lds
    s_add_u32 m0, s23, 1024
    s_nop 0
    buffer_load_dwordx4 v120, s[12:15], s25 offen lds
    s_mov_b32 s25, 1835008
    s_add_u32 m0, s23, 90112
    s_nop 0
    buffer_load_dwordx4 v121, s[12:15], s25 offen lds
    s_add_u32 m0, s23, 91136
    s_nop 0
    buffer_load_dwordx4 v122, s[12:15], s25 offen lds
    s_waitcnt lgkmcnt(6)
    v_mfma_f32_32x32x16_bf16 v[36:51], v[92:95], a[104:107], v[36:51]
    ds_read_b64_tr_b16 v[92:93], v118 offset:8192
    ds_read_b64_tr_b16 v[94:95], v118 offset:9216
    s_waitcnt lgkmcnt(6)
    v_mfma_f32_32x32x16_bf16 v[52:67], v[96:99], a[104:107], v[52:67]
    ds_read_b64_tr_b16 v[96:97], v118 offset:8704
    ds_read_b64_tr_b16 v[98:99], v118 offset:9728
    s_waitcnt lgkmcnt(6)
    v_mfma_f32_32x32x16_bf16 v[36:51], v[108:111], a[108:111], v[36:51]
    ds_read_b64_tr_b16 v[108:109], v118 offset:10240
    ds_read_b64_tr_b16 v[110:111], v118 offset:11264
    s_waitcnt lgkmcnt(6)
    v_mfma_f32_32x32x16_bf16 v[52:67], v[112:115], a[108:111], v[52:67]
    ds_read_b64_tr_b16 v[112:113], v118 offset:10752
    ds_read_b64_tr_b16 v[114:115], v118 offset:11776
    s_waitcnt lgkmcnt(6)
    s_waitcnt vmcnt(45)
    v_mfma_f32_32x32x16_bf16 v[36:51], v[92:95], a[112:115], v[36:51]
    ds_read_b64_tr_b16 v[92:93], v118 offset:12288
    ds_read_b64_tr_b16 v[94:95], v118 offset:13312
    s_waitcnt lgkmcnt(6)
    v_mfma_f32_32x32x16_bf16 v[52:67], v[96:99], a[112:115], v[52:67]
    ds_read_b64_tr_b16 v[96:97], v118 offset:12800
    ds_read_b64_tr_b16 v[98:99], v118 offset:13824
    s_waitcnt lgkmcnt(6)
    s_waitcnt vmcnt(44)
    v_mfma_f32_32x32x16_bf16 v[36:51], v[108:111], a[116:119], v[36:51]
    ds_read_b64_tr_b16 v[108:109], v118 offset:14336
    ds_read_b64_tr_b16 v[110:111], v118 offset:15360
    s_waitcnt lgkmcnt(6)
    v_mfma_f32_32x32x16_bf16 v[52:67], v[112:115], a[116:119], v[52:67]
    ds_read_b64_tr_b16 v[112:113], v118 offset:14848
    ds_read_b64_tr_b16 v[114:115], v118 offset:15872
    s_waitcnt vmcnt(6)
    s_barrier
    v_add_u32 v118, 131072, v117
    ds_read_b64_tr_b16 v[84:85], v118 offset:0
    ds_read_b64_tr_b16 v[86:87], v118 offset:1024
    s_mov_b32 s25, 262144
    s_add_u32 m0, s23, 16384
    s_nop 0
    buffer_load_dwordx4 v119, s[12:15], s25 offen lds
    s_add_u32 m0, s23, 17408
    s_nop 0
    buffer_load_dwordx4 v120, s[12:15], s25 offen lds
    ds_read_b64_tr_b16 v[88:89], v118 offset:512
    ds_read_b64_tr_b16 v[90:91], v118 offset:1536
    s_mov_b32 s25, 1966080
    s_add_u32 m0, s23, 106496
    s_nop 0
    buffer_load_dwordx4 v121, s[12:15], s25 offen lds
    s_add_u32 m0, s23, 107520
    s_nop 0
    buffer_load_dwordx4 v122, s[12:15], s25 offen lds
    s_waitcnt lgkmcnt(10)
    v_mfma_f32_32x32x16_bf16 v[36:51], v[92:95], a[120:123], v[36:51]
    ds_read_b64_tr_b16 v[92:93], v118 offset:8192
    ds_read_b64_tr_b16 v[94:95], v118 offset:9216
    s_waitcnt lgkmcnt(10)
    v_mfma_f32_32x32x16_bf16 v[52:67], v[96:99], a[120:123], v[52:67]
    ds_read_b64_tr_b16 v[96:97], v118 offset:8704
    ds_read_b64_tr_b16 v[98:99], v118 offset:9728
    ds_read_b64_tr_b16 v[100:101], v118 offset:2048
    ds_read_b64_tr_b16 v[102:103], v118 offset:3072
    ds_read_b64_tr_b16 v[104:105], v118 offset:2560
    ds_read_b64_tr_b16 v[106:107], v118 offset:3584
    s_waitcnt lgkmcnt(14)
    v_mfma_f32_32x32x16_bf16 v[36:51], v[108:111], a[124:127], v[36:51]
    ds_read_b64_tr_b16 v[108:109], v118 offset:10240
    ds_read_b64_tr_b16 v[110:111], v118 offset:11264
    s_waitcnt lgkmcnt(14)
    v_mfma_f32_32x32x16_bf16 v[52:67], v[112:115], a[124:127], v[52:67]
    ds_read_b64_tr_b16 v[112:113], v118 offset:10752
    ds_read_b64_tr_b16 v[114:115], v118 offset:11776
    s_waitcnt lgkmcnt(14)
    v_mfma_f32_32x32x16_bf16 v[4:19], v[84:87], a[0:3], v[4:19]
    ds_read_b64_tr_b16 v[84:85], v118 offset:4096
    ds_read_b64_tr_b16 v[86:87], v118 offset:5120
    s_waitcnt lgkmcnt(14)
    v_mfma_f32_32x32x16_bf16 v[20:35], v[88:91], a[0:3], v[20:35]
    ds_read_b64_tr_b16 v[88:89], v118 offset:4608
    ds_read_b64_tr_b16 v[90:91], v118 offset:5632
    s_waitcnt lgkmcnt(14)
    v_mfma_f32_32x32x16_bf16 v[36:51], v[92:95], a[128:131], v[36:51]
    ds_read_b64_tr_b16 v[92:93], v118 offset:12288
    ds_read_b64_tr_b16 v[94:95], v118 offset:13312
    s_waitcnt lgkmcnt(14)
    v_mfma_f32_32x32x16_bf16 v[52:67], v[96:99], a[128:131], v[52:67]
    ds_read_b64_tr_b16 v[96:97], v118 offset:12800
    ds_read_b64_tr_b16 v[98:99], v118 offset:13824
    s_waitcnt lgkmcnt(14)
    v_mfma_f32_32x32x16_bf16 v[4:19], v[100:103], a[4:7], v[4:19]
    ds_read_b64_tr_b16 v[100:101], v118 offset:6144
    ds_read_b64_tr_b16 v[102:103], v118 offset:7168
    s_mov_b32 s24, 57344
    buffer_load_dwordx4 a[0:3], v116, s[8:11], s24 offen offset:0
    s_waitcnt lgkmcnt(14)
    v_mfma_f32_32x32x16_bf16 v[20:35], v[104:107], a[4:7], v[20:35]
    ds_read_b64_tr_b16 v[104:105], v118 offset:6656
    ds_read_b64_tr_b16 v[106:107], v118 offset:7680
    s_waitcnt lgkmcnt(14)
    v_mfma_f32_32x32x16_bf16 v[36:51], v[108:111], a[132:135], v[36:51]
    ds_read_b64_tr_b16 v[108:109], v118 offset:14336
    ds_read_b64_tr_b16 v[110:111], v118 offset:15360
    s_waitcnt lgkmcnt(14)
    v_mfma_f32_32x32x16_bf16 v[52:67], v[112:115], a[132:135], v[52:67]
    ds_read_b64_tr_b16 v[112:113], v118 offset:14848
    ds_read_b64_tr_b16 v[114:115], v118 offset:15872
    s_waitcnt lgkmcnt(14)
    v_mfma_f32_32x32x16_bf16 v[4:19], v[84:87], a[8:11], v[4:19]
    s_waitcnt vmcnt(7)
    s_barrier
    v_add_u32 v118, 0, v117
    ds_read_b64_tr_b16 v[84:85], v118 offset:0
    ds_read_b64_tr_b16 v[86:87], v118 offset:1024
    buffer_load_dwordx4 a[4:7], v116, s[8:11], s24 offen offset:1024
    s_mov_b32 s25, 393216
    s_add_u32 m0, s23, 32768
    s_nop 0
    buffer_load_dwordx4 v119, s[12:15], s25 offen lds
    s_waitcnt lgkmcnt(14)
    v_mfma_f32_32x32x16_bf16 v[20:35], v[88:91], a[8:11], v[20:35]
    ds_read_b64_tr_b16 v[88:89], v118 offset:512
    ds_read_b64_tr_b16 v[90:91], v118 offset:1536
    s_add_u32 m0, s23, 33792
    s_nop 0
    buffer_load_dwordx4 v120, s[12:15], s25 offen lds
    s_mov_b32 s25, 2097152
    s_add_u32 m0, s23, 122880
    s_nop 0
    buffer_load_dwordx4 v121, s[12:15], s25 offen lds
    s_waitcnt lgkmcnt(14)
    v_mfma_f32_32x32x16_bf16 v[36:51], v[92:95], a[136:139], v[36:51]
    ds_read_b64_tr_b16 v[92:93], v118 offset:8192
    ds_read_b64_tr_b16 v[94:95], v118 offset:9216
    s_add_u32 m0, s23, 123904
    s_nop 0
    buffer_load_dwordx4 v122, s[12:15], s25 offen lds
    s_waitcnt lgkmcnt(14)
    v_mfma_f32_32x32x16_bf16 v[52:67], v[96:99], a[136:139], v[52:67]
    ds_read_b64_tr_b16 v[96:97], v118 offset:8704
    ds_read_b64_tr_b16 v[98:99], v118 offset:9728
    s_waitcnt lgkmcnt(14)
    v_mfma_f32_32x32x16_bf16 v[4:19], v[100:103], a[12:15], v[4:19]
    ds_read_b64_tr_b16 v[100:101], v118 offset:2048
    ds_read_b64_tr_b16 v[102:103], v118 offset:3072
    buffer_load_dwordx4 a[8:11], v116, s[8:11], s24 offen offset:2048
    s_waitcnt lgkmcnt(14)
    v_mfma_f32_32x32x16_bf16 v[20:35], v[104:107], a[12:15], v[20:35]
    ds_read_b64_tr_b16 v[104:105], v118 offset:2560
    ds_read_b64_tr_b16 v[106:107], v118 offset:3584
    s_waitcnt lgkmcnt(14)
    v_mfma_f32_32x32x16_bf16 v[36:51], v[108:111], a[140:143], v[36:51]
    ds_read_b64_tr_b16 v[108:109], v118 offset:10240
    ds_read_b64_tr_b16 v[110:111], v118 offset:11264
    s_waitcnt lgkmcnt(14)
    v_mfma_f32_32x32x16_bf16 v[52:67], v[112:115], a[140:143], v[52:67]
    ds_read_b64_tr_b16 v[112:113], v118 offset:10752
    ds_read_b64_tr_b16 v[114:115], v118 offset:11776
    s_waitcnt lgkmcnt(14)
    v_mfma_f32_32x32x16_bf16 v[4:19], v[84:87], a[16:19], v[4:19]
    ds_read_b64_tr_b16 v[84:85], v118 offset:4096
    ds_read_b64_tr_b16 v[86:87], v118 offset:5120
    buffer_load_dwordx4 a[12:15], v116, s[8:11], s24 offen offset:3072
    s_waitcnt lgkmcnt(14)
    v_mfma_f32_32x32x16_bf16 v[20:35], v[88:91], a[16:19], v[20:35]
    ds_read_b64_tr_b16 v[88:89], v118 offset:4608
    ds_read_b64_tr_b16 v[90:91], v118 offset:5632
    s_waitcnt lgkmcnt(14)
    v_mfma_f32_32x32x16_bf16 v[36:51], v[92:95], a[144:147], v[36:51]
    ds_read_b64_tr_b16 v[92:93], v118 offset:12288
    ds_read_b64_tr_b16 v[94:95], v118 offset:13312
    s_waitcnt lgkmcnt(14)
    v_mfma_f32_32x32x16_bf16 v[52:67], v[96:99], a[144:147], v[52:67]
    ds_read_b64_tr_b16 v[96:97], v118 offset:12800
    ds_read_b64_tr_b16 v[98:99], v118 offset:13824
    s_waitcnt lgkmcnt(14)
    v_mfma_f32_32x32x16_bf16 v[4:19], v[100:103], a[20:23], v[4:19]
    ds_read_b64_tr_b16 v[100:101], v118 offset:6144
    ds_read_b64_tr_b16 v[102:103], v118 offset:7168
    s_mov_b32 s24, 61440
    buffer_load_dwordx4 a[16:19], v116, s[8:11], s24 offen offset:0
    s_waitcnt lgkmcnt(14)
    v_mfma_f32_32x32x16_bf16 v[20:35], v[104:107], a[20:23], v[20:35]
    ds_read_b64_tr_b16 v[104:105], v118 offset:6656
    ds_read_b64_tr_b16 v[106:107], v118 offset:7680
    s_waitcnt lgkmcnt(14)
    v_mfma_f32_32x32x16_bf16 v[36:51], v[108:111], a[148:151], v[36:51]
    ds_read_b64_tr_b16 v[108:109], v118 offset:14336
    ds_read_b64_tr_b16 v[110:111], v118 offset:15360
    s_waitcnt lgkmcnt(14)
    v_mfma_f32_32x32x16_bf16 v[52:67], v[112:115], a[148:151], v[52:67]
    ds_read_b64_tr_b16 v[112:113], v118 offset:14848
    ds_read_b64_tr_b16 v[114:115], v118 offset:15872
    s_waitcnt lgkmcnt(14)
    v_mfma_f32_32x32x16_bf16 v[4:19], v[84:87], a[24:27], v[4:19]
    s_waitcnt vmcnt(11)
    s_barrier
    v_add_u32 v118, 16384, v117
    ds_read_b64_tr_b16 v[84:85], v118 offset:0
    ds_read_b64_tr_b16 v[86:87], v118 offset:1024
    buffer_load_dwordx4 a[20:23], v116, s[8:11], s24 offen offset:1024
    s_mov_b32 s25, 524288
    s_add_u32 m0, s23, 49152
    s_nop 0
    buffer_load_dwordx4 v119, s[12:15], s25 offen lds
    s_waitcnt lgkmcnt(14)
    v_mfma_f32_32x32x16_bf16 v[20:35], v[88:91], a[24:27], v[20:35]
    ds_read_b64_tr_b16 v[88:89], v118 offset:512
    ds_read_b64_tr_b16 v[90:91], v118 offset:1536
    s_add_u32 m0, s23, 50176
    s_nop 0
    buffer_load_dwordx4 v120, s[12:15], s25 offen lds
    s_mov_b32 s25, 2228224
    s_add_u32 m0, s23, 139264
    s_nop 0
    buffer_load_dwordx4 v121, s[12:15], s25 offen lds
    s_waitcnt lgkmcnt(14)
    v_mfma_f32_32x32x16_bf16 v[36:51], v[92:95], a[152:155], v[36:51]
    ds_read_b64_tr_b16 v[92:93], v118 offset:8192
    ds_read_b64_tr_b16 v[94:95], v118 offset:9216
    s_add_u32 m0, s23, 140288
    s_nop 0
    buffer_load_dwordx4 v122, s[12:15], s25 offen lds
    s_waitcnt lgkmcnt(14)
    v_mfma_f32_32x32x16_bf16 v[52:67], v[96:99], a[152:155], v[52:67]
    ds_read_b64_tr_b16 v[96:97], v118 offset:8704
    ds_read_b64_tr_b16 v[98:99], v118 offset:9728
    s_waitcnt lgkmcnt(14)
    v_mfma_f32_32x32x16_bf16 v[4:19], v[100:103], a[28:31], v[4:19]
    ds_read_b64_tr_b16 v[100:101], v118 offset:2048
    ds_read_b64_tr_b16 v[102:103], v118 offset:3072
    buffer_load_dwordx4 a[24:27], v116, s[8:11], s24 offen offset:2048
    s_waitcnt lgkmcnt(14)
    v_mfma_f32_32x32x16_bf16 v[20:35], v[104:107], a[28:31], v[20:35]
    ds_read_b64_tr_b16 v[104:105], v118 offset:2560
    ds_read_b64_tr_b16 v[106:107], v118 offset:3584
    s_waitcnt lgkmcnt(14)
    v_mfma_f32_32x32x16_bf16 v[36:51], v[108:111], a[156:159], v[36:51]
    ds_read_b64_tr_b16 v[108:109], v118 offset:10240
    ds_read_b64_tr_b16 v[110:111], v118 offset:11264
    s_waitcnt lgkmcnt(14)
    v_mfma_f32_32x32x16_bf16 v[52:67], v[112:115], a[156:159], v[52:67]
    ds_read_b64_tr_b16 v[112:113], v118 offset:10752
    ds_read_b64_tr_b16 v[114:115], v118 offset:11776
    s_waitcnt lgkmcnt(14)
    v_mfma_f32_32x32x16_bf16 v[4:19], v[84:87], a[32:35], v[4:19]
    ds_read_b64_tr_b16 v[84:85], v118 offset:4096
    ds_read_b64_tr_b16 v[86:87], v118 offset:5120
    buffer_load_dwordx4 a[28:31], v116, s[8:11], s24 offen offset:3072
    s_waitcnt lgkmcnt(14)
    v_mfma_f32_32x32x16_bf16 v[20:35], v[88:91], a[32:35], v[20:35]
    ds_read_b64_tr_b16 v[88:89], v118 offset:4608
    ds_read_b64_tr_b16 v[90:91], v118 offset:5632
    s_waitcnt lgkmcnt(14)
    v_mfma_f32_32x32x16_bf16 v[36:51], v[92:95], a[160:163], v[36:51]
    ds_read_b64_tr_b16 v[92:93], v118 offset:12288
    ds_read_b64_tr_b16 v[94:95], v118 offset:13312
    s_waitcnt lgkmcnt(14)
    v_mfma_f32_32x32x16_bf16 v[52:67], v[96:99], a[160:163], v[52:67]
    ds_read_b64_tr_b16 v[96:97], v118 offset:12800
    ds_read_b64_tr_b16 v[98:99], v118 offset:13824
    s_waitcnt lgkmcnt(14)
    v_mfma_f32_32x32x16_bf16 v[4:19], v[100:103], a[36:39], v[4:19]
    ds_read_b64_tr_b16 v[100:101], v118 offset:6144
    ds_read_b64_tr_b16 v[102:103], v118 offset:7168
    s_mov_b32 s24, 65536
    buffer_load_dwordx4 a[32:35], v116, s[8:11], s24 offen offset:0
    s_waitcnt lgkmcnt(14)
    v_mfma_f32_32x32x16_bf16 v[20:35], v[104:107], a[36:39], v[20:35]
    ds_read_b64_tr_b16 v[104:105], v118 offset:6656
    ds_read_b64_tr_b16 v[106:107], v118 offset:7680
    s_waitcnt lgkmcnt(14)
    v_mfma_f32_32x32x16_bf16 v[36:51], v[108:111], a[164:167], v[36:51]
    ds_read_b64_tr_b16 v[108:109], v118 offset:14336
    ds_read_b64_tr_b16 v[110:111], v118 offset:15360
    s_waitcnt lgkmcnt(14)
    v_mfma_f32_32x32x16_bf16 v[52:67], v[112:115], a[164:167], v[52:67]
    ds_read_b64_tr_b16 v[112:113], v118 offset:14848
    ds_read_b64_tr_b16 v[114:115], v118 offset:15872
    s_waitcnt lgkmcnt(14)
    v_mfma_f32_32x32x16_bf16 v[4:19], v[84:87], a[40:43], v[4:19]
    s_waitcnt vmcnt(13)
    s_barrier
    v_add_u32 v118, 32768, v117
    ds_read_b64_tr_b16 v[84:85], v118 offset:0
    ds_read_b64_tr_b16 v[86:87], v118 offset:1024
    buffer_load_dwordx4 a[36:39], v116, s[8:11], s24 offen offset:1024
    s_mov_b32 s25, 655360
    s_add_u32 m0, s23, 65536
    s_nop 0
    buffer_load_dwordx4 v119, s[12:15], s25 offen lds
    s_waitcnt lgkmcnt(14)
    v_mfma_f32_32x32x16_bf16 v[20:35], v[88:91], a[40:43], v[20:35]
    ds_read_b64_tr_b16 v[88:89], v118 offset:512
    ds_read_b64_tr_b16 v[90:91], v118 offset:1536
    s_add_u32 m0, s23, 66560
    s_nop 0
    buffer_load_dwordx4 v120, s[12:15], s25 offen lds
    s_mov_b32 s25, 2359296
    s_add_u32 m0, s23, 8192
    s_nop 0
    buffer_load_dwordx4 v121, s[12:15], s25 offen lds
    s_waitcnt lgkmcnt(14)
    v_mfma_f32_32x32x16_bf16 v[36:51], v[92:95], a[168:171], v[36:51]
    ds_read_b64_tr_b16 v[92:93], v118 offset:8192
    ds_read_b64_tr_b16 v[94:95], v118 offset:9216
    s_add_u32 m0, s23, 9216
    s_nop 0
    buffer_load_dwordx4 v122, s[12:15], s25 offen lds
    s_waitcnt lgkmcnt(14)
    v_mfma_f32_32x32x16_bf16 v[52:67], v[96:99], a[168:171], v[52:67]
    ds_read_b64_tr_b16 v[96:97], v118 offset:8704
    ds_read_b64_tr_b16 v[98:99], v118 offset:9728
    s_waitcnt lgkmcnt(14)
    v_mfma_f32_32x32x16_bf16 v[4:19], v[100:103], a[44:47], v[4:19]
    ds_read_b64_tr_b16 v[100:101], v118 offset:2048
    ds_read_b64_tr_b16 v[102:103], v118 offset:3072
    buffer_load_dwordx4 a[40:43], v116, s[8:11], s24 offen offset:2048
    s_waitcnt lgkmcnt(14)
    v_mfma_f32_32x32x16_bf16 v[20:35], v[104:107], a[44:47], v[20:35]
    ds_read_b64_tr_b16 v[104:105], v118 offset:2560
    ds_read_b64_tr_b16 v[106:107], v118 offset:3584
    s_waitcnt lgkmcnt(14)
    v_mfma_f32_32x32x16_bf16 v[36:51], v[108:111], a[172:175], v[36:51]
    ds_read_b64_tr_b16 v[108:109], v118 offset:10240
    ds_read_b64_tr_b16 v[110:111], v118 offset:11264
    s_waitcnt lgkmcnt(14)
    v_mfma_f32_32x32x16_bf16 v[52:67], v[112:115], a[172:175], v[52:67]
    ds_read_b64_tr_b16 v[112:113], v118 offset:10752
    ds_read_b64_tr_b16 v[114:115], v118 offset:11776
    s_waitcnt lgkmcnt(14)
    v_mfma_f32_32x32x16_bf16 v[4:19], v[84:87], a[48:51], v[4:19]
    ds_read_b64_tr_b16 v[84:85], v118 offset:4096
    ds_read_b64_tr_b16 v[86:87], v118 offset:5120
    buffer_load_dwordx4 a[44:47], v116, s[8:11], s24 offen offset:3072
    s_waitcnt lgkmcnt(14)
    v_mfma_f32_32x32x16_bf16 v[20:35], v[88:91], a[48:51], v[20:35]
    ds_read_b64_tr_b16 v[88:89], v118 offset:4608
    ds_read_b64_tr_b16 v[90:91], v118 offset:5632
    s_waitcnt lgkmcnt(14)
    v_mfma_f32_32x32x16_bf16 v[36:51], v[92:95], a[176:179], v[36:51]
    ds_read_b64_tr_b16 v[92:93], v118 offset:12288
    ds_read_b64_tr_b16 v[94:95], v118 offset:13312
    s_waitcnt lgkmcnt(14)
    v_mfma_f32_32x32x16_bf16 v[52:67], v[96:99], a[176:179], v[52:67]
    ds_read_b64_tr_b16 v[96:97], v118 offset:12800
    ds_read_b64_tr_b16 v[98:99], v118 offset:13824
    s_waitcnt lgkmcnt(14)
    v_mfma_f32_32x32x16_bf16 v[4:19], v[100:103], a[52:55], v[4:19]
    ds_read_b64_tr_b16 v[100:101], v118 offset:6144
    ds_read_b64_tr_b16 v[102:103], v118 offset:7168
    s_mov_b32 s24, 69632
    buffer_load_dwordx4 a[48:51], v116, s[8:11], s24 offen offset:0
    s_waitcnt lgkmcnt(14)
    v_mfma_f32_32x32x16_bf16 v[20:35], v[104:107], a[52:55], v[20:35]
    ds_read_b64_tr_b16 v[104:105], v118 offset:6656
    ds_read_b64_tr_b16 v[106:107], v118 offset:7680
    s_waitcnt lgkmcnt(14)
    v_mfma_f32_32x32x16_bf16 v[36:51], v[108:111], a[180:183], v[36:51]
    ds_read_b64_tr_b16 v[108:109], v118 offset:14336
    ds_read_b64_tr_b16 v[110:111], v118 offset:15360
    s_waitcnt lgkmcnt(14)
    v_mfma_f32_32x32x16_bf16 v[52:67], v[112:115], a[180:183], v[52:67]
    ds_read_b64_tr_b16 v[112:113], v118 offset:14848
    ds_read_b64_tr_b16 v[114:115], v118 offset:15872
    s_waitcnt lgkmcnt(14)
    v_mfma_f32_32x32x16_bf16 v[4:19], v[84:87], a[56:59], v[4:19]
    s_waitcnt vmcnt(13)
    s_barrier
    v_add_u32 v118, 49152, v117
    ds_read_b64_tr_b16 v[84:85], v118 offset:0
    ds_read_b64_tr_b16 v[86:87], v118 offset:1024
    buffer_load_dwordx4 a[52:55], v116, s[8:11], s24 offen offset:1024
    s_mov_b32 s25, 786432
    s_add_u32 m0, s23, 81920
    s_nop 0
    buffer_load_dwordx4 v119, s[12:15], s25 offen lds
    s_waitcnt lgkmcnt(14)
    v_mfma_f32_32x32x16_bf16 v[20:35], v[88:91], a[56:59], v[20:35]
    ds_read_b64_tr_b16 v[88:89], v118 offset:512
    ds_read_b64_tr_b16 v[90:91], v118 offset:1536
    s_add_u32 m0, s23, 82944
    s_nop 0
    buffer_load_dwordx4 v120, s[12:15], s25 offen lds
    s_mov_b32 s25, 2490368
    s_add_u32 m0, s23, 24576
    s_nop 0
    buffer_load_dwordx4 v121, s[12:15], s25 offen lds
    s_waitcnt lgkmcnt(14)
    v_mfma_f32_32x32x16_bf16 v[36:51], v[92:95], a[184:187], v[36:51]
    ds_read_b64_tr_b16 v[92:93], v118 offset:8192
    ds_read_b64_tr_b16 v[94:95], v118 offset:9216
    s_add_u32 m0, s23, 25600
    s_nop 0
    buffer_load_dwordx4 v122, s[12:15], s25 offen lds
    s_waitcnt lgkmcnt(14)
    v_mfma_f32_32x32x16_bf16 v[52:67], v[96:99], a[184:187], v[52:67]
    ds_read_b64_tr_b16 v[96:97], v118 offset:8704
    ds_read_b64_tr_b16 v[98:99], v118 offset:9728
    s_waitcnt lgkmcnt(14)
    v_mfma_f32_32x32x16_bf16 v[4:19], v[100:103], a[60:63], v[4:19]
    ds_read_b64_tr_b16 v[100:101], v118 offset:2048
    ds_read_b64_tr_b16 v[102:103], v118 offset:3072
    buffer_load_dwordx4 a[56:59], v116, s[8:11], s24 offen offset:2048
    s_waitcnt lgkmcnt(14)
    v_mfma_f32_32x32x16_bf16 v[20:35], v[104:107], a[60:63], v[20:35]
    ds_read_b64_tr_b16 v[104:105], v118 offset:2560
    ds_read_b64_tr_b16 v[106:107], v118 offset:3584
    s_waitcnt lgkmcnt(14)
    v_mfma_f32_32x32x16_bf16 v[36:51], v[108:111], a[188:191], v[36:51]
    ds_read_b64_tr_b16 v[108:109], v118 offset:10240
    ds_read_b64_tr_b16 v[110:111], v118 offset:11264
    s_waitcnt lgkmcnt(14)
    v_mfma_f32_32x32x16_bf16 v[52:67], v[112:115], a[188:191], v[52:67]
    ds_read_b64_tr_b16 v[112:113], v118 offset:10752
    ds_read_b64_tr_b16 v[114:115], v118 offset:11776
    s_waitcnt lgkmcnt(14)
    v_mfma_f32_32x32x16_bf16 v[4:19], v[84:87], a[64:67], v[4:19]
    ds_read_b64_tr_b16 v[84:85], v118 offset:4096
    ds_read_b64_tr_b16 v[86:87], v118 offset:5120
    buffer_load_dwordx4 a[60:63], v116, s[8:11], s24 offen offset:3072
    s_waitcnt lgkmcnt(14)
    v_mfma_f32_32x32x16_bf16 v[20:35], v[88:91], a[64:67], v[20:35]
    ds_read_b64_tr_b16 v[88:89], v118 offset:4608
    ds_read_b64_tr_b16 v[90:91], v118 offset:5632
    s_waitcnt lgkmcnt(14)
    v_mfma_f32_32x32x16_bf16 v[36:51], v[92:95], a[192:195], v[36:51]
    ds_read_b64_tr_b16 v[92:93], v118 offset:12288
    ds_read_b64_tr_b16 v[94:95], v118 offset:13312
    s_waitcnt lgkmcnt(14)
    v_mfma_f32_32x32x16_bf16 v[52:67], v[96:99], a[192:195], v[52:67]
    ds_read_b64_tr_b16 v[96:97], v118 offset:12800
    ds_read_b64_tr_b16 v[98:99], v118 offset:13824
    s_waitcnt lgkmcnt(14)
    v_mfma_f32_32x32x16_bf16 v[4:19], v[100:103], a[68:71], v[4:19]
    ds_read_b64_tr_b16 v[100:101], v118 offset:6144
    ds_read_b64_tr_b16 v[102:103], v118 offset:7168
    s_mov_b32 s24, 73728
    buffer_load_dwordx4 a[64:67], v116, s[8:11], s24 offen offset:0
    s_waitcnt lgkmcnt(14)
    v_mfma_f32_32x32x16_bf16 v[20:35], v[104:107], a[68:71], v[20:35]
    ds_read_b64_tr_b16 v[104:105], v118 offset:6656
    ds_read_b64_tr_b16 v[106:107], v118 offset:7680
    s_waitcnt lgkmcnt(14)
    v_mfma_f32_32x32x16_bf16 v[36:51], v[108:111], a[196:199], v[36:51]
    ds_read_b64_tr_b16 v[108:109], v118 offset:14336
    ds_read_b64_tr_b16 v[110:111], v118 offset:15360
    s_waitcnt lgkmcnt(14)
    v_mfma_f32_32x32x16_bf16 v[52:67], v[112:115], a[196:199], v[52:67]
    ds_read_b64_tr_b16 v[112:113], v118 offset:14848
    ds_read_b64_tr_b16 v[114:115], v118 offset:15872
    s_waitcnt lgkmcnt(14)
    v_mfma_f32_32x32x16_bf16 v[4:19], v[84:87], a[72:75], v[4:19]
    s_waitcnt vmcnt(13)
    s_barrier
    v_add_u32 v118, 65536, v117
    ds_read_b64_tr_b16 v[84:85], v118 offset:0
    ds_read_b64_tr_b16 v[86:87], v118 offset:1024
    buffer_load_dwordx4 a[68:71], v116, s[8:11], s24 offen offset:1024
    s_mov_b32 s25, 917504
    s_add_u32 m0, s23, 98304
    s_nop 0
    buffer_load_dwordx4 v119, s[12:15], s25 offen lds
    s_waitcnt lgkmcnt(14)
    v_mfma_f32_32x32x16_bf16 v[20:35], v[88:91], a[72:75], v[20:35]
    ds_read_b64_tr_b16 v[88:89], v118 offset:512
    ds_read_b64_tr_b16 v[90:91], v118 offset:1536
    s_add_u32 m0, s23, 99328
    s_nop 0
    buffer_load_dwordx4 v120, s[12:15], s25 offen lds
    s_mov_b32 s25, 2621440
    s_add_u32 m0, s23, 40960
    s_nop 0
    buffer_load_dwordx4 v121, s[12:15], s25 offen lds
    s_waitcnt lgkmcnt(14)
    v_mfma_f32_32x32x16_bf16 v[36:51], v[92:95], a[200:203], v[36:51]
    ds_read_b64_tr_b16 v[92:93], v118 offset:8192
    ds_read_b64_tr_b16 v[94:95], v118 offset:9216
    s_add_u32 m0, s23, 41984
    s_nop 0
    buffer_load_dwordx4 v122, s[12:15], s25 offen lds
    s_waitcnt lgkmcnt(14)
    v_mfma_f32_32x32x16_bf16 v[52:67], v[96:99], a[200:203], v[52:67]
    ds_read_b64_tr_b16 v[96:97], v118 offset:8704
    ds_read_b64_tr_b16 v[98:99], v118 offset:9728
    s_waitcnt lgkmcnt(14)
    v_mfma_f32_32x32x16_bf16 v[4:19], v[100:103], a[76:79], v[4:19]
    ds_read_b64_tr_b16 v[100:101], v118 offset:2048
    ds_read_b64_tr_b16 v[102:103], v118 offset:3072
    buffer_load_dwordx4 a[72:75], v116, s[8:11], s24 offen offset:2048
    s_waitcnt lgkmcnt(14)
    v_mfma_f32_32x32x16_bf16 v[20:35], v[104:107], a[76:79], v[20:35]
    ds_read_b64_tr_b16 v[104:105], v118 offset:2560
    ds_read_b64_tr_b16 v[106:107], v118 offset:3584
    s_waitcnt lgkmcnt(14)
    v_mfma_f32_32x32x16_bf16 v[36:51], v[108:111], a[204:207], v[36:51]
    ds_read_b64_tr_b16 v[108:109], v118 offset:10240
    ds_read_b64_tr_b16 v[110:111], v118 offset:11264
    s_waitcnt lgkmcnt(14)
    v_mfma_f32_32x32x16_bf16 v[52:67], v[112:115], a[204:207], v[52:67]
    ds_read_b64_tr_b16 v[112:113], v118 offset:10752
    ds_read_b64_tr_b16 v[114:115], v118 offset:11776
    s_waitcnt lgkmcnt(14)
    v_mfma_f32_32x32x16_bf16 v[4:19], v[84:87], a[80:83], v[4:19]
    ds_read_b64_tr_b16 v[84:85], v118 offset:4096
    ds_read_b64_tr_b16 v[86:87], v118 offset:5120
    buffer_load_dwordx4 a[76:79], v116, s[8:11], s24 offen offset:3072
    s_waitcnt lgkmcnt(14)
    v_mfma_f32_32x32x16_bf16 v[20:35], v[88:91], a[80:83], v[20:35]
    ds_read_b64_tr_b16 v[88:89], v118 offset:4608
    ds_read_b64_tr_b16 v[90:91], v118 offset:5632
    s_waitcnt lgkmcnt(14)
    v_mfma_f32_32x32x16_bf16 v[36:51], v[92:95], a[208:211], v[36:51]
    ds_read_b64_tr_b16 v[92:93], v118 offset:12288
    ds_read_b64_tr_b16 v[94:95], v118 offset:13312
    s_waitcnt lgkmcnt(14)
    v_mfma_f32_32x32x16_bf16 v[52:67], v[96:99], a[208:211], v[52:67]
    ds_read_b64_tr_b16 v[96:97], v118 offset:12800
    ds_read_b64_tr_b16 v[98:99], v118 offset:13824
    s_waitcnt lgkmcnt(14)
    v_mfma_f32_32x32x16_bf16 v[4:19], v[100:103], a[84:87], v[4:19]
    ds_read_b64_tr_b16 v[100:101], v118 offset:6144
    ds_read_b64_tr_b16 v[102:103], v118 offset:7168
    s_mov_b32 s24, 77824
    buffer_load_dwordx4 a[80:83], v116, s[8:11], s24 offen offset:0
    s_waitcnt lgkmcnt(14)
    v_mfma_f32_32x32x16_bf16 v[20:35], v[104:107], a[84:87], v[20:35]
    ds_read_b64_tr_b16 v[104:105], v118 offset:6656
    ds_read_b64_tr_b16 v[106:107], v118 offset:7680
    s_waitcnt lgkmcnt(14)
    v_mfma_f32_32x32x16_bf16 v[36:51], v[108:111], a[212:215], v[36:51]
    ds_read_b64_tr_b16 v[108:109], v118 offset:14336
    ds_read_b64_tr_b16 v[110:111], v118 offset:15360
    s_waitcnt lgkmcnt(14)
    v_mfma_f32_32x32x16_bf16 v[52:67], v[112:115], a[212:215], v[52:67]
    ds_read_b64_tr_b16 v[112:113], v118 offset:14848
    ds_read_b64_tr_b16 v[114:115], v118 offset:15872
    s_waitcnt lgkmcnt(14)
    v_mfma_f32_32x32x16_bf16 v[4:19], v[84:87], a[88:91], v[4:19]
    s_waitcnt vmcnt(13)
    s_barrier
    v_add_u32 v118, 81920, v117
    ds_read_b64_tr_b16 v[84:85], v118 offset:0
    ds_read_b64_tr_b16 v[86:87], v118 offset:1024
    buffer_load_dwordx4 a[84:87], v116, s[8:11], s24 offen offset:1024
    s_mov_b32 s25, 1048576
    s_add_u32 m0, s23, 114688
    s_nop 0
    buffer_load_dwordx4 v119, s[12:15], s25 offen lds
    s_waitcnt lgkmcnt(14)
    v_mfma_f32_32x32x16_bf16 v[20:35], v[88:91], a[88:91], v[20:35]
    ds_read_b64_tr_b16 v[88:89], v118 offset:512
    ds_read_b64_tr_b16 v[90:91], v118 offset:1536
    s_add_u32 m0, s23, 115712
    s_nop 0
    buffer_load_dwordx4 v120, s[12:15], s25 offen lds
    s_mov_b32 s25, 2752512
    s_add_u32 m0, s23, 57344
    s_nop 0
    buffer_load_dwordx4 v121, s[12:15], s25 offen lds
    s_waitcnt lgkmcnt(14)
    v_mfma_f32_32x32x16_bf16 v[36:51], v[92:95], a[216:219], v[36:51]
    ds_read_b64_tr_b16 v[92:93], v118 offset:8192
    ds_read_b64_tr_b16 v[94:95], v118 offset:9216
    s_add_u32 m0, s23, 58368
    s_nop 0
    buffer_load_dwordx4 v122, s[12:15], s25 offen lds
    s_waitcnt lgkmcnt(14)
    v_mfma_f32_32x32x16_bf16 v[52:67], v[96:99], a[216:219], v[52:67]
    ds_read_b64_tr_b16 v[96:97], v118 offset:8704
    ds_read_b64_tr_b16 v[98:99], v118 offset:9728
    s_waitcnt lgkmcnt(14)
    v_mfma_f32_32x32x16_bf16 v[4:19], v[100:103], a[92:95], v[4:19]
    ds_read_b64_tr_b16 v[100:101], v118 offset:2048
    ds_read_b64_tr_b16 v[102:103], v118 offset:3072
    buffer_load_dwordx4 a[88:91], v116, s[8:11], s24 offen offset:2048
    s_waitcnt lgkmcnt(14)
    v_mfma_f32_32x32x16_bf16 v[20:35], v[104:107], a[92:95], v[20:35]
    ds_read_b64_tr_b16 v[104:105], v118 offset:2560
    ds_read_b64_tr_b16 v[106:107], v118 offset:3584
    s_waitcnt lgkmcnt(14)
    v_mfma_f32_32x32x16_bf16 v[36:51], v[108:111], a[220:223], v[36:51]
    ds_read_b64_tr_b16 v[108:109], v118 offset:10240
    ds_read_b64_tr_b16 v[110:111], v118 offset:11264
    s_waitcnt lgkmcnt(14)
    v_mfma_f32_32x32x16_bf16 v[52:67], v[112:115], a[220:223], v[52:67]
    ds_read_b64_tr_b16 v[112:113], v118 offset:10752
    ds_read_b64_tr_b16 v[114:115], v118 offset:11776
    s_waitcnt lgkmcnt(14)
    v_mfma_f32_32x32x16_bf16 v[4:19], v[84:87], a[96:99], v[4:19]
    ds_read_b64_tr_b16 v[84:85], v118 offset:4096
    ds_read_b64_tr_b16 v[86:87], v118 offset:5120
    buffer_load_dwordx4 a[92:95], v116, s[8:11], s24 offen offset:3072
    s_waitcnt lgkmcnt(14)
    v_mfma_f32_32x32x16_bf16 v[20:35], v[88:91], a[96:99], v[20:35]
    ds_read_b64_tr_b16 v[88:89], v118 offset:4608
    ds_read_b64_tr_b16 v[90:91], v118 offset:5632
    s_waitcnt lgkmcnt(14)
    v_mfma_f32_32x32x16_bf16 v[36:51], v[92:95], a[0:3], v[36:51]
    ds_read_b64_tr_b16 v[92:93], v118 offset:12288
    ds_read_b64_tr_b16 v[94:95], v118 offset:13312
    s_waitcnt lgkmcnt(14)
    v_mfma_f32_32x32x16_bf16 v[52:67], v[96:99], a[0:3], v[52:67]
    ds_read_b64_tr_b16 v[96:97], v118 offset:12800
    ds_read_b64_tr_b16 v[98:99], v118 offset:13824
    s_waitcnt lgkmcnt(14)
    v_mfma_f32_32x32x16_bf16 v[4:19], v[100:103], a[100:103], v[4:19]
    ds_read_b64_tr_b16 v[100:101], v118 offset:6144
    ds_read_b64_tr_b16 v[102:103], v118 offset:7168
    s_mov_b32 s24, 81920
    buffer_load_dwordx4 a[96:99], v116, s[8:11], s24 offen offset:0
    s_waitcnt lgkmcnt(14)
    v_mfma_f32_32x32x16_bf16 v[20:35], v[104:107], a[100:103], v[20:35]
    ds_read_b64_tr_b16 v[104:105], v118 offset:6656
    ds_read_b64_tr_b16 v[106:107], v118 offset:7680
    s_waitcnt lgkmcnt(14)
    v_mfma_f32_32x32x16_bf16 v[36:51], v[108:111], a[4:7], v[36:51]
    ds_read_b64_tr_b16 v[108:109], v118 offset:14336
    ds_read_b64_tr_b16 v[110:111], v118 offset:15360
    s_waitcnt lgkmcnt(14)
    v_mfma_f32_32x32x16_bf16 v[52:67], v[112:115], a[4:7], v[52:67]
    ds_read_b64_tr_b16 v[112:113], v118 offset:14848
    ds_read_b64_tr_b16 v[114:115], v118 offset:15872
    s_waitcnt lgkmcnt(14)
    v_mfma_f32_32x32x16_bf16 v[4:19], v[84:87], a[104:107], v[4:19]
    s_waitcnt vmcnt(13)
    s_barrier
    v_add_u32 v118, 98304, v117
    ds_read_b64_tr_b16 v[84:85], v118 offset:0
    ds_read_b64_tr_b16 v[86:87], v118 offset:1024
    buffer_load_dwordx4 a[100:103], v116, s[8:11], s24 offen offset:1024
    s_mov_b32 s25, 1179648
    s_add_u32 m0, s23, 131072
    s_nop 0
    buffer_load_dwordx4 v119, s[12:15], s25 offen lds
    s_waitcnt lgkmcnt(14)
    v_mfma_f32_32x32x16_bf16 v[20:35], v[88:91], a[104:107], v[20:35]
    ds_read_b64_tr_b16 v[88:89], v118 offset:512
    ds_read_b64_tr_b16 v[90:91], v118 offset:1536
    s_add_u32 m0, s23, 132096
    s_nop 0
    buffer_load_dwordx4 v120, s[12:15], s25 offen lds
    s_mov_b32 s25, 2883584
    s_add_u32 m0, s23, 73728
    s_nop 0
    buffer_load_dwordx4 v121, s[12:15], s25 offen lds
    s_waitcnt lgkmcnt(14)
    v_mfma_f32_32x32x16_bf16 v[36:51], v[92:95], a[8:11], v[36:51]
    ds_read_b64_tr_b16 v[92:93], v118 offset:8192
    ds_read_b64_tr_b16 v[94:95], v118 offset:9216
    s_add_u32 m0, s23, 74752
    s_nop 0
    buffer_load_dwordx4 v122, s[12:15], s25 offen lds
    s_waitcnt lgkmcnt(14)
    v_mfma_f32_32x32x16_bf16 v[52:67], v[96:99], a[8:11], v[52:67]
    ds_read_b64_tr_b16 v[96:97], v118 offset:8704
    ds_read_b64_tr_b16 v[98:99], v118 offset:9728
    s_waitcnt lgkmcnt(14)
    v_mfma_f32_32x32x16_bf16 v[4:19], v[100:103], a[108:111], v[4:19]
    ds_read_b64_tr_b16 v[100:101], v118 offset:2048
    ds_read_b64_tr_b16 v[102:103], v118 offset:3072
    buffer_load_dwordx4 a[104:107], v116, s[8:11], s24 offen offset:2048
    s_waitcnt lgkmcnt(14)
    v_mfma_f32_32x32x16_bf16 v[20:35], v[104:107], a[108:111], v[20:35]
    ds_read_b64_tr_b16 v[104:105], v118 offset:2560
    ds_read_b64_tr_b16 v[106:107], v118 offset:3584
    s_waitcnt lgkmcnt(14)
    v_mfma_f32_32x32x16_bf16 v[36:51], v[108:111], a[12:15], v[36:51]
    ds_read_b64_tr_b16 v[108:109], v118 offset:10240
    ds_read_b64_tr_b16 v[110:111], v118 offset:11264
    s_waitcnt lgkmcnt(14)
    v_mfma_f32_32x32x16_bf16 v[52:67], v[112:115], a[12:15], v[52:67]
    ds_read_b64_tr_b16 v[112:113], v118 offset:10752
    ds_read_b64_tr_b16 v[114:115], v118 offset:11776
    s_waitcnt lgkmcnt(14)
    v_mfma_f32_32x32x16_bf16 v[4:19], v[84:87], a[112:115], v[4:19]
    ds_read_b64_tr_b16 v[84:85], v118 offset:4096
    ds_read_b64_tr_b16 v[86:87], v118 offset:5120
    buffer_load_dwordx4 a[108:111], v116, s[8:11], s24 offen offset:3072
    s_waitcnt lgkmcnt(14)
    v_mfma_f32_32x32x16_bf16 v[20:35], v[88:91], a[112:115], v[20:35]
    ds_read_b64_tr_b16 v[88:89], v118 offset:4608
    ds_read_b64_tr_b16 v[90:91], v118 offset:5632
    s_waitcnt lgkmcnt(14)
    v_mfma_f32_32x32x16_bf16 v[36:51], v[92:95], a[16:19], v[36:51]
    ds_read_b64_tr_b16 v[92:93], v118 offset:12288
    ds_read_b64_tr_b16 v[94:95], v118 offset:13312
    s_waitcnt lgkmcnt(14)
    v_mfma_f32_32x32x16_bf16 v[52:67], v[96:99], a[16:19], v[52:67]
    ds_read_b64_tr_b16 v[96:97], v118 offset:12800
    ds_read_b64_tr_b16 v[98:99], v118 offset:13824
    s_waitcnt lgkmcnt(14)
    v_mfma_f32_32x32x16_bf16 v[4:19], v[100:103], a[116:119], v[4:19]
    ds_read_b64_tr_b16 v[100:101], v118 offset:6144
    ds_read_b64_tr_b16 v[102:103], v118 offset:7168
    s_mov_b32 s24, 86016
    buffer_load_dwordx4 a[112:115], v116, s[8:11], s24 offen offset:0
    s_waitcnt lgkmcnt(14)
    v_mfma_f32_32x32x16_bf16 v[20:35], v[104:107], a[116:119], v[20:35]
    ds_read_b64_tr_b16 v[104:105], v118 offset:6656
    ds_read_b64_tr_b16 v[106:107], v118 offset:7680
    s_waitcnt lgkmcnt(14)
    v_mfma_f32_32x32x16_bf16 v[36:51], v[108:111], a[20:23], v[36:51]
    ds_read_b64_tr_b16 v[108:109], v118 offset:14336
    ds_read_b64_tr_b16 v[110:111], v118 offset:15360
    s_waitcnt lgkmcnt(14)
    v_mfma_f32_32x32x16_bf16 v[52:67], v[112:115], a[20:23], v[52:67]
    ds_read_b64_tr_b16 v[112:113], v118 offset:14848
    ds_read_b64_tr_b16 v[114:115], v118 offset:15872
    s_waitcnt lgkmcnt(14)
    v_mfma_f32_32x32x16_bf16 v[4:19], v[84:87], a[120:123], v[4:19]
    s_waitcnt vmcnt(13)
    s_barrier
    v_add_u32 v118, 114688, v117
    ds_read_b64_tr_b16 v[84:85], v118 offset:0
    ds_read_b64_tr_b16 v[86:87], v118 offset:1024
    buffer_load_dwordx4 a[116:119], v116, s[8:11], s24 offen offset:1024
    s_mov_b32 s25, 1310720
    s_add_u32 m0, s23, 0
    s_nop 0
    buffer_load_dwordx4 v119, s[12:15], s25 offen lds
    s_waitcnt lgkmcnt(14)
    v_mfma_f32_32x32x16_bf16 v[20:35], v[88:91], a[120:123], v[20:35]
    ds_read_b64_tr_b16 v[88:89], v118 offset:512
    ds_read_b64_tr_b16 v[90:91], v118 offset:1536
    s_add_u32 m0, s23, 1024
    s_nop 0
    buffer_load_dwordx4 v120, s[12:15], s25 offen lds
    s_mov_b32 s25, 3014656
    s_add_u32 m0, s23, 90112
    s_nop 0
    buffer_load_dwordx4 v121, s[12:15], s25 offen lds
    s_waitcnt lgkmcnt(14)
    v_mfma_f32_32x32x16_bf16 v[36:51], v[92:95], a[24:27], v[36:51]
    ds_read_b64_tr_b16 v[92:93], v118 offset:8192
    ds_read_b64_tr_b16 v[94:95], v118 offset:9216
    s_add_u32 m0, s23, 91136
    s_nop 0
    buffer_load_dwordx4 v122, s[12:15], s25 offen lds
    s_waitcnt lgkmcnt(14)
    v_mfma_f32_32x32x16_bf16 v[52:67], v[96:99], a[24:27], v[52:67]
    ds_read_b64_tr_b16 v[96:97], v118 offset:8704
    ds_read_b64_tr_b16 v[98:99], v118 offset:9728
    s_waitcnt lgkmcnt(14)
    v_mfma_f32_32x32x16_bf16 v[4:19], v[100:103], a[124:127], v[4:19]
    ds_read_b64_tr_b16 v[100:101], v118 offset:2048
    ds_read_b64_tr_b16 v[102:103], v118 offset:3072
    buffer_load_dwordx4 a[120:123], v116, s[8:11], s24 offen offset:2048
    s_waitcnt lgkmcnt(14)
    v_mfma_f32_32x32x16_bf16 v[20:35], v[104:107], a[124:127], v[20:35]
    ds_read_b64_tr_b16 v[104:105], v118 offset:2560
    ds_read_b64_tr_b16 v[106:107], v118 offset:3584
    s_waitcnt lgkmcnt(14)
    v_mfma_f32_32x32x16_bf16 v[36:51], v[108:111], a[28:31], v[36:51]
    ds_read_b64_tr_b16 v[108:109], v118 offset:10240
    ds_read_b64_tr_b16 v[110:111], v118 offset:11264
    s_waitcnt lgkmcnt(14)
    v_mfma_f32_32x32x16_bf16 v[52:67], v[112:115], a[28:31], v[52:67]
    ds_read_b64_tr_b16 v[112:113], v118 offset:10752
    ds_read_b64_tr_b16 v[114:115], v118 offset:11776
    s_waitcnt lgkmcnt(14)
    v_mfma_f32_32x32x16_bf16 v[4:19], v[84:87], a[128:131], v[4:19]
    ds_read_b64_tr_b16 v[84:85], v118 offset:4096
    ds_read_b64_tr_b16 v[86:87], v118 offset:5120
    buffer_load_dwordx4 a[124:127], v116, s[8:11], s24 offen offset:3072
    s_waitcnt lgkmcnt(14)
    v_mfma_f32_32x32x16_bf16 v[20:35], v[88:91], a[128:131], v[20:35]
    ds_read_b64_tr_b16 v[88:89], v118 offset:4608
    ds_read_b64_tr_b16 v[90:91], v118 offset:5632
    s_waitcnt lgkmcnt(14)
    v_mfma_f32_32x32x16_bf16 v[36:51], v[92:95], a[32:35], v[36:51]
    ds_read_b64_tr_b16 v[92:93], v118 offset:12288
    ds_read_b64_tr_b16 v[94:95], v118 offset:13312
    s_waitcnt lgkmcnt(14)
    v_mfma_f32_32x32x16_bf16 v[52:67], v[96:99], a[32:35], v[52:67]
    ds_read_b64_tr_b16 v[96:97], v118 offset:12800
    ds_read_b64_tr_b16 v[98:99], v118 offset:13824
    s_waitcnt lgkmcnt(14)
    v_mfma_f32_32x32x16_bf16 v[4:19], v[100:103], a[132:135], v[4:19]
    ds_read_b64_tr_b16 v[100:101], v118 offset:6144
    ds_read_b64_tr_b16 v[102:103], v118 offset:7168
    s_mov_b32 s24, 90112
    buffer_load_dwordx4 a[128:131], v116, s[8:11], s24 offen offset:0
    s_waitcnt lgkmcnt(14)
    v_mfma_f32_32x32x16_bf16 v[20:35], v[104:107], a[132:135], v[20:35]
    ds_read_b64_tr_b16 v[104:105], v118 offset:6656
    ds_read_b64_tr_b16 v[106:107], v118 offset:7680
    s_waitcnt lgkmcnt(14)
    v_mfma_f32_32x32x16_bf16 v[36:51], v[108:111], a[36:39], v[36:51]
    ds_read_b64_tr_b16 v[108:109], v118 offset:14336
    ds_read_b64_tr_b16 v[110:111], v118 offset:15360
    s_waitcnt lgkmcnt(14)
    v_mfma_f32_32x32x16_bf16 v[52:67], v[112:115], a[36:39], v[52:67]
    ds_read_b64_tr_b16 v[112:113], v118 offset:14848
    ds_read_b64_tr_b16 v[114:115], v118 offset:15872
    s_waitcnt lgkmcnt(14)
    v_mfma_f32_32x32x16_bf16 v[4:19], v[84:87], a[136:139], v[4:19]
    s_waitcnt vmcnt(13)
    s_barrier
    v_add_u32 v118, 131072, v117
    ds_read_b64_tr_b16 v[84:85], v118 offset:0
    ds_read_b64_tr_b16 v[86:87], v118 offset:1024
    buffer_load_dwordx4 a[132:135], v116, s[8:11], s24 offen offset:1024
    s_mov_b32 s25, 1441792
    s_add_u32 m0, s23, 16384
    s_nop 0
    buffer_load_dwordx4 v119, s[12:15], s25 offen lds
    s_waitcnt lgkmcnt(14)
    v_mfma_f32_32x32x16_bf16 v[20:35], v[88:91], a[136:139], v[20:35]
    ds_read_b64_tr_b16 v[88:89], v118 offset:512
    ds_read_b64_tr_b16 v[90:91], v118 offset:1536
    s_add_u32 m0, s23, 17408
    s_nop 0
    buffer_load_dwordx4 v120, s[12:15], s25 offen lds
    s_mov_b32 s25, 3145728
    s_add_u32 m0, s23, 106496
    s_nop 0
    buffer_load_dwordx4 v121, s[12:15], s25 offen lds
    s_waitcnt lgkmcnt(14)
    v_mfma_f32_32x32x16_bf16 v[36:51], v[92:95], a[40:43], v[36:51]
    ds_read_b64_tr_b16 v[92:93], v118 offset:8192
    ds_read_b64_tr_b16 v[94:95], v118 offset:9216
    s_add_u32 m0, s23, 107520
    s_nop 0
    buffer_load_dwordx4 v122, s[12:15], s25 offen lds
    s_waitcnt lgkmcnt(14)
    v_mfma_f32_32x32x16_bf16 v[52:67], v[96:99], a[40:43], v[52:67]
    ds_read_b64_tr_b16 v[96:97], v118 offset:8704
    ds_read_b64_tr_b16 v[98:99], v118 offset:9728
    s_waitcnt lgkmcnt(14)
    v_mfma_f32_32x32x16_bf16 v[4:19], v[100:103], a[140:143], v[4:19]
    ds_read_b64_tr_b16 v[100:101], v118 offset:2048
    ds_read_b64_tr_b16 v[102:103], v118 offset:3072
    buffer_load_dwordx4 a[136:139], v116, s[8:11], s24 offen offset:2048
    s_waitcnt lgkmcnt(14)
    v_mfma_f32_32x32x16_bf16 v[20:35], v[104:107], a[140:143], v[20:35]
    ds_read_b64_tr_b16 v[104:105], v118 offset:2560
    ds_read_b64_tr_b16 v[106:107], v118 offset:3584
    s_waitcnt lgkmcnt(14)
    v_mfma_f32_32x32x16_bf16 v[36:51], v[108:111], a[44:47], v[36:51]
    ds_read_b64_tr_b16 v[108:109], v118 offset:10240
    ds_read_b64_tr_b16 v[110:111], v118 offset:11264
    s_waitcnt lgkmcnt(14)
    v_mfma_f32_32x32x16_bf16 v[52:67], v[112:115], a[44:47], v[52:67]
    ds_read_b64_tr_b16 v[112:113], v118 offset:10752
    ds_read_b64_tr_b16 v[114:115], v118 offset:11776
    s_waitcnt lgkmcnt(14)
    v_mfma_f32_32x32x16_bf16 v[4:19], v[84:87], a[144:147], v[4:19]
    ds_read_b64_tr_b16 v[84:85], v118 offset:4096
    ds_read_b64_tr_b16 v[86:87], v118 offset:5120
    buffer_load_dwordx4 a[140:143], v116, s[8:11], s24 offen offset:3072
    s_waitcnt lgkmcnt(14)
    v_mfma_f32_32x32x16_bf16 v[20:35], v[88:91], a[144:147], v[20:35]
    ds_read_b64_tr_b16 v[88:89], v118 offset:4608
    ds_read_b64_tr_b16 v[90:91], v118 offset:5632
    s_waitcnt lgkmcnt(14)
    v_mfma_f32_32x32x16_bf16 v[36:51], v[92:95], a[48:51], v[36:51]
    ds_read_b64_tr_b16 v[92:93], v118 offset:12288
    ds_read_b64_tr_b16 v[94:95], v118 offset:13312
    s_waitcnt lgkmcnt(14)
    v_mfma_f32_32x32x16_bf16 v[52:67], v[96:99], a[48:51], v[52:67]
    ds_read_b64_tr_b16 v[96:97], v118 offset:12800
    ds_read_b64_tr_b16 v[98:99], v118 offset:13824
    s_waitcnt lgkmcnt(14)
    v_mfma_f32_32x32x16_bf16 v[4:19], v[100:103], a[148:151], v[4:19]
    ds_read_b64_tr_b16 v[100:101], v118 offset:6144
    ds_read_b64_tr_b16 v[102:103], v118 offset:7168
    s_mov_b32 s24, 94208
    buffer_load_dwordx4 a[144:147], v116, s[8:11], s24 offen offset:0
    s_waitcnt lgkmcnt(14)
    v_mfma_f32_32x32x16_bf16 v[20:35], v[104:107], a[148:151], v[20:35]
    ds_read_b64_tr_b16 v[104:105], v118 offset:6656
    ds_read_b64_tr_b16 v[106:107], v118 offset:7680
    s_waitcnt lgkmcnt(14)
    v_mfma_f32_32x32x16_bf16 v[36:51], v[108:111], a[52:55], v[36:51]
    ds_read_b64_tr_b16 v[108:109], v118 offset:14336
    ds_read_b64_tr_b16 v[110:111], v118 offset:15360
    s_waitcnt lgkmcnt(14)
    v_mfma_f32_32x32x16_bf16 v[52:67], v[112:115], a[52:55], v[52:67]
    ds_read_b64_tr_b16 v[112:113], v118 offset:14848
    ds_read_b64_tr_b16 v[114:115], v118 offset:15872
    s_waitcnt lgkmcnt(14)
    v_mfma_f32_32x32x16_bf16 v[4:19], v[84:87], a[152:155], v[4:19]
    s_waitcnt vmcnt(13)
    s_barrier
    v_add_u32 v118, 0, v117
    ds_read_b64_tr_b16 v[84:85], v118 offset:0
    ds_read_b64_tr_b16 v[86:87], v118 offset:1024
    buffer_load_dwordx4 a[148:151], v116, s[8:11], s24 offen offset:1024
    s_mov_b32 s25, 1572864
    s_add_u32 m0, s23, 32768
    s_nop 0
    buffer_load_dwordx4 v119, s[12:15], s25 offen lds
    s_waitcnt lgkmcnt(14)
    v_mfma_f32_32x32x16_bf16 v[20:35], v[88:91], a[152:155], v[20:35]
    ds_read_b64_tr_b16 v[88:89], v118 offset:512
    ds_read_b64_tr_b16 v[90:91], v118 offset:1536
    s_add_u32 m0, s23, 33792
    s_nop 0
    buffer_load_dwordx4 v120, s[12:15], s25 offen lds
    s_mov_b32 s25, 3276800
    s_add_u32 m0, s23, 122880
    s_nop 0
    buffer_load_dwordx4 v121, s[12:15], s25 offen lds
    s_waitcnt lgkmcnt(14)
    v_mfma_f32_32x32x16_bf16 v[36:51], v[92:95], a[56:59], v[36:51]
    ds_read_b64_tr_b16 v[92:93], v118 offset:8192
    ds_read_b64_tr_b16 v[94:95], v118 offset:9216
    s_add_u32 m0, s23, 123904
    s_nop 0
    buffer_load_dwordx4 v122, s[12:15], s25 offen lds
    s_waitcnt lgkmcnt(14)
    v_mfma_f32_32x32x16_bf16 v[52:67], v[96:99], a[56:59], v[52:67]
    ds_read_b64_tr_b16 v[96:97], v118 offset:8704
    ds_read_b64_tr_b16 v[98:99], v118 offset:9728
    s_waitcnt lgkmcnt(14)
    v_mfma_f32_32x32x16_bf16 v[4:19], v[100:103], a[156:159], v[4:19]
    ds_read_b64_tr_b16 v[100:101], v118 offset:2048
    ds_read_b64_tr_b16 v[102:103], v118 offset:3072
    buffer_load_dwordx4 a[152:155], v116, s[8:11], s24 offen offset:2048
    s_waitcnt lgkmcnt(14)
    v_mfma_f32_32x32x16_bf16 v[20:35], v[104:107], a[156:159], v[20:35]
    ds_read_b64_tr_b16 v[104:105], v118 offset:2560
    ds_read_b64_tr_b16 v[106:107], v118 offset:3584
    s_waitcnt lgkmcnt(14)
    v_mfma_f32_32x32x16_bf16 v[36:51], v[108:111], a[60:63], v[36:51]
    ds_read_b64_tr_b16 v[108:109], v118 offset:10240
    ds_read_b64_tr_b16 v[110:111], v118 offset:11264
    s_waitcnt lgkmcnt(14)
    v_mfma_f32_32x32x16_bf16 v[52:67], v[112:115], a[60:63], v[52:67]
    ds_read_b64_tr_b16 v[112:113], v118 offset:10752
    ds_read_b64_tr_b16 v[114:115], v118 offset:11776
    s_waitcnt lgkmcnt(14)
    v_mfma_f32_32x32x16_bf16 v[4:19], v[84:87], a[160:163], v[4:19]
    ds_read_b64_tr_b16 v[84:85], v118 offset:4096
    ds_read_b64_tr_b16 v[86:87], v118 offset:5120
    buffer_load_dwordx4 a[156:159], v116, s[8:11], s24 offen offset:3072
    s_waitcnt lgkmcnt(14)
    v_mfma_f32_32x32x16_bf16 v[20:35], v[88:91], a[160:163], v[20:35]
    ds_read_b64_tr_b16 v[88:89], v118 offset:4608
    ds_read_b64_tr_b16 v[90:91], v118 offset:5632
    s_waitcnt lgkmcnt(14)
    v_mfma_f32_32x32x16_bf16 v[36:51], v[92:95], a[64:67], v[36:51]
    ds_read_b64_tr_b16 v[92:93], v118 offset:12288
    ds_read_b64_tr_b16 v[94:95], v118 offset:13312
    s_waitcnt lgkmcnt(14)
    v_mfma_f32_32x32x16_bf16 v[52:67], v[96:99], a[64:67], v[52:67]
    ds_read_b64_tr_b16 v[96:97], v118 offset:12800
    ds_read_b64_tr_b16 v[98:99], v118 offset:13824
    s_waitcnt lgkmcnt(14)
    v_mfma_f32_32x32x16_bf16 v[4:19], v[100:103], a[164:167], v[4:19]
    ds_read_b64_tr_b16 v[100:101], v118 offset:6144
    ds_read_b64_tr_b16 v[102:103], v118 offset:7168
    s_mov_b32 s24, 98304
    buffer_load_dwordx4 a[160:163], v116, s[8:11], s24 offen offset:0
    s_waitcnt lgkmcnt(14)
    v_mfma_f32_32x32x16_bf16 v[20:35], v[104:107], a[164:167], v[20:35]
    ds_read_b64_tr_b16 v[104:105], v118 offset:6656
    ds_read_b64_tr_b16 v[106:107], v118 offset:7680
    s_waitcnt lgkmcnt(14)
    v_mfma_f32_32x32x16_bf16 v[36:51], v[108:111], a[68:71], v[36:51]
    ds_read_b64_tr_b16 v[108:109], v118 offset:14336
    ds_read_b64_tr_b16 v[110:111], v118 offset:15360
    s_waitcnt lgkmcnt(14)
    v_mfma_f32_32x32x16_bf16 v[52:67], v[112:115], a[68:71], v[52:67]
    ds_read_b64_tr_b16 v[112:113], v118 offset:14848
    ds_read_b64_tr_b16 v[114:115], v118 offset:15872
    s_waitcnt lgkmcnt(14)
    v_mfma_f32_32x32x16_bf16 v[4:19], v[84:87], a[168:171], v[4:19]
    s_waitcnt vmcnt(13)
    s_barrier
    v_add_u32 v118, 16384, v117
    ds_read_b64_tr_b16 v[84:85], v118 offset:0
    ds_read_b64_tr_b16 v[86:87], v118 offset:1024
    buffer_load_dwordx4 a[164:167], v116, s[8:11], s24 offen offset:1024
    s_mov_b32 s25, 1703936
    s_add_u32 m0, s23, 49152
    s_nop 0
    buffer_load_dwordx4 v119, s[12:15], s25 offen lds
    s_waitcnt lgkmcnt(14)
    v_mfma_f32_32x32x16_bf16 v[20:35], v[88:91], a[168:171], v[20:35]
    ds_read_b64_tr_b16 v[88:89], v118 offset:512
    ds_read_b64_tr_b16 v[90:91], v118 offset:1536
    s_add_u32 m0, s23, 50176
    s_nop 0
    buffer_load_dwordx4 v120, s[12:15], s25 offen lds
    s_mov_b32 s25, 3407872
    s_add_u32 m0, s23, 139264
    s_nop 0
    buffer_load_dwordx4 v121, s[12:15], s25 offen lds
    s_waitcnt lgkmcnt(14)
    v_mfma_f32_32x32x16_bf16 v[36:51], v[92:95], a[72:75], v[36:51]
    ds_read_b64_tr_b16 v[92:93], v118 offset:8192
    ds_read_b64_tr_b16 v[94:95], v118 offset:9216
    s_add_u32 m0, s23, 140288
    s_nop 0
    buffer_load_dwordx4 v122, s[12:15], s25 offen lds
    s_waitcnt lgkmcnt(14)
    v_mfma_f32_32x32x16_bf16 v[52:67], v[96:99], a[72:75], v[52:67]
    ds_read_b64_tr_b16 v[96:97], v118 offset:8704
    ds_read_b64_tr_b16 v[98:99], v118 offset:9728
    s_waitcnt lgkmcnt(14)
    v_mfma_f32_32x32x16_bf16 v[4:19], v[100:103], a[172:175], v[4:19]
    ds_read_b64_tr_b16 v[100:101], v118 offset:2048
    ds_read_b64_tr_b16 v[102:103], v118 offset:3072
    buffer_load_dwordx4 a[168:171], v116, s[8:11], s24 offen offset:2048
    s_waitcnt lgkmcnt(14)
    v_mfma_f32_32x32x16_bf16 v[20:35], v[104:107], a[172:175], v[20:35]
    ds_read_b64_tr_b16 v[104:105], v118 offset:2560
    ds_read_b64_tr_b16 v[106:107], v118 offset:3584
    s_waitcnt lgkmcnt(14)
    v_mfma_f32_32x32x16_bf16 v[36:51], v[108:111], a[76:79], v[36:51]
    ds_read_b64_tr_b16 v[108:109], v118 offset:10240
    ds_read_b64_tr_b16 v[110:111], v118 offset:11264
    s_waitcnt lgkmcnt(14)
    v_mfma_f32_32x32x16_bf16 v[52:67], v[112:115], a[76:79], v[52:67]
    ds_read_b64_tr_b16 v[112:113], v118 offset:10752
    ds_read_b64_tr_b16 v[114:115], v118 offset:11776
    s_waitcnt lgkmcnt(14)
    v_mfma_f32_32x32x16_bf16 v[4:19], v[84:87], a[176:179], v[4:19]
    ds_read_b64_tr_b16 v[84:85], v118 offset:4096
    ds_read_b64_tr_b16 v[86:87], v118 offset:5120
    buffer_load_dwordx4 a[172:175], v116, s[8:11], s24 offen offset:3072
    s_waitcnt lgkmcnt(14)
    v_mfma_f32_32x32x16_bf16 v[20:35], v[88:91], a[176:179], v[20:35]
    ds_read_b64_tr_b16 v[88:89], v118 offset:4608
    ds_read_b64_tr_b16 v[90:91], v118 offset:5632
    s_waitcnt lgkmcnt(14)
    v_mfma_f32_32x32x16_bf16 v[36:51], v[92:95], a[80:83], v[36:51]
    ds_read_b64_tr_b16 v[92:93], v118 offset:12288
    ds_read_b64_tr_b16 v[94:95], v118 offset:13312
    s_waitcnt lgkmcnt(14)
    v_mfma_f32_32x32x16_bf16 v[52:67], v[96:99], a[80:83], v[52:67]
    ds_read_b64_tr_b16 v[96:97], v118 offset:12800
    ds_read_b64_tr_b16 v[98:99], v118 offset:13824
    s_waitcnt lgkmcnt(14)
    v_mfma_f32_32x32x16_bf16 v[4:19], v[100:103], a[180:183], v[4:19]
    ds_read_b64_tr_b16 v[100:101], v118 offset:6144
    ds_read_b64_tr_b16 v[102:103], v118 offset:7168
    s_mov_b32 s24, 102400
    buffer_load_dwordx4 a[176:179], v116, s[8:11], s24 offen offset:0
    s_waitcnt lgkmcnt(14)
    v_mfma_f32_32x32x16_bf16 v[20:35], v[104:107], a[180:183], v[20:35]
    ds_read_b64_tr_b16 v[104:105], v118 offset:6656
    ds_read_b64_tr_b16 v[106:107], v118 offset:7680
    s_waitcnt lgkmcnt(14)
    v_mfma_f32_32x32x16_bf16 v[36:51], v[108:111], a[84:87], v[36:51]
    ds_read_b64_tr_b16 v[108:109], v118 offset:14336
    ds_read_b64_tr_b16 v[110:111], v118 offset:15360
    s_waitcnt lgkmcnt(14)
    v_mfma_f32_32x32x16_bf16 v[52:67], v[112:115], a[84:87], v[52:67]
    ds_read_b64_tr_b16 v[112:113], v118 offset:14848
    ds_read_b64_tr_b16 v[114:115], v118 offset:15872
    s_waitcnt lgkmcnt(14)
    v_mfma_f32_32x32x16_bf16 v[4:19], v[84:87], a[184:187], v[4:19]
    s_waitcnt vmcnt(13)
    s_barrier
    v_add_u32 v118, 32768, v117
    ds_read_b64_tr_b16 v[84:85], v118 offset:0
    ds_read_b64_tr_b16 v[86:87], v118 offset:1024
    buffer_load_dwordx4 a[180:183], v116, s[8:11], s24 offen offset:1024
    s_mov_b32 s25, 1835008
    s_add_u32 m0, s23, 65536
    s_nop 0
    buffer_load_dwordx4 v119, s[12:15], s25 offen lds
    s_waitcnt lgkmcnt(14)
    v_mfma_f32_32x32x16_bf16 v[20:35], v[88:91], a[184:187], v[20:35]
    ds_read_b64_tr_b16 v[88:89], v118 offset:512
    ds_read_b64_tr_b16 v[90:91], v118 offset:1536
    s_add_u32 m0, s23, 66560
    s_nop 0
    buffer_load_dwordx4 v120, s[12:15], s25 offen lds
    s_mov_b32 s25, 3538944
    s_add_u32 m0, s23, 8192
    s_nop 0
    buffer_load_dwordx4 v121, s[12:15], s25 offen lds
    s_waitcnt lgkmcnt(14)
    v_mfma_f32_32x32x16_bf16 v[36:51], v[92:95], a[88:91], v[36:51]
    ds_read_b64_tr_b16 v[92:93], v118 offset:8192
    ds_read_b64_tr_b16 v[94:95], v118 offset:9216
    s_add_u32 m0, s23, 9216
    s_nop 0
    buffer_load_dwordx4 v122, s[12:15], s25 offen lds
    s_waitcnt lgkmcnt(14)
    v_mfma_f32_32x32x16_bf16 v[52:67], v[96:99], a[88:91], v[52:67]
    ds_read_b64_tr_b16 v[96:97], v118 offset:8704
    ds_read_b64_tr_b16 v[98:99], v118 offset:9728
    s_waitcnt lgkmcnt(14)
    v_mfma_f32_32x32x16_bf16 v[4:19], v[100:103], a[188:191], v[4:19]
    ds_read_b64_tr_b16 v[100:101], v118 offset:2048
    ds_read_b64_tr_b16 v[102:103], v118 offset:3072
    buffer_load_dwordx4 a[184:187], v116, s[8:11], s24 offen offset:2048
    s_waitcnt lgkmcnt(14)
    v_mfma_f32_32x32x16_bf16 v[20:35], v[104:107], a[188:191], v[20:35]
    ds_read_b64_tr_b16 v[104:105], v118 offset:2560
    ds_read_b64_tr_b16 v[106:107], v118 offset:3584
    s_waitcnt lgkmcnt(14)
    v_mfma_f32_32x32x16_bf16 v[36:51], v[108:111], a[92:95], v[36:51]
    ds_read_b64_tr_b16 v[108:109], v118 offset:10240
    ds_read_b64_tr_b16 v[110:111], v118 offset:11264
    s_waitcnt lgkmcnt(14)
    v_mfma_f32_32x32x16_bf16 v[52:67], v[112:115], a[92:95], v[52:67]
    ds_read_b64_tr_b16 v[112:113], v118 offset:10752
    ds_read_b64_tr_b16 v[114:115], v118 offset:11776
    s_waitcnt lgkmcnt(14)
    v_mfma_f32_32x32x16_bf16 v[4:19], v[84:87], a[192:195], v[4:19]
    ds_read_b64_tr_b16 v[84:85], v118 offset:4096
    ds_read_b64_tr_b16 v[86:87], v118 offset:5120
    buffer_load_dwordx4 a[188:191], v116, s[8:11], s24 offen offset:3072
    s_waitcnt lgkmcnt(14)
    v_mfma_f32_32x32x16_bf16 v[20:35], v[88:91], a[192:195], v[20:35]
    ds_read_b64_tr_b16 v[88:89], v118 offset:4608
    ds_read_b64_tr_b16 v[90:91], v118 offset:5632
    s_waitcnt lgkmcnt(14)
    v_mfma_f32_32x32x16_bf16 v[36:51], v[92:95], a[96:99], v[36:51]
    ds_read_b64_tr_b16 v[92:93], v118 offset:12288
    ds_read_b64_tr_b16 v[94:95], v118 offset:13312
    s_waitcnt lgkmcnt(14)
    v_mfma_f32_32x32x16_bf16 v[52:67], v[96:99], a[96:99], v[52:67]
    ds_read_b64_tr_b16 v[96:97], v118 offset:12800
    ds_read_b64_tr_b16 v[98:99], v118 offset:13824
    s_waitcnt lgkmcnt(14)
    v_mfma_f32_32x32x16_bf16 v[4:19], v[100:103], a[196:199], v[4:19]
    ds_read_b64_tr_b16 v[100:101], v118 offset:6144
    ds_read_b64_tr_b16 v[102:103], v118 offset:7168
    s_mov_b32 s24, 106496
    buffer_load_dwordx4 a[192:195], v116, s[8:11], s24 offen offset:0
    s_waitcnt lgkmcnt(14)
    v_mfma_f32_32x32x16_bf16 v[20:35], v[104:107], a[196:199], v[20:35]
    ds_read_b64_tr_b16 v[104:105], v118 offset:6656
    ds_read_b64_tr_b16 v[106:107], v118 offset:7680
    s_waitcnt lgkmcnt(14)
    v_mfma_f32_32x32x16_bf16 v[36:51], v[108:111], a[100:103], v[36:51]
    ds_read_b64_tr_b16 v[108:109], v118 offset:14336
    ds_read_b64_tr_b16 v[110:111], v118 offset:15360
    s_waitcnt lgkmcnt(14)
    v_mfma_f32_32x32x16_bf16 v[52:67], v[112:115], a[100:103], v[52:67]
    ds_read_b64_tr_b16 v[112:113], v118 offset:14848
    ds_read_b64_tr_b16 v[114:115], v118 offset:15872
    s_waitcnt lgkmcnt(14)
    v_mfma_f32_32x32x16_bf16 v[4:19], v[84:87], a[200:203], v[4:19]
    s_waitcnt vmcnt(13)
    s_barrier
    v_add_u32 v118, 49152, v117
    ds_read_b64_tr_b16 v[84:85], v118 offset:0
    ds_read_b64_tr_b16 v[86:87], v118 offset:1024
    buffer_load_dwordx4 a[196:199], v116, s[8:11], s24 offen offset:1024
    s_mov_b32 s25, 1966080
    s_add_u32 m0, s23, 81920
    s_nop 0
    buffer_load_dwordx4 v119, s[12:15], s25 offen lds
    s_waitcnt lgkmcnt(14)
    v_mfma_f32_32x32x16_bf16 v[20:35], v[88:91], a[200:203], v[20:35]
    ds_read_b64_tr_b16 v[88:89], v118 offset:512
    ds_read_b64_tr_b16 v[90:91], v118 offset:1536
    s_add_u32 m0, s23, 82944
    s_nop 0
    buffer_load_dwordx4 v120, s[12:15], s25 offen lds
    s_waitcnt lgkmcnt(14)
    v_mfma_f32_32x32x16_bf16 v[36:51], v[92:95], a[104:107], v[36:51]
    ds_read_b64_tr_b16 v[92:93], v118 offset:8192
    ds_read_b64_tr_b16 v[94:95], v118 offset:9216
    s_waitcnt lgkmcnt(14)
    v_mfma_f32_32x32x16_bf16 v[52:67], v[96:99], a[104:107], v[52:67]
    ds_read_b64_tr_b16 v[96:97], v118 offset:8704
    ds_read_b64_tr_b16 v[98:99], v118 offset:9728
    s_waitcnt lgkmcnt(14)
    v_mfma_f32_32x32x16_bf16 v[4:19], v[100:103], a[204:207], v[4:19]
    ds_read_b64_tr_b16 v[100:101], v118 offset:2048
    ds_read_b64_tr_b16 v[102:103], v118 offset:3072
    buffer_load_dwordx4 a[200:203], v116, s[8:11], s24 offen offset:2048
    s_waitcnt lgkmcnt(14)
    v_mfma_f32_32x32x16_bf16 v[20:35], v[104:107], a[204:207], v[20:35]
    ds_read_b64_tr_b16 v[104:105], v118 offset:2560
    ds_read_b64_tr_b16 v[106:107], v118 offset:3584
    s_waitcnt lgkmcnt(14)
    v_mfma_f32_32x32x16_bf16 v[36:51], v[108:111], a[108:111], v[36:51]
    ds_read_b64_tr_b16 v[108:109], v118 offset:10240
    ds_read_b64_tr_b16 v[110:111], v118 offset:11264
    s_waitcnt lgkmcnt(14)
    v_mfma_f32_32x32x16_bf16 v[52:67], v[112:115], a[108:111], v[52:67]
    ds_read_b64_tr_b16 v[112:113], v118 offset:10752
    ds_read_b64_tr_b16 v[114:115], v118 offset:11776
    s_waitcnt lgkmcnt(14)
    v_mfma_f32_32x32x16_bf16 v[4:19], v[84:87], a[208:211], v[4:19]
    ds_read_b64_tr_b16 v[84:85], v118 offset:4096
    ds_read_b64_tr_b16 v[86:87], v118 offset:5120
    buffer_load_dwordx4 a[204:207], v116, s[8:11], s24 offen offset:3072
    s_waitcnt lgkmcnt(14)
    v_mfma_f32_32x32x16_bf16 v[20:35], v[88:91], a[208:211], v[20:35]
    ds_read_b64_tr_b16 v[88:89], v118 offset:4608
    ds_read_b64_tr_b16 v[90:91], v118 offset:5632
    s_waitcnt lgkmcnt(14)
    v_mfma_f32_32x32x16_bf16 v[36:51], v[92:95], a[112:115], v[36:51]
    ds_read_b64_tr_b16 v[92:93], v118 offset:12288
    ds_read_b64_tr_b16 v[94:95], v118 offset:13312
    s_waitcnt lgkmcnt(14)
    v_mfma_f32_32x32x16_bf16 v[52:67], v[96:99], a[112:115], v[52:67]
    ds_read_b64_tr_b16 v[96:97], v118 offset:12800
    ds_read_b64_tr_b16 v[98:99], v118 offset:13824
    s_waitcnt lgkmcnt(14)
    v_mfma_f32_32x32x16_bf16 v[4:19], v[100:103], a[212:215], v[4:19]
    ds_read_b64_tr_b16 v[100:101], v118 offset:6144
    ds_read_b64_tr_b16 v[102:103], v118 offset:7168
    s_mov_b32 s24, 110592
    buffer_load_dwordx4 a[208:211], v116, s[8:11], s24 offen offset:0
    s_waitcnt lgkmcnt(14)
    v_mfma_f32_32x32x16_bf16 v[20:35], v[104:107], a[212:215], v[20:35]
    ds_read_b64_tr_b16 v[104:105], v118 offset:6656
    ds_read_b64_tr_b16 v[106:107], v118 offset:7680
    s_waitcnt lgkmcnt(14)
    v_mfma_f32_32x32x16_bf16 v[36:51], v[108:111], a[116:119], v[36:51]
    ds_read_b64_tr_b16 v[108:109], v118 offset:14336
    ds_read_b64_tr_b16 v[110:111], v118 offset:15360
    s_waitcnt lgkmcnt(14)
    v_mfma_f32_32x32x16_bf16 v[52:67], v[112:115], a[116:119], v[52:67]
    ds_read_b64_tr_b16 v[112:113], v118 offset:14848
    ds_read_b64_tr_b16 v[114:115], v118 offset:15872
    s_waitcnt lgkmcnt(14)
    v_mfma_f32_32x32x16_bf16 v[4:19], v[84:87], a[216:219], v[4:19]
    s_waitcnt vmcnt(11)
    s_barrier
    v_add_u32 v118, 65536, v117
    ds_read_b64_tr_b16 v[84:85], v118 offset:0
    ds_read_b64_tr_b16 v[86:87], v118 offset:1024
    buffer_load_dwordx4 a[212:215], v116, s[8:11], s24 offen offset:1024
    s_mov_b32 s25, 2097152
    s_add_u32 m0, s23, 98304
    s_nop 0
    buffer_load_dwordx4 v119, s[12:15], s25 offen lds
    s_waitcnt lgkmcnt(14)
    v_mfma_f32_32x32x16_bf16 v[20:35], v[88:91], a[216:219], v[20:35]
    ds_read_b64_tr_b16 v[88:89], v118 offset:512
    ds_read_b64_tr_b16 v[90:91], v118 offset:1536
    s_add_u32 m0, s23, 99328
    s_nop 0
    buffer_load_dwordx4 v120, s[12:15], s25 offen lds
    s_waitcnt lgkmcnt(14)
    v_mfma_f32_32x32x16_bf16 v[36:51], v[92:95], a[120:123], v[36:51]
    ds_read_b64_tr_b16 v[92:93], v118 offset:8192
    ds_read_b64_tr_b16 v[94:95], v118 offset:9216
    s_waitcnt lgkmcnt(14)
    v_mfma_f32_32x32x16_bf16 v[52:67], v[96:99], a[120:123], v[52:67]
    ds_read_b64_tr_b16 v[96:97], v118 offset:8704
    ds_read_b64_tr_b16 v[98:99], v118 offset:9728
    s_waitcnt lgkmcnt(14)
    v_mfma_f32_32x32x16_bf16 v[4:19], v[100:103], a[220:223], v[4:19]
    ds_read_b64_tr_b16 v[100:101], v118 offset:2048
    ds_read_b64_tr_b16 v[102:103], v118 offset:3072
    buffer_load_dwordx4 a[216:219], v116, s[8:11], s24 offen offset:2048
    s_waitcnt lgkmcnt(14)
    v_mfma_f32_32x32x16_bf16 v[20:35], v[104:107], a[220:223], v[20:35]
    ds_read_b64_tr_b16 v[104:105], v118 offset:2560
    ds_read_b64_tr_b16 v[106:107], v118 offset:3584
    s_waitcnt lgkmcnt(14)
    v_mfma_f32_32x32x16_bf16 v[36:51], v[108:111], a[124:127], v[36:51]
    ds_read_b64_tr_b16 v[108:109], v118 offset:10240
    ds_read_b64_tr_b16 v[110:111], v118 offset:11264
    s_waitcnt lgkmcnt(14)
    v_mfma_f32_32x32x16_bf16 v[52:67], v[112:115], a[124:127], v[52:67]
    ds_read_b64_tr_b16 v[112:113], v118 offset:10752
    ds_read_b64_tr_b16 v[114:115], v118 offset:11776
    s_waitcnt lgkmcnt(14)
    v_mfma_f32_32x32x16_bf16 v[4:19], v[84:87], a[0:3], v[4:19]
    ds_read_b64_tr_b16 v[84:85], v118 offset:4096
    ds_read_b64_tr_b16 v[86:87], v118 offset:5120
    buffer_load_dwordx4 a[220:223], v116, s[8:11], s24 offen offset:3072
    s_waitcnt lgkmcnt(14)
    v_mfma_f32_32x32x16_bf16 v[20:35], v[88:91], a[0:3], v[20:35]
    ds_read_b64_tr_b16 v[88:89], v118 offset:4608
    ds_read_b64_tr_b16 v[90:91], v118 offset:5632
    s_waitcnt lgkmcnt(14)
    v_mfma_f32_32x32x16_bf16 v[36:51], v[92:95], a[128:131], v[36:51]
    ds_read_b64_tr_b16 v[92:93], v118 offset:12288
    ds_read_b64_tr_b16 v[94:95], v118 offset:13312
    s_waitcnt lgkmcnt(14)
    v_mfma_f32_32x32x16_bf16 v[52:67], v[96:99], a[128:131], v[52:67]
    ds_read_b64_tr_b16 v[96:97], v118 offset:12800
    ds_read_b64_tr_b16 v[98:99], v118 offset:13824
    s_waitcnt lgkmcnt(14)
    v_mfma_f32_32x32x16_bf16 v[4:19], v[100:103], a[4:7], v[4:19]
    ds_read_b64_tr_b16 v[100:101], v118 offset:6144
    ds_read_b64_tr_b16 v[102:103], v118 offset:7168
    s_waitcnt lgkmcnt(14)
    v_mfma_f32_32x32x16_bf16 v[20:35], v[104:107], a[4:7], v[20:35]
    ds_read_b64_tr_b16 v[104:105], v118 offset:6656
    ds_read_b64_tr_b16 v[106:107], v118 offset:7680
    s_waitcnt lgkmcnt(14)
    v_mfma_f32_32x32x16_bf16 v[36:51], v[108:111], a[132:135], v[36:51]
    ds_read_b64_tr_b16 v[108:109], v118 offset:14336
    ds_read_b64_tr_b16 v[110:111], v118 offset:15360
    s_waitcnt lgkmcnt(14)
    v_mfma_f32_32x32x16_bf16 v[52:67], v[112:115], a[132:135], v[52:67]
    ds_read_b64_tr_b16 v[112:113], v118 offset:14848
    ds_read_b64_tr_b16 v[114:115], v118 offset:15872
    s_waitcnt lgkmcnt(14)
    v_mfma_f32_32x32x16_bf16 v[4:19], v[84:87], a[8:11], v[4:19]
    s_waitcnt vmcnt(8)
    s_barrier
    v_add_u32 v118, 81920, v117
    ds_read_b64_tr_b16 v[84:85], v118 offset:0
    ds_read_b64_tr_b16 v[86:87], v118 offset:1024
    s_mov_b32 s25, 2228224
    s_add_u32 m0, s23, 114688
    s_nop 0
    buffer_load_dwordx4 v119, s[12:15], s25 offen lds
    s_waitcnt lgkmcnt(14)
    v_mfma_f32_32x32x16_bf16 v[20:35], v[88:91], a[8:11], v[20:35]
    ds_read_b64_tr_b16 v[88:89], v118 offset:512
    ds_read_b64_tr_b16 v[90:91], v118 offset:1536
    s_add_u32 m0, s23, 115712
    s_nop 0
    buffer_load_dwordx4 v120, s[12:15], s25 offen lds
    s_mov_b32 s25, 2359296
    s_add_u32 m0, s23, 131072
    s_nop 0
    buffer_load_dwordx4 v119, s[12:15], s25 offen lds
    s_waitcnt lgkmcnt(14)
    v_mfma_f32_32x32x16_bf16 v[36:51], v[92:95], a[136:139], v[36:51]
    ds_read_b64_tr_b16 v[92:93], v118 offset:8192
    ds_read_b64_tr_b16 v[94:95], v118 offset:9216
    s_add_u32 m0, s23, 132096
    s_nop 0
    buffer_load_dwordx4 v120, s[12:15], s25 offen lds
    s_mov_b32 s25, 2490368
    s_add_u32 m0, s23, 0
    s_nop 0
    buffer_load_dwordx4 v119, s[12:15], s25 offen lds
    s_waitcnt lgkmcnt(14)
    v_mfma_f32_32x32x16_bf16 v[52:67], v[96:99], a[136:139], v[52:67]
    ds_read_b64_tr_b16 v[96:97], v118 offset:8704
    ds_read_b64_tr_b16 v[98:99], v118 offset:9728
    s_add_u32 m0, s23, 1024
    s_nop 0
    buffer_load_dwordx4 v120, s[12:15], s25 offen lds
    s_mov_b32 s25, 2621440
    s_add_u32 m0, s23, 16384
    s_nop 0
    buffer_load_dwordx4 v119, s[12:15], s25 offen lds
    s_waitcnt lgkmcnt(14)
    v_mfma_f32_32x32x16_bf16 v[4:19], v[100:103], a[12:15], v[4:19]
    ds_read_b64_tr_b16 v[100:101], v118 offset:2048
    ds_read_b64_tr_b16 v[102:103], v118 offset:3072
    s_add_u32 m0, s23, 17408
    s_nop 0
    buffer_load_dwordx4 v120, s[12:15], s25 offen lds
    s_mov_b32 s25, 2752512
    s_add_u32 m0, s23, 32768
    s_nop 0
    buffer_load_dwordx4 v119, s[12:15], s25 offen lds
    s_waitcnt lgkmcnt(14)
    v_mfma_f32_32x32x16_bf16 v[20:35], v[104:107], a[12:15], v[20:35]
    ds_read_b64_tr_b16 v[104:105], v118 offset:2560
    ds_read_b64_tr_b16 v[106:107], v118 offset:3584
    s_add_u32 m0, s23, 33792
    s_nop 0
    buffer_load_dwordx4 v120, s[12:15], s25 offen lds
    s_waitcnt lgkmcnt(14)
    v_mfma_f32_32x32x16_bf16 v[36:51], v[108:111], a[140:143], v[36:51]
    ds_read_b64_tr_b16 v[108:109], v118 offset:10240
    ds_read_b64_tr_b16 v[110:111], v118 offset:11264
    s_mov_b32 s25, 2883584
    s_add_u32 m0, s23, 49152
    s_nop 0
    buffer_load_dwordx4 v119, s[12:15], s25 offen lds
    s_waitcnt lgkmcnt(14)
    v_mfma_f32_32x32x16_bf16 v[52:67], v[112:115], a[140:143], v[52:67]
    ds_read_b64_tr_b16 v[112:113], v118 offset:10752
    ds_read_b64_tr_b16 v[114:115], v118 offset:11776
    s_add_u32 m0, s23, 50176
    s_nop 0
    buffer_load_dwordx4 v120, s[12:15], s25 offen lds
    s_waitcnt lgkmcnt(14)
    v_mfma_f32_32x32x16_bf16 v[4:19], v[84:87], a[16:19], v[4:19]
    ds_read_b64_tr_b16 v[84:85], v118 offset:4096
    ds_read_b64_tr_b16 v[86:87], v118 offset:5120
    s_waitcnt lgkmcnt(14)
    v_mfma_f32_32x32x16_bf16 v[20:35], v[88:91], a[16:19], v[20:35]
    ds_read_b64_tr_b16 v[88:89], v118 offset:4608
    ds_read_b64_tr_b16 v[90:91], v118 offset:5632
    s_waitcnt lgkmcnt(14)
    v_mfma_f32_32x32x16_bf16 v[36:51], v[92:95], a[144:147], v[36:51]
    ds_read_b64_tr_b16 v[92:93], v118 offset:12288
    ds_read_b64_tr_b16 v[94:95], v118 offset:13312
    s_waitcnt lgkmcnt(14)
    v_mfma_f32_32x32x16_bf16 v[52:67], v[96:99], a[144:147], v[52:67]
    ds_read_b64_tr_b16 v[96:97], v118 offset:12800
    ds_read_b64_tr_b16 v[98:99], v118 offset:13824
    s_waitcnt lgkmcnt(14)
    v_mfma_f32_32x32x16_bf16 v[4:19], v[100:103], a[20:23], v[4:19]
    ds_read_b64_tr_b16 v[100:101], v118 offset:6144
    ds_read_b64_tr_b16 v[102:103], v118 offset:7168
    s_waitcnt lgkmcnt(14)
    v_mfma_f32_32x32x16_bf16 v[20:35], v[104:107], a[20:23], v[20:35]
    ds_read_b64_tr_b16 v[104:105], v118 offset:6656
    ds_read_b64_tr_b16 v[106:107], v118 offset:7680
    s_waitcnt lgkmcnt(14)
    v_mfma_f32_32x32x16_bf16 v[36:51], v[108:111], a[148:151], v[36:51]
    ds_read_b64_tr_b16 v[108:109], v118 offset:14336
    ds_read_b64_tr_b16 v[110:111], v118 offset:15360
    s_waitcnt lgkmcnt(14)
    v_mfma_f32_32x32x16_bf16 v[52:67], v[112:115], a[148:151], v[52:67]
    ds_read_b64_tr_b16 v[112:113], v118 offset:14848
    ds_read_b64_tr_b16 v[114:115], v118 offset:15872
    s_waitcnt lgkmcnt(14)
    v_mfma_f32_32x32x16_bf16 v[4:19], v[84:87], a[24:27], v[4:19]
    s_waitcnt vmcnt(14)
    s_barrier
    v_add_u32 v118, 98304, v117
    ds_read_b64_tr_b16 v[84:85], v118 offset:0
    ds_read_b64_tr_b16 v[86:87], v118 offset:1024
    s_waitcnt lgkmcnt(14)
    v_mfma_f32_32x32x16_bf16 v[20:35], v[88:91], a[24:27], v[20:35]
    ds_read_b64_tr_b16 v[88:89], v118 offset:512
    ds_read_b64_tr_b16 v[90:91], v118 offset:1536
    s_mov_b32 s25, 3014656
    s_add_u32 m0, s23, 65536
    s_nop 0
    buffer_load_dwordx4 v119, s[12:15], s25 offen lds
    s_waitcnt lgkmcnt(14)
    v_mfma_f32_32x32x16_bf16 v[36:51], v[92:95], a[152:155], v[36:51]
    ds_read_b64_tr_b16 v[92:93], v118 offset:8192
    ds_read_b64_tr_b16 v[94:95], v118 offset:9216
    s_add_u32 m0, s23, 66560
    s_nop 0
    buffer_load_dwordx4 v120, s[12:15], s25 offen lds
    s_waitcnt lgkmcnt(14)
    v_mfma_f32_32x32x16_bf16 v[52:67], v[96:99], a[152:155], v[52:67]
    ds_read_b64_tr_b16 v[96:97], v118 offset:8704
    ds_read_b64_tr_b16 v[98:99], v118 offset:9728
    s_waitcnt lgkmcnt(14)
    v_mfma_f32_32x32x16_bf16 v[4:19], v[100:103], a[28:31], v[4:19]
    ds_read_b64_tr_b16 v[100:101], v118 offset:2048
    ds_read_b64_tr_b16 v[102:103], v118 offset:3072
    s_waitcnt lgkmcnt(14)
    v_mfma_f32_32x32x16_bf16 v[20:35], v[104:107], a[28:31], v[20:35]
    ds_read_b64_tr_b16 v[104:105], v118 offset:2560
    ds_read_b64_tr_b16 v[106:107], v118 offset:3584
    s_waitcnt lgkmcnt(14)
    v_mfma_f32_32x32x16_bf16 v[36:51], v[108:111], a[156:159], v[36:51]
    ds_read_b64_tr_b16 v[108:109], v118 offset:10240
    ds_read_b64_tr_b16 v[110:111], v118 offset:11264
    s_waitcnt lgkmcnt(14)
    v_mfma_f32_32x32x16_bf16 v[52:67], v[112:115], a[156:159], v[52:67]
    ds_read_b64_tr_b16 v[112:113], v118 offset:10752
    ds_read_b64_tr_b16 v[114:115], v118 offset:11776
    s_waitcnt lgkmcnt(14)
    v_mfma_f32_32x32x16_bf16 v[4:19], v[84:87], a[32:35], v[4:19]
    ds_read_b64_tr_b16 v[84:85], v118 offset:4096
    ds_read_b64_tr_b16 v[86:87], v118 offset:5120
    s_waitcnt lgkmcnt(14)
    v_mfma_f32_32x32x16_bf16 v[20:35], v[88:91], a[32:35], v[20:35]
    ds_read_b64_tr_b16 v[88:89], v118 offset:4608
    ds_read_b64_tr_b16 v[90:91], v118 offset:5632
    s_waitcnt lgkmcnt(14)
    v_mfma_f32_32x32x16_bf16 v[36:51], v[92:95], a[160:163], v[36:51]
    ds_read_b64_tr_b16 v[92:93], v118 offset:12288
    ds_read_b64_tr_b16 v[94:95], v118 offset:13312
    s_waitcnt lgkmcnt(14)
    v_mfma_f32_32x32x16_bf16 v[52:67], v[96:99], a[160:163], v[52:67]
    ds_read_b64_tr_b16 v[96:97], v118 offset:12800
    ds_read_b64_tr_b16 v[98:99], v118 offset:13824
    s_waitcnt lgkmcnt(14)
    v_mfma_f32_32x32x16_bf16 v[4:19], v[100:103], a[36:39], v[4:19]
    ds_read_b64_tr_b16 v[100:101], v118 offset:6144
    ds_read_b64_tr_b16 v[102:103], v118 offset:7168
    s_waitcnt lgkmcnt(14)
    v_mfma_f32_32x32x16_bf16 v[20:35], v[104:107], a[36:39], v[20:35]
    ds_read_b64_tr_b16 v[104:105], v118 offset:6656
    ds_read_b64_tr_b16 v[106:107], v118 offset:7680
    s_waitcnt lgkmcnt(14)
    v_mfma_f32_32x32x16_bf16 v[36:51], v[108:111], a[164:167], v[36:51]
    ds_read_b64_tr_b16 v[108:109], v118 offset:14336
    ds_read_b64_tr_b16 v[110:111], v118 offset:15360
    s_waitcnt lgkmcnt(14)
    v_mfma_f32_32x32x16_bf16 v[52:67], v[112:115], a[164:167], v[52:67]
    ds_read_b64_tr_b16 v[112:113], v118 offset:14848
    ds_read_b64_tr_b16 v[114:115], v118 offset:15872
    s_waitcnt lgkmcnt(14)
    v_mfma_f32_32x32x16_bf16 v[4:19], v[84:87], a[40:43], v[4:19]
    s_waitcnt vmcnt(12)
    s_barrier
    v_add_u32 v118, 114688, v117
    ds_read_b64_tr_b16 v[84:85], v118 offset:0
    ds_read_b64_tr_b16 v[86:87], v118 offset:1024
    s_waitcnt lgkmcnt(14)
    v_mfma_f32_32x32x16_bf16 v[20:35], v[88:91], a[40:43], v[20:35]
    ds_read_b64_tr_b16 v[88:89], v118 offset:512
    ds_read_b64_tr_b16 v[90:91], v118 offset:1536
    s_mov_b32 s25, 3145728
    s_add_u32 m0, s23, 81920
    s_nop 0
    buffer_load_dwordx4 v119, s[12:15], s25 offen lds
    s_waitcnt lgkmcnt(14)
    v_mfma_f32_32x32x16_bf16 v[36:51], v[92:95], a[168:171], v[36:51]
    ds_read_b64_tr_b16 v[92:93], v118 offset:8192
    ds_read_b64_tr_b16 v[94:95], v118 offset:9216
    s_add_u32 m0, s23, 82944
    s_nop 0
    buffer_load_dwordx4 v120, s[12:15], s25 offen lds
    s_waitcnt lgkmcnt(14)
    v_mfma_f32_32x32x16_bf16 v[52:67], v[96:99], a[168:171], v[52:67]
    ds_read_b64_tr_b16 v[96:97], v118 offset:8704
    ds_read_b64_tr_b16 v[98:99], v118 offset:9728
    s_waitcnt lgkmcnt(14)
    v_mfma_f32_32x32x16_bf16 v[4:19], v[100:103], a[44:47], v[4:19]
    ds_read_b64_tr_b16 v[100:101], v118 offset:2048
    ds_read_b64_tr_b16 v[102:103], v118 offset:3072
    s_waitcnt lgkmcnt(14)
    v_mfma_f32_32x32x16_bf16 v[20:35], v[104:107], a[44:47], v[20:35]
    ds_read_b64_tr_b16 v[104:105], v118 offset:2560
    ds_read_b64_tr_b16 v[106:107], v118 offset:3584
    s_waitcnt lgkmcnt(14)
    v_mfma_f32_32x32x16_bf16 v[36:51], v[108:111], a[172:175], v[36:51]
    ds_read_b64_tr_b16 v[108:109], v118 offset:10240
    ds_read_b64_tr_b16 v[110:111], v118 offset:11264
    s_waitcnt lgkmcnt(14)
    v_mfma_f32_32x32x16_bf16 v[52:67], v[112:115], a[172:175], v[52:67]
    ds_read_b64_tr_b16 v[112:113], v118 offset:10752
    ds_read_b64_tr_b16 v[114:115], v118 offset:11776
    s_waitcnt lgkmcnt(14)
    v_mfma_f32_32x32x16_bf16 v[4:19], v[84:87], a[48:51], v[4:19]
    ds_read_b64_tr_b16 v[84:85], v118 offset:4096
    ds_read_b64_tr_b16 v[86:87], v118 offset:5120
    s_waitcnt lgkmcnt(14)
    v_mfma_f32_32x32x16_bf16 v[20:35], v[88:91], a[48:51], v[20:35]
    ds_read_b64_tr_b16 v[88:89], v118 offset:4608
    ds_read_b64_tr_b16 v[90:91], v118 offset:5632
    s_waitcnt lgkmcnt(14)
    v_mfma_f32_32x32x16_bf16 v[36:51], v[92:95], a[176:179], v[36:51]
    ds_read_b64_tr_b16 v[92:93], v118 offset:12288
    ds_read_b64_tr_b16 v[94:95], v118 offset:13312
    s_waitcnt lgkmcnt(14)
    v_mfma_f32_32x32x16_bf16 v[52:67], v[96:99], a[176:179], v[52:67]
    ds_read_b64_tr_b16 v[96:97], v118 offset:12800
    ds_read_b64_tr_b16 v[98:99], v118 offset:13824
    s_waitcnt lgkmcnt(14)
    v_mfma_f32_32x32x16_bf16 v[4:19], v[100:103], a[52:55], v[4:19]
    ds_read_b64_tr_b16 v[100:101], v118 offset:6144
    ds_read_b64_tr_b16 v[102:103], v118 offset:7168
    s_waitcnt lgkmcnt(14)
    v_mfma_f32_32x32x16_bf16 v[20:35], v[104:107], a[52:55], v[20:35]
    ds_read_b64_tr_b16 v[104:105], v118 offset:6656
    ds_read_b64_tr_b16 v[106:107], v118 offset:7680
    s_waitcnt lgkmcnt(14)
    v_mfma_f32_32x32x16_bf16 v[36:51], v[108:111], a[180:183], v[36:51]
    ds_read_b64_tr_b16 v[108:109], v118 offset:14336
    ds_read_b64_tr_b16 v[110:111], v118 offset:15360
    s_waitcnt lgkmcnt(14)
    v_mfma_f32_32x32x16_bf16 v[52:67], v[112:115], a[180:183], v[52:67]
    ds_read_b64_tr_b16 v[112:113], v118 offset:14848
    ds_read_b64_tr_b16 v[114:115], v118 offset:15872
    s_waitcnt lgkmcnt(14)
    v_mfma_f32_32x32x16_bf16 v[4:19], v[84:87], a[56:59], v[4:19]
    s_waitcnt vmcnt(12)
    s_barrier
    v_add_u32 v118, 131072, v117
    ds_read_b64_tr_b16 v[84:85], v118 offset:0
    ds_read_b64_tr_b16 v[86:87], v118 offset:1024
    s_waitcnt lgkmcnt(14)
    v_mfma_f32_32x32x16_bf16 v[20:35], v[88:91], a[56:59], v[20:35]
    ds_read_b64_tr_b16 v[88:89], v118 offset:512
    ds_read_b64_tr_b16 v[90:91], v118 offset:1536
    s_mov_b32 s25, 3276800
    s_add_u32 m0, s23, 98304
    s_nop 0
    buffer_load_dwordx4 v119, s[12:15], s25 offen lds
    s_waitcnt lgkmcnt(14)
    v_mfma_f32_32x32x16_bf16 v[36:51], v[92:95], a[184:187], v[36:51]
    ds_read_b64_tr_b16 v[92:93], v118 offset:8192
    ds_read_b64_tr_b16 v[94:95], v118 offset:9216
    s_add_u32 m0, s23, 99328
    s_nop 0
    buffer_load_dwordx4 v120, s[12:15], s25 offen lds
    s_waitcnt lgkmcnt(14)
    v_mfma_f32_32x32x16_bf16 v[52:67], v[96:99], a[184:187], v[52:67]
    ds_read_b64_tr_b16 v[96:97], v118 offset:8704
    ds_read_b64_tr_b16 v[98:99], v118 offset:9728
    s_waitcnt lgkmcnt(14)
    v_mfma_f32_32x32x16_bf16 v[4:19], v[100:103], a[60:63], v[4:19]
    ds_read_b64_tr_b16 v[100:101], v118 offset:2048
    ds_read_b64_tr_b16 v[102:103], v118 offset:3072
    s_waitcnt lgkmcnt(14)
    v_mfma_f32_32x32x16_bf16 v[20:35], v[104:107], a[60:63], v[20:35]
    ds_read_b64_tr_b16 v[104:105], v118 offset:2560
    ds_read_b64_tr_b16 v[106:107], v118 offset:3584
    s_waitcnt lgkmcnt(14)
    v_mfma_f32_32x32x16_bf16 v[36:51], v[108:111], a[188:191], v[36:51]
    ds_read_b64_tr_b16 v[108:109], v118 offset:10240
    ds_read_b64_tr_b16 v[110:111], v118 offset:11264
    s_waitcnt lgkmcnt(14)
    v_mfma_f32_32x32x16_bf16 v[52:67], v[112:115], a[188:191], v[52:67]
    ds_read_b64_tr_b16 v[112:113], v118 offset:10752
    ds_read_b64_tr_b16 v[114:115], v118 offset:11776
    s_waitcnt lgkmcnt(14)
    v_mfma_f32_32x32x16_bf16 v[4:19], v[84:87], a[64:67], v[4:19]
    ds_read_b64_tr_b16 v[84:85], v118 offset:4096
    ds_read_b64_tr_b16 v[86:87], v118 offset:5120
    s_waitcnt lgkmcnt(14)
    v_mfma_f32_32x32x16_bf16 v[20:35], v[88:91], a[64:67], v[20:35]
    ds_read_b64_tr_b16 v[88:89], v118 offset:4608
    ds_read_b64_tr_b16 v[90:91], v118 offset:5632
    s_waitcnt lgkmcnt(14)
    v_mfma_f32_32x32x16_bf16 v[36:51], v[92:95], a[192:195], v[36:51]
    ds_read_b64_tr_b16 v[92:93], v118 offset:12288
    ds_read_b64_tr_b16 v[94:95], v118 offset:13312
    s_waitcnt lgkmcnt(14)
    v_mfma_f32_32x32x16_bf16 v[52:67], v[96:99], a[192:195], v[52:67]
    ds_read_b64_tr_b16 v[96:97], v118 offset:12800
    ds_read_b64_tr_b16 v[98:99], v118 offset:13824
    s_waitcnt lgkmcnt(14)
    v_mfma_f32_32x32x16_bf16 v[4:19], v[100:103], a[68:71], v[4:19]
    ds_read_b64_tr_b16 v[100:101], v118 offset:6144
    ds_read_b64_tr_b16 v[102:103], v118 offset:7168
    s_waitcnt lgkmcnt(14)
    v_mfma_f32_32x32x16_bf16 v[20:35], v[104:107], a[68:71], v[20:35]
    ds_read_b64_tr_b16 v[104:105], v118 offset:6656
    ds_read_b64_tr_b16 v[106:107], v118 offset:7680
    s_waitcnt lgkmcnt(14)
    v_mfma_f32_32x32x16_bf16 v[36:51], v[108:111], a[196:199], v[36:51]
    ds_read_b64_tr_b16 v[108:109], v118 offset:14336
    ds_read_b64_tr_b16 v[110:111], v118 offset:15360
    s_waitcnt lgkmcnt(14)
    v_mfma_f32_32x32x16_bf16 v[52:67], v[112:115], a[196:199], v[52:67]
    ds_read_b64_tr_b16 v[112:113], v118 offset:14848
    ds_read_b64_tr_b16 v[114:115], v118 offset:15872
    s_waitcnt lgkmcnt(14)
    v_mfma_f32_32x32x16_bf16 v[4:19], v[84:87], a[72:75], v[4:19]
    s_waitcnt vmcnt(12)
    s_barrier
    v_add_u32 v118, 0, v117
    ds_read_b64_tr_b16 v[84:85], v118 offset:0
    ds_read_b64_tr_b16 v[86:87], v118 offset:1024
    s_waitcnt lgkmcnt(14)
    v_mfma_f32_32x32x16_bf16 v[20:35], v[88:91], a[72:75], v[20:35]
    ds_read_b64_tr_b16 v[88:89], v118 offset:512
    ds_read_b64_tr_b16 v[90:91], v118 offset:1536
    s_mov_b32 s25, 3407872
    s_add_u32 m0, s23, 114688
    s_nop 0
    buffer_load_dwordx4 v119, s[12:15], s25 offen lds
    s_waitcnt lgkmcnt(14)
    v_mfma_f32_32x32x16_bf16 v[36:51], v[92:95], a[200:203], v[36:51]
    ds_read_b64_tr_b16 v[92:93], v118 offset:8192
    ds_read_b64_tr_b16 v[94:95], v118 offset:9216
    s_add_u32 m0, s23, 115712
    s_nop 0
    buffer_load_dwordx4 v120, s[12:15], s25 offen lds
    s_waitcnt lgkmcnt(14)
    v_mfma_f32_32x32x16_bf16 v[52:67], v[96:99], a[200:203], v[52:67]
    ds_read_b64_tr_b16 v[96:97], v118 offset:8704
    ds_read_b64_tr_b16 v[98:99], v118 offset:9728
    s_waitcnt lgkmcnt(14)
    v_mfma_f32_32x32x16_bf16 v[4:19], v[100:103], a[76:79], v[4:19]
    ds_read_b64_tr_b16 v[100:101], v118 offset:2048
    ds_read_b64_tr_b16 v[102:103], v118 offset:3072
    s_waitcnt lgkmcnt(14)
    v_mfma_f32_32x32x16_bf16 v[20:35], v[104:107], a[76:79], v[20:35]
    ds_read_b64_tr_b16 v[104:105], v118 offset:2560
    ds_read_b64_tr_b16 v[106:107], v118 offset:3584
    s_waitcnt lgkmcnt(14)
    v_mfma_f32_32x32x16_bf16 v[36:51], v[108:111], a[204:207], v[36:51]
    ds_read_b64_tr_b16 v[108:109], v118 offset:10240
    ds_read_b64_tr_b16 v[110:111], v118 offset:11264
    s_waitcnt lgkmcnt(14)
    v_mfma_f32_32x32x16_bf16 v[52:67], v[112:115], a[204:207], v[52:67]
    ds_read_b64_tr_b16 v[112:113], v118 offset:10752
    ds_read_b64_tr_b16 v[114:115], v118 offset:11776
    s_waitcnt lgkmcnt(14)
    v_mfma_f32_32x32x16_bf16 v[4:19], v[84:87], a[80:83], v[4:19]
    ds_read_b64_tr_b16 v[84:85], v118 offset:4096
    ds_read_b64_tr_b16 v[86:87], v118 offset:5120
    s_waitcnt lgkmcnt(14)
    v_mfma_f32_32x32x16_bf16 v[20:35], v[88:91], a[80:83], v[20:35]
    ds_read_b64_tr_b16 v[88:89], v118 offset:4608
    ds_read_b64_tr_b16 v[90:91], v118 offset:5632
    s_waitcnt lgkmcnt(14)
    v_mfma_f32_32x32x16_bf16 v[36:51], v[92:95], a[208:211], v[36:51]
    ds_read_b64_tr_b16 v[92:93], v118 offset:12288
    ds_read_b64_tr_b16 v[94:95], v118 offset:13312
    s_waitcnt lgkmcnt(14)
    v_mfma_f32_32x32x16_bf16 v[52:67], v[96:99], a[208:211], v[52:67]
    ds_read_b64_tr_b16 v[96:97], v118 offset:12800
    ds_read_b64_tr_b16 v[98:99], v118 offset:13824
    s_waitcnt lgkmcnt(14)
    v_mfma_f32_32x32x16_bf16 v[4:19], v[100:103], a[84:87], v[4:19]
    ds_read_b64_tr_b16 v[100:101], v118 offset:6144
    ds_read_b64_tr_b16 v[102:103], v118 offset:7168
    s_waitcnt lgkmcnt(14)
    v_mfma_f32_32x32x16_bf16 v[20:35], v[104:107], a[84:87], v[20:35]
    ds_read_b64_tr_b16 v[104:105], v118 offset:6656
    ds_read_b64_tr_b16 v[106:107], v118 offset:7680
    s_waitcnt lgkmcnt(14)
    v_mfma_f32_32x32x16_bf16 v[36:51], v[108:111], a[212:215], v[36:51]
    ds_read_b64_tr_b16 v[108:109], v118 offset:14336
    ds_read_b64_tr_b16 v[110:111], v118 offset:15360
    s_waitcnt lgkmcnt(14)
    v_mfma_f32_32x32x16_bf16 v[52:67], v[112:115], a[212:215], v[52:67]
    ds_read_b64_tr_b16 v[112:113], v118 offset:14848
    ds_read_b64_tr_b16 v[114:115], v118 offset:15872
    s_waitcnt lgkmcnt(14)
    v_mfma_f32_32x32x16_bf16 v[4:19], v[84:87], a[88:91], v[4:19]
    s_waitcnt vmcnt(12)
    s_barrier
    v_add_u32 v118, 16384, v117
    ds_read_b64_tr_b16 v[84:85], v118 offset:0
    ds_read_b64_tr_b16 v[86:87], v118 offset:1024
    s_waitcnt lgkmcnt(14)
    v_mfma_f32_32x32x16_bf16 v[20:35], v[88:91], a[88:91], v[20:35]
    ds_read_b64_tr_b16 v[88:89], v118 offset:512
    ds_read_b64_tr_b16 v[90:91], v118 offset:1536
    s_mov_b32 s25, 3538944
    s_add_u32 m0, s23, 131072
    s_nop 0
    buffer_load_dwordx4 v119, s[12:15], s25 offen lds
    s_waitcnt lgkmcnt(14)
    v_mfma_f32_32x32x16_bf16 v[36:51], v[92:95], a[216:219], v[36:51]
    s_add_u32 m0, s23, 132096
    s_nop 0
    buffer_load_dwordx4 v120, s[12:15], s25 offen lds
    s_waitcnt lgkmcnt(12)
    v_mfma_f32_32x32x16_bf16 v[52:67], v[96:99], a[216:219], v[52:67]
    s_waitcnt lgkmcnt(10)
    v_mfma_f32_32x32x16_bf16 v[4:19], v[100:103], a[92:95], v[4:19]
    ds_read_b64_tr_b16 v[100:101], v118 offset:2048
    ds_read_b64_tr_b16 v[102:103], v118 offset:3072
    s_waitcnt lgkmcnt(10)
    v_mfma_f32_32x32x16_bf16 v[20:35], v[104:107], a[92:95], v[20:35]
    ds_read_b64_tr_b16 v[104:105], v118 offset:2560
    ds_read_b64_tr_b16 v[106:107], v118 offset:3584
    s_waitcnt lgkmcnt(10)
    v_mfma_f32_32x32x16_bf16 v[36:51], v[108:111], a[220:223], v[36:51]
    s_waitcnt lgkmcnt(8)
    v_mfma_f32_32x32x16_bf16 v[52:67], v[112:115], a[220:223], v[52:67]
    s_waitcnt lgkmcnt(6)
    v_mfma_f32_32x32x16_bf16 v[4:19], v[84:87], a[96:99], v[4:19]
    ds_read_b64_tr_b16 v[84:85], v118 offset:4096
    ds_read_b64_tr_b16 v[86:87], v118 offset:5120
    s_waitcnt lgkmcnt(6)
    v_mfma_f32_32x32x16_bf16 v[20:35], v[88:91], a[96:99], v[20:35]
    ds_read_b64_tr_b16 v[88:89], v118 offset:4608
    ds_read_b64_tr_b16 v[90:91], v118 offset:5632
    s_waitcnt lgkmcnt(6)
    v_mfma_f32_32x32x16_bf16 v[4:19], v[100:103], a[100:103], v[4:19]
    ds_read_b64_tr_b16 v[100:101], v118 offset:6144
    ds_read_b64_tr_b16 v[102:103], v118 offset:7168
    s_nop 15
    s_nop 3
    v_cvt_pk_bf16_f32 v132, v36, v37
    v_cvt_pk_bf16_f32 v133, v38, v39
    v_cvt_pk_bf16_f32 v134, v40, v41
    v_cvt_pk_bf16_f32 v135, v42, v43
    buffer_store_dwordx4 v[132:135], v124, s[44:47], s28 offen offset:0 sc1
    v_cvt_pk_bf16_f32 v136, v44, v45
    v_cvt_pk_bf16_f32 v137, v46, v47
    v_cvt_pk_bf16_f32 v138, v48, v49
    v_cvt_pk_bf16_f32 v139, v50, v51
    buffer_store_dwordx4 v[136:139], v124, s[44:47], s28 offen offset:1024 sc1
    v_cvt_pk_bf16_f32 v140, v52, v53
    v_cvt_pk_bf16_f32 v141, v54, v55
    v_cvt_pk_bf16_f32 v142, v56, v57
    v_cvt_pk_bf16_f32 v143, v58, v59
    buffer_store_dwordx4 v[140:143], v124, s[44:47], s28 offen offset:2048 sc1
    v_cvt_pk_bf16_f32 v144, v60, v61
    v_cvt_pk_bf16_f32 v145, v62, v63
    v_cvt_pk_bf16_f32 v146, v64, v65
    v_cvt_pk_bf16_f32 v147, v66, v67
    buffer_store_dwordx4 v[144:147], v124, s[44:47], s28 offen offset:3072 sc1
    s_waitcnt lgkmcnt(6)
    v_mfma_f32_32x32x16_bf16 v[20:35], v[104:107], a[100:103], v[20:35]
    ds_read_b64_tr_b16 v[104:105], v118 offset:6656
    ds_read_b64_tr_b16 v[106:107], v118 offset:7680
    s_waitcnt lgkmcnt(6)
    v_mfma_f32_32x32x16_bf16 v[4:19], v[84:87], a[104:107], v[4:19]
    s_waitcnt vmcnt(16)
    s_barrier
    v_add_u32 v118, 32768, v117
    ds_read_b64_tr_b16 v[84:85], v118 offset:0
    ds_read_b64_tr_b16 v[86:87], v118 offset:1024
    s_waitcnt lgkmcnt(6)
    v_mfma_f32_32x32x16_bf16 v[20:35], v[88:91], a[104:107], v[20:35]
    ds_read_b64_tr_b16 v[88:89], v118 offset:512
    ds_read_b64_tr_b16 v[90:91], v118 offset:1536
    s_waitcnt lgkmcnt(6)
    v_mfma_f32_32x32x16_bf16 v[4:19], v[100:103], a[108:111], v[4:19]
    ds_read_b64_tr_b16 v[100:101], v118 offset:2048
    ds_read_b64_tr_b16 v[102:103], v118 offset:3072
    s_waitcnt lgkmcnt(6)
    v_mfma_f32_32x32x16_bf16 v[20:35], v[104:107], a[108:111], v[20:35]
    ds_read_b64_tr_b16 v[104:105], v118 offset:2560
    ds_read_b64_tr_b16 v[106:107], v118 offset:3584
    s_waitcnt lgkmcnt(6)
    v_mfma_f32_32x32x16_bf16 v[4:19], v[84:87], a[112:115], v[4:19]
    ds_read_b64_tr_b16 v[84:85], v118 offset:4096
    ds_read_b64_tr_b16 v[86:87], v118 offset:5120
    s_waitcnt lgkmcnt(6)
    v_mfma_f32_32x32x16_bf16 v[20:35], v[88:91], a[112:115], v[20:35]
    ds_read_b64_tr_b16 v[88:89], v118 offset:4608
    ds_read_b64_tr_b16 v[90:91], v118 offset:5632
    s_waitcnt lgkmcnt(6)
    v_mfma_f32_32x32x16_bf16 v[4:19], v[100:103], a[116:119], v[4:19]
    ds_read_b64_tr_b16 v[100:101], v118 offset:6144
    ds_read_b64_tr_b16 v[102:103], v118 offset:7168
    s_waitcnt lgkmcnt(6)
    v_mfma_f32_32x32x16_bf16 v[20:35], v[104:107], a[116:119], v[20:35]
    ds_read_b64_tr_b16 v[104:105], v118 offset:6656
    ds_read_b64_tr_b16 v[106:107], v118 offset:7680
    s_waitcnt lgkmcnt(6)
    v_mfma_f32_32x32x16_bf16 v[4:19], v[84:87], a[120:123], v[4:19]
    s_waitcnt vmcnt(14)
    s_barrier
    v_add_u32 v118, 49152, v117
    ds_read_b64_tr_b16 v[84:85], v118 offset:0
    ds_read_b64_tr_b16 v[86:87], v118 offset:1024
    s_waitcnt lgkmcnt(6)
    v_mfma_f32_32x32x16_bf16 v[20:35], v[88:91], a[120:123], v[20:35]
    ds_read_b64_tr_b16 v[88:89], v118 offset:512
    ds_read_b64_tr_b16 v[90:91], v118 offset:1536
    s_waitcnt lgkmcnt(6)
    v_mfma_f32_32x32x16_bf16 v[4:19], v[100:103], a[124:127], v[4:19]
    ds_read_b64_tr_b16 v[100:101], v118 offset:2048
    ds_read_b64_tr_b16 v[102:103], v118 offset:3072
    s_waitcnt lgkmcnt(6)
    v_mfma_f32_32x32x16_bf16 v[20:35], v[104:107], a[124:127], v[20:35]
    ds_read_b64_tr_b16 v[104:105], v118 offset:2560
    ds_read_b64_tr_b16 v[106:107], v118 offset:3584
    s_waitcnt lgkmcnt(6)
    v_mfma_f32_32x32x16_bf16 v[4:19], v[84:87], a[128:131], v[4:19]
    ds_read_b64_tr_b16 v[84:85], v118 offset:4096
    ds_read_b64_tr_b16 v[86:87], v118 offset:5120
    s_waitcnt lgkmcnt(6)
    v_mfma_f32_32x32x16_bf16 v[20:35], v[88:91], a[128:131], v[20:35]
    ds_read_b64_tr_b16 v[88:89], v118 offset:4608
    ds_read_b64_tr_b16 v[90:91], v118 offset:5632
    s_waitcnt lgkmcnt(6)
    v_mfma_f32_32x32x16_bf16 v[4:19], v[100:103], a[132:135], v[4:19]
    ds_read_b64_tr_b16 v[100:101], v118 offset:6144
    ds_read_b64_tr_b16 v[102:103], v118 offset:7168
    s_waitcnt lgkmcnt(6)
    v_mfma_f32_32x32x16_bf16 v[20:35], v[104:107], a[132:135], v[20:35]
    ds_read_b64_tr_b16 v[104:105], v118 offset:6656
    ds_read_b64_tr_b16 v[106:107], v118 offset:7680
    s_waitcnt lgkmcnt(6)
    v_mfma_f32_32x32x16_bf16 v[4:19], v[84:87], a[136:139], v[4:19]
    s_waitcnt vmcnt(12)
    s_barrier
    v_add_u32 v118, 65536, v117
    ds_read_b64_tr_b16 v[84:85], v118 offset:0
    ds_read_b64_tr_b16 v[86:87], v118 offset:1024
    s_waitcnt lgkmcnt(6)
    v_mfma_f32_32x32x16_bf16 v[20:35], v[88:91], a[136:139], v[20:35]
    ds_read_b64_tr_b16 v[88:89], v118 offset:512
    ds_read_b64_tr_b16 v[90:91], v118 offset:1536
    s_waitcnt lgkmcnt(6)
    v_mfma_f32_32x32x16_bf16 v[4:19], v[100:103], a[140:143], v[4:19]
    ds_read_b64_tr_b16 v[100:101], v118 offset:2048
    ds_read_b64_tr_b16 v[102:103], v118 offset:3072
    s_waitcnt lgkmcnt(6)
    v_mfma_f32_32x32x16_bf16 v[20:35], v[104:107], a[140:143], v[20:35]
    ds_read_b64_tr_b16 v[104:105], v118 offset:2560
    ds_read_b64_tr_b16 v[106:107], v118 offset:3584
    s_waitcnt lgkmcnt(6)
    v_mfma_f32_32x32x16_bf16 v[4:19], v[84:87], a[144:147], v[4:19]
    ds_read_b64_tr_b16 v[84:85], v118 offset:4096
    ds_read_b64_tr_b16 v[86:87], v118 offset:5120
    s_waitcnt lgkmcnt(6)
    v_mfma_f32_32x32x16_bf16 v[20:35], v[88:91], a[144:147], v[20:35]
    ds_read_b64_tr_b16 v[88:89], v118 offset:4608
    ds_read_b64_tr_b16 v[90:91], v118 offset:5632
    s_waitcnt lgkmcnt(6)
    v_mfma_f32_32x32x16_bf16 v[4:19], v[100:103], a[148:151], v[4:19]
    ds_read_b64_tr_b16 v[100:101], v118 offset:6144
    ds_read_b64_tr_b16 v[102:103], v118 offset:7168
    buffer_load_dwordx4 v[156:159], v124, s[44:47], s29 offen offset:0 sc1
    buffer_load_dwordx4 v[160:163], v124, s[44:47], s29 offen offset:1024 sc1
    buffer_load_dwordx4 v[164:167], v124, s[44:47], s29 offen offset:2048 sc1
    buffer_load_dwordx4 v[168:171], v124, s[44:47], s29 offen offset:3072 sc1
    s_waitcnt lgkmcnt(6)
    v_mfma_f32_32x32x16_bf16 v[20:35], v[104:107], a[148:151], v[20:35]
    ds_read_b64_tr_b16 v[104:105], v118 offset:6656
    ds_read_b64_tr_b16 v[106:107], v118 offset:7680
    s_waitcnt lgkmcnt(6)
    v_mfma_f32_32x32x16_bf16 v[4:19], v[84:87], a[152:155], v[4:19]
    s_waitcnt vmcnt(14)
    s_barrier
    v_add_u32 v118, 81920, v117
    ds_read_b64_tr_b16 v[84:85], v118 offset:0
    ds_read_b64_tr_b16 v[86:87], v118 offset:1024
    s_waitcnt lgkmcnt(6)
    v_mfma_f32_32x32x16_bf16 v[20:35], v[88:91], a[152:155], v[20:35]
    ds_read_b64_tr_b16 v[88:89], v118 offset:512
    ds_read_b64_tr_b16 v[90:91], v118 offset:1536
    s_waitcnt lgkmcnt(6)
    v_mfma_f32_32x32x16_bf16 v[4:19], v[100:103], a[156:159], v[4:19]
    ds_read_b64_tr_b16 v[100:101], v118 offset:2048
    ds_read_b64_tr_b16 v[102:103], v118 offset:3072
    s_waitcnt lgkmcnt(6)
    v_mfma_f32_32x32x16_bf16 v[20:35], v[104:107], a[156:159], v[20:35]
    ds_read_b64_tr_b16 v[104:105], v118 offset:2560
    ds_read_b64_tr_b16 v[106:107], v118 offset:3584
    s_waitcnt lgkmcnt(6)
    v_mfma_f32_32x32x16_bf16 v[4:19], v[84:87], a[160:163], v[4:19]
    ds_read_b64_tr_b16 v[84:85], v118 offset:4096
    ds_read_b64_tr_b16 v[86:87], v118 offset:5120
    s_waitcnt lgkmcnt(6)
    v_mfma_f32_32x32x16_bf16 v[20:35], v[88:91], a[160:163], v[20:35]
    ds_read_b64_tr_b16 v[88:89], v118 offset:4608
    ds_read_b64_tr_b16 v[90:91], v118 offset:5632
    s_waitcnt lgkmcnt(6)
    v_mfma_f32_32x32x16_bf16 v[4:19], v[100:103], a[164:167], v[4:19]
    ds_read_b64_tr_b16 v[100:101], v118 offset:6144
    ds_read_b64_tr_b16 v[102:103], v118 offset:7168
    s_waitcnt lgkmcnt(6)
    v_mfma_f32_32x32x16_bf16 v[20:35], v[104:107], a[164:167], v[20:35]
    ds_read_b64_tr_b16 v[104:105], v118 offset:6656
    ds_read_b64_tr_b16 v[106:107], v118 offset:7680
    s_waitcnt lgkmcnt(6)
    v_mfma_f32_32x32x16_bf16 v[4:19], v[84:87], a[168:171], v[4:19]
    s_waitcnt vmcnt(12)
    s_barrier
    v_add_u32 v118, 98304, v117
    ds_read_b64_tr_b16 v[84:85], v118 offset:0
    ds_read_b64_tr_b16 v[86:87], v118 offset:1024
    s_waitcnt lgkmcnt(6)
    v_mfma_f32_32x32x16_bf16 v[20:35], v[88:91], a[168:171], v[20:35]
    ds_read_b64_tr_b16 v[88:89], v118 offset:512
    ds_read_b64_tr_b16 v[90:91], v118 offset:1536
    s_waitcnt lgkmcnt(6)
    v_mfma_f32_32x32x16_bf16 v[4:19], v[100:103], a[172:175], v[4:19]
    ds_read_b64_tr_b16 v[100:101], v118 offset:2048
    ds_read_b64_tr_b16 v[102:103], v118 offset:3072
    s_waitcnt lgkmcnt(6)
    v_mfma_f32_32x32x16_bf16 v[20:35], v[104:107], a[172:175], v[20:35]
    ds_read_b64_tr_b16 v[104:105], v118 offset:2560
    ds_read_b64_tr_b16 v[106:107], v118 offset:3584
    s_waitcnt lgkmcnt(6)
    v_mfma_f32_32x32x16_bf16 v[4:19], v[84:87], a[176:179], v[4:19]
    ds_read_b64_tr_b16 v[84:85], v118 offset:4096
    ds_read_b64_tr_b16 v[86:87], v118 offset:5120
    s_waitcnt lgkmcnt(6)
    v_mfma_f32_32x32x16_bf16 v[20:35], v[88:91], a[176:179], v[20:35]
    ds_read_b64_tr_b16 v[88:89], v118 offset:4608
    ds_read_b64_tr_b16 v[90:91], v118 offset:5632
    s_waitcnt lgkmcnt(6)
    v_mfma_f32_32x32x16_bf16 v[4:19], v[100:103], a[180:183], v[4:19]
    ds_read_b64_tr_b16 v[100:101], v118 offset:6144
    ds_read_b64_tr_b16 v[102:103], v118 offset:7168
    buffer_load_dwordx4 v[172:175], v124, s[44:47], s29 offen offset:0 sc1
    buffer_load_dwordx4 v[176:179], v124, s[44:47], s29 offen offset:1024 sc1
    buffer_load_dwordx4 v[180:183], v124, s[44:47], s29 offen offset:2048 sc1
    buffer_load_dwordx4 v[184:187], v124, s[44:47], s29 offen offset:3072 sc1
    s_waitcnt lgkmcnt(6)
    v_mfma_f32_32x32x16_bf16 v[20:35], v[104:107], a[180:183], v[20:35]
    ds_read_b64_tr_b16 v[104:105], v118 offset:6656
    ds_read_b64_tr_b16 v[106:107], v118 offset:7680
    s_waitcnt lgkmcnt(6)
    v_mfma_f32_32x32x16_bf16 v[4:19], v[84:87], a[184:187], v[4:19]
    s_waitcnt vmcnt(14)
    s_barrier
    v_add_u32 v118, 114688, v117
    ds_read_b64_tr_b16 v[84:85], v118 offset:0
    ds_read_b64_tr_b16 v[86:87], v118 offset:1024
    s_waitcnt lgkmcnt(6)
    v_mfma_f32_32x32x16_bf16 v[20:35], v[88:91], a[184:187], v[20:35]
    ds_read_b64_tr_b16 v[88:89], v118 offset:512
    ds_read_b64_tr_b16 v[90:91], v118 offset:1536
    s_waitcnt lgkmcnt(6)
    v_mfma_f32_32x32x16_bf16 v[4:19], v[100:103], a[188:191], v[4:19]
    ds_read_b64_tr_b16 v[100:101], v118 offset:2048
    ds_read_b64_tr_b16 v[102:103], v118 offset:3072
    s_waitcnt lgkmcnt(6)
    v_mfma_f32_32x32x16_bf16 v[20:35], v[104:107], a[188:191], v[20:35]
    ds_read_b64_tr_b16 v[104:105], v118 offset:2560
    ds_read_b64_tr_b16 v[106:107], v118 offset:3584
    s_waitcnt lgkmcnt(6)
    v_mfma_f32_32x32x16_bf16 v[4:19], v[84:87], a[192:195], v[4:19]
    ds_read_b64_tr_b16 v[84:85], v118 offset:4096
    ds_read_b64_tr_b16 v[86:87], v118 offset:5120
    s_waitcnt lgkmcnt(6)
    v_mfma_f32_32x32x16_bf16 v[20:35], v[88:91], a[192:195], v[20:35]
    ds_read_b64_tr_b16 v[88:89], v118 offset:4608
    ds_read_b64_tr_b16 v[90:91], v118 offset:5632
    s_waitcnt lgkmcnt(6)
    v_mfma_f32_32x32x16_bf16 v[4:19], v[100:103], a[196:199], v[4:19]
    ds_read_b64_tr_b16 v[100:101], v118 offset:6144
    ds_read_b64_tr_b16 v[102:103], v118 offset:7168
    s_waitcnt lgkmcnt(6)
    v_mfma_f32_32x32x16_bf16 v[20:35], v[104:107], a[196:199], v[20:35]
    ds_read_b64_tr_b16 v[104:105], v118 offset:6656
    ds_read_b64_tr_b16 v[106:107], v118 offset:7680
    s_waitcnt lgkmcnt(6)
    v_mfma_f32_32x32x16_bf16 v[4:19], v[84:87], a[200:203], v[4:19]
    s_waitcnt vmcnt(12)
    s_barrier
    v_add_u32 v118, 131072, v117
    ds_read_b64_tr_b16 v[84:85], v118 offset:0
    ds_read_b64_tr_b16 v[86:87], v118 offset:1024
    s_waitcnt lgkmcnt(6)
    v_mfma_f32_32x32x16_bf16 v[20:35], v[88:91], a[200:203], v[20:35]
    ds_read_b64_tr_b16 v[88:89], v118 offset:512
    ds_read_b64_tr_b16 v[90:91], v118 offset:1536
    s_waitcnt lgkmcnt(6)
    v_mfma_f32_32x32x16_bf16 v[4:19], v[100:103], a[204:207], v[4:19]
    ds_read_b64_tr_b16 v[100:101], v118 offset:2048
    ds_read_b64_tr_b16 v[102:103], v118 offset:3072
    s_waitcnt lgkmcnt(6)
    v_mfma_f32_32x32x16_bf16 v[20:35], v[104:107], a[204:207], v[20:35]
    ds_read_b64_tr_b16 v[104:105], v118 offset:2560
    ds_read_b64_tr_b16 v[106:107], v118 offset:3584
    s_waitcnt lgkmcnt(6)
    v_mfma_f32_32x32x16_bf16 v[4:19], v[84:87], a[208:211], v[4:19]
    ds_read_b64_tr_b16 v[84:85], v118 offset:4096
    ds_read_b64_tr_b16 v[86:87], v118 offset:5120
    s_waitcnt lgkmcnt(6)
    v_mfma_f32_32x32x16_bf16 v[20:35], v[88:91], a[208:211], v[20:35]
    ds_read_b64_tr_b16 v[88:89], v118 offset:4608
    ds_read_b64_tr_b16 v[90:91], v118 offset:5632
    s_waitcnt lgkmcnt(6)
    v_mfma_f32_32x32x16_bf16 v[4:19], v[100:103], a[212:215], v[4:19]
    ds_read_b64_tr_b16 v[100:101], v118 offset:6144
    ds_read_b64_tr_b16 v[102:103], v118 offset:7168
    buffer_load_dwordx4 v[188:191], v124, s[44:47], s29 offen offset:0 sc1
    buffer_load_dwordx4 v[192:195], v124, s[44:47], s29 offen offset:1024 sc1
    buffer_load_dwordx4 v[196:199], v124, s[44:47], s29 offen offset:2048 sc1
    buffer_load_dwordx4 v[200:203], v124, s[44:47], s29 offen offset:3072 sc1
    s_waitcnt lgkmcnt(6)
    v_mfma_f32_32x32x16_bf16 v[20:35], v[104:107], a[212:215], v[20:35]
    ds_read_b64_tr_b16 v[104:105], v118 offset:6656
    ds_read_b64_tr_b16 v[106:107], v118 offset:7680
    s_waitcnt lgkmcnt(6)
    v_mfma_f32_32x32x16_bf16 v[4:19], v[84:87], a[216:219], v[4:19]
    s_waitcnt lgkmcnt(4)
    v_mfma_f32_32x32x16_bf16 v[20:35], v[88:91], a[216:219], v[20:35]
    s_waitcnt lgkmcnt(2)
    v_mfma_f32_32x32x16_bf16 v[4:19], v[100:103], a[220:223], v[4:19]
    s_waitcnt lgkmcnt(0)
    v_mfma_f32_32x32x16_bf16 v[20:35], v[104:107], a[220:223], v[20:35]
    s_waitcnt lgkmcnt(0)
    s_nop 15
    buffer_load_dwordx4 v[204:207], v124, s[44:47], s29 offen offset:0 sc1
    buffer_load_dwordx4 v[208:211], v124, s[44:47], s29 offen offset:1024 sc1
    buffer_load_dwordx4 v[212:215], v124, s[44:47], s29 offen offset:2048 sc1
    buffer_load_dwordx4 v[216:219], v124, s[44:47], s29 offen offset:3072 sc1
    s_mov_b32 s30, 4000
    s_waitcnt vmcnt(15)
    v_max3_u32 v152, v156, v157, v158
    v_max_u32 v152, v152, v159
    s_waitcnt vmcnt(14)
    v_max3_u32 v152, v152, v160, v161
    v_max3_u32 v152, v152, v162, v163
    s_waitcnt vmcnt(13)
    v_max3_u32 v152, v152, v164, v165
    v_max3_u32 v152, v152, v166, v167
    s_waitcnt vmcnt(12)
    v_max3_u32 v152, v152, v168, v169
    v_max3_u32 v152, v152, v170, v171
    v_cmp_eq_u32 vcc, -1, v152
    s_cbranch_vccz k5_got0
    s_waitcnt vmcnt(11)
    v_max3_u32 v152, v172, v173, v174
    v_max_u32 v152, v152, v175
    s_waitcnt vmcnt(10)
    v_max3_u32 v152, v152, v176, v177
    v_max3_u32 v152, v152, v178, v179
    s_waitcnt vmcnt(9)
    v_max3_u32 v152, v152, v180, v181
    v_max3_u32 v152, v152, v182, v183
    s_waitcnt vmcnt(8)
    v_max3_u32 v152, v152, v184, v185
    v_max3_u32 v152, v152, v186, v187
    v_cmp_eq_u32 vcc, -1, v152
    s_cbranch_vccz k5_got1
    s_waitcnt vmcnt(7)
    v_max3_u32 v152, v188, v189, v190
    v_max_u32 v152, v152, v191
    s_waitcnt vmcnt(6)
    v_max3_u32 v152, v152, v192, v193
    v_max3_u32 v152, v152, v194, v195
    s_waitcnt vmcnt(5)
    v_max3_u32 v152, v152, v196, v197
    v_max3_u32 v152, v152, v198, v199
    s_waitcnt vmcnt(4)
    v_max3_u32 v152, v152, v200, v201
    v_max3_u32 v152, v152, v202, v203
    v_cmp_eq_u32 vcc, -1, v152
    s_cbranch_vccz k5_got2
k5_poll:
    s_waitcnt vmcnt(3)
    v_max3_u32 v152, v204, v205, v206
    v_max_u32 v152, v152, v207
    s_waitcnt vmcnt(2)
    v_max3_u32 v152, v152, v208, v209
    v_max3_u32 v152, v152, v210, v211
    s_waitcnt vmcnt(1)
    v_max3_u32 v152, v152, v212, v213
    v_max3_u32 v152, v152, v214, v215
    s_waitcnt vmcnt(0)
    v_max3_u32 v152, v152, v216, v217
    v_max3_u32 v152, v152, v218, v219
    v_cmp_eq_u32 vcc, -1, v152
    s_cbranch_vccz k5_got3
    buffer_load_dwordx4 v[204:207], v124, s[44:47], s29 offen offset:0 sc1
    buffer_load_dwordx4 v[208:211], v124, s[44:47], s29 offen offset:1024 sc1
    buffer_load_dwordx4 v[212:215], v124, s[44:47], s29 offen offset:2048 sc1
    buffer_load_dwordx4 v[216:219], v124, s[44:47], s29 offen offset:3072 sc1
    s_sub_u32 s30, s30, 1
    s_cmp_lg_u32 s30, 0
    s_cbranch_scc1 k5_poll
    s_waitcnt vmcnt(0)
k5_got3:
    v_lshlrev_b32 v148, 16, v204
    v_and_b32 v149, 0xffff0000, v204
    v_pk_add_f32 v[4:5], v[4:5], v[148:149]
    v_lshlrev_b32 v150, 16, v205
    v_and_b32 v151, 0xffff0000, v205
    v_pk_add_f32 v[6:7], v[6:7], v[150:151]
    v_lshlrev_b32 v148, 16, v206
    v_and_b32 v149, 0xffff0000, v206
    v_pk_add_f32 v[8:9], v[8:9], v[148:149]
    v_lshlrev_b32 v150, 16, v207
    v_and_b32 v151, 0xffff0000, v207
    v_pk_add_f32 v[10:11], v[10:11], v[150:151]
    v_lshlrev_b32 v148, 16, v208
    v_and_b32 v149, 0xffff0000, v208
    v_pk_add_f32 v[12:13], v[12:13], v[148:149]
    v_lshlrev_b32 v150, 16, v209
    v_and_b32 v151, 0xffff0000, v209
    v_pk_add_f32 v[14:15], v[14:15], v[150:151]
    v_lshlrev_b32 v148, 16, v210
    v_and_b32 v149, 0xffff0000, v210
    v_pk_add_f32 v[16:17], v[16:17], v[148:149]
    v_lshlrev_b32 v150, 16, v211
    v_and_b32 v151, 0xffff0000, v211
    v_pk_add_f32 v[18:19], v[18:19], v[150:151]
    v_lshlrev_b32 v148, 16, v212
    v_and_b32 v149, 0xffff0000, v212
    v_pk_add_f32 v[20:21], v[20:21], v[148:149]
    v_lshlrev_b32 v150, 16, v213
    v_and_b32 v151, 0xffff0000, v213
    v_pk_add_f32 v[22:23], v[22:23], v[150:151]
    v_lshlrev_b32 v148, 16, v214
    v_and_b32 v149, 0xffff0000, v214
    v_pk_add_f32 v[24:25], v[24:25], v[148:149]
    v_lshlrev_b32 v150, 16, v215
    v_and_b32 v151, 0xffff0000, v215
    v_pk_add_f32 v[26:27], v[26:27], v[150:151]
    v_lshlrev_b32 v148, 16, v216
    v_and_b32 v149, 0xffff0000, v216
    v_pk_add_f32 v[28:29], v[28:29], v[148:149]
    v_lshlrev_b32 v150, 16, v217
    v_and_b32 v151, 0xffff0000, v217
    v_pk_add_f32 v[30:31], v[30:31], v[150:151]
    v_lshlrev_b32 v148, 16, v218
    v_and_b32 v149, 0xffff0000, v218
    v_pk_add_f32 v[32:33], v[32:33], v[148:149]
    v_lshlrev_b32 v150, 16, v219
    v_and_b32 v151, 0xffff0000, v219
    v_pk_add_f32 v[34:35], v[34:35], v[150:151]
    s_branch k5_fin
k5_got2:
    v_lshlrev_b32 v148, 16, v188
    v_and_b32 v149, 0xffff0000, v188
    v_pk_add_f32 v[4:5], v[4:5], v[148:149]
    v_lshlrev_b32 v150, 16, v189
    v_and_b32 v151, 0xffff0000, v189
    v_pk_add_f32 v[6:7], v[6:7], v[150:151]
    v_lshlrev_b32 v148, 16, v190
    v_and_b32 v149, 0xffff0000, v190
    v_pk_add_f32 v[8:9], v[8:9], v[148:149]
    v_lshlrev_b32 v150, 16, v191
    v_and_b32 v151, 0xffff0000, v191
    v_pk_add_f32 v[10:11], v[10:11], v[150:151]
    v_lshlrev_b32 v148, 16, v192
    v_and_b32 v149, 0xffff0000, v192
    v_pk_add_f32 v[12:13], v[12:13], v[148:149]
    v_lshlrev_b32 v150, 16, v193
    v_and_b32 v151, 0xffff0000, v193
    v_pk_add_f32 v[14:15], v[14:15], v[150:151]
    v_lshlrev_b32 v148, 16, v194
    v_and_b32 v149, 0xffff0000, v194
    v_pk_add_f32 v[16:17], v[16:17], v[148:149]
    v_lshlrev_b32 v150, 16, v195
    v_and_b32 v151, 0xffff0000, v195
    v_pk_add_f32 v[18:19], v[18:19], v[150:151]
    v_lshlrev_b32 v148, 16, v196
    v_and_b32 v149, 0xffff0000, v196
    v_pk_add_f32 v[20:21], v[20:21], v[148:149]
    v_lshlrev_b32 v150, 16, v197
    v_and_b32 v151, 0xffff0000, v197
    v_pk_add_f32 v[22:23], v[22:23], v[150:151]
    v_lshlrev_b32 v148, 16, v198
    v_and_b32 v149, 0xffff0000, v198
    v_pk_add_f32 v[24:25], v[24:25], v[148:149]
    v_lshlrev_b32 v150, 16, v199
    v_and_b32 v151, 0xffff0000, v199
    v_pk_add_f32 v[26:27], v[26:27], v[150:151]
    v_lshlrev_b32 v148, 16, v200
    v_and_b32 v149, 0xffff0000, v200
    v_pk_add_f32 v[28:29], v[28:29], v[148:149]
    v_lshlrev_b32 v150, 16, v201
    v_and_b32 v151, 0xffff0000, v201
    v_pk_add_f32 v[30:31], v[30:31], v[150:151]
    v_lshlrev_b32 v148, 16, v202
    v_and_b32 v149, 0xffff0000, v202
    v_pk_add_f32 v[32:33], v[32:33], v[148:149]
    v_lshlrev_b32 v150, 16, v203
    v_and_b32 v151, 0xffff0000, v203
    v_pk_add_f32 v[34:35], v[34:35], v[150:151]
    s_branch k5_fin
k5_got1:
    v_lshlrev_b32 v148, 16, v172
    v_and_b32 v149, 0xffff0000, v172
    v_pk_add_f32 v[4:5], v[4:5], v[148:149]
    v_lshlrev_b32 v150, 16, v173
    v_and_b32 v151, 0xffff0000, v173
    v_pk_add_f32 v[6:7], v[6:7], v[150:151]
    v_lshlrev_b32 v148, 16, v174
    v_and_b32 v149, 0xffff0000, v174
    v_pk_add_f32 v[8:9], v[8:9], v[148:149]
    v_lshlrev_b32 v150, 16, v175
    v_and_b32 v151, 0xffff0000, v175
    v_pk_add_f32 v[10:11], v[10:11], v[150:151]
    v_lshlrev_b32 v148, 16, v176
    v_and_b32 v149, 0xffff0000, v176
    v_pk_add_f32 v[12:13], v[12:13], v[148:149]
    v_lshlrev_b32 v150, 16, v177
    v_and_b32 v151, 0xffff0000, v177
    v_pk_add_f32 v[14:15], v[14:15], v[150:151]
    v_lshlrev_b32 v148, 16, v178
    v_and_b32 v149, 0xffff0000, v178
    v_pk_add_f32 v[16:17], v[16:17], v[148:149]
    v_lshlrev_b32 v150, 16, v179
    v_and_b32 v151, 0xffff0000, v179
    v_pk_add_f32 v[18:19], v[18:19], v[150:151]
    v_lshlrev_b32 v148, 16, v180
    v_and_b32 v149, 0xffff0000, v180
    v_pk_add_f32 v[20:21], v[20:21], v[148:149]
    v_lshlrev_b32 v150, 16, v181
    v_and_b32 v151, 0xffff0000, v181
    v_pk_add_f32 v[22:23], v[22:23], v[150:151]
    v_lshlrev_b32 v148, 16, v182
    v_and_b32 v149, 0xffff0000, v182
    v_pk_add_f32 v[24:25], v[24:25], v[148:149]
    v_lshlrev_b32 v150, 16, v183
    v_and_b32 v151, 0xffff0000, v183
    v_pk_add_f32 v[26:27], v[26:27], v[150:151]
    v_lshlrev_b32 v148, 16, v184
    v_and_b32 v149, 0xffff0000, v184
    v_pk_add_f32 v[28:29], v[28:29], v[148:149]
    v_lshlrev_b32 v150, 16, v185
    v_and_b32 v151, 0xffff0000, v185
    v_pk_add_f32 v[30:31], v[30:31], v[150:151]
    v_lshlrev_b32 v148, 16, v186
    v_and_b32 v149, 0xffff0000, v186
    v_pk_add_f32 v[32:33], v[32:33], v[148:149]
    v_lshlrev_b32 v150, 16, v187
    v_and_b32 v151, 0xffff0000, v187
    v_pk_add_f32 v[34:35], v[34:35], v[150:151]
    s_branch k5_fin
k5_got0:
    v_lshlrev_b32 v148, 16, v156
    v_and_b32 v149, 0xffff0000, v156
    v_pk_add_f32 v[4:5], v[4:5], v[148:149]
    v_lshlrev_b32 v150, 16, v157
    v_and_b32 v151, 0xffff0000, v157
    v_pk_add_f32 v[6:7], v[6:7], v[150:151]
    v_lshlrev_b32 v148, 16, v158
    v_and_b32 v149, 0xffff0000, v158
    v_pk_add_f32 v[8:9], v[8:9], v[148:149]
    v_lshlrev_b32 v150, 16, v159
    v_and_b32 v151, 0xffff0000, v159
    v_pk_add_f32 v[10:11], v[10:11], v[150:151]
    v_lshlrev_b32 v148, 16, v160
    v_and_b32 v149, 0xffff0000, v160
    v_pk_add_f32 v[12:13], v[12:13], v[148:149]
    v_lshlrev_b32 v150, 16, v161
    v_and_b32 v151, 0xffff0000, v161
    v_pk_add_f32 v[14:15], v[14:15], v[150:151]
    v_lshlrev_b32 v148, 16, v162
    v_and_b32 v149, 0xffff0000, v162
    v_pk_add_f32 v[16:17], v[16:17], v[148:149]
    v_lshlrev_b32 v150, 16, v163
    v_and_b32 v151, 0xffff0000, v163
    v_pk_add_f32 v[18:19], v[18:19], v[150:151]
    v_lshlrev_b32 v148, 16, v164
    v_and_b32 v149, 0xffff0000, v164
    v_pk_add_f32 v[20:21], v[20:21], v[148:149]
    v_lshlrev_b32 v150, 16, v165
    v_and_b32 v151, 0xffff0000, v165
    v_pk_add_f32 v[22:23], v[22:23], v[150:151]
    v_lshlrev_b32 v148, 16, v166
    v_and_b32 v149, 0xffff0000, v166
    v_pk_add_f32 v[24:25], v[24:25], v[148:149]
    v_lshlrev_b32 v150, 16, v167
    v_and_b32 v151, 0xffff0000, v167
    v_pk_add_f32 v[26:27], v[26:27], v[150:151]
    v_lshlrev_b32 v148, 16, v168
    v_and_b32 v149, 0xffff0000, v168
    v_pk_add_f32 v[28:29], v[28:29], v[148:149]
    v_lshlrev_b32 v150, 16, v169
    v_and_b32 v151, 0xffff0000, v169
    v_pk_add_f32 v[30:31], v[30:31], v[150:151]
    v_lshlrev_b32 v148, 16, v170
    v_and_b32 v149, 0xffff0000, v170
    v_pk_add_f32 v[32:33], v[32:33], v[148:149]
    v_lshlrev_b32 v150, 16, v171
    v_and_b32 v151, 0xffff0000, v171
    v_pk_add_f32 v[34:35], v[34:35], v[150:151]
k5_fin:
    v_cvt_pk_bf16_f32 v132, v4, v5
    v_cvt_pk_bf16_f32 v133, v6, v7
    v_cvt_pk_bf16_f32 v134, v8, v9
    v_cvt_pk_bf16_f32 v135, v10, v11
    v_cvt_pk_bf16_f32 v136, v12, v13
    v_cvt_pk_bf16_f32 v137, v14, v15
    v_cvt_pk_bf16_f32 v138, v16, v17
    v_cvt_pk_bf16_f32 v139, v18, v19
    v_cvt_pk_bf16_f32 v140, v20, v21
    v_cvt_pk_bf16_f32 v141, v22, v23
    v_cvt_pk_bf16_f32 v142, v24, v25
    v_cvt_pk_bf16_f32 v143, v26, v27
    v_cvt_pk_bf16_f32 v144, v28, v29
    v_cvt_pk_bf16_f32 v145, v30, v31
    v_cvt_pk_bf16_f32 v146, v32, v33
    v_cvt_pk_bf16_f32 v147, v34, v35
    s_nop 1
    v_permlane32_swap_b32 v132, v134
    v_permlane32_swap_b32 v133, v135
    v_permlane32_swap_b32 v136, v138
    v_permlane32_swap_b32 v137, v139
    v_permlane32_swap_b32 v140, v142
    v_permlane32_swap_b32 v141, v143
    v_permlane32_swap_b32 v144, v146
    v_permlane32_swap_b32 v145, v147
    ds_write_b128 v126, v[132:135]
    ds_write_b128 v127, v[136:139]
    ds_write_b128 v128, v[140:143]
    ds_write_b128 v129, v[144:147]
    s_waitcnt lgkmcnt(0)
    ds_read_b128 v[132:135], v130 offset:0
    ds_read_b128 v[136:139], v130 offset:1024
    ds_read_b128 v[140:143], v130 offset:2048
    ds_read_b128 v[144:147], v130 offset:3072
    s_mov_b32 s16, 0
    s_waitcnt lgkmcnt(3)
    buffer_store_dwordx4 v[132:135], v125, s[40:43], s16 offen sc1
    s_mov_b32 s16, 16384
    s_waitcnt lgkmcnt(2)
    buffer_store_dwordx4 v[136:139], v125, s[40:43], s16 offen sc1
    s_mov_b32 s16, 32768
    s_waitcnt lgkmcnt(1)
    buffer_store_dwordx4 v[140:143], v125, s[40:43], s16 offen sc1
    s_mov_b32 s16, 49152
    s_waitcnt lgkmcnt(0)
    buffer_store_dwordx4 v[144:147], v125, s[40:43], s16 offen sc1
k5_done:
    s_endpgm
.section .rodata,"a"
.p2align 6
.amdhsa_kernel k0_ln_kernel
  .amdhsa_next_free_vgpr 64
  .amdhsa_next_free_sgpr 96
  .amdhsa_accum_offset 64
  .amdhsa_group_segment_fixed_size 0
  .amdhsa_kernarg_size 80
  .amdhsa_user_sgpr_count 2
  .amdhsa_user_sgpr_kernarg_segment_ptr 1
  .amdhsa_system_sgpr_workgroup_id_x 1
.end_amdhsa_kernel
.p2align 6
.amdhsa_kernel k1_qkv_kernel
  .amdhsa_next_free_vgpr 228
  .amdhsa_next_free_sgpr 96
  .amdhsa_accum_offset 228
  .amdhsa_group_segment_fixed_size 0
  .amdhsa_kernarg_size 80
  .amdhsa_user_sgpr_count 2
  .amdhsa_user_sgpr_kernarg_segment_ptr 1
  .amdhsa_system_sgpr_workgroup_id_x 1
.end_amdhsa_kernel
.p2align 6
.amdhsa_kernel k34_kernel
  .amdhsa_next_free_vgpr 252
  .amdhsa_next_free_sgpr 96
  .amdhsa_accum_offset 252
  .amdhsa_group_segment_fixed_size 0
  .amdhsa_kernarg_size 80
  .amdhsa_user_sgpr_count 2
  .amdhsa_user_sgpr_kernarg_segment_ptr 1
  .amdhsa_system_sgpr_workgroup_id_x 1
.end_amdhsa_kernel
.p2align 6
.amdhsa_kernel k5_down_kernel
  .amdhsa_next_free_vgpr 444
  .amdhsa_next_free_sgpr 96
  .amdhsa_accum_offset 220
  .amdhsa_group_segment_fixed_size 0
  .amdhsa_kernarg_size 80
  .amdhsa_user_sgpr_count 2
  .amdhsa_user_sgpr_kernarg_segment_ptr 1
  .amdhsa_system_sgpr_workgroup_id_x 1
.end_amdhsa_kernel
```
